```python
import torch

def _softmax(x, axis=-1):
    return torch.softmax(x, dim=axis)
def _gelu(x):
    return torch.nn.functional.gelu(x, approximate="tanh")
def _silu(x):
    return torch.nn.functional.silu(x)
def _sigmoid(x):
    return torch.sigmoid(x)
def _layernorm(x, axis=-1, eps=1e-5):
    m = x.mean(dim=axis, keepdim=True)
    v = x.var(dim=axis, keepdim=True, unbiased=False)
    return (x - m) / torch.sqrt(v + eps)
def _scatter_add(tgt, idx, src, axis=0):
    return tgt.clone().index_add_(axis, idx, src)
def _segment_sum(src, seg, n):
    out = torch.zeros((n,) + src.shape[1:], dtype=src.dtype)
    return out.index_add_(0, seg, src)
def _pad(x, pw):
    flat = tuple(v for pair in reversed(pw) for v in pair)
    return torch.nn.functional.pad(x, flat)

kernel_name = 'concat_heads__gqa_block_cached__mha_block_cached__near_ridge'

def setup_inputs():

    _w = (lambda a: (lambda t: t.to(torch.bfloat16) if t.is_floating_point() else t)(torch.as_tensor(a)))
    def _A_setup():
        B, Sq, D = 16, 112, 640
        Hq, Hkv, Sk, Dh = 32, 32, 512, 128
        assert Hq % Hkv == 0, (Hq, Hkv)
        return {
            "x": _w((lambda *s: torch.randn(*s, dtype=torch.bfloat16) * 0.8)(B, Sq, D)),
            "k_cache": _w((lambda *s: torch.randn(*s, dtype=torch.bfloat16) * 0.8)(B, Hkv, Sk, Dh)),
            "v_cache": _w((lambda *s: torch.randn(*s, dtype=torch.bfloat16) * 0.05)(B, Hkv, Sk, Dh)),
            "wq": _w((lambda *s: torch.randn(*s, dtype=torch.bfloat16) * 0.8)(D, Hq * Dh) * (D ** -0.5)),
            "wo": _w((lambda *s: torch.randn(*s, dtype=torch.bfloat16) * 0.05)(Hq * Dh, D) * ((Hq * Dh) ** -0.5)),
        }
    _A_in = _A_setup()

    def _B_setup():
        B, Sq, D = 16, 112, 640
        H, Sk, Dh = 32, 512, 128
        return {
            "x": _w((lambda *s: torch.randn(*s, dtype=torch.bfloat16) * 0.8)(B, Sq, D)),
            "k_cache": _w((lambda *s: torch.randn(*s, dtype=torch.bfloat16) * 0.8)(B, H, Sk, Dh)),
            "v_cache": _w((lambda *s: torch.randn(*s, dtype=torch.bfloat16) * 0.05)(B, H, Sk, Dh)),
            "wq": _w((lambda *s: torch.randn(*s, dtype=torch.bfloat16) * 0.8)(D, H * Dh) * (D ** -0.5)),
            "wo": _w((lambda *s: torch.randn(*s, dtype=torch.bfloat16) * 0.05)(H * Dh, D) * ((H * Dh) ** -0.5)),
        }
    _B_in = _B_setup()

    return {
        "A_x": _A_in["x"],
        "A_k_cache": _A_in["k_cache"],
        "A_v_cache": _A_in["v_cache"],
        "A_wq": _A_in["wq"],
        "A_wo": _A_in["wo"],
        "B_x": _B_in["x"],
        "B_k_cache": _B_in["k_cache"],
        "B_v_cache": _B_in["v_cache"],
        "B_wq": _B_in["wq"],
        "B_wo": _B_in["wo"],
    }

def reference(A_x, A_k_cache, A_v_cache, A_wq, A_wo, B_x, B_k_cache, B_v_cache, B_wq, B_wo):
    def _A_ref(x, k_cache, v_cache, wq, wo):
        B, Sq, D = x.shape
        Hq, Dh = 32, 128
        Hkv = k_cache.shape[1]
        rep = Hq // Hkv
        q = (lambda x, *d: x.permute(*d))((x @ wq).reshape(B, Sq, Hq, Dh), 0, 2, 1, 3)
        k = (lambda x, n, axis: torch.repeat_interleave(x, n, dim=axis))(k_cache, rep, axis=1)
        v = (lambda x, n, axis: torch.repeat_interleave(x, n, dim=axis))(v_cache, rep, axis=1)
        scores = torch.einsum("bhqd,bhkd->bhqk", q, k) * (Dh ** -0.5)
        p = _softmax(scores, axis=-1)
        o = torch.einsum("bhqk,bhkd->bhqd", p, v)
        return (lambda x, *d: x.permute(*d))(o, 0, 2, 1, 3).reshape(B, Sq, Hq * Dh) @ wo

    def _B_ref(x, k_cache, v_cache, wq, wo):
        B, Sq, D = x.shape
        H, Dh = 32, 128
        q = (lambda x, *d: x.permute(*d))((x @ wq).reshape(B, Sq, H, Dh), 0, 2, 1, 3)
        scores = torch.einsum("bhqd,bhkd->bhqk", q, k_cache) * (Dh ** -0.5)
        p = _softmax(scores, axis=-1)
        o = torch.einsum("bhqk,bhkd->bhqd", p, v_cache)
        return (lambda x, *d: x.permute(*d))(o, 0, 2, 1, 3).reshape(B, Sq, H * Dh) @ wo

    a = _A_ref(A_x, A_k_cache, A_v_cache, A_wq, A_wo)
    b = _B_ref(B_x, B_k_cache, B_v_cache, B_wq, B_wo)
    return torch.concatenate([a, b], axis=-1)
```

```asm
; @launch grid=(256,1,1) block=(512,1,1) lds=163840
.amdgcn_target "amdgcn-amd-amdhsa--gfx950"
.text
.globl concat_heads__gqa_block_cached__mha_block_cached__near_ridge_kernel
.p2align 8
.type concat_heads__gqa_block_cached__mha_block_cached__near_ridge_kernel,@function
concat_heads__gqa_block_cached__mha_block_cached__near_ridge_kernel:
    s_cmp_ge_u32 s2, 256
    s_cbranch_scc1 m_exit
    s_load_dwordx16 s[32:47], s[0:1], 0
    s_load_dwordx8 s[48:55], s[0:1], 64
    s_load_dwordx2 s[56:57], s[0:1], 96
    v_lshrrev_b32 v1, 6, v0
    v_and_b32 v0, 63, v0
    v_readfirstlane_b32 s24, v1
    s_and_b32 s70, s2, 7
    s_lshr_b32 s71, s2, 3
    s_lshr_b32 s25, s70, 2
    s_and_b32 s72, s70, 3
    s_and_b32 s73, s71, 1
    s_lshl_b32 s72, s72, 1
    s_add_u32 s27, s72, s73
    s_lshr_b32 s26, s71, 1
    s_lshl_b32 s61, s27, 10
    s_lshl_b32 s70, s24, 7
    s_add_u32 s61, s61, s70
    s_mul_i32 s66, s24, 12288
    s_add_u32 s66, s66, 32768
    s_lshl_b32 s67, s24, 10
    s_add_u32 s67, s67, 131072
    s_and_b32 s70, s27, 1
    s_mul_i32 s70, s70, 10
    s_add_u32 s70, s70, s26
    s_cmp_ge_u32 s70, 20
    s_cselect_b32 s71, 20, 0
    s_sub_u32 s70, s70, s71
    s_lshl_b32 s100, s70, 18
    v_mov_b32 v255, v0
    v_lshrrev_b32 v251, 4, v0
    v_lshrrev_b32 v252, 2, v0
    s_lshl_b32 s70, s24, 4
    v_add_u32 v252, s70, v252
    v_mul_u32_u24 v252, 1280, v252
    v_lshrrev_b32 v253, 5, v0
    v_mul_u32_u24 v253, 3, v253
    v_and_b32 v254, 3, v0
    v_xor_b32 v253, v253, v254
    v_lshl_add_u32 v246, v253, 4, v252
    v_lshrrev_b32 v252, 3, v0
    v_lshlrev_b32 v252, 13, v252
    v_and_b32 v253, 1, v251
    v_lshlrev_b32 v253, 1, v253
    v_and_b32 v254, 7, v0
    v_xor_b32 v253, v253, v254
    v_lshl_add_u32 v240, v253, 4, v252
    v_xor_b32 v241, 64, v240
    s_waitcnt lgkmcnt(0)
    s_cmp_eq_u32 s25, 0
    s_cselect_b64 s[32:33], s[32:33], s[42:43]
    s_cselect_b64 s[34:35], s[34:35], s[44:45]
    s_cselect_b64 s[36:37], s[36:37], s[46:47]
    s_cselect_b64 s[38:39], s[38:39], s[48:49]
    s_cselect_b64 s[40:41], s[40:41], s[50:51]
    s_mov_b64 s[58:59], s[40:41]
    s_mov_b64 s[86:87], s[54:55]
    s_mov_b64 s[98:99], s[52:53]
    s_mov_b32 s12, s38
    s_and_b32 s13, s39, 0xffff
    s_mov_b32 s14, 5242880
    s_mov_b32 s15, 0x00020000
    s_mul_i32 s70, s26, 143360
    s_add_u32 s16, s32, s70
    s_addc_u32 s17, s33, 0
    s_and_b32 s17, s17, 0xffff
    s_mov_b32 s18, 143360
    s_mov_b32 s19, 0x00020000
    s_lshr_b32 s62, s100, 12
    s_add_u32 m0, s67, 0
    s_nop 0
    buffer_load_dwordx4 v246, s[16:19], s62 offen lds
    s_add_u32 s62, s61, s100
    s_add_u32 m0, s66, 0
    s_nop 0
    buffer_load_dwordx4 v240, s[12:15], s62 offen lds
    s_add_u32 s62, s61, s100
    s_add_u32 s62, s62, 65536
    s_add_u32 m0, s66, 1024
    s_nop 0
    buffer_load_dwordx4 v241, s[12:15], s62 offen lds
    s_add_u32 s62, s61, s100
    s_add_u32 s62, s62, 131072
    s_add_u32 m0, s66, 2048
    s_nop 0
    buffer_load_dwordx4 v240, s[12:15], s62 offen lds
    s_add_u32 s62, s61, s100
    s_add_u32 s62, s62, 196608
    s_add_u32 m0, s66, 3072
    s_nop 0
    buffer_load_dwordx4 v241, s[12:15], s62 offen lds
    s_lshl_b32 s70, s26, 5
    s_lshl_b32 s71, s27, 2
    s_add_u32 s70, s70, s71
    s_lshl_b32 s70, s70, 17
    s_add_u32 s4, s34, s70
    s_addc_u32 s5, s35, 0
    s_and_b32 s5, s5, 0xffff
    s_mov_b32 s6, 524288
    s_mov_b32 s7, 0x00020000
    s_add_u32 s8, s36, s70
    s_addc_u32 s9, s37, 0
    s_and_b32 s9, s9, 0xffff
    s_mov_b32 s10, 524288
    s_mov_b32 s11, 0x00020000
    s_mov_b32 s36, s100
    s_add_u32 s37, s36, 262144
    s_cmp_ge_u32 s37, 5242880
    s_cselect_b32 s37, 0, s37
    s_add_u32 s38, s37, 262144
    s_cmp_ge_u32 s38, 5242880
    s_cselect_b32 s38, 0, s38
    s_add_u32 s39, s38, 262144
    s_cmp_ge_u32 s39, 5242880
    s_cselect_b32 s39, 0, s39
    s_add_u32 s40, s39, 262144
    s_cmp_ge_u32 s40, 5242880
    s_cselect_b32 s40, 0, s40
    s_add_u32 s41, s40, 262144
    s_cmp_ge_u32 s41, 5242880
    s_cselect_b32 s41, 0, s41
    s_add_u32 s42, s41, 262144
    s_cmp_ge_u32 s42, 5242880
    s_cselect_b32 s42, 0, s42
    s_add_u32 s43, s42, 262144
    s_cmp_ge_u32 s43, 5242880
    s_cselect_b32 s43, 0, s43
    s_add_u32 s44, s43, 262144
    s_cmp_ge_u32 s44, 5242880
    s_cselect_b32 s44, 0, s44
    s_add_u32 s45, s44, 262144
    s_cmp_ge_u32 s45, 5242880
    s_cselect_b32 s45, 0, s45
    s_add_u32 s46, s45, 262144
    s_cmp_ge_u32 s46, 5242880
    s_cselect_b32 s46, 0, s46
    s_add_u32 s47, s46, 262144
    s_cmp_ge_u32 s47, 5242880
    s_cselect_b32 s47, 0, s47
    s_add_u32 s48, s47, 262144
    s_cmp_ge_u32 s48, 5242880
    s_cselect_b32 s48, 0, s48
    s_add_u32 s49, s48, 262144
    s_cmp_ge_u32 s49, 5242880
    s_cselect_b32 s49, 0, s49
    s_add_u32 s50, s49, 262144
    s_cmp_ge_u32 s50, 5242880
    s_cselect_b32 s50, 0, s50
    s_add_u32 s51, s50, 262144
    s_cmp_ge_u32 s51, 5242880
    s_cselect_b32 s51, 0, s51
    s_add_u32 s52, s51, 262144
    s_cmp_ge_u32 s52, 5242880
    s_cselect_b32 s52, 0, s52
    s_add_u32 s53, s52, 262144
    s_cmp_ge_u32 s53, 5242880
    s_cselect_b32 s53, 0, s53
    s_add_u32 s54, s53, 262144
    s_cmp_ge_u32 s54, 5242880
    s_cselect_b32 s54, 0, s54
    s_add_u32 s55, s54, 262144
    s_cmp_ge_u32 s55, 5242880
    s_cselect_b32 s55, 0, s55
    s_lshr_b32 s62, s37, 12
    s_add_u32 m0, s67, 8192
    s_nop 0
    buffer_load_dwordx4 v246, s[16:19], s62 offen lds
    s_add_u32 s62, s61, s37
    s_add_u32 m0, s66, 4096
    s_nop 0
    buffer_load_dwordx4 v240, s[12:15], s62 offen lds
    s_add_u32 s62, s61, s37
    s_add_u32 s62, s62, 65536
    s_add_u32 m0, s66, 5120
    s_nop 0
    buffer_load_dwordx4 v241, s[12:15], s62 offen lds
    s_add_u32 s62, s61, s37
    s_add_u32 s62, s62, 131072
    s_add_u32 m0, s66, 6144
    s_nop 0
    buffer_load_dwordx4 v240, s[12:15], s62 offen lds
    s_add_u32 s62, s61, s37
    s_add_u32 s62, s62, 196608
    s_add_u32 m0, s66, 7168
    s_nop 0
    buffer_load_dwordx4 v241, s[12:15], s62 offen lds
    v_bfe_u32 v252, v255, 2, 2
    v_and_b32 v253, 3, v255
    v_lshl_add_u32 v254, v251, 3, v252
    v_lshlrev_b32 v254, 7, v254
    v_lshl_add_u32 v254, v253, 3, v254
    v_add_u32 v254, s66, v254
    v_lshrrev_b32 v252, 1, v252
    v_and_b32 v253, 1, v251
    v_lshl_or_b32 v252, v253, 1, v252
    v_xor_b32 v253, 0, v252
    v_lshl_add_u32 v242, v253, 5, v254
    v_xor_b32 v253, 1, v252
    v_lshl_add_u32 v243, v253, 5, v254
    v_xor_b32 v253, 2, v252
    v_lshl_add_u32 v244, v253, 5, v254
    v_xor_b32 v253, 3, v252
    v_lshl_add_u32 v245, v253, 5, v254
    v_and_b32 v252, 15, v255
    v_lshrrev_b32 v253, 3, v252
    v_mul_u32_u24 v253, 3, v253
    v_xor_b32 v253, v253, v251
    v_lshlrev_b32 v253, 4, v253
    v_lshl_add_u32 v253, v252, 6, v253
    v_add_u32 v247, 131072, v253
    v_lshrrev_b32 v253, 1, v251
    v_lshl_add_u32 v253, v253, 4, v252
    v_lshlrev_b32 v253, 4, v253
    v_and_b32 v254, 1, v251
    v_lshl_add_u32 v253, v254, 3, v253
    s_and_b32 s70, s24, 1
    s_lshl_b32 s70, s70, 11
    s_lshr_b32 s71, s24, 1
    s_mov_b32 s72, 106496
    s_cmp_eq_u32 s71, 1
    s_cselect_b32 s72, 135168, s72
    s_cmp_eq_u32 s71, 2
    s_cselect_b32 s72, 65536, s72
    s_add_u32 s70, s70, s72
    v_add_u32 v248, s70, v253
    s_lshl_b32 s70, s24, 2
    v_add_u32 v253, s70, v251
    v_and_b32 v254, 15, v253
    v_xor_b32 v254, v254, v252
    v_lshlrev_b32 v254, 4, v254
    v_lshl_add_u32 v249, v253, 8, v254
    v_and_b32 v254, 7, v253
    v_lshlrev_b32 v254, 1, v254
    v_xor_b32 v254, v254, v252
    v_lshlrev_b32 v254, 4, v254
    v_lshl_add_u32 v250, v253, 8, v254
    s_mov_b32 s64, 1040356334
    s_lshr_b32 s70, s2, 3
    s_and_b32 s71, s2, 7
    s_lshl_b32 s71, s71, 1
    s_add_u32 s70, s70, s71
    s_and_b32 s70, s70, 15
    s_lshl_b32 s84, s70, 13
    v_and_b32 v201, 15, v255
    v_lshrrev_b32 v202, 4, v255
    v_add_u32 v203, 0, v202
    v_xor_b32 v203, v203, v201
    v_lshlrev_b32 v203, 4, v203
    v_lshl_add_u32 v0, v201, 8, v203
    v_add_u32 v203, 4, v202
    v_xor_b32 v203, v203, v201
    v_lshlrev_b32 v203, 4, v203
    v_lshl_add_u32 v1, v201, 8, v203
    v_add_u32 v203, 8, v202
    v_xor_b32 v203, v203, v201
    v_lshlrev_b32 v203, 4, v203
    v_lshl_add_u32 v2, v201, 8, v203
    v_add_u32 v203, 12, v202
    v_xor_b32 v203, v203, v201
    v_lshlrev_b32 v203, 4, v203
    v_lshl_add_u32 v3, v201, 8, v203
    v_bfe_u32 v203, v255, 2, 2
    v_lshl_add_u32 v203, v202, 2, v203
    v_and_b32 v204, 3, v255
    v_lshlrev_b32 v204, 3, v204
    v_lshl_add_u32 v204, v203, 8, v204
    v_and_b32 v205, 7, v203
    v_xor_b32 v206, 0, v205
    v_lshl_add_u32 v4, v206, 5, v204
    v_xor_b32 v206, 1, v205
    v_lshl_add_u32 v5, v206, 5, v204
    v_xor_b32 v206, 2, v205
    v_lshl_add_u32 v6, v206, 5, v204
    v_xor_b32 v206, 3, v205
    v_lshl_add_u32 v7, v206, 5, v204
    v_xor_b32 v206, 4, v205
    v_lshl_add_u32 v8, v206, 5, v204
    v_xor_b32 v206, 5, v205
    v_lshl_add_u32 v9, v206, 5, v204
    v_xor_b32 v206, 6, v205
    v_lshl_add_u32 v10, v206, 5, v204
    v_xor_b32 v206, 7, v205
    v_lshl_add_u32 v11, v206, 5, v204
    s_and_b32 s70, s24, 3
    s_lshl_b32 s70, s70, 13
    v_lshlrev_b32 v203, 4, v255
    v_add_u32 v13, s70, v203
    s_lshr_b32 s62, s38, 12
    s_add_u32 m0, s67, 16384
    s_nop 0
    buffer_load_dwordx4 v246, s[16:19], s62 offen lds
    s_add_u32 s62, s61, s38
    s_add_u32 m0, s66, 8192
    s_nop 0
    buffer_load_dwordx4 v240, s[12:15], s62 offen lds
    s_add_u32 s62, s61, s38
    s_add_u32 s62, s62, 65536
    s_add_u32 m0, s66, 9216
    s_nop 0
    buffer_load_dwordx4 v241, s[12:15], s62 offen lds
    s_add_u32 s62, s61, s38
    s_add_u32 s62, s62, 131072
    s_add_u32 m0, s66, 10240
    s_nop 0
    buffer_load_dwordx4 v240, s[12:15], s62 offen lds
    s_add_u32 s62, s61, s38
    s_add_u32 s62, s62, 196608
    s_add_u32 m0, s66, 11264
    s_nop 0
    buffer_load_dwordx4 v241, s[12:15], s62 offen lds
    s_waitcnt vmcnt(10)
    s_barrier
    ds_read_b128 v[64:67], v247 offset:0
    ds_read_b128 v[68:71], v247 offset:1024
    ds_read_b128 v[72:75], v247 offset:2048
    ds_read_b128 v[76:79], v247 offset:3072
    ds_read_b128 v[80:83], v247 offset:4096
    ds_read_b128 v[84:87], v247 offset:5120
    ds_read_b128 v[88:91], v247 offset:6144
    ds_read_b64_tr_b16 v[32:33], v242 offset:0
    ds_read_b64_tr_b16 v[34:35], v242 offset:512
    ds_read_b64_tr_b16 v[36:37], v243 offset:0
    ds_read_b64_tr_b16 v[38:39], v243 offset:512
    ds_read_b64_tr_b16 v[40:41], v244 offset:0
    ds_read_b64_tr_b16 v[42:43], v244 offset:512
    ds_read_b64_tr_b16 v[44:45], v245 offset:0
    ds_read_b64_tr_b16 v[46:47], v245 offset:512
    s_waitcnt lgkmcnt(0)
    v_mfma_f32_16x16x32_bf16 v[128:131], v[32:35], v[64:67], 0
    s_lshr_b32 s62, s39, 12
    s_add_u32 m0, s67, 24576
    s_nop 0
    buffer_load_dwordx4 v246, s[16:19], s62 offen lds
    v_mfma_f32_16x16x32_bf16 v[132:135], v[32:35], v[68:71], 0
    v_mfma_f32_16x16x32_bf16 v[136:139], v[32:35], v[72:75], 0
    v_mfma_f32_16x16x32_bf16 v[140:143], v[32:35], v[76:79], 0
    v_mfma_f32_16x16x32_bf16 v[144:147], v[32:35], v[80:83], 0
    s_add_u32 s62, s61, s39
    s_add_u32 m0, s66, 0
    s_nop 0
    buffer_load_dwordx4 v240, s[12:15], s62 offen lds
    v_mfma_f32_16x16x32_bf16 v[148:151], v[32:35], v[84:87], 0
    v_mfma_f32_16x16x32_bf16 v[152:155], v[32:35], v[88:91], 0
    v_mfma_f32_16x16x32_bf16 v[156:159], v[36:39], v[64:67], 0
    v_mfma_f32_16x16x32_bf16 v[160:163], v[36:39], v[68:71], 0
    s_add_u32 s62, s61, s39
    s_add_u32 s62, s62, 65536
    s_add_u32 m0, s66, 1024
    s_nop 0
    buffer_load_dwordx4 v241, s[12:15], s62 offen lds
    v_mfma_f32_16x16x32_bf16 v[164:167], v[36:39], v[72:75], 0
    v_mfma_f32_16x16x32_bf16 v[168:171], v[36:39], v[76:79], 0
    v_mfma_f32_16x16x32_bf16 v[172:175], v[36:39], v[80:83], 0
    v_mfma_f32_16x16x32_bf16 v[176:179], v[36:39], v[84:87], 0
    s_add_u32 s62, s61, s39
    s_add_u32 s62, s62, 131072
    s_add_u32 m0, s66, 2048
    s_nop 0
    buffer_load_dwordx4 v240, s[12:15], s62 offen lds
    v_mfma_f32_16x16x32_bf16 v[180:183], v[36:39], v[88:91], 0
    v_mfma_f32_16x16x32_bf16 v[184:187], v[40:43], v[64:67], 0
    v_mfma_f32_16x16x32_bf16 v[188:191], v[40:43], v[68:71], 0
    v_mfma_f32_16x16x32_bf16 v[192:195], v[40:43], v[72:75], 0
    s_add_u32 s62, s61, s39
    s_add_u32 s62, s62, 196608
    s_add_u32 m0, s66, 3072
    s_nop 0
    buffer_load_dwordx4 v241, s[12:15], s62 offen lds
    v_mfma_f32_16x16x32_bf16 v[196:199], v[40:43], v[76:79], 0
    v_mfma_f32_16x16x32_bf16 v[200:203], v[40:43], v[80:83], 0
    v_mfma_f32_16x16x32_bf16 v[204:207], v[40:43], v[84:87], 0
    v_mfma_f32_16x16x32_bf16 v[208:211], v[40:43], v[88:91], 0
    v_mfma_f32_16x16x32_bf16 v[212:215], v[44:47], v[64:67], 0
    v_mfma_f32_16x16x32_bf16 v[216:219], v[44:47], v[68:71], 0
    v_mfma_f32_16x16x32_bf16 v[220:223], v[44:47], v[72:75], 0
    v_mfma_f32_16x16x32_bf16 v[224:227], v[44:47], v[76:79], 0
    v_mfma_f32_16x16x32_bf16 v[228:231], v[44:47], v[80:83], 0
    v_mfma_f32_16x16x32_bf16 v[232:235], v[44:47], v[84:87], 0
    v_mfma_f32_16x16x32_bf16 v[236:239], v[44:47], v[88:91], 0
    s_waitcnt vmcnt(5)
    s_barrier
    ds_read_b128 v[92:95], v247 offset:8192
    ds_read_b128 v[96:99], v247 offset:9216
    ds_read_b128 v[100:103], v247 offset:10240
    ds_read_b128 v[104:107], v247 offset:11264
    ds_read_b128 v[108:111], v247 offset:12288
    ds_read_b128 v[112:115], v247 offset:13312
    ds_read_b128 v[116:119], v247 offset:14336
    ds_read_b64_tr_b16 v[48:49], v242 offset:4096
    ds_read_b64_tr_b16 v[50:51], v242 offset:4608
    ds_read_b64_tr_b16 v[52:53], v243 offset:4096
    ds_read_b64_tr_b16 v[54:55], v243 offset:4608
    ds_read_b64_tr_b16 v[56:57], v244 offset:4096
    ds_read_b64_tr_b16 v[58:59], v244 offset:4608
    ds_read_b64_tr_b16 v[60:61], v245 offset:4096
    ds_read_b64_tr_b16 v[62:63], v245 offset:4608
    s_waitcnt lgkmcnt(0)
    v_mfma_f32_16x16x32_bf16 v[128:131], v[48:51], v[92:95], v[128:131]
    s_lshr_b32 s62, s40, 12
    s_add_u32 m0, s67, 0
    s_nop 0
    buffer_load_dwordx4 v246, s[16:19], s62 offen lds
    v_mfma_f32_16x16x32_bf16 v[132:135], v[48:51], v[96:99], v[132:135]
    ds_read_b128 v[64:67], v247 offset:16384
    v_mfma_f32_16x16x32_bf16 v[136:139], v[48:51], v[100:103], v[136:139]
    v_mfma_f32_16x16x32_bf16 v[140:143], v[48:51], v[104:107], v[140:143]
    ds_read_b128 v[68:71], v247 offset:17408
    v_mfma_f32_16x16x32_bf16 v[144:147], v[48:51], v[108:111], v[144:147]
    s_add_u32 s62, s61, s40
    s_add_u32 m0, s66, 4096
    s_nop 0
    buffer_load_dwordx4 v240, s[12:15], s62 offen lds
    v_mfma_f32_16x16x32_bf16 v[148:151], v[48:51], v[112:115], v[148:151]
    ds_read_b128 v[72:75], v247 offset:18432
    v_mfma_f32_16x16x32_bf16 v[152:155], v[48:51], v[116:119], v[152:155]
    v_mfma_f32_16x16x32_bf16 v[156:159], v[52:55], v[92:95], v[156:159]
    ds_read_b128 v[76:79], v247 offset:19456
    v_mfma_f32_16x16x32_bf16 v[160:163], v[52:55], v[96:99], v[160:163]
    s_add_u32 s62, s61, s40
    s_add_u32 s62, s62, 65536
    s_add_u32 m0, s66, 5120
    s_nop 0
    buffer_load_dwordx4 v241, s[12:15], s62 offen lds
    v_mfma_f32_16x16x32_bf16 v[164:167], v[52:55], v[100:103], v[164:167]
    ds_read_b128 v[80:83], v247 offset:20480
    v_mfma_f32_16x16x32_bf16 v[168:171], v[52:55], v[104:107], v[168:171]
    v_mfma_f32_16x16x32_bf16 v[172:175], v[52:55], v[108:111], v[172:175]
    ds_read_b128 v[84:87], v247 offset:21504
    v_mfma_f32_16x16x32_bf16 v[176:179], v[52:55], v[112:115], v[176:179]
    s_add_u32 s62, s61, s40
    s_add_u32 s62, s62, 131072
    s_add_u32 m0, s66, 6144
    s_nop 0
    buffer_load_dwordx4 v240, s[12:15], s62 offen lds
    v_mfma_f32_16x16x32_bf16 v[180:183], v[52:55], v[116:119], v[180:183]
    ds_read_b128 v[88:91], v247 offset:22528
    v_mfma_f32_16x16x32_bf16 v[184:187], v[56:59], v[92:95], v[184:187]
    v_mfma_f32_16x16x32_bf16 v[188:191], v[56:59], v[96:99], v[188:191]
    ds_read_b64_tr_b16 v[32:33], v242 offset:8192
    ds_read_b64_tr_b16 v[34:35], v242 offset:8704
    v_mfma_f32_16x16x32_bf16 v[192:195], v[56:59], v[100:103], v[192:195]
    s_add_u32 s62, s61, s40
    s_add_u32 s62, s62, 196608
    s_add_u32 m0, s66, 7168
    s_nop 0
    buffer_load_dwordx4 v241, s[12:15], s62 offen lds
    v_mfma_f32_16x16x32_bf16 v[196:199], v[56:59], v[104:107], v[196:199]
    ds_read_b64_tr_b16 v[36:37], v243 offset:8192
    ds_read_b64_tr_b16 v[38:39], v243 offset:8704
    v_mfma_f32_16x16x32_bf16 v[200:203], v[56:59], v[108:111], v[200:203]
    v_mfma_f32_16x16x32_bf16 v[204:207], v[56:59], v[112:115], v[204:207]
    ds_read_b64_tr_b16 v[40:41], v244 offset:8192
    ds_read_b64_tr_b16 v[42:43], v244 offset:8704
    v_mfma_f32_16x16x32_bf16 v[208:211], v[56:59], v[116:119], v[208:211]
    v_mfma_f32_16x16x32_bf16 v[212:215], v[60:63], v[92:95], v[212:215]
    ds_read_b64_tr_b16 v[44:45], v245 offset:8192
    ds_read_b64_tr_b16 v[46:47], v245 offset:8704
    v_mfma_f32_16x16x32_bf16 v[216:219], v[60:63], v[96:99], v[216:219]
    v_mfma_f32_16x16x32_bf16 v[220:223], v[60:63], v[100:103], v[220:223]
    v_mfma_f32_16x16x32_bf16 v[224:227], v[60:63], v[104:107], v[224:227]
    v_mfma_f32_16x16x32_bf16 v[228:231], v[60:63], v[108:111], v[228:231]
    v_mfma_f32_16x16x32_bf16 v[232:235], v[60:63], v[112:115], v[232:235]
    v_mfma_f32_16x16x32_bf16 v[236:239], v[60:63], v[116:119], v[236:239]
    s_waitcnt vmcnt(5)
    s_barrier
    s_waitcnt lgkmcnt(0)
    v_mfma_f32_16x16x32_bf16 v[128:131], v[32:35], v[64:67], v[128:131]
    s_lshr_b32 s62, s41, 12
    s_add_u32 m0, s67, 8192
    s_nop 0
    buffer_load_dwordx4 v246, s[16:19], s62 offen lds
    v_mfma_f32_16x16x32_bf16 v[132:135], v[32:35], v[68:71], v[132:135]
    ds_read_b128 v[92:95], v247 offset:24576
    v_mfma_f32_16x16x32_bf16 v[136:139], v[32:35], v[72:75], v[136:139]
    v_mfma_f32_16x16x32_bf16 v[140:143], v[32:35], v[76:79], v[140:143]
    ds_read_b128 v[96:99], v247 offset:25600
    v_mfma_f32_16x16x32_bf16 v[144:147], v[32:35], v[80:83], v[144:147]
    s_add_u32 s62, s61, s41
    s_add_u32 m0, s66, 8192
    s_nop 0
    buffer_load_dwordx4 v240, s[12:15], s62 offen lds
    v_mfma_f32_16x16x32_bf16 v[148:151], v[32:35], v[84:87], v[148:151]
    ds_read_b128 v[100:103], v247 offset:26624
    v_mfma_f32_16x16x32_bf16 v[152:155], v[32:35], v[88:91], v[152:155]
    v_mfma_f32_16x16x32_bf16 v[156:159], v[36:39], v[64:67], v[156:159]
    ds_read_b128 v[104:107], v247 offset:27648
    v_mfma_f32_16x16x32_bf16 v[160:163], v[36:39], v[68:71], v[160:163]
    s_add_u32 s62, s61, s41
    s_add_u32 s62, s62, 65536
    s_add_u32 m0, s66, 9216
    s_nop 0
    buffer_load_dwordx4 v241, s[12:15], s62 offen lds
    v_mfma_f32_16x16x32_bf16 v[164:167], v[36:39], v[72:75], v[164:167]
    ds_read_b128 v[108:111], v247 offset:28672
    v_mfma_f32_16x16x32_bf16 v[168:171], v[36:39], v[76:79], v[168:171]
    v_mfma_f32_16x16x32_bf16 v[172:175], v[36:39], v[80:83], v[172:175]
    ds_read_b128 v[112:115], v247 offset:29696
    v_mfma_f32_16x16x32_bf16 v[176:179], v[36:39], v[84:87], v[176:179]
    s_add_u32 s62, s61, s41
    s_add_u32 s62, s62, 131072
    s_add_u32 m0, s66, 10240
    s_nop 0
    buffer_load_dwordx4 v240, s[12:15], s62 offen lds
    v_mfma_f32_16x16x32_bf16 v[180:183], v[36:39], v[88:91], v[180:183]
    ds_read_b128 v[116:119], v247 offset:30720
    v_mfma_f32_16x16x32_bf16 v[184:187], v[40:43], v[64:67], v[184:187]
    v_mfma_f32_16x16x32_bf16 v[188:191], v[40:43], v[68:71], v[188:191]
    ds_read_b64_tr_b16 v[48:49], v242 offset:0
    ds_read_b64_tr_b16 v[50:51], v242 offset:512
    v_mfma_f32_16x16x32_bf16 v[192:195], v[40:43], v[72:75], v[192:195]
    s_add_u32 s62, s61, s41
    s_add_u32 s62, s62, 196608
    s_add_u32 m0, s66, 11264
    s_nop 0
    buffer_load_dwordx4 v241, s[12:15], s62 offen lds
    v_mfma_f32_16x16x32_bf16 v[196:199], v[40:43], v[76:79], v[196:199]
    ds_read_b64_tr_b16 v[52:53], v243 offset:0
    ds_read_b64_tr_b16 v[54:55], v243 offset:512
    v_mfma_f32_16x16x32_bf16 v[200:203], v[40:43], v[80:83], v[200:203]
    v_mfma_f32_16x16x32_bf16 v[204:207], v[40:43], v[84:87], v[204:207]
    ds_read_b64_tr_b16 v[56:57], v244 offset:0
    ds_read_b64_tr_b16 v[58:59], v244 offset:512
    v_mfma_f32_16x16x32_bf16 v[208:211], v[40:43], v[88:91], v[208:211]
    v_mfma_f32_16x16x32_bf16 v[212:215], v[44:47], v[64:67], v[212:215]
    ds_read_b64_tr_b16 v[60:61], v245 offset:0
    ds_read_b64_tr_b16 v[62:63], v245 offset:512
    v_mfma_f32_16x16x32_bf16 v[216:219], v[44:47], v[68:71], v[216:219]
    v_mfma_f32_16x16x32_bf16 v[220:223], v[44:47], v[72:75], v[220:223]
    v_mfma_f32_16x16x32_bf16 v[224:227], v[44:47], v[76:79], v[224:227]
    v_mfma_f32_16x16x32_bf16 v[228:231], v[44:47], v[80:83], v[228:231]
    v_mfma_f32_16x16x32_bf16 v[232:235], v[44:47], v[84:87], v[232:235]
    v_mfma_f32_16x16x32_bf16 v[236:239], v[44:47], v[88:91], v[236:239]
    s_waitcnt vmcnt(5)
    s_barrier
    s_waitcnt lgkmcnt(0)
    v_mfma_f32_16x16x32_bf16 v[128:131], v[48:51], v[92:95], v[128:131]
    s_lshr_b32 s62, s42, 12
    s_add_u32 m0, s67, 16384
    s_nop 0
    buffer_load_dwordx4 v246, s[16:19], s62 offen lds
    v_mfma_f32_16x16x32_bf16 v[132:135], v[48:51], v[96:99], v[132:135]
    ds_read_b128 v[64:67], v247 offset:0
    v_mfma_f32_16x16x32_bf16 v[136:139], v[48:51], v[100:103], v[136:139]
    v_mfma_f32_16x16x32_bf16 v[140:143], v[48:51], v[104:107], v[140:143]
    ds_read_b128 v[68:71], v247 offset:1024
    v_mfma_f32_16x16x32_bf16 v[144:147], v[48:51], v[108:111], v[144:147]
    s_add_u32 s62, s61, s42
    s_add_u32 m0, s66, 0
    s_nop 0
    buffer_load_dwordx4 v240, s[12:15], s62 offen lds
    v_mfma_f32_16x16x32_bf16 v[148:151], v[48:51], v[112:115], v[148:151]
    ds_read_b128 v[72:75], v247 offset:2048
    v_mfma_f32_16x16x32_bf16 v[152:155], v[48:51], v[116:119], v[152:155]
    v_mfma_f32_16x16x32_bf16 v[156:159], v[52:55], v[92:95], v[156:159]
    ds_read_b128 v[76:79], v247 offset:3072
    v_mfma_f32_16x16x32_bf16 v[160:163], v[52:55], v[96:99], v[160:163]
    s_add_u32 s62, s61, s42
    s_add_u32 s62, s62, 65536
    s_add_u32 m0, s66, 1024
    s_nop 0
    buffer_load_dwordx4 v241, s[12:15], s62 offen lds
    v_mfma_f32_16x16x32_bf16 v[164:167], v[52:55], v[100:103], v[164:167]
    ds_read_b128 v[80:83], v247 offset:4096
    v_mfma_f32_16x16x32_bf16 v[168:171], v[52:55], v[104:107], v[168:171]
    v_mfma_f32_16x16x32_bf16 v[172:175], v[52:55], v[108:111], v[172:175]
    ds_read_b128 v[84:87], v247 offset:5120
    v_mfma_f32_16x16x32_bf16 v[176:179], v[52:55], v[112:115], v[176:179]
    s_add_u32 s62, s61, s42
    s_add_u32 s62, s62, 131072
    s_add_u32 m0, s66, 2048
    s_nop 0
    buffer_load_dwordx4 v240, s[12:15], s62 offen lds
    v_mfma_f32_16x16x32_bf16 v[180:183], v[52:55], v[116:119], v[180:183]
    ds_read_b128 v[88:91], v247 offset:6144
    v_mfma_f32_16x16x32_bf16 v[184:187], v[56:59], v[92:95], v[184:187]
    v_mfma_f32_16x16x32_bf16 v[188:191], v[56:59], v[96:99], v[188:191]
    ds_read_b64_tr_b16 v[32:33], v242 offset:4096
    ds_read_b64_tr_b16 v[34:35], v242 offset:4608
    v_mfma_f32_16x16x32_bf16 v[192:195], v[56:59], v[100:103], v[192:195]
    s_add_u32 s62, s61, s42
    s_add_u32 s62, s62, 196608
    s_add_u32 m0, s66, 3072
    s_nop 0
    buffer_load_dwordx4 v241, s[12:15], s62 offen lds
    v_mfma_f32_16x16x32_bf16 v[196:199], v[56:59], v[104:107], v[196:199]
    ds_read_b64_tr_b16 v[36:37], v243 offset:4096
    ds_read_b64_tr_b16 v[38:39], v243 offset:4608
    v_mfma_f32_16x16x32_bf16 v[200:203], v[56:59], v[108:111], v[200:203]
    v_mfma_f32_16x16x32_bf16 v[204:207], v[56:59], v[112:115], v[204:207]
    ds_read_b64_tr_b16 v[40:41], v244 offset:4096
    ds_read_b64_tr_b16 v[42:43], v244 offset:4608
    v_mfma_f32_16x16x32_bf16 v[208:211], v[56:59], v[116:119], v[208:211]
    v_mfma_f32_16x16x32_bf16 v[212:215], v[60:63], v[92:95], v[212:215]
    ds_read_b64_tr_b16 v[44:45], v245 offset:4096
    ds_read_b64_tr_b16 v[46:47], v245 offset:4608
    v_mfma_f32_16x16x32_bf16 v[216:219], v[60:63], v[96:99], v[216:219]
    v_mfma_f32_16x16x32_bf16 v[220:223], v[60:63], v[100:103], v[220:223]
    v_mfma_f32_16x16x32_bf16 v[224:227], v[60:63], v[104:107], v[224:227]
    v_mfma_f32_16x16x32_bf16 v[228:231], v[60:63], v[108:111], v[228:231]
    v_mfma_f32_16x16x32_bf16 v[232:235], v[60:63], v[112:115], v[232:235]
    v_mfma_f32_16x16x32_bf16 v[236:239], v[60:63], v[116:119], v[236:239]
    s_waitcnt vmcnt(5)
    s_barrier
    s_waitcnt lgkmcnt(0)
    v_mfma_f32_16x16x32_bf16 v[128:131], v[32:35], v[64:67], v[128:131]
    s_lshr_b32 s62, s43, 12
    s_add_u32 m0, s67, 24576
    s_nop 0
    buffer_load_dwordx4 v246, s[16:19], s62 offen lds
    v_mfma_f32_16x16x32_bf16 v[132:135], v[32:35], v[68:71], v[132:135]
    ds_read_b128 v[92:95], v247 offset:8192
    v_mfma_f32_16x16x32_bf16 v[136:139], v[32:35], v[72:75], v[136:139]
    v_mfma_f32_16x16x32_bf16 v[140:143], v[32:35], v[76:79], v[140:143]
    ds_read_b128 v[96:99], v247 offset:9216
    v_mfma_f32_16x16x32_bf16 v[144:147], v[32:35], v[80:83], v[144:147]
    s_add_u32 s62, s61, s43
    s_add_u32 m0, s66, 4096
    s_nop 0
    buffer_load_dwordx4 v240, s[12:15], s62 offen lds
    v_mfma_f32_16x16x32_bf16 v[148:151], v[32:35], v[84:87], v[148:151]
    ds_read_b128 v[100:103], v247 offset:10240
    v_mfma_f32_16x16x32_bf16 v[152:155], v[32:35], v[88:91], v[152:155]
    v_mfma_f32_16x16x32_bf16 v[156:159], v[36:39], v[64:67], v[156:159]
    ds_read_b128 v[104:107], v247 offset:11264
    v_mfma_f32_16x16x32_bf16 v[160:163], v[36:39], v[68:71], v[160:163]
    s_add_u32 s62, s61, s43
    s_add_u32 s62, s62, 65536
    s_add_u32 m0, s66, 5120
    s_nop 0
    buffer_load_dwordx4 v241, s[12:15], s62 offen lds
    v_mfma_f32_16x16x32_bf16 v[164:167], v[36:39], v[72:75], v[164:167]
    ds_read_b128 v[108:111], v247 offset:12288
    v_mfma_f32_16x16x32_bf16 v[168:171], v[36:39], v[76:79], v[168:171]
    v_mfma_f32_16x16x32_bf16 v[172:175], v[36:39], v[80:83], v[172:175]
    ds_read_b128 v[112:115], v247 offset:13312
    v_mfma_f32_16x16x32_bf16 v[176:179], v[36:39], v[84:87], v[176:179]
    s_add_u32 s62, s61, s43
    s_add_u32 s62, s62, 131072
    s_add_u32 m0, s66, 6144
    s_nop 0
    buffer_load_dwordx4 v240, s[12:15], s62 offen lds
    v_mfma_f32_16x16x32_bf16 v[180:183], v[36:39], v[88:91], v[180:183]
    ds_read_b128 v[116:119], v247 offset:14336
    v_mfma_f32_16x16x32_bf16 v[184:187], v[40:43], v[64:67], v[184:187]
    v_mfma_f32_16x16x32_bf16 v[188:191], v[40:43], v[68:71], v[188:191]
    ds_read_b64_tr_b16 v[48:49], v242 offset:8192
    ds_read_b64_tr_b16 v[50:51], v242 offset:8704
    v_mfma_f32_16x16x32_bf16 v[192:195], v[40:43], v[72:75], v[192:195]
    s_add_u32 s62, s61, s43
    s_add_u32 s62, s62, 196608
    s_add_u32 m0, s66, 7168
    s_nop 0
    buffer_load_dwordx4 v241, s[12:15], s62 offen lds
    v_mfma_f32_16x16x32_bf16 v[196:199], v[40:43], v[76:79], v[196:199]
    ds_read_b64_tr_b16 v[52:53], v243 offset:8192
    ds_read_b64_tr_b16 v[54:55], v243 offset:8704
    v_mfma_f32_16x16x32_bf16 v[200:203], v[40:43], v[80:83], v[200:203]
    v_mfma_f32_16x16x32_bf16 v[204:207], v[40:43], v[84:87], v[204:207]
    ds_read_b64_tr_b16 v[56:57], v244 offset:8192
    ds_read_b64_tr_b16 v[58:59], v244 offset:8704
    v_mfma_f32_16x16x32_bf16 v[208:211], v[40:43], v[88:91], v[208:211]
    v_mfma_f32_16x16x32_bf16 v[212:215], v[44:47], v[64:67], v[212:215]
    ds_read_b64_tr_b16 v[60:61], v245 offset:8192
    ds_read_b64_tr_b16 v[62:63], v245 offset:8704
    v_mfma_f32_16x16x32_bf16 v[216:219], v[44:47], v[68:71], v[216:219]
    v_mfma_f32_16x16x32_bf16 v[220:223], v[44:47], v[72:75], v[220:223]
    v_mfma_f32_16x16x32_bf16 v[224:227], v[44:47], v[76:79], v[224:227]
    v_mfma_f32_16x16x32_bf16 v[228:231], v[44:47], v[80:83], v[228:231]
    v_mfma_f32_16x16x32_bf16 v[232:235], v[44:47], v[84:87], v[232:235]
    v_mfma_f32_16x16x32_bf16 v[236:239], v[44:47], v[88:91], v[236:239]
    s_waitcnt vmcnt(5)
    s_barrier
    s_waitcnt lgkmcnt(0)
    v_mfma_f32_16x16x32_bf16 v[128:131], v[48:51], v[92:95], v[128:131]
    s_lshr_b32 s62, s44, 12
    s_add_u32 m0, s67, 0
    s_nop 0
    buffer_load_dwordx4 v246, s[16:19], s62 offen lds
    v_mfma_f32_16x16x32_bf16 v[132:135], v[48:51], v[96:99], v[132:135]
    ds_read_b128 v[64:67], v247 offset:16384
    v_mfma_f32_16x16x32_bf16 v[136:139], v[48:51], v[100:103], v[136:139]
    v_mfma_f32_16x16x32_bf16 v[140:143], v[48:51], v[104:107], v[140:143]
    ds_read_b128 v[68:71], v247 offset:17408
    v_mfma_f32_16x16x32_bf16 v[144:147], v[48:51], v[108:111], v[144:147]
    s_add_u32 s62, s61, s44
    s_add_u32 m0, s66, 8192
    s_nop 0
    buffer_load_dwordx4 v240, s[12:15], s62 offen lds
    v_mfma_f32_16x16x32_bf16 v[148:151], v[48:51], v[112:115], v[148:151]
    ds_read_b128 v[72:75], v247 offset:18432
    v_mfma_f32_16x16x32_bf16 v[152:155], v[48:51], v[116:119], v[152:155]
    v_mfma_f32_16x16x32_bf16 v[156:159], v[52:55], v[92:95], v[156:159]
    ds_read_b128 v[76:79], v247 offset:19456
    v_mfma_f32_16x16x32_bf16 v[160:163], v[52:55], v[96:99], v[160:163]
    s_add_u32 s62, s61, s44
    s_add_u32 s62, s62, 65536
    s_add_u32 m0, s66, 9216
    s_nop 0
    buffer_load_dwordx4 v241, s[12:15], s62 offen lds
    v_mfma_f32_16x16x32_bf16 v[164:167], v[52:55], v[100:103], v[164:167]
    ds_read_b128 v[80:83], v247 offset:20480
    v_mfma_f32_16x16x32_bf16 v[168:171], v[52:55], v[104:107], v[168:171]
    v_mfma_f32_16x16x32_bf16 v[172:175], v[52:55], v[108:111], v[172:175]
    ds_read_b128 v[84:87], v247 offset:21504
    v_mfma_f32_16x16x32_bf16 v[176:179], v[52:55], v[112:115], v[176:179]
    s_add_u32 s62, s61, s44
    s_add_u32 s62, s62, 131072
    s_add_u32 m0, s66, 10240
    s_nop 0
    buffer_load_dwordx4 v240, s[12:15], s62 offen lds
    v_mfma_f32_16x16x32_bf16 v[180:183], v[52:55], v[116:119], v[180:183]
    ds_read_b128 v[88:91], v247 offset:22528
    v_mfma_f32_16x16x32_bf16 v[184:187], v[56:59], v[92:95], v[184:187]
    v_mfma_f32_16x16x32_bf16 v[188:191], v[56:59], v[96:99], v[188:191]
    ds_read_b64_tr_b16 v[32:33], v242 offset:0
    ds_read_b64_tr_b16 v[34:35], v242 offset:512
    v_mfma_f32_16x16x32_bf16 v[192:195], v[56:59], v[100:103], v[192:195]
    s_add_u32 s62, s61, s44
    s_add_u32 s62, s62, 196608
    s_add_u32 m0, s66, 11264
    s_nop 0
    buffer_load_dwordx4 v241, s[12:15], s62 offen lds
    v_mfma_f32_16x16x32_bf16 v[196:199], v[56:59], v[104:107], v[196:199]
    ds_read_b64_tr_b16 v[36:37], v243 offset:0
    ds_read_b64_tr_b16 v[38:39], v243 offset:512
    v_mfma_f32_16x16x32_bf16 v[200:203], v[56:59], v[108:111], v[200:203]
    v_mfma_f32_16x16x32_bf16 v[204:207], v[56:59], v[112:115], v[204:207]
    ds_read_b64_tr_b16 v[40:41], v244 offset:0
    ds_read_b64_tr_b16 v[42:43], v244 offset:512
    v_mfma_f32_16x16x32_bf16 v[208:211], v[56:59], v[116:119], v[208:211]
    v_mfma_f32_16x16x32_bf16 v[212:215], v[60:63], v[92:95], v[212:215]
    ds_read_b64_tr_b16 v[44:45], v245 offset:0
    ds_read_b64_tr_b16 v[46:47], v245 offset:512
    v_mfma_f32_16x16x32_bf16 v[216:219], v[60:63], v[96:99], v[216:219]
    v_mfma_f32_16x16x32_bf16 v[220:223], v[60:63], v[100:103], v[220:223]
    v_mfma_f32_16x16x32_bf16 v[224:227], v[60:63], v[104:107], v[224:227]
    v_mfma_f32_16x16x32_bf16 v[228:231], v[60:63], v[108:111], v[228:231]
    v_mfma_f32_16x16x32_bf16 v[232:235], v[60:63], v[112:115], v[232:235]
    v_mfma_f32_16x16x32_bf16 v[236:239], v[60:63], v[116:119], v[236:239]
    s_waitcnt vmcnt(5)
    s_barrier
    s_waitcnt lgkmcnt(0)
    v_mfma_f32_16x16x32_bf16 v[128:131], v[32:35], v[64:67], v[128:131]
    s_lshr_b32 s62, s45, 12
    s_add_u32 m0, s67, 8192
    s_nop 0
    buffer_load_dwordx4 v246, s[16:19], s62 offen lds
    v_mfma_f32_16x16x32_bf16 v[132:135], v[32:35], v[68:71], v[132:135]
    ds_read_b128 v[92:95], v247 offset:24576
    v_mfma_f32_16x16x32_bf16 v[136:139], v[32:35], v[72:75], v[136:139]
    v_mfma_f32_16x16x32_bf16 v[140:143], v[32:35], v[76:79], v[140:143]
    ds_read_b128 v[96:99], v247 offset:25600
    v_mfma_f32_16x16x32_bf16 v[144:147], v[32:35], v[80:83], v[144:147]
    s_add_u32 s62, s61, s45
    s_add_u32 m0, s66, 0
    s_nop 0
    buffer_load_dwordx4 v240, s[12:15], s62 offen lds
    v_mfma_f32_16x16x32_bf16 v[148:151], v[32:35], v[84:87], v[148:151]
    ds_read_b128 v[100:103], v247 offset:26624
    v_mfma_f32_16x16x32_bf16 v[152:155], v[32:35], v[88:91], v[152:155]
    v_mfma_f32_16x16x32_bf16 v[156:159], v[36:39], v[64:67], v[156:159]
    ds_read_b128 v[104:107], v247 offset:27648
    v_mfma_f32_16x16x32_bf16 v[160:163], v[36:39], v[68:71], v[160:163]
    s_add_u32 s62, s61, s45
    s_add_u32 s62, s62, 65536
    s_add_u32 m0, s66, 1024
    s_nop 0
    buffer_load_dwordx4 v241, s[12:15], s62 offen lds
    v_mfma_f32_16x16x32_bf16 v[164:167], v[36:39], v[72:75], v[164:167]
    ds_read_b128 v[108:111], v247 offset:28672
    v_mfma_f32_16x16x32_bf16 v[168:171], v[36:39], v[76:79], v[168:171]
    v_mfma_f32_16x16x32_bf16 v[172:175], v[36:39], v[80:83], v[172:175]
    ds_read_b128 v[112:115], v247 offset:29696
    v_mfma_f32_16x16x32_bf16 v[176:179], v[36:39], v[84:87], v[176:179]
    s_add_u32 s62, s61, s45
    s_add_u32 s62, s62, 131072
    s_add_u32 m0, s66, 2048
    s_nop 0
    buffer_load_dwordx4 v240, s[12:15], s62 offen lds
    v_mfma_f32_16x16x32_bf16 v[180:183], v[36:39], v[88:91], v[180:183]
    ds_read_b128 v[116:119], v247 offset:30720
    v_mfma_f32_16x16x32_bf16 v[184:187], v[40:43], v[64:67], v[184:187]
    v_mfma_f32_16x16x32_bf16 v[188:191], v[40:43], v[68:71], v[188:191]
    ds_read_b64_tr_b16 v[48:49], v242 offset:4096
    ds_read_b64_tr_b16 v[50:51], v242 offset:4608
    v_mfma_f32_16x16x32_bf16 v[192:195], v[40:43], v[72:75], v[192:195]
    s_add_u32 s62, s61, s45
    s_add_u32 s62, s62, 196608
    s_add_u32 m0, s66, 3072
    s_nop 0
    buffer_load_dwordx4 v241, s[12:15], s62 offen lds
    v_mfma_f32_16x16x32_bf16 v[196:199], v[40:43], v[76:79], v[196:199]
    ds_read_b64_tr_b16 v[52:53], v243 offset:4096
    ds_read_b64_tr_b16 v[54:55], v243 offset:4608
    v_mfma_f32_16x16x32_bf16 v[200:203], v[40:43], v[80:83], v[200:203]
    v_mfma_f32_16x16x32_bf16 v[204:207], v[40:43], v[84:87], v[204:207]
    ds_read_b64_tr_b16 v[56:57], v244 offset:4096
    ds_read_b64_tr_b16 v[58:59], v244 offset:4608
    v_mfma_f32_16x16x32_bf16 v[208:211], v[40:43], v[88:91], v[208:211]
    v_mfma_f32_16x16x32_bf16 v[212:215], v[44:47], v[64:67], v[212:215]
    ds_read_b64_tr_b16 v[60:61], v245 offset:4096
    ds_read_b64_tr_b16 v[62:63], v245 offset:4608
    v_mfma_f32_16x16x32_bf16 v[216:219], v[44:47], v[68:71], v[216:219]
    v_mfma_f32_16x16x32_bf16 v[220:223], v[44:47], v[72:75], v[220:223]
    v_mfma_f32_16x16x32_bf16 v[224:227], v[44:47], v[76:79], v[224:227]
    v_mfma_f32_16x16x32_bf16 v[228:231], v[44:47], v[80:83], v[228:231]
    v_mfma_f32_16x16x32_bf16 v[232:235], v[44:47], v[84:87], v[232:235]
    v_mfma_f32_16x16x32_bf16 v[236:239], v[44:47], v[88:91], v[236:239]
    s_waitcnt vmcnt(5)
    s_barrier
    s_waitcnt lgkmcnt(0)
    v_mfma_f32_16x16x32_bf16 v[128:131], v[48:51], v[92:95], v[128:131]
    s_lshr_b32 s62, s46, 12
    s_add_u32 m0, s67, 16384
    s_nop 0
    buffer_load_dwordx4 v246, s[16:19], s62 offen lds
    v_mfma_f32_16x16x32_bf16 v[132:135], v[48:51], v[96:99], v[132:135]
    ds_read_b128 v[64:67], v247 offset:0
    v_mfma_f32_16x16x32_bf16 v[136:139], v[48:51], v[100:103], v[136:139]
    v_mfma_f32_16x16x32_bf16 v[140:143], v[48:51], v[104:107], v[140:143]
    ds_read_b128 v[68:71], v247 offset:1024
    v_mfma_f32_16x16x32_bf16 v[144:147], v[48:51], v[108:111], v[144:147]
    s_add_u32 s62, s61, s46
    s_add_u32 m0, s66, 4096
    s_nop 0
    buffer_load_dwordx4 v240, s[12:15], s62 offen lds
    v_mfma_f32_16x16x32_bf16 v[148:151], v[48:51], v[112:115], v[148:151]
    ds_read_b128 v[72:75], v247 offset:2048
    v_mfma_f32_16x16x32_bf16 v[152:155], v[48:51], v[116:119], v[152:155]
    v_mfma_f32_16x16x32_bf16 v[156:159], v[52:55], v[92:95], v[156:159]
    ds_read_b128 v[76:79], v247 offset:3072
    v_mfma_f32_16x16x32_bf16 v[160:163], v[52:55], v[96:99], v[160:163]
    s_add_u32 s62, s61, s46
    s_add_u32 s62, s62, 65536
    s_add_u32 m0, s66, 5120
    s_nop 0
    buffer_load_dwordx4 v241, s[12:15], s62 offen lds
    v_mfma_f32_16x16x32_bf16 v[164:167], v[52:55], v[100:103], v[164:167]
    ds_read_b128 v[80:83], v247 offset:4096
    v_mfma_f32_16x16x32_bf16 v[168:171], v[52:55], v[104:107], v[168:171]
    v_mfma_f32_16x16x32_bf16 v[172:175], v[52:55], v[108:111], v[172:175]
    ds_read_b128 v[84:87], v247 offset:5120
    v_mfma_f32_16x16x32_bf16 v[176:179], v[52:55], v[112:115], v[176:179]
    s_add_u32 s62, s61, s46
    s_add_u32 s62, s62, 131072
    s_add_u32 m0, s66, 6144
    s_nop 0
    buffer_load_dwordx4 v240, s[12:15], s62 offen lds
    v_mfma_f32_16x16x32_bf16 v[180:183], v[52:55], v[116:119], v[180:183]
    ds_read_b128 v[88:91], v247 offset:6144
    v_mfma_f32_16x16x32_bf16 v[184:187], v[56:59], v[92:95], v[184:187]
    v_mfma_f32_16x16x32_bf16 v[188:191], v[56:59], v[96:99], v[188:191]
    ds_read_b64_tr_b16 v[32:33], v242 offset:8192
    ds_read_b64_tr_b16 v[34:35], v242 offset:8704
    v_mfma_f32_16x16x32_bf16 v[192:195], v[56:59], v[100:103], v[192:195]
    s_add_u32 s62, s61, s46
    s_add_u32 s62, s62, 196608
    s_add_u32 m0, s66, 7168
    s_nop 0
    buffer_load_dwordx4 v241, s[12:15], s62 offen lds
    v_mfma_f32_16x16x32_bf16 v[196:199], v[56:59], v[104:107], v[196:199]
    ds_read_b64_tr_b16 v[36:37], v243 offset:8192
    ds_read_b64_tr_b16 v[38:39], v243 offset:8704
    v_mfma_f32_16x16x32_bf16 v[200:203], v[56:59], v[108:111], v[200:203]
    v_mfma_f32_16x16x32_bf16 v[204:207], v[56:59], v[112:115], v[204:207]
    ds_read_b64_tr_b16 v[40:41], v244 offset:8192
    ds_read_b64_tr_b16 v[42:43], v244 offset:8704
    v_mfma_f32_16x16x32_bf16 v[208:211], v[56:59], v[116:119], v[208:211]
    v_mfma_f32_16x16x32_bf16 v[212:215], v[60:63], v[92:95], v[212:215]
    ds_read_b64_tr_b16 v[44:45], v245 offset:8192
    ds_read_b64_tr_b16 v[46:47], v245 offset:8704
    v_mfma_f32_16x16x32_bf16 v[216:219], v[60:63], v[96:99], v[216:219]
    v_mfma_f32_16x16x32_bf16 v[220:223], v[60:63], v[100:103], v[220:223]
    v_mfma_f32_16x16x32_bf16 v[224:227], v[60:63], v[104:107], v[224:227]
    v_mfma_f32_16x16x32_bf16 v[228:231], v[60:63], v[108:111], v[228:231]
    v_mfma_f32_16x16x32_bf16 v[232:235], v[60:63], v[112:115], v[232:235]
    v_mfma_f32_16x16x32_bf16 v[236:239], v[60:63], v[116:119], v[236:239]
    s_waitcnt vmcnt(5)
    s_barrier
    s_waitcnt lgkmcnt(0)
    v_mfma_f32_16x16x32_bf16 v[128:131], v[32:35], v[64:67], v[128:131]
    s_lshr_b32 s62, s47, 12
    s_add_u32 m0, s67, 24576
    s_nop 0
    buffer_load_dwordx4 v246, s[16:19], s62 offen lds
    v_mfma_f32_16x16x32_bf16 v[132:135], v[32:35], v[68:71], v[132:135]
    ds_read_b128 v[92:95], v247 offset:8192
    v_mfma_f32_16x16x32_bf16 v[136:139], v[32:35], v[72:75], v[136:139]
    v_mfma_f32_16x16x32_bf16 v[140:143], v[32:35], v[76:79], v[140:143]
    ds_read_b128 v[96:99], v247 offset:9216
    v_mfma_f32_16x16x32_bf16 v[144:147], v[32:35], v[80:83], v[144:147]
    s_add_u32 s62, s61, s47
    s_add_u32 m0, s66, 8192
    s_nop 0
    buffer_load_dwordx4 v240, s[12:15], s62 offen lds
    v_mfma_f32_16x16x32_bf16 v[148:151], v[32:35], v[84:87], v[148:151]
    ds_read_b128 v[100:103], v247 offset:10240
    v_mfma_f32_16x16x32_bf16 v[152:155], v[32:35], v[88:91], v[152:155]
    v_mfma_f32_16x16x32_bf16 v[156:159], v[36:39], v[64:67], v[156:159]
    ds_read_b128 v[104:107], v247 offset:11264
    v_mfma_f32_16x16x32_bf16 v[160:163], v[36:39], v[68:71], v[160:163]
    s_add_u32 s62, s61, s47
    s_add_u32 s62, s62, 65536
    s_add_u32 m0, s66, 9216
    s_nop 0
    buffer_load_dwordx4 v241, s[12:15], s62 offen lds
    v_mfma_f32_16x16x32_bf16 v[164:167], v[36:39], v[72:75], v[164:167]
    ds_read_b128 v[108:111], v247 offset:12288
    v_mfma_f32_16x16x32_bf16 v[168:171], v[36:39], v[76:79], v[168:171]
    v_mfma_f32_16x16x32_bf16 v[172:175], v[36:39], v[80:83], v[172:175]
    ds_read_b128 v[112:115], v247 offset:13312
    v_mfma_f32_16x16x32_bf16 v[176:179], v[36:39], v[84:87], v[176:179]
    s_add_u32 s62, s61, s47
    s_add_u32 s62, s62, 131072
    s_add_u32 m0, s66, 10240
    s_nop 0
    buffer_load_dwordx4 v240, s[12:15], s62 offen lds
    v_mfma_f32_16x16x32_bf16 v[180:183], v[36:39], v[88:91], v[180:183]
    ds_read_b128 v[116:119], v247 offset:14336
    v_mfma_f32_16x16x32_bf16 v[184:187], v[40:43], v[64:67], v[184:187]
    v_mfma_f32_16x16x32_bf16 v[188:191], v[40:43], v[68:71], v[188:191]
    ds_read_b64_tr_b16 v[48:49], v242 offset:0
    ds_read_b64_tr_b16 v[50:51], v242 offset:512
    v_mfma_f32_16x16x32_bf16 v[192:195], v[40:43], v[72:75], v[192:195]
    s_add_u32 s62, s61, s47
    s_add_u32 s62, s62, 196608
    s_add_u32 m0, s66, 11264
    s_nop 0
    buffer_load_dwordx4 v241, s[12:15], s62 offen lds
    v_mfma_f32_16x16x32_bf16 v[196:199], v[40:43], v[76:79], v[196:199]
    ds_read_b64_tr_b16 v[52:53], v243 offset:0
    ds_read_b64_tr_b16 v[54:55], v243 offset:512
    v_mfma_f32_16x16x32_bf16 v[200:203], v[40:43], v[80:83], v[200:203]
    v_mfma_f32_16x16x32_bf16 v[204:207], v[40:43], v[84:87], v[204:207]
    ds_read_b64_tr_b16 v[56:57], v244 offset:0
    ds_read_b64_tr_b16 v[58:59], v244 offset:512
    v_mfma_f32_16x16x32_bf16 v[208:211], v[40:43], v[88:91], v[208:211]
    v_mfma_f32_16x16x32_bf16 v[212:215], v[44:47], v[64:67], v[212:215]
    ds_read_b64_tr_b16 v[60:61], v245 offset:0
    ds_read_b64_tr_b16 v[62:63], v245 offset:512
    v_mfma_f32_16x16x32_bf16 v[216:219], v[44:47], v[68:71], v[216:219]
    v_mfma_f32_16x16x32_bf16 v[220:223], v[44:47], v[72:75], v[220:223]
    v_mfma_f32_16x16x32_bf16 v[224:227], v[44:47], v[76:79], v[224:227]
    v_mfma_f32_16x16x32_bf16 v[228:231], v[44:47], v[80:83], v[228:231]
    v_mfma_f32_16x16x32_bf16 v[232:235], v[44:47], v[84:87], v[232:235]
    v_mfma_f32_16x16x32_bf16 v[236:239], v[44:47], v[88:91], v[236:239]
    s_waitcnt vmcnt(5)
    s_barrier
    s_waitcnt lgkmcnt(0)
    v_mfma_f32_16x16x32_bf16 v[128:131], v[48:51], v[92:95], v[128:131]
    s_lshr_b32 s62, s48, 12
    s_add_u32 m0, s67, 0
    s_nop 0
    buffer_load_dwordx4 v246, s[16:19], s62 offen lds
    v_mfma_f32_16x16x32_bf16 v[132:135], v[48:51], v[96:99], v[132:135]
    ds_read_b128 v[64:67], v247 offset:16384
    v_mfma_f32_16x16x32_bf16 v[136:139], v[48:51], v[100:103], v[136:139]
    v_mfma_f32_16x16x32_bf16 v[140:143], v[48:51], v[104:107], v[140:143]
    ds_read_b128 v[68:71], v247 offset:17408
    v_mfma_f32_16x16x32_bf16 v[144:147], v[48:51], v[108:111], v[144:147]
    s_add_u32 s62, s61, s48
    s_add_u32 m0, s66, 0
    s_nop 0
    buffer_load_dwordx4 v240, s[12:15], s62 offen lds
    v_mfma_f32_16x16x32_bf16 v[148:151], v[48:51], v[112:115], v[148:151]
    ds_read_b128 v[72:75], v247 offset:18432
    v_mfma_f32_16x16x32_bf16 v[152:155], v[48:51], v[116:119], v[152:155]
    v_mfma_f32_16x16x32_bf16 v[156:159], v[52:55], v[92:95], v[156:159]
    ds_read_b128 v[76:79], v247 offset:19456
    v_mfma_f32_16x16x32_bf16 v[160:163], v[52:55], v[96:99], v[160:163]
    s_add_u32 s62, s61, s48
    s_add_u32 s62, s62, 65536
    s_add_u32 m0, s66, 1024
    s_nop 0
    buffer_load_dwordx4 v241, s[12:15], s62 offen lds
    v_mfma_f32_16x16x32_bf16 v[164:167], v[52:55], v[100:103], v[164:167]
    ds_read_b128 v[80:83], v247 offset:20480
    v_mfma_f32_16x16x32_bf16 v[168:171], v[52:55], v[104:107], v[168:171]
    v_mfma_f32_16x16x32_bf16 v[172:175], v[52:55], v[108:111], v[172:175]
    ds_read_b128 v[84:87], v247 offset:21504
    v_mfma_f32_16x16x32_bf16 v[176:179], v[52:55], v[112:115], v[176:179]
    s_add_u32 s62, s61, s48
    s_add_u32 s62, s62, 131072
    s_add_u32 m0, s66, 2048
    s_nop 0
    buffer_load_dwordx4 v240, s[12:15], s62 offen lds
    v_mfma_f32_16x16x32_bf16 v[180:183], v[52:55], v[116:119], v[180:183]
    ds_read_b128 v[88:91], v247 offset:22528
    v_mfma_f32_16x16x32_bf16 v[184:187], v[56:59], v[92:95], v[184:187]
    v_mfma_f32_16x16x32_bf16 v[188:191], v[56:59], v[96:99], v[188:191]
    ds_read_b64_tr_b16 v[32:33], v242 offset:4096
    ds_read_b64_tr_b16 v[34:35], v242 offset:4608
    v_mfma_f32_16x16x32_bf16 v[192:195], v[56:59], v[100:103], v[192:195]
    s_add_u32 s62, s61, s48
    s_add_u32 s62, s62, 196608
    s_add_u32 m0, s66, 3072
    s_nop 0
    buffer_load_dwordx4 v241, s[12:15], s62 offen lds
    v_mfma_f32_16x16x32_bf16 v[196:199], v[56:59], v[104:107], v[196:199]
    ds_read_b64_tr_b16 v[36:37], v243 offset:4096
    ds_read_b64_tr_b16 v[38:39], v243 offset:4608
    v_mfma_f32_16x16x32_bf16 v[200:203], v[56:59], v[108:111], v[200:203]
    v_mfma_f32_16x16x32_bf16 v[204:207], v[56:59], v[112:115], v[204:207]
    ds_read_b64_tr_b16 v[40:41], v244 offset:4096
    ds_read_b64_tr_b16 v[42:43], v244 offset:4608
    v_mfma_f32_16x16x32_bf16 v[208:211], v[56:59], v[116:119], v[208:211]
    v_mfma_f32_16x16x32_bf16 v[212:215], v[60:63], v[92:95], v[212:215]
    ds_read_b64_tr_b16 v[44:45], v245 offset:4096
    ds_read_b64_tr_b16 v[46:47], v245 offset:4608
    v_mfma_f32_16x16x32_bf16 v[216:219], v[60:63], v[96:99], v[216:219]
    v_mfma_f32_16x16x32_bf16 v[220:223], v[60:63], v[100:103], v[220:223]
    v_mfma_f32_16x16x32_bf16 v[224:227], v[60:63], v[104:107], v[224:227]
    v_mfma_f32_16x16x32_bf16 v[228:231], v[60:63], v[108:111], v[228:231]
    v_mfma_f32_16x16x32_bf16 v[232:235], v[60:63], v[112:115], v[232:235]
    v_mfma_f32_16x16x32_bf16 v[236:239], v[60:63], v[116:119], v[236:239]
    s_waitcnt vmcnt(5)
    s_barrier
    s_waitcnt lgkmcnt(0)
    v_mfma_f32_16x16x32_bf16 v[128:131], v[32:35], v[64:67], v[128:131]
    s_lshr_b32 s62, s49, 12
    s_add_u32 m0, s67, 8192
    s_nop 0
    buffer_load_dwordx4 v246, s[16:19], s62 offen lds
    v_mfma_f32_16x16x32_bf16 v[132:135], v[32:35], v[68:71], v[132:135]
    ds_read_b128 v[92:95], v247 offset:24576
    v_mfma_f32_16x16x32_bf16 v[136:139], v[32:35], v[72:75], v[136:139]
    v_mfma_f32_16x16x32_bf16 v[140:143], v[32:35], v[76:79], v[140:143]
    ds_read_b128 v[96:99], v247 offset:25600
    v_mfma_f32_16x16x32_bf16 v[144:147], v[32:35], v[80:83], v[144:147]
    s_add_u32 s62, s61, s49
    s_add_u32 m0, s66, 4096
    s_nop 0
    buffer_load_dwordx4 v240, s[12:15], s62 offen lds
    v_mfma_f32_16x16x32_bf16 v[148:151], v[32:35], v[84:87], v[148:151]
    ds_read_b128 v[100:103], v247 offset:26624
    v_mfma_f32_16x16x32_bf16 v[152:155], v[32:35], v[88:91], v[152:155]
    v_mfma_f32_16x16x32_bf16 v[156:159], v[36:39], v[64:67], v[156:159]
    ds_read_b128 v[104:107], v247 offset:27648
    v_mfma_f32_16x16x32_bf16 v[160:163], v[36:39], v[68:71], v[160:163]
    s_add_u32 s62, s61, s49
    s_add_u32 s62, s62, 65536
    s_add_u32 m0, s66, 5120
    s_nop 0
    buffer_load_dwordx4 v241, s[12:15], s62 offen lds
    v_mfma_f32_16x16x32_bf16 v[164:167], v[36:39], v[72:75], v[164:167]
    ds_read_b128 v[108:111], v247 offset:28672
    v_mfma_f32_16x16x32_bf16 v[168:171], v[36:39], v[76:79], v[168:171]
    v_mfma_f32_16x16x32_bf16 v[172:175], v[36:39], v[80:83], v[172:175]
    ds_read_b128 v[112:115], v247 offset:29696
    v_mfma_f32_16x16x32_bf16 v[176:179], v[36:39], v[84:87], v[176:179]
    s_add_u32 s62, s61, s49
    s_add_u32 s62, s62, 131072
    s_add_u32 m0, s66, 6144
    s_nop 0
    buffer_load_dwordx4 v240, s[12:15], s62 offen lds
    v_mfma_f32_16x16x32_bf16 v[180:183], v[36:39], v[88:91], v[180:183]
    ds_read_b128 v[116:119], v247 offset:30720
    v_mfma_f32_16x16x32_bf16 v[184:187], v[40:43], v[64:67], v[184:187]
    v_mfma_f32_16x16x32_bf16 v[188:191], v[40:43], v[68:71], v[188:191]
    ds_read_b64_tr_b16 v[48:49], v242 offset:8192
    ds_read_b64_tr_b16 v[50:51], v242 offset:8704
    v_mfma_f32_16x16x32_bf16 v[192:195], v[40:43], v[72:75], v[192:195]
    s_add_u32 s62, s61, s49
    s_add_u32 s62, s62, 196608
    s_add_u32 m0, s66, 7168
    s_nop 0
    buffer_load_dwordx4 v241, s[12:15], s62 offen lds
    v_mfma_f32_16x16x32_bf16 v[196:199], v[40:43], v[76:79], v[196:199]
    ds_read_b64_tr_b16 v[52:53], v243 offset:8192
    ds_read_b64_tr_b16 v[54:55], v243 offset:8704
    v_mfma_f32_16x16x32_bf16 v[200:203], v[40:43], v[80:83], v[200:203]
    v_mfma_f32_16x16x32_bf16 v[204:207], v[40:43], v[84:87], v[204:207]
    ds_read_b64_tr_b16 v[56:57], v244 offset:8192
    ds_read_b64_tr_b16 v[58:59], v244 offset:8704
    v_mfma_f32_16x16x32_bf16 v[208:211], v[40:43], v[88:91], v[208:211]
    v_mfma_f32_16x16x32_bf16 v[212:215], v[44:47], v[64:67], v[212:215]
    ds_read_b64_tr_b16 v[60:61], v245 offset:8192
    ds_read_b64_tr_b16 v[62:63], v245 offset:8704
    v_mfma_f32_16x16x32_bf16 v[216:219], v[44:47], v[68:71], v[216:219]
    v_mfma_f32_16x16x32_bf16 v[220:223], v[44:47], v[72:75], v[220:223]
    v_mfma_f32_16x16x32_bf16 v[224:227], v[44:47], v[76:79], v[224:227]
    v_mfma_f32_16x16x32_bf16 v[228:231], v[44:47], v[80:83], v[228:231]
    v_mfma_f32_16x16x32_bf16 v[232:235], v[44:47], v[84:87], v[232:235]
    v_mfma_f32_16x16x32_bf16 v[236:239], v[44:47], v[88:91], v[236:239]
    s_waitcnt vmcnt(5)
    s_barrier
    s_waitcnt lgkmcnt(0)
    v_mfma_f32_16x16x32_bf16 v[128:131], v[48:51], v[92:95], v[128:131]
    s_lshr_b32 s62, s50, 12
    s_add_u32 m0, s67, 16384
    s_nop 0
    buffer_load_dwordx4 v246, s[16:19], s62 offen lds
    v_mfma_f32_16x16x32_bf16 v[132:135], v[48:51], v[96:99], v[132:135]
    ds_read_b128 v[64:67], v247 offset:0
    v_mfma_f32_16x16x32_bf16 v[136:139], v[48:51], v[100:103], v[136:139]
    v_mfma_f32_16x16x32_bf16 v[140:143], v[48:51], v[104:107], v[140:143]
    ds_read_b128 v[68:71], v247 offset:1024
    v_mfma_f32_16x16x32_bf16 v[144:147], v[48:51], v[108:111], v[144:147]
    s_add_u32 s62, s61, s50
    s_add_u32 m0, s66, 8192
    s_nop 0
    buffer_load_dwordx4 v240, s[12:15], s62 offen lds
    v_mfma_f32_16x16x32_bf16 v[148:151], v[48:51], v[112:115], v[148:151]
    ds_read_b128 v[72:75], v247 offset:2048
    v_mfma_f32_16x16x32_bf16 v[152:155], v[48:51], v[116:119], v[152:155]
    v_mfma_f32_16x16x32_bf16 v[156:159], v[52:55], v[92:95], v[156:159]
    ds_read_b128 v[76:79], v247 offset:3072
    v_mfma_f32_16x16x32_bf16 v[160:163], v[52:55], v[96:99], v[160:163]
    s_add_u32 s62, s61, s50
    s_add_u32 s62, s62, 65536
    s_add_u32 m0, s66, 9216
    s_nop 0
    buffer_load_dwordx4 v241, s[12:15], s62 offen lds
    v_mfma_f32_16x16x32_bf16 v[164:167], v[52:55], v[100:103], v[164:167]
    ds_read_b128 v[80:83], v247 offset:4096
    v_mfma_f32_16x16x32_bf16 v[168:171], v[52:55], v[104:107], v[168:171]
    v_mfma_f32_16x16x32_bf16 v[172:175], v[52:55], v[108:111], v[172:175]
    ds_read_b128 v[84:87], v247 offset:5120
    v_mfma_f32_16x16x32_bf16 v[176:179], v[52:55], v[112:115], v[176:179]
    s_add_u32 s62, s61, s50
    s_add_u32 s62, s62, 131072
    s_add_u32 m0, s66, 10240
    s_nop 0
    buffer_load_dwordx4 v240, s[12:15], s62 offen lds
    v_mfma_f32_16x16x32_bf16 v[180:183], v[52:55], v[116:119], v[180:183]
    ds_read_b128 v[88:91], v247 offset:6144
    v_mfma_f32_16x16x32_bf16 v[184:187], v[56:59], v[92:95], v[184:187]
    v_mfma_f32_16x16x32_bf16 v[188:191], v[56:59], v[96:99], v[188:191]
    ds_read_b64_tr_b16 v[32:33], v242 offset:0
    ds_read_b64_tr_b16 v[34:35], v242 offset:512
    v_mfma_f32_16x16x32_bf16 v[192:195], v[56:59], v[100:103], v[192:195]
    s_add_u32 s62, s61, s50
    s_add_u32 s62, s62, 196608
    s_add_u32 m0, s66, 11264
    s_nop 0
    buffer_load_dwordx4 v241, s[12:15], s62 offen lds
    v_mfma_f32_16x16x32_bf16 v[196:199], v[56:59], v[104:107], v[196:199]
    ds_read_b64_tr_b16 v[36:37], v243 offset:0
    ds_read_b64_tr_b16 v[38:39], v243 offset:512
    v_mfma_f32_16x16x32_bf16 v[200:203], v[56:59], v[108:111], v[200:203]
    v_mfma_f32_16x16x32_bf16 v[204:207], v[56:59], v[112:115], v[204:207]
    ds_read_b64_tr_b16 v[40:41], v244 offset:0
    ds_read_b64_tr_b16 v[42:43], v244 offset:512
    v_mfma_f32_16x16x32_bf16 v[208:211], v[56:59], v[116:119], v[208:211]
    v_mfma_f32_16x16x32_bf16 v[212:215], v[60:63], v[92:95], v[212:215]
    ds_read_b64_tr_b16 v[44:45], v245 offset:0
    ds_read_b64_tr_b16 v[46:47], v245 offset:512
    v_mfma_f32_16x16x32_bf16 v[216:219], v[60:63], v[96:99], v[216:219]
    v_mfma_f32_16x16x32_bf16 v[220:223], v[60:63], v[100:103], v[220:223]
    v_mfma_f32_16x16x32_bf16 v[224:227], v[60:63], v[104:107], v[224:227]
    v_mfma_f32_16x16x32_bf16 v[228:231], v[60:63], v[108:111], v[228:231]
    v_mfma_f32_16x16x32_bf16 v[232:235], v[60:63], v[112:115], v[232:235]
    v_mfma_f32_16x16x32_bf16 v[236:239], v[60:63], v[116:119], v[236:239]
    s_waitcnt vmcnt(5)
    s_barrier
    s_waitcnt lgkmcnt(0)
    v_mfma_f32_16x16x32_bf16 v[128:131], v[32:35], v[64:67], v[128:131]
    s_lshr_b32 s62, s51, 12
    s_add_u32 m0, s67, 24576
    s_nop 0
    buffer_load_dwordx4 v246, s[16:19], s62 offen lds
    v_mfma_f32_16x16x32_bf16 v[132:135], v[32:35], v[68:71], v[132:135]
    ds_read_b128 v[92:95], v247 offset:8192
    v_mfma_f32_16x16x32_bf16 v[136:139], v[32:35], v[72:75], v[136:139]
    v_mfma_f32_16x16x32_bf16 v[140:143], v[32:35], v[76:79], v[140:143]
    ds_read_b128 v[96:99], v247 offset:9216
    v_mfma_f32_16x16x32_bf16 v[144:147], v[32:35], v[80:83], v[144:147]
    s_add_u32 s62, s61, s51
    s_add_u32 m0, s66, 0
    s_nop 0
    buffer_load_dwordx4 v240, s[12:15], s62 offen lds
    v_mfma_f32_16x16x32_bf16 v[148:151], v[32:35], v[84:87], v[148:151]
    ds_read_b128 v[100:103], v247 offset:10240
    v_mfma_f32_16x16x32_bf16 v[152:155], v[32:35], v[88:91], v[152:155]
    v_mfma_f32_16x16x32_bf16 v[156:159], v[36:39], v[64:67], v[156:159]
    ds_read_b128 v[104:107], v247 offset:11264
    v_mfma_f32_16x16x32_bf16 v[160:163], v[36:39], v[68:71], v[160:163]
    s_add_u32 s62, s61, s51
    s_add_u32 s62, s62, 65536
    s_add_u32 m0, s66, 1024
    s_nop 0
    buffer_load_dwordx4 v241, s[12:15], s62 offen lds
    v_mfma_f32_16x16x32_bf16 v[164:167], v[36:39], v[72:75], v[164:167]
    ds_read_b128 v[108:111], v247 offset:12288
    v_mfma_f32_16x16x32_bf16 v[168:171], v[36:39], v[76:79], v[168:171]
    v_mfma_f32_16x16x32_bf16 v[172:175], v[36:39], v[80:83], v[172:175]
    ds_read_b128 v[112:115], v247 offset:13312
    v_mfma_f32_16x16x32_bf16 v[176:179], v[36:39], v[84:87], v[176:179]
    s_add_u32 s62, s61, s51
    s_add_u32 s62, s62, 131072
    s_add_u32 m0, s66, 2048
    s_nop 0
    buffer_load_dwordx4 v240, s[12:15], s62 offen lds
    v_mfma_f32_16x16x32_bf16 v[180:183], v[36:39], v[88:91], v[180:183]
    ds_read_b128 v[116:119], v247 offset:14336
    v_mfma_f32_16x16x32_bf16 v[184:187], v[40:43], v[64:67], v[184:187]
    v_mfma_f32_16x16x32_bf16 v[188:191], v[40:43], v[68:71], v[188:191]
    ds_read_b64_tr_b16 v[48:49], v242 offset:4096
    ds_read_b64_tr_b16 v[50:51], v242 offset:4608
    v_mfma_f32_16x16x32_bf16 v[192:195], v[40:43], v[72:75], v[192:195]
    s_add_u32 s62, s61, s51
    s_add_u32 s62, s62, 196608
    s_add_u32 m0, s66, 3072
    s_nop 0
    buffer_load_dwordx4 v241, s[12:15], s62 offen lds
    v_mfma_f32_16x16x32_bf16 v[196:199], v[40:43], v[76:79], v[196:199]
    ds_read_b64_tr_b16 v[52:53], v243 offset:4096
    ds_read_b64_tr_b16 v[54:55], v243 offset:4608
    v_mfma_f32_16x16x32_bf16 v[200:203], v[40:43], v[80:83], v[200:203]
    v_mfma_f32_16x16x32_bf16 v[204:207], v[40:43], v[84:87], v[204:207]
    ds_read_b64_tr_b16 v[56:57], v244 offset:4096
    ds_read_b64_tr_b16 v[58:59], v244 offset:4608
    v_mfma_f32_16x16x32_bf16 v[208:211], v[40:43], v[88:91], v[208:211]
    v_mfma_f32_16x16x32_bf16 v[212:215], v[44:47], v[64:67], v[212:215]
    ds_read_b64_tr_b16 v[60:61], v245 offset:4096
    ds_read_b64_tr_b16 v[62:63], v245 offset:4608
    v_mfma_f32_16x16x32_bf16 v[216:219], v[44:47], v[68:71], v[216:219]
    v_mfma_f32_16x16x32_bf16 v[220:223], v[44:47], v[72:75], v[220:223]
    v_mfma_f32_16x16x32_bf16 v[224:227], v[44:47], v[76:79], v[224:227]
    v_mfma_f32_16x16x32_bf16 v[228:231], v[44:47], v[80:83], v[228:231]
    v_mfma_f32_16x16x32_bf16 v[232:235], v[44:47], v[84:87], v[232:235]
    v_mfma_f32_16x16x32_bf16 v[236:239], v[44:47], v[88:91], v[236:239]
    s_waitcnt vmcnt(5)
    s_barrier
    s_waitcnt lgkmcnt(0)
    v_mfma_f32_16x16x32_bf16 v[128:131], v[48:51], v[92:95], v[128:131]
    s_lshr_b32 s62, s52, 12
    s_add_u32 m0, s67, 0
    s_nop 0
    buffer_load_dwordx4 v246, s[16:19], s62 offen lds
    v_mfma_f32_16x16x32_bf16 v[132:135], v[48:51], v[96:99], v[132:135]
    ds_read_b128 v[64:67], v247 offset:16384
    v_mfma_f32_16x16x32_bf16 v[136:139], v[48:51], v[100:103], v[136:139]
    v_mfma_f32_16x16x32_bf16 v[140:143], v[48:51], v[104:107], v[140:143]
    ds_read_b128 v[68:71], v247 offset:17408
    v_mfma_f32_16x16x32_bf16 v[144:147], v[48:51], v[108:111], v[144:147]
    s_add_u32 s62, s61, s52
    s_add_u32 m0, s66, 4096
    s_nop 0
    buffer_load_dwordx4 v240, s[12:15], s62 offen lds
    v_mfma_f32_16x16x32_bf16 v[148:151], v[48:51], v[112:115], v[148:151]
    ds_read_b128 v[72:75], v247 offset:18432
    v_mfma_f32_16x16x32_bf16 v[152:155], v[48:51], v[116:119], v[152:155]
    v_mfma_f32_16x16x32_bf16 v[156:159], v[52:55], v[92:95], v[156:159]
    ds_read_b128 v[76:79], v247 offset:19456
    v_mfma_f32_16x16x32_bf16 v[160:163], v[52:55], v[96:99], v[160:163]
    s_add_u32 s62, s61, s52
    s_add_u32 s62, s62, 65536
    s_add_u32 m0, s66, 5120
    s_nop 0
    buffer_load_dwordx4 v241, s[12:15], s62 offen lds
    v_mfma_f32_16x16x32_bf16 v[164:167], v[52:55], v[100:103], v[164:167]
    ds_read_b128 v[80:83], v247 offset:20480
    v_mfma_f32_16x16x32_bf16 v[168:171], v[52:55], v[104:107], v[168:171]
    v_mfma_f32_16x16x32_bf16 v[172:175], v[52:55], v[108:111], v[172:175]
    ds_read_b128 v[84:87], v247 offset:21504
    v_mfma_f32_16x16x32_bf16 v[176:179], v[52:55], v[112:115], v[176:179]
    s_add_u32 s62, s61, s52
    s_add_u32 s62, s62, 131072
    s_add_u32 m0, s66, 6144
    s_nop 0
    buffer_load_dwordx4 v240, s[12:15], s62 offen lds
    v_mfma_f32_16x16x32_bf16 v[180:183], v[52:55], v[116:119], v[180:183]
    ds_read_b128 v[88:91], v247 offset:22528
    v_mfma_f32_16x16x32_bf16 v[184:187], v[56:59], v[92:95], v[184:187]
    v_mfma_f32_16x16x32_bf16 v[188:191], v[56:59], v[96:99], v[188:191]
    ds_read_b64_tr_b16 v[32:33], v242 offset:8192
    ds_read_b64_tr_b16 v[34:35], v242 offset:8704
    v_mfma_f32_16x16x32_bf16 v[192:195], v[56:59], v[100:103], v[192:195]
    s_add_u32 s62, s61, s52
    s_add_u32 s62, s62, 196608
    s_add_u32 m0, s66, 7168
    s_nop 0
    buffer_load_dwordx4 v241, s[12:15], s62 offen lds
    v_mfma_f32_16x16x32_bf16 v[196:199], v[56:59], v[104:107], v[196:199]
    ds_read_b64_tr_b16 v[36:37], v243 offset:8192
    ds_read_b64_tr_b16 v[38:39], v243 offset:8704
    v_mfma_f32_16x16x32_bf16 v[200:203], v[56:59], v[108:111], v[200:203]
    v_mfma_f32_16x16x32_bf16 v[204:207], v[56:59], v[112:115], v[204:207]
    ds_read_b64_tr_b16 v[40:41], v244 offset:8192
    ds_read_b64_tr_b16 v[42:43], v244 offset:8704
    v_mfma_f32_16x16x32_bf16 v[208:211], v[56:59], v[116:119], v[208:211]
    v_mfma_f32_16x16x32_bf16 v[212:215], v[60:63], v[92:95], v[212:215]
    ds_read_b64_tr_b16 v[44:45], v245 offset:8192
    ds_read_b64_tr_b16 v[46:47], v245 offset:8704
    v_mfma_f32_16x16x32_bf16 v[216:219], v[60:63], v[96:99], v[216:219]
    v_mfma_f32_16x16x32_bf16 v[220:223], v[60:63], v[100:103], v[220:223]
    v_mfma_f32_16x16x32_bf16 v[224:227], v[60:63], v[104:107], v[224:227]
    v_mfma_f32_16x16x32_bf16 v[228:231], v[60:63], v[108:111], v[228:231]
    v_mfma_f32_16x16x32_bf16 v[232:235], v[60:63], v[112:115], v[232:235]
    v_mfma_f32_16x16x32_bf16 v[236:239], v[60:63], v[116:119], v[236:239]
    s_waitcnt vmcnt(5)
    s_barrier
    s_waitcnt lgkmcnt(0)
    v_mfma_f32_16x16x32_bf16 v[128:131], v[32:35], v[64:67], v[128:131]
    s_lshr_b32 s62, s53, 12
    s_add_u32 m0, s67, 8192
    s_nop 0
    buffer_load_dwordx4 v246, s[16:19], s62 offen lds
    v_mfma_f32_16x16x32_bf16 v[132:135], v[32:35], v[68:71], v[132:135]
    ds_read_b128 v[92:95], v247 offset:24576
    v_mfma_f32_16x16x32_bf16 v[136:139], v[32:35], v[72:75], v[136:139]
    v_mfma_f32_16x16x32_bf16 v[140:143], v[32:35], v[76:79], v[140:143]
    ds_read_b128 v[96:99], v247 offset:25600
    v_mfma_f32_16x16x32_bf16 v[144:147], v[32:35], v[80:83], v[144:147]
    s_add_u32 s62, s61, s53
    s_add_u32 m0, s66, 8192
    s_nop 0
    buffer_load_dwordx4 v240, s[12:15], s62 offen lds
    v_mfma_f32_16x16x32_bf16 v[148:151], v[32:35], v[84:87], v[148:151]
    ds_read_b128 v[100:103], v247 offset:26624
    v_mfma_f32_16x16x32_bf16 v[152:155], v[32:35], v[88:91], v[152:155]
    v_mfma_f32_16x16x32_bf16 v[156:159], v[36:39], v[64:67], v[156:159]
    ds_read_b128 v[104:107], v247 offset:27648
    v_mfma_f32_16x16x32_bf16 v[160:163], v[36:39], v[68:71], v[160:163]
    s_add_u32 s62, s61, s53
    s_add_u32 s62, s62, 65536
    s_add_u32 m0, s66, 9216
    s_nop 0
    buffer_load_dwordx4 v241, s[12:15], s62 offen lds
    v_mfma_f32_16x16x32_bf16 v[164:167], v[36:39], v[72:75], v[164:167]
    ds_read_b128 v[108:111], v247 offset:28672
    v_mfma_f32_16x16x32_bf16 v[168:171], v[36:39], v[76:79], v[168:171]
    v_mfma_f32_16x16x32_bf16 v[172:175], v[36:39], v[80:83], v[172:175]
    ds_read_b128 v[112:115], v247 offset:29696
    v_mfma_f32_16x16x32_bf16 v[176:179], v[36:39], v[84:87], v[176:179]
    s_add_u32 s62, s61, s53
    s_add_u32 s62, s62, 131072
    s_add_u32 m0, s66, 10240
    s_nop 0
    buffer_load_dwordx4 v240, s[12:15], s62 offen lds
    v_mfma_f32_16x16x32_bf16 v[180:183], v[36:39], v[88:91], v[180:183]
    ds_read_b128 v[116:119], v247 offset:30720
    v_mfma_f32_16x16x32_bf16 v[184:187], v[40:43], v[64:67], v[184:187]
    v_mfma_f32_16x16x32_bf16 v[188:191], v[40:43], v[68:71], v[188:191]
    ds_read_b64_tr_b16 v[48:49], v242 offset:0
    ds_read_b64_tr_b16 v[50:51], v242 offset:512
    v_mfma_f32_16x16x32_bf16 v[192:195], v[40:43], v[72:75], v[192:195]
    s_add_u32 s62, s61, s53
    s_add_u32 s62, s62, 196608
    s_add_u32 m0, s66, 11264
    s_nop 0
    buffer_load_dwordx4 v241, s[12:15], s62 offen lds
    v_mfma_f32_16x16x32_bf16 v[196:199], v[40:43], v[76:79], v[196:199]
    ds_read_b64_tr_b16 v[52:53], v243 offset:0
    ds_read_b64_tr_b16 v[54:55], v243 offset:512
    v_mfma_f32_16x16x32_bf16 v[200:203], v[40:43], v[80:83], v[200:203]
    v_mfma_f32_16x16x32_bf16 v[204:207], v[40:43], v[84:87], v[204:207]
    ds_read_b64_tr_b16 v[56:57], v244 offset:0
    ds_read_b64_tr_b16 v[58:59], v244 offset:512
    v_mfma_f32_16x16x32_bf16 v[208:211], v[40:43], v[88:91], v[208:211]
    v_mfma_f32_16x16x32_bf16 v[212:215], v[44:47], v[64:67], v[212:215]
    ds_read_b64_tr_b16 v[60:61], v245 offset:0
    ds_read_b64_tr_b16 v[62:63], v245 offset:512
    v_mfma_f32_16x16x32_bf16 v[216:219], v[44:47], v[68:71], v[216:219]
    v_mfma_f32_16x16x32_bf16 v[220:223], v[44:47], v[72:75], v[220:223]
    v_mfma_f32_16x16x32_bf16 v[224:227], v[44:47], v[76:79], v[224:227]
    v_mfma_f32_16x16x32_bf16 v[228:231], v[44:47], v[80:83], v[228:231]
    v_mfma_f32_16x16x32_bf16 v[232:235], v[44:47], v[84:87], v[232:235]
    v_mfma_f32_16x16x32_bf16 v[236:239], v[44:47], v[88:91], v[236:239]
    s_waitcnt vmcnt(5)
    s_barrier
    s_waitcnt lgkmcnt(0)
    v_mfma_f32_16x16x32_bf16 v[128:131], v[48:51], v[92:95], v[128:131]
    s_lshr_b32 s62, s54, 12
    s_add_u32 m0, s67, 16384
    s_nop 0
    buffer_load_dwordx4 v246, s[16:19], s62 offen lds
    v_mfma_f32_16x16x32_bf16 v[132:135], v[48:51], v[96:99], v[132:135]
    ds_read_b128 v[64:67], v247 offset:0
    v_mfma_f32_16x16x32_bf16 v[136:139], v[48:51], v[100:103], v[136:139]
    v_mfma_f32_16x16x32_bf16 v[140:143], v[48:51], v[104:107], v[140:143]
    ds_read_b128 v[68:71], v247 offset:1024
    v_mfma_f32_16x16x32_bf16 v[144:147], v[48:51], v[108:111], v[144:147]
    s_add_u32 s62, s61, s54
    s_add_u32 m0, s66, 0
    s_nop 0
    buffer_load_dwordx4 v240, s[12:15], s62 offen lds
    v_mfma_f32_16x16x32_bf16 v[148:151], v[48:51], v[112:115], v[148:151]
    ds_read_b128 v[72:75], v247 offset:2048
    v_mfma_f32_16x16x32_bf16 v[152:155], v[48:51], v[116:119], v[152:155]
    v_mfma_f32_16x16x32_bf16 v[156:159], v[52:55], v[92:95], v[156:159]
    ds_read_b128 v[76:79], v247 offset:3072
    v_mfma_f32_16x16x32_bf16 v[160:163], v[52:55], v[96:99], v[160:163]
    s_add_u32 s62, s61, s54
    s_add_u32 s62, s62, 65536
    s_add_u32 m0, s66, 1024
    s_nop 0
    buffer_load_dwordx4 v241, s[12:15], s62 offen lds
    v_mfma_f32_16x16x32_bf16 v[164:167], v[52:55], v[100:103], v[164:167]
    ds_read_b128 v[80:83], v247 offset:4096
    v_mfma_f32_16x16x32_bf16 v[168:171], v[52:55], v[104:107], v[168:171]
    v_mfma_f32_16x16x32_bf16 v[172:175], v[52:55], v[108:111], v[172:175]
    ds_read_b128 v[84:87], v247 offset:5120
    v_mfma_f32_16x16x32_bf16 v[176:179], v[52:55], v[112:115], v[176:179]
    s_add_u32 s62, s61, s54
    s_add_u32 s62, s62, 131072
    s_add_u32 m0, s66, 2048
    s_nop 0
    buffer_load_dwordx4 v240, s[12:15], s62 offen lds
    v_mfma_f32_16x16x32_bf16 v[180:183], v[52:55], v[116:119], v[180:183]
    ds_read_b128 v[88:91], v247 offset:6144
    v_mfma_f32_16x16x32_bf16 v[184:187], v[56:59], v[92:95], v[184:187]
    v_mfma_f32_16x16x32_bf16 v[188:191], v[56:59], v[96:99], v[188:191]
    ds_read_b64_tr_b16 v[32:33], v242 offset:4096
    ds_read_b64_tr_b16 v[34:35], v242 offset:4608
    v_mfma_f32_16x16x32_bf16 v[192:195], v[56:59], v[100:103], v[192:195]
    s_add_u32 s62, s61, s54
    s_add_u32 s62, s62, 196608
    s_add_u32 m0, s66, 3072
    s_nop 0
    buffer_load_dwordx4 v241, s[12:15], s62 offen lds
    v_mfma_f32_16x16x32_bf16 v[196:199], v[56:59], v[104:107], v[196:199]
    ds_read_b64_tr_b16 v[36:37], v243 offset:4096
    ds_read_b64_tr_b16 v[38:39], v243 offset:4608
    v_mfma_f32_16x16x32_bf16 v[200:203], v[56:59], v[108:111], v[200:203]
    v_mfma_f32_16x16x32_bf16 v[204:207], v[56:59], v[112:115], v[204:207]
    ds_read_b64_tr_b16 v[40:41], v244 offset:4096
    ds_read_b64_tr_b16 v[42:43], v244 offset:4608
    v_mfma_f32_16x16x32_bf16 v[208:211], v[56:59], v[116:119], v[208:211]
    v_mfma_f32_16x16x32_bf16 v[212:215], v[60:63], v[92:95], v[212:215]
    ds_read_b64_tr_b16 v[44:45], v245 offset:4096
    ds_read_b64_tr_b16 v[46:47], v245 offset:4608
    v_mfma_f32_16x16x32_bf16 v[216:219], v[60:63], v[96:99], v[216:219]
    v_mfma_f32_16x16x32_bf16 v[220:223], v[60:63], v[100:103], v[220:223]
    v_mfma_f32_16x16x32_bf16 v[224:227], v[60:63], v[104:107], v[224:227]
    v_mfma_f32_16x16x32_bf16 v[228:231], v[60:63], v[108:111], v[228:231]
    v_mfma_f32_16x16x32_bf16 v[232:235], v[60:63], v[112:115], v[232:235]
    v_mfma_f32_16x16x32_bf16 v[236:239], v[60:63], v[116:119], v[236:239]
    s_waitcnt vmcnt(5)
    s_barrier
    s_waitcnt lgkmcnt(0)
    v_mfma_f32_16x16x32_bf16 v[128:131], v[32:35], v[64:67], v[128:131]
    s_lshr_b32 s62, s55, 12
    s_add_u32 m0, s67, 24576
    s_nop 0
    buffer_load_dwordx4 v246, s[16:19], s62 offen lds
    v_mfma_f32_16x16x32_bf16 v[132:135], v[32:35], v[68:71], v[132:135]
    ds_read_b128 v[92:95], v247 offset:8192
    v_mfma_f32_16x16x32_bf16 v[136:139], v[32:35], v[72:75], v[136:139]
    v_mfma_f32_16x16x32_bf16 v[140:143], v[32:35], v[76:79], v[140:143]
    ds_read_b128 v[96:99], v247 offset:9216
    v_mfma_f32_16x16x32_bf16 v[144:147], v[32:35], v[80:83], v[144:147]
    s_add_u32 s62, s61, s55
    s_add_u32 m0, s66, 4096
    s_nop 0
    buffer_load_dwordx4 v240, s[12:15], s62 offen lds
    v_mfma_f32_16x16x32_bf16 v[148:151], v[32:35], v[84:87], v[148:151]
    ds_read_b128 v[100:103], v247 offset:10240
    v_mfma_f32_16x16x32_bf16 v[152:155], v[32:35], v[88:91], v[152:155]
    v_mfma_f32_16x16x32_bf16 v[156:159], v[36:39], v[64:67], v[156:159]
    ds_read_b128 v[104:107], v247 offset:11264
    v_mfma_f32_16x16x32_bf16 v[160:163], v[36:39], v[68:71], v[160:163]
    s_add_u32 s62, s61, s55
    s_add_u32 s62, s62, 65536
    s_add_u32 m0, s66, 5120
    s_nop 0
    buffer_load_dwordx4 v241, s[12:15], s62 offen lds
    v_mfma_f32_16x16x32_bf16 v[164:167], v[36:39], v[72:75], v[164:167]
    ds_read_b128 v[108:111], v247 offset:12288
    v_mfma_f32_16x16x32_bf16 v[168:171], v[36:39], v[76:79], v[168:171]
    v_mfma_f32_16x16x32_bf16 v[172:175], v[36:39], v[80:83], v[172:175]
    ds_read_b128 v[112:115], v247 offset:13312
    v_mfma_f32_16x16x32_bf16 v[176:179], v[36:39], v[84:87], v[176:179]
    s_add_u32 s62, s61, s55
    s_add_u32 s62, s62, 131072
    s_add_u32 m0, s66, 6144
    s_nop 0
    buffer_load_dwordx4 v240, s[12:15], s62 offen lds
    v_mfma_f32_16x16x32_bf16 v[180:183], v[36:39], v[88:91], v[180:183]
    ds_read_b128 v[116:119], v247 offset:14336
    v_mfma_f32_16x16x32_bf16 v[184:187], v[40:43], v[64:67], v[184:187]
    v_mfma_f32_16x16x32_bf16 v[188:191], v[40:43], v[68:71], v[188:191]
    ds_read_b64_tr_b16 v[48:49], v242 offset:8192
    ds_read_b64_tr_b16 v[50:51], v242 offset:8704
    v_mfma_f32_16x16x32_bf16 v[192:195], v[40:43], v[72:75], v[192:195]
    s_add_u32 s62, s61, s55
    s_add_u32 s62, s62, 196608
    s_add_u32 m0, s66, 7168
    s_nop 0
    buffer_load_dwordx4 v241, s[12:15], s62 offen lds
    v_mfma_f32_16x16x32_bf16 v[196:199], v[40:43], v[76:79], v[196:199]
    ds_read_b64_tr_b16 v[52:53], v243 offset:8192
    ds_read_b64_tr_b16 v[54:55], v243 offset:8704
    v_mfma_f32_16x16x32_bf16 v[200:203], v[40:43], v[80:83], v[200:203]
    v_mfma_f32_16x16x32_bf16 v[204:207], v[40:43], v[84:87], v[204:207]
    ds_read_b64_tr_b16 v[56:57], v244 offset:8192
    ds_read_b64_tr_b16 v[58:59], v244 offset:8704
    v_mfma_f32_16x16x32_bf16 v[208:211], v[40:43], v[88:91], v[208:211]
    v_mfma_f32_16x16x32_bf16 v[212:215], v[44:47], v[64:67], v[212:215]
    ds_read_b64_tr_b16 v[60:61], v245 offset:8192
    ds_read_b64_tr_b16 v[62:63], v245 offset:8704
    v_mfma_f32_16x16x32_bf16 v[216:219], v[44:47], v[68:71], v[216:219]
    v_mfma_f32_16x16x32_bf16 v[220:223], v[44:47], v[72:75], v[220:223]
    v_mfma_f32_16x16x32_bf16 v[224:227], v[44:47], v[76:79], v[224:227]
    v_mfma_f32_16x16x32_bf16 v[228:231], v[44:47], v[80:83], v[228:231]
    v_mfma_f32_16x16x32_bf16 v[232:235], v[44:47], v[84:87], v[232:235]
    v_mfma_f32_16x16x32_bf16 v[236:239], v[44:47], v[88:91], v[236:239]
    s_waitcnt vmcnt(5)
    s_barrier
    s_waitcnt lgkmcnt(0)
    v_mfma_f32_16x16x32_bf16 v[128:131], v[48:51], v[92:95], v[128:131]
    s_add_u32 s62, s84, 0
    s_and_b32 s62, s62, 0x1ffff
    s_lshl_b32 s68, s24, 10
    s_add_u32 m0, s68, 0
    s_nop 0
    buffer_load_dwordx4 v249, s[4:7], s62 offen nt lds
    v_mfma_f32_16x16x32_bf16 v[132:135], v[48:51], v[96:99], v[132:135]
    ds_read_b128 v[64:67], v247 offset:16384
    v_mfma_f32_16x16x32_bf16 v[136:139], v[48:51], v[100:103], v[136:139]
    v_mfma_f32_16x16x32_bf16 v[140:143], v[48:51], v[104:107], v[140:143]
    ds_read_b128 v[68:71], v247 offset:17408
    v_mfma_f32_16x16x32_bf16 v[144:147], v[48:51], v[108:111], v[144:147]
    s_add_u32 s62, s84, 8192
    s_and_b32 s62, s62, 0x1ffff
    s_lshl_b32 s68, s24, 10
    s_add_u32 m0, s68, 16384
    s_nop 0
    buffer_load_dwordx4 v249, s[4:7], s62 offen nt lds
    v_mfma_f32_16x16x32_bf16 v[148:151], v[48:51], v[112:115], v[148:151]
    ds_read_b128 v[72:75], v247 offset:18432
    v_mfma_f32_16x16x32_bf16 v[152:155], v[48:51], v[116:119], v[152:155]
    v_mfma_f32_16x16x32_bf16 v[156:159], v[52:55], v[92:95], v[156:159]
    ds_read_b128 v[76:79], v247 offset:19456
    v_mfma_f32_16x16x32_bf16 v[160:163], v[52:55], v[96:99], v[160:163]
    v_mfma_f32_16x16x32_bf16 v[164:167], v[52:55], v[100:103], v[164:167]
    ds_read_b128 v[80:83], v247 offset:20480
    v_mfma_f32_16x16x32_bf16 v[168:171], v[52:55], v[104:107], v[168:171]
    v_mfma_f32_16x16x32_bf16 v[172:175], v[52:55], v[108:111], v[172:175]
    ds_read_b128 v[84:87], v247 offset:21504
    v_mfma_f32_16x16x32_bf16 v[176:179], v[52:55], v[112:115], v[176:179]
    v_mfma_f32_16x16x32_bf16 v[180:183], v[52:55], v[116:119], v[180:183]
    ds_read_b128 v[88:91], v247 offset:22528
    v_mfma_f32_16x16x32_bf16 v[184:187], v[56:59], v[92:95], v[184:187]
    v_mfma_f32_16x16x32_bf16 v[188:191], v[56:59], v[96:99], v[188:191]
    ds_read_b64_tr_b16 v[32:33], v242 offset:0
    ds_read_b64_tr_b16 v[34:35], v242 offset:512
    v_mfma_f32_16x16x32_bf16 v[192:195], v[56:59], v[100:103], v[192:195]
    v_mfma_f32_16x16x32_bf16 v[196:199], v[56:59], v[104:107], v[196:199]
    ds_read_b64_tr_b16 v[36:37], v243 offset:0
    ds_read_b64_tr_b16 v[38:39], v243 offset:512
    v_mfma_f32_16x16x32_bf16 v[200:203], v[56:59], v[108:111], v[200:203]
    v_mfma_f32_16x16x32_bf16 v[204:207], v[56:59], v[112:115], v[204:207]
    ds_read_b64_tr_b16 v[40:41], v244 offset:0
    ds_read_b64_tr_b16 v[42:43], v244 offset:512
    v_mfma_f32_16x16x32_bf16 v[208:211], v[56:59], v[116:119], v[208:211]
    v_mfma_f32_16x16x32_bf16 v[212:215], v[60:63], v[92:95], v[212:215]
    ds_read_b64_tr_b16 v[44:45], v245 offset:0
    ds_read_b64_tr_b16 v[46:47], v245 offset:512
    v_mfma_f32_16x16x32_bf16 v[216:219], v[60:63], v[96:99], v[216:219]
    v_mfma_f32_16x16x32_bf16 v[220:223], v[60:63], v[100:103], v[220:223]
    v_mfma_f32_16x16x32_bf16 v[224:227], v[60:63], v[104:107], v[224:227]
    v_mfma_f32_16x16x32_bf16 v[228:231], v[60:63], v[108:111], v[228:231]
    v_mfma_f32_16x16x32_bf16 v[232:235], v[60:63], v[112:115], v[232:235]
    v_mfma_f32_16x16x32_bf16 v[236:239], v[60:63], v[116:119], v[236:239]
    s_waitcnt vmcnt(2)
    s_barrier
    s_waitcnt lgkmcnt(0)
    v_mfma_f32_16x16x32_bf16 v[128:131], v[32:35], v[64:67], v[128:131]
    s_add_u32 s62, s84, 0
    s_and_b32 s62, s62, 0x1ffff
    s_lshl_b32 s68, s24, 10
    s_add_u32 m0, s68, 8192
    s_nop 0
    buffer_load_dwordx4 v250, s[8:11], s62 offen nt lds
    v_mfma_f32_16x16x32_bf16 v[132:135], v[32:35], v[68:71], v[132:135]
    ds_read_b128 v[92:95], v247 offset:24576
    v_mfma_f32_16x16x32_bf16 v[136:139], v[32:35], v[72:75], v[136:139]
    v_mfma_f32_16x16x32_bf16 v[140:143], v[32:35], v[76:79], v[140:143]
    ds_read_b128 v[96:99], v247 offset:25600
    v_mfma_f32_16x16x32_bf16 v[144:147], v[32:35], v[80:83], v[144:147]
    s_add_u32 s62, s84, 8192
    s_and_b32 s62, s62, 0x1ffff
    s_lshl_b32 s68, s24, 10
    s_add_u32 m0, s68, 24576
    s_nop 0
    buffer_load_dwordx4 v250, s[8:11], s62 offen nt lds
    v_mfma_f32_16x16x32_bf16 v[148:151], v[32:35], v[84:87], v[148:151]
    ds_read_b128 v[100:103], v247 offset:26624
    v_mfma_f32_16x16x32_bf16 v[152:155], v[32:35], v[88:91], v[152:155]
    v_mfma_f32_16x16x32_bf16 v[156:159], v[36:39], v[64:67], v[156:159]
    ds_read_b128 v[104:107], v247 offset:27648
    v_mfma_f32_16x16x32_bf16 v[160:163], v[36:39], v[68:71], v[160:163]
    v_mfma_f32_16x16x32_bf16 v[164:167], v[36:39], v[72:75], v[164:167]
    ds_read_b128 v[108:111], v247 offset:28672
    v_mfma_f32_16x16x32_bf16 v[168:171], v[36:39], v[76:79], v[168:171]
    v_mfma_f32_16x16x32_bf16 v[172:175], v[36:39], v[80:83], v[172:175]
    ds_read_b128 v[112:115], v247 offset:29696
    v_mfma_f32_16x16x32_bf16 v[176:179], v[36:39], v[84:87], v[176:179]
    v_mfma_f32_16x16x32_bf16 v[180:183], v[36:39], v[88:91], v[180:183]
    ds_read_b128 v[116:119], v247 offset:30720
    v_mfma_f32_16x16x32_bf16 v[184:187], v[40:43], v[64:67], v[184:187]
    v_mfma_f32_16x16x32_bf16 v[188:191], v[40:43], v[68:71], v[188:191]
    ds_read_b64_tr_b16 v[48:49], v242 offset:4096
    ds_read_b64_tr_b16 v[50:51], v242 offset:4608
    v_mfma_f32_16x16x32_bf16 v[192:195], v[40:43], v[72:75], v[192:195]
    v_mfma_f32_16x16x32_bf16 v[196:199], v[40:43], v[76:79], v[196:199]
    ds_read_b64_tr_b16 v[52:53], v243 offset:4096
    ds_read_b64_tr_b16 v[54:55], v243 offset:4608
    v_mfma_f32_16x16x32_bf16 v[200:203], v[40:43], v[80:83], v[200:203]
    v_mfma_f32_16x16x32_bf16 v[204:207], v[40:43], v[84:87], v[204:207]
    ds_read_b64_tr_b16 v[56:57], v244 offset:4096
    ds_read_b64_tr_b16 v[58:59], v244 offset:4608
    v_mfma_f32_16x16x32_bf16 v[208:211], v[40:43], v[88:91], v[208:211]
    v_mfma_f32_16x16x32_bf16 v[212:215], v[44:47], v[64:67], v[212:215]
    ds_read_b64_tr_b16 v[60:61], v245 offset:4096
    ds_read_b64_tr_b16 v[62:63], v245 offset:4608
    v_mfma_f32_16x16x32_bf16 v[216:219], v[44:47], v[68:71], v[216:219]
    v_mfma_f32_16x16x32_bf16 v[220:223], v[44:47], v[72:75], v[220:223]
    v_mfma_f32_16x16x32_bf16 v[224:227], v[44:47], v[76:79], v[224:227]
    v_mfma_f32_16x16x32_bf16 v[228:231], v[44:47], v[80:83], v[228:231]
    v_mfma_f32_16x16x32_bf16 v[232:235], v[44:47], v[84:87], v[232:235]
    v_mfma_f32_16x16x32_bf16 v[236:239], v[44:47], v[88:91], v[236:239]
    s_barrier
    s_waitcnt lgkmcnt(0)
    s_waitcnt vmcnt(3)
    s_barrier
    v_mfma_f32_16x16x32_bf16 v[128:131], v[48:51], v[92:95], v[128:131]
    s_add_u32 s62, s84, 16384
    s_and_b32 s62, s62, 0x1ffff
    s_lshl_b32 s68, s24, 10
    s_add_u32 m0, s68, 32768
    s_nop 0
    buffer_load_dwordx4 v249, s[4:7], s62 offen nt lds
    v_mfma_f32_16x16x32_bf16 v[132:135], v[48:51], v[96:99], v[132:135]
    v_mfma_f32_16x16x32_bf16 v[136:139], v[48:51], v[100:103], v[136:139]
    v_mfma_f32_16x16x32_bf16 v[140:143], v[48:51], v[104:107], v[140:143]
    v_mfma_f32_16x16x32_bf16 v[144:147], v[48:51], v[108:111], v[144:147]
    s_add_u32 s62, s84, 24576
    s_and_b32 s62, s62, 0x1ffff
    s_lshl_b32 s68, s24, 10
    s_add_u32 m0, s68, 49152
    s_nop 0
    buffer_load_dwordx4 v249, s[4:7], s62 offen nt lds
    v_mfma_f32_16x16x32_bf16 v[148:151], v[48:51], v[112:115], v[148:151]
    v_mfma_f32_16x16x32_bf16 v[152:155], v[48:51], v[116:119], v[152:155]
    v_mfma_f32_16x16x32_bf16 v[156:159], v[52:55], v[92:95], v[156:159]
    v_mul_f32 v128, s64, v128
    v_mul_f32 v129, s64, v129
    v_mul_f32 v130, s64, v130
    v_mul_f32 v131, s64, v131
    v_cvt_pk_bf16_f32 v128, v128, v129
    v_cvt_pk_bf16_f32 v129, v130, v131
    v_mfma_f32_16x16x32_bf16 v[160:163], v[52:55], v[96:99], v[160:163]
    v_mul_f32 v132, s64, v132
    v_mul_f32 v133, s64, v133
    v_mul_f32 v134, s64, v134
    v_mul_f32 v135, s64, v135
    v_cvt_pk_bf16_f32 v132, v132, v133
    v_cvt_pk_bf16_f32 v133, v134, v135
    s_add_u32 s62, s84, 16384
    s_and_b32 s62, s62, 0x1ffff
    s_lshl_b32 s68, s24, 10
    s_add_u32 m0, s68, 40960
    s_nop 0
    buffer_load_dwordx4 v250, s[8:11], s62 offen nt lds
    v_mfma_f32_16x16x32_bf16 v[164:167], v[52:55], v[100:103], v[164:167]
    v_mul_f32 v136, s64, v136
    v_mul_f32 v137, s64, v137
    v_mul_f32 v138, s64, v138
    v_mul_f32 v139, s64, v139
    v_cvt_pk_bf16_f32 v136, v136, v137
    v_cvt_pk_bf16_f32 v137, v138, v139
    v_mfma_f32_16x16x32_bf16 v[168:171], v[52:55], v[104:107], v[168:171]
    v_mul_f32 v140, s64, v140
    v_mul_f32 v141, s64, v141
    v_mul_f32 v142, s64, v142
    v_mul_f32 v143, s64, v143
    v_cvt_pk_bf16_f32 v140, v140, v141
    v_cvt_pk_bf16_f32 v141, v142, v143
    v_mfma_f32_16x16x32_bf16 v[172:175], v[52:55], v[108:111], v[172:175]
    v_mul_f32 v144, s64, v144
    v_mul_f32 v145, s64, v145
    v_mul_f32 v146, s64, v146
    v_mul_f32 v147, s64, v147
    v_cvt_pk_bf16_f32 v144, v144, v145
    v_cvt_pk_bf16_f32 v145, v146, v147
    v_mfma_f32_16x16x32_bf16 v[176:179], v[52:55], v[112:115], v[176:179]
    v_mul_f32 v148, s64, v148
    v_mul_f32 v149, s64, v149
    v_mul_f32 v150, s64, v150
    v_mul_f32 v151, s64, v151
    v_cvt_pk_bf16_f32 v148, v148, v149
    v_cvt_pk_bf16_f32 v149, v150, v151
    v_mfma_f32_16x16x32_bf16 v[180:183], v[52:55], v[116:119], v[180:183]
    v_mul_f32 v152, s64, v152
    v_mul_f32 v153, s64, v153
    v_mul_f32 v154, s64, v154
    v_mul_f32 v155, s64, v155
    v_cvt_pk_bf16_f32 v152, v152, v153
    v_cvt_pk_bf16_f32 v153, v154, v155
    s_cmp_ge_u32 s24, 6
    s_cbranch_scc1 m_qw1
    ds_write_b64 v248, v[128:129] offset:0
    ds_write_b64 v248, v[132:133] offset:4096
    ds_write_b64 v248, v[136:137] offset:8192
    ds_write_b64 v248, v[140:141] offset:12288
    ds_write_b64 v248, v[144:145] offset:16384
    ds_write_b64 v248, v[148:149] offset:20480
    ds_write_b64 v248, v[152:153] offset:24576
m_qw1:
    v_mfma_f32_16x16x32_bf16 v[184:187], v[56:59], v[92:95], v[184:187]
    v_mul_f32 v156, s64, v156
    v_mul_f32 v157, s64, v157
    v_mul_f32 v158, s64, v158
    v_mul_f32 v159, s64, v159
    v_cvt_pk_bf16_f32 v156, v156, v157
    v_cvt_pk_bf16_f32 v157, v158, v159
    v_mfma_f32_16x16x32_bf16 v[188:191], v[56:59], v[96:99], v[188:191]
    v_mul_f32 v160, s64, v160
    v_mul_f32 v161, s64, v161
    v_mul_f32 v162, s64, v162
    v_mul_f32 v163, s64, v163
    v_cvt_pk_bf16_f32 v160, v160, v161
    v_cvt_pk_bf16_f32 v161, v162, v163
    v_mfma_f32_16x16x32_bf16 v[192:195], v[56:59], v[100:103], v[192:195]
    v_mul_f32 v164, s64, v164
    v_mul_f32 v165, s64, v165
    v_mul_f32 v166, s64, v166
    v_mul_f32 v167, s64, v167
    v_cvt_pk_bf16_f32 v164, v164, v165
    v_cvt_pk_bf16_f32 v165, v166, v167
    v_mfma_f32_16x16x32_bf16 v[196:199], v[56:59], v[104:107], v[196:199]
    v_mul_f32 v168, s64, v168
    v_mul_f32 v169, s64, v169
    v_mul_f32 v170, s64, v170
    v_mul_f32 v171, s64, v171
    v_cvt_pk_bf16_f32 v168, v168, v169
    v_cvt_pk_bf16_f32 v169, v170, v171
    v_mfma_f32_16x16x32_bf16 v[200:203], v[56:59], v[108:111], v[200:203]
    v_mul_f32 v172, s64, v172
    v_mul_f32 v173, s64, v173
    v_mul_f32 v174, s64, v174
    v_mul_f32 v175, s64, v175
    v_cvt_pk_bf16_f32 v172, v172, v173
    v_cvt_pk_bf16_f32 v173, v174, v175
    v_mfma_f32_16x16x32_bf16 v[204:207], v[56:59], v[112:115], v[204:207]
    v_mul_f32 v176, s64, v176
    v_mul_f32 v177, s64, v177
    v_mul_f32 v178, s64, v178
    v_mul_f32 v179, s64, v179
    v_cvt_pk_bf16_f32 v176, v176, v177
    v_cvt_pk_bf16_f32 v177, v178, v179
    v_mfma_f32_16x16x32_bf16 v[208:211], v[56:59], v[116:119], v[208:211]
    v_mul_f32 v180, s64, v180
    v_mul_f32 v181, s64, v181
    v_mul_f32 v182, s64, v182
    v_mul_f32 v183, s64, v183
    v_cvt_pk_bf16_f32 v180, v180, v181
    v_cvt_pk_bf16_f32 v181, v182, v183
    s_cmp_ge_u32 s24, 6
    s_cbranch_scc1 m_qw2
    ds_write_b64 v248, v[156:157] offset:512
    ds_write_b64 v248, v[160:161] offset:4608
    ds_write_b64 v248, v[164:165] offset:8704
    ds_write_b64 v248, v[168:169] offset:12800
    ds_write_b64 v248, v[172:173] offset:16896
    ds_write_b64 v248, v[176:177] offset:20992
    ds_write_b64 v248, v[180:181] offset:25088
m_qw2:
    v_mfma_f32_16x16x32_bf16 v[212:215], v[60:63], v[92:95], v[212:215]
    v_mul_f32 v184, s64, v184
    v_mul_f32 v185, s64, v185
    v_mul_f32 v186, s64, v186
    v_mul_f32 v187, s64, v187
    v_cvt_pk_bf16_f32 v184, v184, v185
    v_cvt_pk_bf16_f32 v185, v186, v187
    v_mfma_f32_16x16x32_bf16 v[216:219], v[60:63], v[96:99], v[216:219]
    v_mul_f32 v188, s64, v188
    v_mul_f32 v189, s64, v189
    v_mul_f32 v190, s64, v190
    v_mul_f32 v191, s64, v191
    v_cvt_pk_bf16_f32 v188, v188, v189
    v_cvt_pk_bf16_f32 v189, v190, v191
    v_mfma_f32_16x16x32_bf16 v[220:223], v[60:63], v[100:103], v[220:223]
    v_mul_f32 v192, s64, v192
    v_mul_f32 v193, s64, v193
    v_mul_f32 v194, s64, v194
    v_mul_f32 v195, s64, v195
    v_cvt_pk_bf16_f32 v192, v192, v193
    v_cvt_pk_bf16_f32 v193, v194, v195
    v_mfma_f32_16x16x32_bf16 v[224:227], v[60:63], v[104:107], v[224:227]
    v_mul_f32 v196, s64, v196
    v_mul_f32 v197, s64, v197
    v_mul_f32 v198, s64, v198
    v_mul_f32 v199, s64, v199
    v_cvt_pk_bf16_f32 v196, v196, v197
    v_cvt_pk_bf16_f32 v197, v198, v199
    v_mfma_f32_16x16x32_bf16 v[228:231], v[60:63], v[108:111], v[228:231]
    v_mul_f32 v200, s64, v200
    v_mul_f32 v201, s64, v201
    v_mul_f32 v202, s64, v202
    v_mul_f32 v203, s64, v203
    v_cvt_pk_bf16_f32 v200, v200, v201
    v_cvt_pk_bf16_f32 v201, v202, v203
    v_mfma_f32_16x16x32_bf16 v[232:235], v[60:63], v[112:115], v[232:235]
    v_mul_f32 v204, s64, v204
    v_mul_f32 v205, s64, v205
    v_mul_f32 v206, s64, v206
    v_mul_f32 v207, s64, v207
    v_cvt_pk_bf16_f32 v204, v204, v205
    v_cvt_pk_bf16_f32 v205, v206, v207
    v_mfma_f32_16x16x32_bf16 v[236:239], v[60:63], v[116:119], v[236:239]
    v_mul_f32 v208, s64, v208
    v_mul_f32 v209, s64, v209
    v_mul_f32 v210, s64, v210
    v_mul_f32 v211, s64, v211
    v_cvt_pk_bf16_f32 v208, v208, v209
    v_cvt_pk_bf16_f32 v209, v210, v211
    s_cmp_ge_u32 s24, 6
    s_cbranch_scc1 m_qw3
    ds_write_b64 v248, v[184:185] offset:1024
    s_waitcnt lgkmcnt(14)
    ds_write_b64 v248, v[188:189] offset:5120
    s_waitcnt lgkmcnt(14)
    ds_write_b64 v248, v[192:193] offset:9216
    s_waitcnt lgkmcnt(14)
    ds_write_b64 v248, v[196:197] offset:13312
    s_waitcnt lgkmcnt(14)
    ds_write_b64 v248, v[200:201] offset:17408
    s_waitcnt lgkmcnt(14)
    ds_write_b64 v248, v[204:205] offset:21504
    s_waitcnt lgkmcnt(14)
    ds_write_b64 v248, v[208:209] offset:25600
m_qw3:
    v_mul_f32 v212, s64, v212
    v_mul_f32 v213, s64, v213
    v_mul_f32 v214, s64, v214
    v_mul_f32 v215, s64, v215
    v_cvt_pk_bf16_f32 v212, v212, v213
    v_cvt_pk_bf16_f32 v213, v214, v215
    v_mul_f32 v216, s64, v216
    v_mul_f32 v217, s64, v217
    v_mul_f32 v218, s64, v218
    v_mul_f32 v219, s64, v219
    v_cvt_pk_bf16_f32 v216, v216, v217
    v_cvt_pk_bf16_f32 v217, v218, v219
    v_mul_f32 v220, s64, v220
    v_mul_f32 v221, s64, v221
    v_mul_f32 v222, s64, v222
    v_mul_f32 v223, s64, v223
    v_cvt_pk_bf16_f32 v220, v220, v221
    v_cvt_pk_bf16_f32 v221, v222, v223
    v_mul_f32 v224, s64, v224
    v_mul_f32 v225, s64, v225
    v_mul_f32 v226, s64, v226
    v_mul_f32 v227, s64, v227
    v_cvt_pk_bf16_f32 v224, v224, v225
    v_cvt_pk_bf16_f32 v225, v226, v227
    v_mul_f32 v228, s64, v228
    v_mul_f32 v229, s64, v229
    v_mul_f32 v230, s64, v230
    v_mul_f32 v231, s64, v231
    v_cvt_pk_bf16_f32 v228, v228, v229
    v_cvt_pk_bf16_f32 v229, v230, v231
    v_mul_f32 v232, s64, v232
    v_mul_f32 v233, s64, v233
    v_mul_f32 v234, s64, v234
    v_mul_f32 v235, s64, v235
    v_cvt_pk_bf16_f32 v232, v232, v233
    v_cvt_pk_bf16_f32 v233, v234, v235
    v_mul_f32 v236, s64, v236
    v_mul_f32 v237, s64, v237
    v_mul_f32 v238, s64, v238
    v_mul_f32 v239, s64, v239
    v_cvt_pk_bf16_f32 v236, v236, v237
    v_cvt_pk_bf16_f32 v237, v238, v239
    s_cmp_ge_u32 s24, 6
    s_cbranch_scc1 m_qw4
    s_waitcnt lgkmcnt(14)
    ds_write_b64 v248, v[212:213] offset:1536
    s_waitcnt lgkmcnt(14)
    ds_write_b64 v248, v[216:217] offset:5632
    s_waitcnt lgkmcnt(14)
    ds_write_b64 v248, v[220:221] offset:9728
    s_waitcnt lgkmcnt(14)
    ds_write_b64 v248, v[224:225] offset:13824
    s_waitcnt lgkmcnt(14)
    ds_write_b64 v248, v[228:229] offset:17920
    s_waitcnt lgkmcnt(14)
    ds_write_b64 v248, v[232:233] offset:22016
    s_waitcnt lgkmcnt(14)
    ds_write_b64 v248, v[236:237] offset:26112
m_qw4:
    s_waitcnt lgkmcnt(0)
    s_cmp_ge_u32 s24, 4
    s_cbranch_scc1 m_pp
    s_cmp_eq_u32 s24, 3
    s_cbranch_scc1 m_a1
    s_branch m_a2
m_pp:
    s_cmp_eq_u32 s24, 7
    s_cbranch_scc1 m_p1
    s_branch m_p2
m_exit:
    s_endpgm
m_a2:
    ds_read_b128 v[96:99], v0 offset:0
    ds_read_b128 v[100:103], v1 offset:0
    ds_read_b128 v[104:107], v2 offset:0
    ds_read_b128 v[108:111], v3 offset:0
    ds_read_b128 v[112:115], v0 offset:4096
    ds_read_b128 v[116:119], v1 offset:4096
    ds_read_b128 v[120:123], v2 offset:4096
    ds_read_b128 v[124:127], v3 offset:4096
    s_setprio 2
    s_mov_b32 s28, s24
    s_mov_b32 s65, 1149239296
    s_mov_b32 s29, 0
    s_mov_b32 s63, 0
    s_mov_b32 s85, 106496
    s_waitcnt lgkmcnt(0)
    s_waitcnt vmcnt(3)
m_a2_loop:
    v_add_u32 v12, s85, v13
    s_barrier
    ds_read_b128 v[64:67], v12 offset:0
    ds_read_b128 v[68:71], v12 offset:1024
    ds_read_b128 v[72:75], v12 offset:2048
    ds_read_b128 v[76:79], v12 offset:3072
    ds_read_b128 v[80:83], v12 offset:4096
    ds_read_b128 v[84:87], v12 offset:5120
    ds_read_b128 v[88:91], v12 offset:6144
    ds_read_b128 v[92:95], v12 offset:7168
    s_waitcnt lgkmcnt(0)
    s_cmp_ge_u32 s29, 1
    s_cbranch_scc0 m_a2_nopark
    ds_write_b128 v12, v[128:131] offset:0
    ds_write_b128 v12, v[132:135] offset:1024
    ds_write_b128 v12, v[136:139] offset:2048
    ds_write_b128 v12, v[140:143] offset:3072
    ds_write_b128 v12, v[144:147] offset:4096
    ds_write_b128 v12, v[148:151] offset:5120
    ds_write_b128 v12, v[152:155] offset:6144
    ds_write_b128 v12, v[156:159] offset:7168
    s_waitcnt lgkmcnt(0)
m_a2_nopark:
    v_mfma_f32_16x16x32_bf16 v[48:51], v[96:99], v[64:67], 0
    ds_read_b64_tr_b16 v[128:129], v4 offset:8192
    ds_read_b64_tr_b16 v[130:131], v4 offset:12288
    v_mfma_f32_16x16x32_bf16 v[48:51], v[100:103], v[68:71], v[48:51]
    ds_read_b64_tr_b16 v[132:133], v5 offset:8192
    ds_read_b64_tr_b16 v[134:135], v5 offset:12288
    v_mfma_f32_16x16x32_bf16 v[48:51], v[104:107], v[72:75], v[48:51]
    ds_read_b64_tr_b16 v[136:137], v6 offset:8192
    ds_read_b64_tr_b16 v[138:139], v6 offset:12288
    v_mfma_f32_16x16x32_bf16 v[48:51], v[108:111], v[76:79], v[48:51]
    ds_read_b64_tr_b16 v[140:141], v7 offset:8192
    ds_read_b64_tr_b16 v[142:143], v7 offset:12288
    v_mfma_f32_16x16x32_bf16 v[56:59], v[112:115], v[64:67], 0
    ds_read_b64_tr_b16 v[144:145], v8 offset:8192
    ds_read_b64_tr_b16 v[146:147], v8 offset:12288
    v_mfma_f32_16x16x32_bf16 v[56:59], v[116:119], v[68:71], v[56:59]
    ds_read_b64_tr_b16 v[148:149], v9 offset:8192
    ds_read_b64_tr_b16 v[150:151], v9 offset:12288
    v_mfma_f32_16x16x32_bf16 v[56:59], v[120:123], v[72:75], v[56:59]
    ds_read_b64_tr_b16 v[152:153], v10 offset:8192
    ds_read_b64_tr_b16 v[154:155], v10 offset:12288
    v_mfma_f32_16x16x32_bf16 v[56:59], v[124:127], v[76:79], v[56:59]
    s_waitcnt lgkmcnt(12)
    ds_read_b64_tr_b16 v[156:157], v11 offset:8192
    ds_read_b64_tr_b16 v[158:159], v11 offset:12288
    v_max3_f32 v20, v48, v49, v50
    s_nop 3
    v_max3_f32 v22, v56, v57, v58
    v_max3_f32 v20, v20, v51, v59
    v_max_f32 v20, v20, v22
    v_mov_b32 v22, v20
    s_nop 1
    v_permlane16_swap_b32 v20, v22
    v_max_f32 v20, v20, v22
    v_mov_b32 v22, v20
    s_nop 1
    v_permlane32_swap_b32 v20, v22
    v_max_f32 v20, v20, v22
    v_sub_f32 v32, 0, v20
    v_sub_f32 v33, 0, v20
    v_sub_f32 v34, 0, v20
    v_sub_f32 v35, 0, v20
    v_sub_f32 v48, v48, v20
    v_sub_f32 v49, v49, v20
    v_sub_f32 v50, v50, v20
    v_sub_f32 v51, v51, v20
    v_sub_f32 v56, v56, v20
    v_sub_f32 v57, v57, v20
    v_sub_f32 v58, v58, v20
    v_sub_f32 v59, v59, v20
    v_exp_f32 v24, v48
    v_exp_f32 v25, v49
    v_exp_f32 v26, v50
    v_exp_f32 v27, v51
    v_exp_f32 v28, v56
    v_exp_f32 v29, v57
    v_exp_f32 v30, v58
    v_exp_f32 v31, v59
    v_mfma_f32_16x16x32_bf16 v[52:55], v[96:99], v[80:83], 0
    v_cvt_pk_bf16_f32 v40, v24, v25
    v_cvt_pk_bf16_f32 v41, v26, v27
    v_mfma_f32_16x16x32_bf16 v[52:55], v[100:103], v[84:87], v[52:55]
    v_cvt_pk_bf16_f32 v42, v28, v29
    v_cvt_pk_bf16_f32 v43, v30, v31
    v_mfma_f32_16x16x32_bf16 v[52:55], v[104:107], v[88:91], v[52:55]
    v_add_f32 v24, v24, v25
    v_add_f32 v26, v26, v27
    v_mfma_f32_16x16x32_bf16 v[52:55], v[108:111], v[92:95], v[52:55]
    v_add_f32 v28, v28, v29
    v_add_f32 v30, v30, v31
    v_mfma_f32_16x16x32_bf16 v[60:63], v[112:115], v[80:83], 0
    v_add_f32 v24, v24, v26
    v_add_f32 v28, v28, v30
    v_mfma_f32_16x16x32_bf16 v[60:63], v[116:119], v[84:87], v[60:63]
    v_add_f32 v18, v24, v28
    v_mfma_f32_16x16x32_bf16 v[60:63], v[120:123], v[88:91], v[60:63]
    v_mov_b32 v16, v18
    v_mfma_f32_16x16x32_bf16 v[60:63], v[124:127], v[92:95], v[60:63]
    s_waitcnt lgkmcnt(0)
    v_mfma_f32_16x16x32_bf16 v[160:163], v[128:131], v[40:43], 0
    ds_read_b128 v[96:99], v0 offset:16384
    ds_read_b128 v[100:103], v1 offset:16384
    v_mfma_f32_16x16x32_bf16 v[168:171], v[132:135], v[40:43], 0
    ds_read_b128 v[104:107], v2 offset:16384
    ds_read_b128 v[108:111], v3 offset:16384
    v_mfma_f32_16x16x32_bf16 v[176:179], v[136:139], v[40:43], 0
    ds_read_b128 v[112:115], v0 offset:20480
    ds_read_b128 v[116:119], v1 offset:20480
    v_mfma_f32_16x16x32_bf16 v[184:187], v[140:143], v[40:43], 0
    ds_read_b128 v[120:123], v2 offset:20480
    ds_read_b128 v[124:127], v3 offset:20480
    v_mfma_f32_16x16x32_bf16 v[192:195], v[144:147], v[40:43], 0
    v_mfma_f32_16x16x32_bf16 v[200:203], v[148:151], v[40:43], 0
    v_mfma_f32_16x16x32_bf16 v[208:211], v[152:155], v[40:43], 0
    v_mfma_f32_16x16x32_bf16 v[216:219], v[156:159], v[40:43], 0
    v_max3_f32 v21, v52, v53, v54
    v_max3_f32 v22, v60, v61, v62
    v_max3_f32 v21, v21, v55, v63
    v_max_f32 v21, v21, v22
    v_mov_b32 v22, v21
    s_nop 1
    v_permlane16_swap_b32 v21, v22
    v_max_f32 v21, v21, v22
    v_mov_b32 v22, v21
    s_nop 1
    v_permlane32_swap_b32 v21, v22
    v_max_f32 v21, v21, v22
    v_sub_f32 v36, 0, v21
    v_sub_f32 v37, 0, v21
    v_sub_f32 v38, 0, v21
    v_sub_f32 v39, 0, v21
    v_sub_f32 v52, v52, v21
    v_sub_f32 v53, v53, v21
    v_sub_f32 v54, v54, v21
    v_sub_f32 v55, v55, v21
    v_sub_f32 v60, v60, v21
    v_sub_f32 v61, v61, v21
    v_sub_f32 v62, v62, v21
    v_sub_f32 v63, v63, v21
    v_exp_f32 v24, v52
    v_exp_f32 v25, v53
    v_exp_f32 v26, v54
    v_exp_f32 v27, v55
    v_exp_f32 v28, v60
    v_exp_f32 v29, v61
    v_exp_f32 v30, v62
    v_exp_f32 v31, v63
    s_waitcnt lgkmcnt(0)
    s_waitcnt vmcnt(0)
    s_barrier
    v_mfma_f32_16x16x32_bf16 v[48:51], v[96:99], v[64:67], v[32:35]
    v_cvt_pk_bf16_f32 v44, v24, v25
    v_cvt_pk_bf16_f32 v45, v26, v27
    v_mfma_f32_16x16x32_bf16 v[48:51], v[100:103], v[68:71], v[48:51]
    v_cvt_pk_bf16_f32 v46, v28, v29
    v_cvt_pk_bf16_f32 v47, v30, v31
    v_mfma_f32_16x16x32_bf16 v[48:51], v[104:107], v[72:75], v[48:51]
    v_add_f32 v24, v24, v25
    v_add_f32 v26, v26, v27
    v_mfma_f32_16x16x32_bf16 v[48:51], v[108:111], v[76:79], v[48:51]
    v_add_f32 v28, v28, v29
    v_add_f32 v30, v30, v31
    v_mfma_f32_16x16x32_bf16 v[56:59], v[112:115], v[64:67], v[32:35]
    v_add_f32 v24, v24, v26
    v_add_f32 v28, v28, v30
    v_mfma_f32_16x16x32_bf16 v[56:59], v[116:119], v[68:71], v[56:59]
    v_add_f32 v19, v24, v28
    v_mfma_f32_16x16x32_bf16 v[56:59], v[120:123], v[72:75], v[56:59]
    v_mov_b32 v17, v19
    v_mfma_f32_16x16x32_bf16 v[56:59], v[124:127], v[76:79], v[56:59]
    v_mfma_f32_16x16x32_bf16 v[164:167], v[128:131], v[44:47], 0
    ds_read_b64_tr_b16 v[128:129], v4 offset:24576
    ds_read_b64_tr_b16 v[130:131], v4 offset:28672
    v_mfma_f32_16x16x32_bf16 v[172:175], v[132:135], v[44:47], 0
    ds_read_b64_tr_b16 v[132:133], v5 offset:24576
    ds_read_b64_tr_b16 v[134:135], v5 offset:28672
    v_mfma_f32_16x16x32_bf16 v[180:183], v[136:139], v[44:47], 0
    ds_read_b64_tr_b16 v[136:137], v6 offset:24576
    ds_read_b64_tr_b16 v[138:139], v6 offset:28672
    v_exp_f32 v24, v48
    v_mfma_f32_16x16x32_bf16 v[188:191], v[140:143], v[44:47], 0
    ds_read_b64_tr_b16 v[140:141], v7 offset:24576
    ds_read_b64_tr_b16 v[142:143], v7 offset:28672
    v_exp_f32 v25, v49
    v_mfma_f32_16x16x32_bf16 v[196:199], v[144:147], v[44:47], 0
    v_exp_f32 v26, v50
    v_exp_f32 v27, v51
    v_mfma_f32_16x16x32_bf16 v[204:207], v[148:151], v[44:47], 0
    v_exp_f32 v28, v56
    v_mfma_f32_16x16x32_bf16 v[212:215], v[152:155], v[44:47], 0
    v_exp_f32 v29, v57
    v_exp_f32 v30, v58
    v_mfma_f32_16x16x32_bf16 v[220:223], v[156:159], v[44:47], 0
    v_exp_f32 v31, v59
    v_mfma_f32_16x16x32_bf16 v[52:55], v[96:99], v[80:83], v[36:39]
    ds_read_b64_tr_b16 v[144:145], v8 offset:24576
    ds_read_b64_tr_b16 v[146:147], v8 offset:28672
    v_cvt_pk_bf16_f32 v40, v24, v25
    v_cvt_pk_bf16_f32 v41, v26, v27
    v_mfma_f32_16x16x32_bf16 v[52:55], v[100:103], v[84:87], v[52:55]
    ds_read_b64_tr_b16 v[148:149], v9 offset:24576
    ds_read_b64_tr_b16 v[150:151], v9 offset:28672
    v_cvt_pk_bf16_f32 v42, v28, v29
    v_cvt_pk_bf16_f32 v43, v30, v31
    v_mfma_f32_16x16x32_bf16 v[52:55], v[104:107], v[88:91], v[52:55]
    s_waitcnt lgkmcnt(8)
    ds_read_b64_tr_b16 v[152:153], v10 offset:24576
    ds_read_b64_tr_b16 v[154:155], v10 offset:28672
    v_add_f32 v24, v24, v25
    v_add_f32 v26, v26, v27
    v_mfma_f32_16x16x32_bf16 v[52:55], v[108:111], v[92:95], v[52:55]
    ds_read_b64_tr_b16 v[156:157], v11 offset:24576
    ds_read_b64_tr_b16 v[158:159], v11 offset:28672
    v_add_f32 v28, v28, v29
    v_add_f32 v30, v30, v31
    v_mfma_f32_16x16x32_bf16 v[60:63], v[112:115], v[80:83], v[36:39]
    v_add_f32 v24, v24, v26
    v_add_f32 v28, v28, v30
    v_mfma_f32_16x16x32_bf16 v[60:63], v[116:119], v[84:87], v[60:63]
    v_add_f32 v18, v24, v28
    v_mfma_f32_16x16x32_bf16 v[60:63], v[120:123], v[88:91], v[60:63]
    v_cmp_lt_f32 vcc, s65, v18
    s_cbranch_vccnz m_a2_c1_0_slow
m_a2_c1_0_back:
    v_add_f32 v16, v16, v18
    v_mfma_f32_16x16x32_bf16 v[60:63], v[124:127], v[92:95], v[60:63]
    v_mfma_f32_16x16x32_bf16 v[160:163], v[128:131], v[40:43], v[160:163]
    ds_read_b128 v[96:99], v0 offset:32768
    ds_read_b128 v[100:103], v1 offset:32768
    v_mfma_f32_16x16x32_bf16 v[168:171], v[132:135], v[40:43], v[168:171]
    s_waitcnt lgkmcnt(12)
    ds_read_b128 v[104:107], v2 offset:32768
    ds_read_b128 v[108:111], v3 offset:32768
    v_mfma_f32_16x16x32_bf16 v[176:179], v[136:139], v[40:43], v[176:179]
    s_waitcnt lgkmcnt(12)
    ds_read_b128 v[112:115], v0 offset:36864
    ds_read_b128 v[116:119], v1 offset:36864
    v_exp_f32 v24, v52
    v_mfma_f32_16x16x32_bf16 v[184:187], v[140:143], v[40:43], v[184:187]
    s_waitcnt lgkmcnt(12)
    ds_read_b128 v[120:123], v2 offset:36864
    ds_read_b128 v[124:127], v3 offset:36864
    v_exp_f32 v25, v53
    v_mfma_f32_16x16x32_bf16 v[192:195], v[144:147], v[40:43], v[192:195]
    s_waitcnt lgkmcnt(12)
    v_exp_f32 v26, v54
    v_exp_f32 v27, v55
    v_mfma_f32_16x16x32_bf16 v[200:203], v[148:151], v[40:43], v[200:203]
    s_waitcnt lgkmcnt(10)
    v_exp_f32 v28, v60
    v_mfma_f32_16x16x32_bf16 v[208:211], v[152:155], v[40:43], v[208:211]
    s_waitcnt lgkmcnt(8)
    v_exp_f32 v29, v61
    v_exp_f32 v30, v62
    v_mfma_f32_16x16x32_bf16 v[216:219], v[156:159], v[40:43], v[216:219]
    v_exp_f32 v31, v63
    s_waitcnt lgkmcnt(0)
    s_barrier
    v_mfma_f32_16x16x32_bf16 v[48:51], v[96:99], v[64:67], v[32:35]
    v_cvt_pk_bf16_f32 v44, v24, v25
    v_cvt_pk_bf16_f32 v45, v26, v27
    v_mfma_f32_16x16x32_bf16 v[48:51], v[100:103], v[68:71], v[48:51]
    v_cvt_pk_bf16_f32 v46, v28, v29
    v_cvt_pk_bf16_f32 v47, v30, v31
    v_mfma_f32_16x16x32_bf16 v[48:51], v[104:107], v[72:75], v[48:51]
    v_add_f32 v24, v24, v25
    v_add_f32 v26, v26, v27
    v_mfma_f32_16x16x32_bf16 v[48:51], v[108:111], v[76:79], v[48:51]
    v_add_f32 v28, v28, v29
    v_add_f32 v30, v30, v31
    v_mfma_f32_16x16x32_bf16 v[56:59], v[112:115], v[64:67], v[32:35]
    v_add_f32 v24, v24, v26
    v_add_f32 v28, v28, v30
    v_mfma_f32_16x16x32_bf16 v[56:59], v[116:119], v[68:71], v[56:59]
    v_add_f32 v19, v24, v28
    v_mfma_f32_16x16x32_bf16 v[56:59], v[120:123], v[72:75], v[56:59]
    v_cmp_lt_f32 vcc, s65, v19
    s_cbranch_vccnz m_a2_c1_1_slow
m_a2_c1_1_back:
    v_add_f32 v17, v17, v19
    v_mfma_f32_16x16x32_bf16 v[56:59], v[124:127], v[76:79], v[56:59]
    v_mfma_f32_16x16x32_bf16 v[164:167], v[128:131], v[44:47], v[164:167]
    ds_read_b64_tr_b16 v[128:129], v4 offset:40960
    ds_read_b64_tr_b16 v[130:131], v4 offset:45056
    v_mfma_f32_16x16x32_bf16 v[172:175], v[132:135], v[44:47], v[172:175]
    ds_read_b64_tr_b16 v[132:133], v5 offset:40960
    ds_read_b64_tr_b16 v[134:135], v5 offset:45056
    v_mfma_f32_16x16x32_bf16 v[180:183], v[136:139], v[44:47], v[180:183]
    ds_read_b64_tr_b16 v[136:137], v6 offset:40960
    ds_read_b64_tr_b16 v[138:139], v6 offset:45056
    v_exp_f32 v24, v48
    v_mfma_f32_16x16x32_bf16 v[188:191], v[140:143], v[44:47], v[188:191]
    ds_read_b64_tr_b16 v[140:141], v7 offset:40960
    ds_read_b64_tr_b16 v[142:143], v7 offset:45056
    v_exp_f32 v25, v49
    v_mfma_f32_16x16x32_bf16 v[196:199], v[144:147], v[44:47], v[196:199]
    v_exp_f32 v26, v50
    v_exp_f32 v27, v51
    v_mfma_f32_16x16x32_bf16 v[204:207], v[148:151], v[44:47], v[204:207]
    v_exp_f32 v28, v56
    v_mfma_f32_16x16x32_bf16 v[212:215], v[152:155], v[44:47], v[212:215]
    v_exp_f32 v29, v57
    v_exp_f32 v30, v58
    v_mfma_f32_16x16x32_bf16 v[220:223], v[156:159], v[44:47], v[220:223]
    v_exp_f32 v31, v59
    v_mfma_f32_16x16x32_bf16 v[52:55], v[96:99], v[80:83], v[36:39]
    ds_read_b64_tr_b16 v[144:145], v8 offset:40960
    ds_read_b64_tr_b16 v[146:147], v8 offset:45056
    v_cvt_pk_bf16_f32 v40, v24, v25
    v_cvt_pk_bf16_f32 v41, v26, v27
    v_mfma_f32_16x16x32_bf16 v[52:55], v[100:103], v[84:87], v[52:55]
    ds_read_b64_tr_b16 v[148:149], v9 offset:40960
    ds_read_b64_tr_b16 v[150:151], v9 offset:45056
    v_cvt_pk_bf16_f32 v42, v28, v29
    v_cvt_pk_bf16_f32 v43, v30, v31
    v_mfma_f32_16x16x32_bf16 v[52:55], v[104:107], v[88:91], v[52:55]
    s_waitcnt lgkmcnt(8)
    ds_read_b64_tr_b16 v[152:153], v10 offset:40960
    ds_read_b64_tr_b16 v[154:155], v10 offset:45056
    v_add_f32 v24, v24, v25
    v_add_f32 v26, v26, v27
    v_mfma_f32_16x16x32_bf16 v[52:55], v[108:111], v[92:95], v[52:55]
    ds_read_b64_tr_b16 v[156:157], v11 offset:40960
    ds_read_b64_tr_b16 v[158:159], v11 offset:45056
    v_add_f32 v28, v28, v29
    v_add_f32 v30, v30, v31
    v_mfma_f32_16x16x32_bf16 v[60:63], v[112:115], v[80:83], v[36:39]
    v_add_f32 v24, v24, v26
    v_add_f32 v28, v28, v30
    v_mfma_f32_16x16x32_bf16 v[60:63], v[116:119], v[84:87], v[60:63]
    v_add_f32 v18, v24, v28
    v_mfma_f32_16x16x32_bf16 v[60:63], v[120:123], v[88:91], v[60:63]
    v_cmp_lt_f32 vcc, s65, v18
    s_cbranch_vccnz m_a2_c2_0_slow
m_a2_c2_0_back:
    v_add_f32 v16, v16, v18
    v_mfma_f32_16x16x32_bf16 v[60:63], v[124:127], v[92:95], v[60:63]
    v_mfma_f32_16x16x32_bf16 v[160:163], v[128:131], v[40:43], v[160:163]
    ds_read_b128 v[96:99], v0 offset:49152
    ds_read_b128 v[100:103], v1 offset:49152
    v_mfma_f32_16x16x32_bf16 v[168:171], v[132:135], v[40:43], v[168:171]
    s_waitcnt lgkmcnt(12)
    ds_read_b128 v[104:107], v2 offset:49152
    ds_read_b128 v[108:111], v3 offset:49152
    v_mfma_f32_16x16x32_bf16 v[176:179], v[136:139], v[40:43], v[176:179]
    s_waitcnt lgkmcnt(12)
    ds_read_b128 v[112:115], v0 offset:53248
    ds_read_b128 v[116:119], v1 offset:53248
    v_exp_f32 v24, v52
    v_mfma_f32_16x16x32_bf16 v[184:187], v[140:143], v[40:43], v[184:187]
    s_waitcnt lgkmcnt(12)
    ds_read_b128 v[120:123], v2 offset:53248
    ds_read_b128 v[124:127], v3 offset:53248
    v_exp_f32 v25, v53
    v_mfma_f32_16x16x32_bf16 v[192:195], v[144:147], v[40:43], v[192:195]
    s_waitcnt lgkmcnt(12)
    v_exp_f32 v26, v54
    v_exp_f32 v27, v55
    v_mfma_f32_16x16x32_bf16 v[200:203], v[148:151], v[40:43], v[200:203]
    s_waitcnt lgkmcnt(10)
    v_exp_f32 v28, v60
    v_mfma_f32_16x16x32_bf16 v[208:211], v[152:155], v[40:43], v[208:211]
    s_waitcnt lgkmcnt(8)
    v_exp_f32 v29, v61
    v_exp_f32 v30, v62
    v_mfma_f32_16x16x32_bf16 v[216:219], v[156:159], v[40:43], v[216:219]
    v_exp_f32 v31, v63
    s_waitcnt lgkmcnt(0)
    s_barrier
    v_mfma_f32_16x16x32_bf16 v[48:51], v[96:99], v[64:67], v[32:35]
    v_cvt_pk_bf16_f32 v44, v24, v25
    v_cvt_pk_bf16_f32 v45, v26, v27
    v_mfma_f32_16x16x32_bf16 v[48:51], v[100:103], v[68:71], v[48:51]
    v_cvt_pk_bf16_f32 v46, v28, v29
    v_cvt_pk_bf16_f32 v47, v30, v31
    v_mfma_f32_16x16x32_bf16 v[48:51], v[104:107], v[72:75], v[48:51]
    v_add_f32 v24, v24, v25
    v_add_f32 v26, v26, v27
    v_mfma_f32_16x16x32_bf16 v[48:51], v[108:111], v[76:79], v[48:51]
    v_add_f32 v28, v28, v29
    v_add_f32 v30, v30, v31
    v_mfma_f32_16x16x32_bf16 v[56:59], v[112:115], v[64:67], v[32:35]
    v_add_f32 v24, v24, v26
    v_add_f32 v28, v28, v30
    v_mfma_f32_16x16x32_bf16 v[56:59], v[116:119], v[68:71], v[56:59]
    v_add_f32 v19, v24, v28
    v_mfma_f32_16x16x32_bf16 v[56:59], v[120:123], v[72:75], v[56:59]
    v_cmp_lt_f32 vcc, s65, v19
    s_cbranch_vccnz m_a2_c2_1_slow
m_a2_c2_1_back:
    v_add_f32 v17, v17, v19
    v_mfma_f32_16x16x32_bf16 v[56:59], v[124:127], v[76:79], v[56:59]
    v_mfma_f32_16x16x32_bf16 v[164:167], v[128:131], v[44:47], v[164:167]
    ds_read_b64_tr_b16 v[128:129], v4 offset:57344
    ds_read_b64_tr_b16 v[130:131], v4 offset:61440
    v_mfma_f32_16x16x32_bf16 v[172:175], v[132:135], v[44:47], v[172:175]
    ds_read_b64_tr_b16 v[132:133], v5 offset:57344
    ds_read_b64_tr_b16 v[134:135], v5 offset:61440
    v_mfma_f32_16x16x32_bf16 v[180:183], v[136:139], v[44:47], v[180:183]
    ds_read_b64_tr_b16 v[136:137], v6 offset:57344
    ds_read_b64_tr_b16 v[138:139], v6 offset:61440
    v_exp_f32 v24, v48
    v_mfma_f32_16x16x32_bf16 v[188:191], v[140:143], v[44:47], v[188:191]
    ds_read_b64_tr_b16 v[140:141], v7 offset:57344
    ds_read_b64_tr_b16 v[142:143], v7 offset:61440
    v_exp_f32 v25, v49
    v_mfma_f32_16x16x32_bf16 v[196:199], v[144:147], v[44:47], v[196:199]
    v_exp_f32 v26, v50
    v_exp_f32 v27, v51
    v_mfma_f32_16x16x32_bf16 v[204:207], v[148:151], v[44:47], v[204:207]
    v_exp_f32 v28, v56
    v_mfma_f32_16x16x32_bf16 v[212:215], v[152:155], v[44:47], v[212:215]
    v_exp_f32 v29, v57
    v_exp_f32 v30, v58
    v_mfma_f32_16x16x32_bf16 v[220:223], v[156:159], v[44:47], v[220:223]
    v_exp_f32 v31, v59
    v_mfma_f32_16x16x32_bf16 v[52:55], v[96:99], v[80:83], v[36:39]
    ds_read_b64_tr_b16 v[144:145], v8 offset:57344
    ds_read_b64_tr_b16 v[146:147], v8 offset:61440
    v_cvt_pk_bf16_f32 v40, v24, v25
    v_cvt_pk_bf16_f32 v41, v26, v27
    v_mfma_f32_16x16x32_bf16 v[52:55], v[100:103], v[84:87], v[52:55]
    ds_read_b64_tr_b16 v[148:149], v9 offset:57344
    ds_read_b64_tr_b16 v[150:151], v9 offset:61440
    v_cvt_pk_bf16_f32 v42, v28, v29
    v_cvt_pk_bf16_f32 v43, v30, v31
    v_mfma_f32_16x16x32_bf16 v[52:55], v[104:107], v[88:91], v[52:55]
    s_waitcnt lgkmcnt(8)
    ds_read_b64_tr_b16 v[152:153], v10 offset:57344
    ds_read_b64_tr_b16 v[154:155], v10 offset:61440
    v_add_f32 v24, v24, v25
    v_add_f32 v26, v26, v27
    v_mfma_f32_16x16x32_bf16 v[52:55], v[108:111], v[92:95], v[52:55]
    ds_read_b64_tr_b16 v[156:157], v11 offset:57344
    ds_read_b64_tr_b16 v[158:159], v11 offset:61440
    v_add_f32 v28, v28, v29
    v_add_f32 v30, v30, v31
    v_mfma_f32_16x16x32_bf16 v[60:63], v[112:115], v[80:83], v[36:39]
    v_add_f32 v24, v24, v26
    v_add_f32 v28, v28, v30
    v_mfma_f32_16x16x32_bf16 v[60:63], v[116:119], v[84:87], v[60:63]
    v_add_f32 v18, v24, v28
    v_mfma_f32_16x16x32_bf16 v[60:63], v[120:123], v[88:91], v[60:63]
    v_cmp_lt_f32 vcc, s65, v18
    s_cbranch_vccnz m_a2_c3_0_slow
m_a2_c3_0_back:
    v_add_f32 v16, v16, v18
    v_mfma_f32_16x16x32_bf16 v[60:63], v[124:127], v[92:95], v[60:63]
    v_mfma_f32_16x16x32_bf16 v[160:163], v[128:131], v[40:43], v[160:163]
    ds_read_b128 v[96:99], v0 offset:0
    ds_read_b128 v[100:103], v1 offset:0
    v_mfma_f32_16x16x32_bf16 v[168:171], v[132:135], v[40:43], v[168:171]
    s_waitcnt lgkmcnt(12)
    ds_read_b128 v[104:107], v2 offset:0
    ds_read_b128 v[108:111], v3 offset:0
    v_mfma_f32_16x16x32_bf16 v[176:179], v[136:139], v[40:43], v[176:179]
    s_waitcnt lgkmcnt(12)
    ds_read_b128 v[112:115], v0 offset:4096
    ds_read_b128 v[116:119], v1 offset:4096
    v_exp_f32 v24, v52
    v_mfma_f32_16x16x32_bf16 v[184:187], v[140:143], v[40:43], v[184:187]
    s_waitcnt lgkmcnt(12)
    ds_read_b128 v[120:123], v2 offset:4096
    ds_read_b128 v[124:127], v3 offset:4096
    v_exp_f32 v25, v53
    v_mfma_f32_16x16x32_bf16 v[192:195], v[144:147], v[40:43], v[192:195]
    s_waitcnt lgkmcnt(12)
    v_exp_f32 v26, v54
    v_exp_f32 v27, v55
    v_mfma_f32_16x16x32_bf16 v[200:203], v[148:151], v[40:43], v[200:203]
    s_waitcnt lgkmcnt(10)
    v_exp_f32 v28, v60
    v_mfma_f32_16x16x32_bf16 v[208:211], v[152:155], v[40:43], v[208:211]
    s_waitcnt lgkmcnt(8)
    v_exp_f32 v29, v61
    v_exp_f32 v30, v62
    v_mfma_f32_16x16x32_bf16 v[216:219], v[156:159], v[40:43], v[216:219]
    v_exp_f32 v31, v63
    s_waitcnt lgkmcnt(0)
    s_barrier
    v_mfma_f32_16x16x32_bf16 v[48:51], v[96:99], v[64:67], v[32:35]
    v_cvt_pk_bf16_f32 v44, v24, v25
    v_cvt_pk_bf16_f32 v45, v26, v27
    v_mfma_f32_16x16x32_bf16 v[48:51], v[100:103], v[68:71], v[48:51]
    v_cvt_pk_bf16_f32 v46, v28, v29
    v_cvt_pk_bf16_f32 v47, v30, v31
    v_mfma_f32_16x16x32_bf16 v[48:51], v[104:107], v[72:75], v[48:51]
    v_add_f32 v24, v24, v25
    v_add_f32 v26, v26, v27
    v_mfma_f32_16x16x32_bf16 v[48:51], v[108:111], v[76:79], v[48:51]
    v_add_f32 v28, v28, v29
    v_add_f32 v30, v30, v31
    v_mfma_f32_16x16x32_bf16 v[56:59], v[112:115], v[64:67], v[32:35]
    v_add_f32 v24, v24, v26
    v_add_f32 v28, v28, v30
    v_mfma_f32_16x16x32_bf16 v[56:59], v[116:119], v[68:71], v[56:59]
    v_add_f32 v19, v24, v28
    v_mfma_f32_16x16x32_bf16 v[56:59], v[120:123], v[72:75], v[56:59]
    v_cmp_lt_f32 vcc, s65, v19
    s_cbranch_vccnz m_a2_c3_1_slow
m_a2_c3_1_back:
    v_add_f32 v17, v17, v19
    v_mfma_f32_16x16x32_bf16 v[56:59], v[124:127], v[76:79], v[56:59]
    v_mfma_f32_16x16x32_bf16 v[164:167], v[128:131], v[44:47], v[164:167]
    ds_read_b64_tr_b16 v[128:129], v4 offset:8192
    ds_read_b64_tr_b16 v[130:131], v4 offset:12288
    v_mfma_f32_16x16x32_bf16 v[172:175], v[132:135], v[44:47], v[172:175]
    ds_read_b64_tr_b16 v[132:133], v5 offset:8192
    ds_read_b64_tr_b16 v[134:135], v5 offset:12288
    v_mfma_f32_16x16x32_bf16 v[180:183], v[136:139], v[44:47], v[180:183]
    ds_read_b64_tr_b16 v[136:137], v6 offset:8192
    ds_read_b64_tr_b16 v[138:139], v6 offset:12288
    v_exp_f32 v24, v48
    v_mfma_f32_16x16x32_bf16 v[188:191], v[140:143], v[44:47], v[188:191]
    ds_read_b64_tr_b16 v[140:141], v7 offset:8192
    ds_read_b64_tr_b16 v[142:143], v7 offset:12288
    v_exp_f32 v25, v49
    v_mfma_f32_16x16x32_bf16 v[196:199], v[144:147], v[44:47], v[196:199]
    v_exp_f32 v26, v50
    v_exp_f32 v27, v51
    v_mfma_f32_16x16x32_bf16 v[204:207], v[148:151], v[44:47], v[204:207]
    v_exp_f32 v28, v56
    v_mfma_f32_16x16x32_bf16 v[212:215], v[152:155], v[44:47], v[212:215]
    v_exp_f32 v29, v57
    v_exp_f32 v30, v58
    v_mfma_f32_16x16x32_bf16 v[220:223], v[156:159], v[44:47], v[220:223]
    v_exp_f32 v31, v59
    v_mfma_f32_16x16x32_bf16 v[52:55], v[96:99], v[80:83], v[36:39]
    ds_read_b64_tr_b16 v[144:145], v8 offset:8192
    ds_read_b64_tr_b16 v[146:147], v8 offset:12288
    v_cvt_pk_bf16_f32 v40, v24, v25
    v_cvt_pk_bf16_f32 v41, v26, v27
    v_mfma_f32_16x16x32_bf16 v[52:55], v[100:103], v[84:87], v[52:55]
    ds_read_b64_tr_b16 v[148:149], v9 offset:8192
    ds_read_b64_tr_b16 v[150:151], v9 offset:12288
    v_cvt_pk_bf16_f32 v42, v28, v29
    v_cvt_pk_bf16_f32 v43, v30, v31
    v_mfma_f32_16x16x32_bf16 v[52:55], v[104:107], v[88:91], v[52:55]
    s_waitcnt lgkmcnt(8)
    ds_read_b64_tr_b16 v[152:153], v10 offset:8192
    ds_read_b64_tr_b16 v[154:155], v10 offset:12288
    v_add_f32 v24, v24, v25
    v_add_f32 v26, v26, v27
    v_mfma_f32_16x16x32_bf16 v[52:55], v[108:111], v[92:95], v[52:55]
    ds_read_b64_tr_b16 v[156:157], v11 offset:8192
    ds_read_b64_tr_b16 v[158:159], v11 offset:12288
    v_add_f32 v28, v28, v29
    v_add_f32 v30, v30, v31
    v_mfma_f32_16x16x32_bf16 v[60:63], v[112:115], v[80:83], v[36:39]
    v_add_f32 v24, v24, v26
    v_add_f32 v28, v28, v30
    v_mfma_f32_16x16x32_bf16 v[60:63], v[116:119], v[84:87], v[60:63]
    v_add_f32 v18, v24, v28
    v_mfma_f32_16x16x32_bf16 v[60:63], v[120:123], v[88:91], v[60:63]
    v_cmp_lt_f32 vcc, s65, v18
    s_cbranch_vccnz m_a2_c4_0_slow
m_a2_c4_0_back:
    v_add_f32 v16, v16, v18
    v_mfma_f32_16x16x32_bf16 v[60:63], v[124:127], v[92:95], v[60:63]
    v_mfma_f32_16x16x32_bf16 v[160:163], v[128:131], v[40:43], v[160:163]
    ds_read_b128 v[96:99], v0 offset:16384
    ds_read_b128 v[100:103], v1 offset:16384
    v_mfma_f32_16x16x32_bf16 v[168:171], v[132:135], v[40:43], v[168:171]
    s_waitcnt lgkmcnt(12)
    ds_read_b128 v[104:107], v2 offset:16384
    ds_read_b128 v[108:111], v3 offset:16384
    v_mfma_f32_16x16x32_bf16 v[176:179], v[136:139], v[40:43], v[176:179]
    s_waitcnt lgkmcnt(12)
    ds_read_b128 v[112:115], v0 offset:20480
    ds_read_b128 v[116:119], v1 offset:20480
    v_exp_f32 v24, v52
    v_mfma_f32_16x16x32_bf16 v[184:187], v[140:143], v[40:43], v[184:187]
    s_waitcnt lgkmcnt(12)
    ds_read_b128 v[120:123], v2 offset:20480
    ds_read_b128 v[124:127], v3 offset:20480
    v_exp_f32 v25, v53
    v_mfma_f32_16x16x32_bf16 v[192:195], v[144:147], v[40:43], v[192:195]
    s_waitcnt lgkmcnt(12)
    v_exp_f32 v26, v54
    v_exp_f32 v27, v55
    v_mfma_f32_16x16x32_bf16 v[200:203], v[148:151], v[40:43], v[200:203]
    s_waitcnt lgkmcnt(10)
    v_exp_f32 v28, v60
    v_mfma_f32_16x16x32_bf16 v[208:211], v[152:155], v[40:43], v[208:211]
    s_waitcnt lgkmcnt(8)
    v_exp_f32 v29, v61
    v_exp_f32 v30, v62
    v_mfma_f32_16x16x32_bf16 v[216:219], v[156:159], v[40:43], v[216:219]
    v_exp_f32 v31, v63
    s_waitcnt lgkmcnt(0)
    s_barrier
    v_mfma_f32_16x16x32_bf16 v[48:51], v[96:99], v[64:67], v[32:35]
    v_cvt_pk_bf16_f32 v44, v24, v25
    v_cvt_pk_bf16_f32 v45, v26, v27
    v_mfma_f32_16x16x32_bf16 v[48:51], v[100:103], v[68:71], v[48:51]
    v_cvt_pk_bf16_f32 v46, v28, v29
    v_cvt_pk_bf16_f32 v47, v30, v31
    v_mfma_f32_16x16x32_bf16 v[48:51], v[104:107], v[72:75], v[48:51]
    v_add_f32 v24, v24, v25
    v_add_f32 v26, v26, v27
    v_mfma_f32_16x16x32_bf16 v[48:51], v[108:111], v[76:79], v[48:51]
    v_add_f32 v28, v28, v29
    v_add_f32 v30, v30, v31
    v_mfma_f32_16x16x32_bf16 v[56:59], v[112:115], v[64:67], v[32:35]
    v_add_f32 v24, v24, v26
    v_add_f32 v28, v28, v30
    v_mfma_f32_16x16x32_bf16 v[56:59], v[116:119], v[68:71], v[56:59]
    v_add_f32 v19, v24, v28
    v_mfma_f32_16x16x32_bf16 v[56:59], v[120:123], v[72:75], v[56:59]
    v_cmp_lt_f32 vcc, s65, v19
    s_cbranch_vccnz m_a2_c4_1_slow
m_a2_c4_1_back:
    v_add_f32 v17, v17, v19
    v_mfma_f32_16x16x32_bf16 v[56:59], v[124:127], v[76:79], v[56:59]
    v_mfma_f32_16x16x32_bf16 v[164:167], v[128:131], v[44:47], v[164:167]
    ds_read_b64_tr_b16 v[128:129], v4 offset:24576
    ds_read_b64_tr_b16 v[130:131], v4 offset:28672
    v_mfma_f32_16x16x32_bf16 v[172:175], v[132:135], v[44:47], v[172:175]
    ds_read_b64_tr_b16 v[132:133], v5 offset:24576
    ds_read_b64_tr_b16 v[134:135], v5 offset:28672
    v_mfma_f32_16x16x32_bf16 v[180:183], v[136:139], v[44:47], v[180:183]
    ds_read_b64_tr_b16 v[136:137], v6 offset:24576
    ds_read_b64_tr_b16 v[138:139], v6 offset:28672
    v_exp_f32 v24, v48
    v_mfma_f32_16x16x32_bf16 v[188:191], v[140:143], v[44:47], v[188:191]
    ds_read_b64_tr_b16 v[140:141], v7 offset:24576
    ds_read_b64_tr_b16 v[142:143], v7 offset:28672
    v_exp_f32 v25, v49
    v_mfma_f32_16x16x32_bf16 v[196:199], v[144:147], v[44:47], v[196:199]
    v_exp_f32 v26, v50
    v_exp_f32 v27, v51
    v_mfma_f32_16x16x32_bf16 v[204:207], v[148:151], v[44:47], v[204:207]
    v_exp_f32 v28, v56
    v_mfma_f32_16x16x32_bf16 v[212:215], v[152:155], v[44:47], v[212:215]
    v_exp_f32 v29, v57
    v_exp_f32 v30, v58
    v_mfma_f32_16x16x32_bf16 v[220:223], v[156:159], v[44:47], v[220:223]
    v_exp_f32 v31, v59
    v_mfma_f32_16x16x32_bf16 v[52:55], v[96:99], v[80:83], v[36:39]
    ds_read_b64_tr_b16 v[144:145], v8 offset:24576
    ds_read_b64_tr_b16 v[146:147], v8 offset:28672
    v_cvt_pk_bf16_f32 v40, v24, v25
    v_cvt_pk_bf16_f32 v41, v26, v27
    v_mfma_f32_16x16x32_bf16 v[52:55], v[100:103], v[84:87], v[52:55]
    ds_read_b64_tr_b16 v[148:149], v9 offset:24576
    ds_read_b64_tr_b16 v[150:151], v9 offset:28672
    v_cvt_pk_bf16_f32 v42, v28, v29
    v_cvt_pk_bf16_f32 v43, v30, v31
    v_mfma_f32_16x16x32_bf16 v[52:55], v[104:107], v[88:91], v[52:55]
    s_waitcnt lgkmcnt(8)
    ds_read_b64_tr_b16 v[152:153], v10 offset:24576
    ds_read_b64_tr_b16 v[154:155], v10 offset:28672
    v_add_f32 v24, v24, v25
    v_add_f32 v26, v26, v27
    v_mfma_f32_16x16x32_bf16 v[52:55], v[108:111], v[92:95], v[52:55]
    ds_read_b64_tr_b16 v[156:157], v11 offset:24576
    ds_read_b64_tr_b16 v[158:159], v11 offset:28672
    v_add_f32 v28, v28, v29
    v_add_f32 v30, v30, v31
    v_mfma_f32_16x16x32_bf16 v[60:63], v[112:115], v[80:83], v[36:39]
    v_add_f32 v24, v24, v26
    v_add_f32 v28, v28, v30
    v_mfma_f32_16x16x32_bf16 v[60:63], v[116:119], v[84:87], v[60:63]
    v_add_f32 v18, v24, v28
    v_mfma_f32_16x16x32_bf16 v[60:63], v[120:123], v[88:91], v[60:63]
    v_cmp_lt_f32 vcc, s65, v18
    s_cbranch_vccnz m_a2_c5_0_slow
m_a2_c5_0_back:
    v_add_f32 v16, v16, v18
    v_mfma_f32_16x16x32_bf16 v[60:63], v[124:127], v[92:95], v[60:63]
    v_mfma_f32_16x16x32_bf16 v[160:163], v[128:131], v[40:43], v[160:163]
    ds_read_b128 v[96:99], v0 offset:32768
    ds_read_b128 v[100:103], v1 offset:32768
    v_mfma_f32_16x16x32_bf16 v[168:171], v[132:135], v[40:43], v[168:171]
    s_waitcnt lgkmcnt(12)
    ds_read_b128 v[104:107], v2 offset:32768
    ds_read_b128 v[108:111], v3 offset:32768
    v_mfma_f32_16x16x32_bf16 v[176:179], v[136:139], v[40:43], v[176:179]
    s_waitcnt lgkmcnt(12)
    ds_read_b128 v[112:115], v0 offset:36864
    ds_read_b128 v[116:119], v1 offset:36864
    v_exp_f32 v24, v52
    v_mfma_f32_16x16x32_bf16 v[184:187], v[140:143], v[40:43], v[184:187]
    s_waitcnt lgkmcnt(12)
    ds_read_b128 v[120:123], v2 offset:36864
    ds_read_b128 v[124:127], v3 offset:36864
    v_exp_f32 v25, v53
    v_mfma_f32_16x16x32_bf16 v[192:195], v[144:147], v[40:43], v[192:195]
    s_waitcnt lgkmcnt(12)
    v_exp_f32 v26, v54
    v_exp_f32 v27, v55
    v_mfma_f32_16x16x32_bf16 v[200:203], v[148:151], v[40:43], v[200:203]
    s_waitcnt lgkmcnt(10)
    v_exp_f32 v28, v60
    v_mfma_f32_16x16x32_bf16 v[208:211], v[152:155], v[40:43], v[208:211]
    s_waitcnt lgkmcnt(8)
    v_exp_f32 v29, v61
    v_exp_f32 v30, v62
    v_mfma_f32_16x16x32_bf16 v[216:219], v[156:159], v[40:43], v[216:219]
    v_exp_f32 v31, v63
    s_waitcnt lgkmcnt(0)
    s_barrier
    v_mfma_f32_16x16x32_bf16 v[48:51], v[96:99], v[64:67], v[32:35]
    v_cvt_pk_bf16_f32 v44, v24, v25
    v_cvt_pk_bf16_f32 v45, v26, v27
    v_mfma_f32_16x16x32_bf16 v[48:51], v[100:103], v[68:71], v[48:51]
    v_cvt_pk_bf16_f32 v46, v28, v29
    v_cvt_pk_bf16_f32 v47, v30, v31
    v_mfma_f32_16x16x32_bf16 v[48:51], v[104:107], v[72:75], v[48:51]
    v_add_f32 v24, v24, v25
    v_add_f32 v26, v26, v27
    v_mfma_f32_16x16x32_bf16 v[48:51], v[108:111], v[76:79], v[48:51]
    v_add_f32 v28, v28, v29
    v_add_f32 v30, v30, v31
    v_mfma_f32_16x16x32_bf16 v[56:59], v[112:115], v[64:67], v[32:35]
    v_add_f32 v24, v24, v26
    v_add_f32 v28, v28, v30
    v_mfma_f32_16x16x32_bf16 v[56:59], v[116:119], v[68:71], v[56:59]
    v_add_f32 v19, v24, v28
    v_mfma_f32_16x16x32_bf16 v[56:59], v[120:123], v[72:75], v[56:59]
    v_cmp_lt_f32 vcc, s65, v19
    s_cbranch_vccnz m_a2_c5_1_slow
m_a2_c5_1_back:
    v_add_f32 v17, v17, v19
    v_mfma_f32_16x16x32_bf16 v[56:59], v[124:127], v[76:79], v[56:59]
    v_mfma_f32_16x16x32_bf16 v[164:167], v[128:131], v[44:47], v[164:167]
    ds_read_b64_tr_b16 v[128:129], v4 offset:40960
    ds_read_b64_tr_b16 v[130:131], v4 offset:45056
    v_mfma_f32_16x16x32_bf16 v[172:175], v[132:135], v[44:47], v[172:175]
    ds_read_b64_tr_b16 v[132:133], v5 offset:40960
    ds_read_b64_tr_b16 v[134:135], v5 offset:45056
    v_mfma_f32_16x16x32_bf16 v[180:183], v[136:139], v[44:47], v[180:183]
    ds_read_b64_tr_b16 v[136:137], v6 offset:40960
    ds_read_b64_tr_b16 v[138:139], v6 offset:45056
    v_exp_f32 v24, v48
    v_mfma_f32_16x16x32_bf16 v[188:191], v[140:143], v[44:47], v[188:191]
    ds_read_b64_tr_b16 v[140:141], v7 offset:40960
    ds_read_b64_tr_b16 v[142:143], v7 offset:45056
    v_exp_f32 v25, v49
    v_mfma_f32_16x16x32_bf16 v[196:199], v[144:147], v[44:47], v[196:199]
    v_exp_f32 v26, v50
    v_exp_f32 v27, v51
    v_mfma_f32_16x16x32_bf16 v[204:207], v[148:151], v[44:47], v[204:207]
    v_exp_f32 v28, v56
    v_mfma_f32_16x16x32_bf16 v[212:215], v[152:155], v[44:47], v[212:215]
    v_exp_f32 v29, v57
    v_exp_f32 v30, v58
    v_mfma_f32_16x16x32_bf16 v[220:223], v[156:159], v[44:47], v[220:223]
    v_exp_f32 v31, v59
    v_mfma_f32_16x16x32_bf16 v[52:55], v[96:99], v[80:83], v[36:39]
    ds_read_b64_tr_b16 v[144:145], v8 offset:40960
    ds_read_b64_tr_b16 v[146:147], v8 offset:45056
    v_cvt_pk_bf16_f32 v40, v24, v25
    v_cvt_pk_bf16_f32 v41, v26, v27
    v_mfma_f32_16x16x32_bf16 v[52:55], v[100:103], v[84:87], v[52:55]
    ds_read_b64_tr_b16 v[148:149], v9 offset:40960
    ds_read_b64_tr_b16 v[150:151], v9 offset:45056
    v_cvt_pk_bf16_f32 v42, v28, v29
    v_cvt_pk_bf16_f32 v43, v30, v31
    v_mfma_f32_16x16x32_bf16 v[52:55], v[104:107], v[88:91], v[52:55]
    s_waitcnt lgkmcnt(8)
    ds_read_b64_tr_b16 v[152:153], v10 offset:40960
    ds_read_b64_tr_b16 v[154:155], v10 offset:45056
    v_add_f32 v24, v24, v25
    v_add_f32 v26, v26, v27
    v_mfma_f32_16x16x32_bf16 v[52:55], v[108:111], v[92:95], v[52:55]
    ds_read_b64_tr_b16 v[156:157], v11 offset:40960
    ds_read_b64_tr_b16 v[158:159], v11 offset:45056
    v_add_f32 v28, v28, v29
    v_add_f32 v30, v30, v31
    v_mfma_f32_16x16x32_bf16 v[60:63], v[112:115], v[80:83], v[36:39]
    v_add_f32 v24, v24, v26
    v_add_f32 v28, v28, v30
    v_mfma_f32_16x16x32_bf16 v[60:63], v[116:119], v[84:87], v[60:63]
    v_add_f32 v18, v24, v28
    v_mfma_f32_16x16x32_bf16 v[60:63], v[120:123], v[88:91], v[60:63]
    v_cmp_lt_f32 vcc, s65, v18
    s_cbranch_vccnz m_a2_c6_0_slow
m_a2_c6_0_back:
    v_add_f32 v16, v16, v18
    v_mfma_f32_16x16x32_bf16 v[60:63], v[124:127], v[92:95], v[60:63]
    v_mfma_f32_16x16x32_bf16 v[160:163], v[128:131], v[40:43], v[160:163]
    ds_read_b128 v[96:99], v0 offset:49152
    ds_read_b128 v[100:103], v1 offset:49152
    v_mfma_f32_16x16x32_bf16 v[168:171], v[132:135], v[40:43], v[168:171]
    s_waitcnt lgkmcnt(12)
    ds_read_b128 v[104:107], v2 offset:49152
    ds_read_b128 v[108:111], v3 offset:49152
    v_mfma_f32_16x16x32_bf16 v[176:179], v[136:139], v[40:43], v[176:179]
    s_waitcnt lgkmcnt(12)
    ds_read_b128 v[112:115], v0 offset:53248
    ds_read_b128 v[116:119], v1 offset:53248
    v_exp_f32 v24, v52
    v_mfma_f32_16x16x32_bf16 v[184:187], v[140:143], v[40:43], v[184:187]
    s_waitcnt lgkmcnt(12)
    ds_read_b128 v[120:123], v2 offset:53248
    ds_read_b128 v[124:127], v3 offset:53248
    v_exp_f32 v25, v53
    v_mfma_f32_16x16x32_bf16 v[192:195], v[144:147], v[40:43], v[192:195]
    s_waitcnt lgkmcnt(12)
    v_exp_f32 v26, v54
    v_exp_f32 v27, v55
    v_mfma_f32_16x16x32_bf16 v[200:203], v[148:151], v[40:43], v[200:203]
    s_waitcnt lgkmcnt(10)
    v_exp_f32 v28, v60
    v_mfma_f32_16x16x32_bf16 v[208:211], v[152:155], v[40:43], v[208:211]
    s_waitcnt lgkmcnt(8)
    v_exp_f32 v29, v61
    v_exp_f32 v30, v62
    v_mfma_f32_16x16x32_bf16 v[216:219], v[156:159], v[40:43], v[216:219]
    v_exp_f32 v31, v63
    s_waitcnt lgkmcnt(0)
    s_barrier
    v_mfma_f32_16x16x32_bf16 v[48:51], v[96:99], v[64:67], v[32:35]
    v_cvt_pk_bf16_f32 v44, v24, v25
    v_cvt_pk_bf16_f32 v45, v26, v27
    v_mfma_f32_16x16x32_bf16 v[48:51], v[100:103], v[68:71], v[48:51]
    v_cvt_pk_bf16_f32 v46, v28, v29
    v_cvt_pk_bf16_f32 v47, v30, v31
    v_mfma_f32_16x16x32_bf16 v[48:51], v[104:107], v[72:75], v[48:51]
    v_add_f32 v24, v24, v25
    v_add_f32 v26, v26, v27
    v_mfma_f32_16x16x32_bf16 v[48:51], v[108:111], v[76:79], v[48:51]
    v_add_f32 v28, v28, v29
    v_add_f32 v30, v30, v31
    v_mfma_f32_16x16x32_bf16 v[56:59], v[112:115], v[64:67], v[32:35]
    v_add_f32 v24, v24, v26
    v_add_f32 v28, v28, v30
    v_mfma_f32_16x16x32_bf16 v[56:59], v[116:119], v[68:71], v[56:59]
    v_add_f32 v19, v24, v28
    v_mfma_f32_16x16x32_bf16 v[56:59], v[120:123], v[72:75], v[56:59]
    v_cmp_lt_f32 vcc, s65, v19
    s_cbranch_vccnz m_a2_c6_1_slow
m_a2_c6_1_back:
    v_add_f32 v17, v17, v19
    v_mfma_f32_16x16x32_bf16 v[56:59], v[124:127], v[76:79], v[56:59]
    v_mfma_f32_16x16x32_bf16 v[164:167], v[128:131], v[44:47], v[164:167]
    ds_read_b64_tr_b16 v[128:129], v4 offset:57344
    ds_read_b64_tr_b16 v[130:131], v4 offset:61440
    v_mfma_f32_16x16x32_bf16 v[172:175], v[132:135], v[44:47], v[172:175]
    ds_read_b64_tr_b16 v[132:133], v5 offset:57344
    ds_read_b64_tr_b16 v[134:135], v5 offset:61440
    v_mfma_f32_16x16x32_bf16 v[180:183], v[136:139], v[44:47], v[180:183]
    ds_read_b64_tr_b16 v[136:137], v6 offset:57344
    ds_read_b64_tr_b16 v[138:139], v6 offset:61440
    v_exp_f32 v24, v48
    v_mfma_f32_16x16x32_bf16 v[188:191], v[140:143], v[44:47], v[188:191]
    ds_read_b64_tr_b16 v[140:141], v7 offset:57344
    ds_read_b64_tr_b16 v[142:143], v7 offset:61440
    v_exp_f32 v25, v49
    v_mfma_f32_16x16x32_bf16 v[196:199], v[144:147], v[44:47], v[196:199]
    v_exp_f32 v26, v50
    v_exp_f32 v27, v51
    v_mfma_f32_16x16x32_bf16 v[204:207], v[148:151], v[44:47], v[204:207]
    v_exp_f32 v28, v56
    v_mfma_f32_16x16x32_bf16 v[212:215], v[152:155], v[44:47], v[212:215]
    v_exp_f32 v29, v57
    v_exp_f32 v30, v58
    v_mfma_f32_16x16x32_bf16 v[220:223], v[156:159], v[44:47], v[220:223]
    v_exp_f32 v31, v59
    v_mfma_f32_16x16x32_bf16 v[52:55], v[96:99], v[80:83], v[36:39]
    ds_read_b64_tr_b16 v[144:145], v8 offset:57344
    ds_read_b64_tr_b16 v[146:147], v8 offset:61440
    v_cvt_pk_bf16_f32 v40, v24, v25
    v_cvt_pk_bf16_f32 v41, v26, v27
    v_mfma_f32_16x16x32_bf16 v[52:55], v[100:103], v[84:87], v[52:55]
    ds_read_b64_tr_b16 v[148:149], v9 offset:57344
    ds_read_b64_tr_b16 v[150:151], v9 offset:61440
    v_cvt_pk_bf16_f32 v42, v28, v29
    v_cvt_pk_bf16_f32 v43, v30, v31
    v_mfma_f32_16x16x32_bf16 v[52:55], v[104:107], v[88:91], v[52:55]
    s_waitcnt lgkmcnt(8)
    ds_read_b64_tr_b16 v[152:153], v10 offset:57344
    ds_read_b64_tr_b16 v[154:155], v10 offset:61440
    v_add_f32 v24, v24, v25
    v_add_f32 v26, v26, v27
    v_mfma_f32_16x16x32_bf16 v[52:55], v[108:111], v[92:95], v[52:55]
    ds_read_b64_tr_b16 v[156:157], v11 offset:57344
    ds_read_b64_tr_b16 v[158:159], v11 offset:61440
    v_add_f32 v28, v28, v29
    v_add_f32 v30, v30, v31
    v_mfma_f32_16x16x32_bf16 v[60:63], v[112:115], v[80:83], v[36:39]
    v_add_f32 v24, v24, v26
    v_add_f32 v28, v28, v30
    v_mfma_f32_16x16x32_bf16 v[60:63], v[116:119], v[84:87], v[60:63]
    v_add_f32 v18, v24, v28
    v_mfma_f32_16x16x32_bf16 v[60:63], v[120:123], v[88:91], v[60:63]
    v_cmp_lt_f32 vcc, s65, v18
    s_cbranch_vccnz m_a2_c7_0_slow
m_a2_c7_0_back:
    v_add_f32 v16, v16, v18
    v_mfma_f32_16x16x32_bf16 v[60:63], v[124:127], v[92:95], v[60:63]
    v_mfma_f32_16x16x32_bf16 v[160:163], v[128:131], v[40:43], v[160:163]
    ds_read_b128 v[96:99], v0 offset:0
    ds_read_b128 v[100:103], v1 offset:0
    v_mfma_f32_16x16x32_bf16 v[168:171], v[132:135], v[40:43], v[168:171]
    s_waitcnt lgkmcnt(12)
    ds_read_b128 v[104:107], v2 offset:0
    ds_read_b128 v[108:111], v3 offset:0
    v_mfma_f32_16x16x32_bf16 v[176:179], v[136:139], v[40:43], v[176:179]
    s_waitcnt lgkmcnt(12)
    ds_read_b128 v[112:115], v0 offset:4096
    ds_read_b128 v[116:119], v1 offset:4096
    v_exp_f32 v24, v52
    v_mfma_f32_16x16x32_bf16 v[184:187], v[140:143], v[40:43], v[184:187]
    s_waitcnt lgkmcnt(12)
    ds_read_b128 v[120:123], v2 offset:4096
    ds_read_b128 v[124:127], v3 offset:4096
    v_exp_f32 v25, v53
    v_mfma_f32_16x16x32_bf16 v[192:195], v[144:147], v[40:43], v[192:195]
    s_waitcnt lgkmcnt(12)
    v_exp_f32 v26, v54
    v_exp_f32 v27, v55
    v_mfma_f32_16x16x32_bf16 v[200:203], v[148:151], v[40:43], v[200:203]
    s_waitcnt lgkmcnt(10)
    v_exp_f32 v28, v60
    v_mfma_f32_16x16x32_bf16 v[208:211], v[152:155], v[40:43], v[208:211]
    s_waitcnt lgkmcnt(8)
    v_exp_f32 v29, v61
    v_exp_f32 v30, v62
    v_mfma_f32_16x16x32_bf16 v[216:219], v[156:159], v[40:43], v[216:219]
    v_exp_f32 v31, v63
    s_waitcnt lgkmcnt(0)
    s_barrier
    v_mfma_f32_16x16x32_bf16 v[48:51], v[96:99], v[64:67], v[32:35]
    v_cvt_pk_bf16_f32 v44, v24, v25
    v_cvt_pk_bf16_f32 v45, v26, v27
    v_mfma_f32_16x16x32_bf16 v[48:51], v[100:103], v[68:71], v[48:51]
    v_cvt_pk_bf16_f32 v46, v28, v29
    v_cvt_pk_bf16_f32 v47, v30, v31
    v_mfma_f32_16x16x32_bf16 v[48:51], v[104:107], v[72:75], v[48:51]
    v_add_f32 v24, v24, v25
    v_add_f32 v26, v26, v27
    v_mfma_f32_16x16x32_bf16 v[48:51], v[108:111], v[76:79], v[48:51]
    v_add_f32 v28, v28, v29
    v_add_f32 v30, v30, v31
    v_mfma_f32_16x16x32_bf16 v[56:59], v[112:115], v[64:67], v[32:35]
    v_add_f32 v24, v24, v26
    v_add_f32 v28, v28, v30
    v_mfma_f32_16x16x32_bf16 v[56:59], v[116:119], v[68:71], v[56:59]
    v_add_f32 v19, v24, v28
    v_mfma_f32_16x16x32_bf16 v[56:59], v[120:123], v[72:75], v[56:59]
    v_cmp_lt_f32 vcc, s65, v19
    s_cbranch_vccnz m_a2_c7_1_slow
m_a2_c7_1_back:
    v_add_f32 v17, v17, v19
    v_mfma_f32_16x16x32_bf16 v[56:59], v[124:127], v[76:79], v[56:59]
    v_mfma_f32_16x16x32_bf16 v[164:167], v[128:131], v[44:47], v[164:167]
    ds_read_b64_tr_b16 v[128:129], v4 offset:8192
    ds_read_b64_tr_b16 v[130:131], v4 offset:12288
    v_mfma_f32_16x16x32_bf16 v[172:175], v[132:135], v[44:47], v[172:175]
    ds_read_b64_tr_b16 v[132:133], v5 offset:8192
    ds_read_b64_tr_b16 v[134:135], v5 offset:12288
    v_mfma_f32_16x16x32_bf16 v[180:183], v[136:139], v[44:47], v[180:183]
    ds_read_b64_tr_b16 v[136:137], v6 offset:8192
    ds_read_b64_tr_b16 v[138:139], v6 offset:12288
    v_exp_f32 v24, v48
    v_mfma_f32_16x16x32_bf16 v[188:191], v[140:143], v[44:47], v[188:191]
    ds_read_b64_tr_b16 v[140:141], v7 offset:8192
    ds_read_b64_tr_b16 v[142:143], v7 offset:12288
    v_exp_f32 v25, v49
    v_mfma_f32_16x16x32_bf16 v[196:199], v[144:147], v[44:47], v[196:199]
    v_exp_f32 v26, v50
    v_exp_f32 v27, v51
    v_mfma_f32_16x16x32_bf16 v[204:207], v[148:151], v[44:47], v[204:207]
    v_exp_f32 v28, v56
    v_mfma_f32_16x16x32_bf16 v[212:215], v[152:155], v[44:47], v[212:215]
    v_exp_f32 v29, v57
    v_exp_f32 v30, v58
    v_mfma_f32_16x16x32_bf16 v[220:223], v[156:159], v[44:47], v[220:223]
    v_exp_f32 v31, v59
    v_mfma_f32_16x16x32_bf16 v[52:55], v[96:99], v[80:83], v[36:39]
    ds_read_b64_tr_b16 v[144:145], v8 offset:8192
    ds_read_b64_tr_b16 v[146:147], v8 offset:12288
    v_cvt_pk_bf16_f32 v40, v24, v25
    v_cvt_pk_bf16_f32 v41, v26, v27
    v_mfma_f32_16x16x32_bf16 v[52:55], v[100:103], v[84:87], v[52:55]
    ds_read_b64_tr_b16 v[148:149], v9 offset:8192
    ds_read_b64_tr_b16 v[150:151], v9 offset:12288
    v_cvt_pk_bf16_f32 v42, v28, v29
    v_cvt_pk_bf16_f32 v43, v30, v31
    v_mfma_f32_16x16x32_bf16 v[52:55], v[104:107], v[88:91], v[52:55]
    s_waitcnt lgkmcnt(8)
    ds_read_b64_tr_b16 v[152:153], v10 offset:8192
    ds_read_b64_tr_b16 v[154:155], v10 offset:12288
    v_add_f32 v24, v24, v25
    v_add_f32 v26, v26, v27
    v_mfma_f32_16x16x32_bf16 v[52:55], v[108:111], v[92:95], v[52:55]
    ds_read_b64_tr_b16 v[156:157], v11 offset:8192
    ds_read_b64_tr_b16 v[158:159], v11 offset:12288
    v_add_f32 v28, v28, v29
    v_add_f32 v30, v30, v31
    v_mfma_f32_16x16x32_bf16 v[60:63], v[112:115], v[80:83], v[36:39]
    v_add_f32 v24, v24, v26
    v_add_f32 v28, v28, v30
    v_mfma_f32_16x16x32_bf16 v[60:63], v[116:119], v[84:87], v[60:63]
    v_add_f32 v18, v24, v28
    v_mfma_f32_16x16x32_bf16 v[60:63], v[120:123], v[88:91], v[60:63]
    v_cmp_lt_f32 vcc, s65, v18
    s_cbranch_vccnz m_a2_c8_0_slow
m_a2_c8_0_back:
    v_add_f32 v16, v16, v18
    v_mfma_f32_16x16x32_bf16 v[60:63], v[124:127], v[92:95], v[60:63]
    v_mfma_f32_16x16x32_bf16 v[160:163], v[128:131], v[40:43], v[160:163]
    ds_read_b128 v[96:99], v0 offset:16384
    ds_read_b128 v[100:103], v1 offset:16384
    v_mfma_f32_16x16x32_bf16 v[168:171], v[132:135], v[40:43], v[168:171]
    s_waitcnt lgkmcnt(12)
    ds_read_b128 v[104:107], v2 offset:16384
    ds_read_b128 v[108:111], v3 offset:16384
    v_mfma_f32_16x16x32_bf16 v[176:179], v[136:139], v[40:43], v[176:179]
    s_waitcnt lgkmcnt(12)
    ds_read_b128 v[112:115], v0 offset:20480
    ds_read_b128 v[116:119], v1 offset:20480
    v_exp_f32 v24, v52
    v_mfma_f32_16x16x32_bf16 v[184:187], v[140:143], v[40:43], v[184:187]
    s_waitcnt lgkmcnt(12)
    ds_read_b128 v[120:123], v2 offset:20480
    ds_read_b128 v[124:127], v3 offset:20480
    v_exp_f32 v25, v53
    v_mfma_f32_16x16x32_bf16 v[192:195], v[144:147], v[40:43], v[192:195]
    s_waitcnt lgkmcnt(12)
    v_exp_f32 v26, v54
    v_exp_f32 v27, v55
    v_mfma_f32_16x16x32_bf16 v[200:203], v[148:151], v[40:43], v[200:203]
    s_waitcnt lgkmcnt(10)
    v_exp_f32 v28, v60
    v_mfma_f32_16x16x32_bf16 v[208:211], v[152:155], v[40:43], v[208:211]
    s_waitcnt lgkmcnt(8)
    v_exp_f32 v29, v61
    v_exp_f32 v30, v62
    v_mfma_f32_16x16x32_bf16 v[216:219], v[156:159], v[40:43], v[216:219]
    v_exp_f32 v31, v63
    s_waitcnt lgkmcnt(0)
    s_barrier
    v_mfma_f32_16x16x32_bf16 v[48:51], v[96:99], v[64:67], v[32:35]
    v_cvt_pk_bf16_f32 v44, v24, v25
    v_cvt_pk_bf16_f32 v45, v26, v27
    v_mfma_f32_16x16x32_bf16 v[48:51], v[100:103], v[68:71], v[48:51]
    v_cvt_pk_bf16_f32 v46, v28, v29
    v_cvt_pk_bf16_f32 v47, v30, v31
    v_mfma_f32_16x16x32_bf16 v[48:51], v[104:107], v[72:75], v[48:51]
    v_add_f32 v24, v24, v25
    v_add_f32 v26, v26, v27
    v_mfma_f32_16x16x32_bf16 v[48:51], v[108:111], v[76:79], v[48:51]
    v_add_f32 v28, v28, v29
    v_add_f32 v30, v30, v31
    v_mfma_f32_16x16x32_bf16 v[56:59], v[112:115], v[64:67], v[32:35]
    v_add_f32 v24, v24, v26
    v_add_f32 v28, v28, v30
    v_mfma_f32_16x16x32_bf16 v[56:59], v[116:119], v[68:71], v[56:59]
    v_add_f32 v19, v24, v28
    v_mfma_f32_16x16x32_bf16 v[56:59], v[120:123], v[72:75], v[56:59]
    v_cmp_lt_f32 vcc, s65, v19
    s_cbranch_vccnz m_a2_c8_1_slow
m_a2_c8_1_back:
    v_add_f32 v17, v17, v19
    v_mfma_f32_16x16x32_bf16 v[56:59], v[124:127], v[76:79], v[56:59]
    v_mfma_f32_16x16x32_bf16 v[164:167], v[128:131], v[44:47], v[164:167]
    ds_read_b64_tr_b16 v[128:129], v4 offset:24576
    ds_read_b64_tr_b16 v[130:131], v4 offset:28672
    v_mfma_f32_16x16x32_bf16 v[172:175], v[132:135], v[44:47], v[172:175]
    ds_read_b64_tr_b16 v[132:133], v5 offset:24576
    ds_read_b64_tr_b16 v[134:135], v5 offset:28672
    v_mfma_f32_16x16x32_bf16 v[180:183], v[136:139], v[44:47], v[180:183]
    ds_read_b64_tr_b16 v[136:137], v6 offset:24576
    ds_read_b64_tr_b16 v[138:139], v6 offset:28672
    v_exp_f32 v24, v48
    v_mfma_f32_16x16x32_bf16 v[188:191], v[140:143], v[44:47], v[188:191]
    ds_read_b64_tr_b16 v[140:141], v7 offset:24576
    ds_read_b64_tr_b16 v[142:143], v7 offset:28672
    v_exp_f32 v25, v49
    v_mfma_f32_16x16x32_bf16 v[196:199], v[144:147], v[44:47], v[196:199]
    v_exp_f32 v26, v50
    v_exp_f32 v27, v51
    v_mfma_f32_16x16x32_bf16 v[204:207], v[148:151], v[44:47], v[204:207]
    v_exp_f32 v28, v56
    v_mfma_f32_16x16x32_bf16 v[212:215], v[152:155], v[44:47], v[212:215]
    v_exp_f32 v29, v57
    v_exp_f32 v30, v58
    v_mfma_f32_16x16x32_bf16 v[220:223], v[156:159], v[44:47], v[220:223]
    v_exp_f32 v31, v59
    v_mfma_f32_16x16x32_bf16 v[52:55], v[96:99], v[80:83], v[36:39]
    ds_read_b64_tr_b16 v[144:145], v8 offset:24576
    ds_read_b64_tr_b16 v[146:147], v8 offset:28672
    v_cvt_pk_bf16_f32 v40, v24, v25
    v_cvt_pk_bf16_f32 v41, v26, v27
    v_mfma_f32_16x16x32_bf16 v[52:55], v[100:103], v[84:87], v[52:55]
    ds_read_b64_tr_b16 v[148:149], v9 offset:24576
    ds_read_b64_tr_b16 v[150:151], v9 offset:28672
    v_cvt_pk_bf16_f32 v42, v28, v29
    v_cvt_pk_bf16_f32 v43, v30, v31
    v_mfma_f32_16x16x32_bf16 v[52:55], v[104:107], v[88:91], v[52:55]
    s_waitcnt lgkmcnt(8)
    ds_read_b64_tr_b16 v[152:153], v10 offset:24576
    ds_read_b64_tr_b16 v[154:155], v10 offset:28672
    v_add_f32 v24, v24, v25
    v_add_f32 v26, v26, v27
    v_mfma_f32_16x16x32_bf16 v[52:55], v[108:111], v[92:95], v[52:55]
    ds_read_b64_tr_b16 v[156:157], v11 offset:24576
    ds_read_b64_tr_b16 v[158:159], v11 offset:28672
    v_add_f32 v28, v28, v29
    v_add_f32 v30, v30, v31
    v_mfma_f32_16x16x32_bf16 v[60:63], v[112:115], v[80:83], v[36:39]
    v_add_f32 v24, v24, v26
    v_add_f32 v28, v28, v30
    v_mfma_f32_16x16x32_bf16 v[60:63], v[116:119], v[84:87], v[60:63]
    v_add_f32 v18, v24, v28
    v_mfma_f32_16x16x32_bf16 v[60:63], v[120:123], v[88:91], v[60:63]
    v_cmp_lt_f32 vcc, s65, v18
    s_cbranch_vccnz m_a2_c9_0_slow
m_a2_c9_0_back:
    v_add_f32 v16, v16, v18
    v_mfma_f32_16x16x32_bf16 v[60:63], v[124:127], v[92:95], v[60:63]
    v_mfma_f32_16x16x32_bf16 v[160:163], v[128:131], v[40:43], v[160:163]
    ds_read_b128 v[96:99], v0 offset:32768
    ds_read_b128 v[100:103], v1 offset:32768
    v_mfma_f32_16x16x32_bf16 v[168:171], v[132:135], v[40:43], v[168:171]
    s_waitcnt lgkmcnt(12)
    ds_read_b128 v[104:107], v2 offset:32768
    ds_read_b128 v[108:111], v3 offset:32768
    v_mfma_f32_16x16x32_bf16 v[176:179], v[136:139], v[40:43], v[176:179]
    s_waitcnt lgkmcnt(12)
    ds_read_b128 v[112:115], v0 offset:36864
    ds_read_b128 v[116:119], v1 offset:36864
    v_exp_f32 v24, v52
    v_mfma_f32_16x16x32_bf16 v[184:187], v[140:143], v[40:43], v[184:187]
    s_waitcnt lgkmcnt(12)
    ds_read_b128 v[120:123], v2 offset:36864
    ds_read_b128 v[124:127], v3 offset:36864
    v_exp_f32 v25, v53
    v_mfma_f32_16x16x32_bf16 v[192:195], v[144:147], v[40:43], v[192:195]
    s_waitcnt lgkmcnt(12)
    v_exp_f32 v26, v54
    v_exp_f32 v27, v55
    v_mfma_f32_16x16x32_bf16 v[200:203], v[148:151], v[40:43], v[200:203]
    s_waitcnt lgkmcnt(10)
    v_exp_f32 v28, v60
    v_mfma_f32_16x16x32_bf16 v[208:211], v[152:155], v[40:43], v[208:211]
    s_waitcnt lgkmcnt(8)
    v_exp_f32 v29, v61
    v_exp_f32 v30, v62
    v_mfma_f32_16x16x32_bf16 v[216:219], v[156:159], v[40:43], v[216:219]
    v_exp_f32 v31, v63
    s_waitcnt lgkmcnt(0)
    s_barrier
    v_mfma_f32_16x16x32_bf16 v[48:51], v[96:99], v[64:67], v[32:35]
    v_cvt_pk_bf16_f32 v44, v24, v25
    v_cvt_pk_bf16_f32 v45, v26, v27
    v_mfma_f32_16x16x32_bf16 v[48:51], v[100:103], v[68:71], v[48:51]
    v_cvt_pk_bf16_f32 v46, v28, v29
    v_cvt_pk_bf16_f32 v47, v30, v31
    v_mfma_f32_16x16x32_bf16 v[48:51], v[104:107], v[72:75], v[48:51]
    v_add_f32 v24, v24, v25
    v_add_f32 v26, v26, v27
    v_mfma_f32_16x16x32_bf16 v[48:51], v[108:111], v[76:79], v[48:51]
    v_add_f32 v28, v28, v29
    v_add_f32 v30, v30, v31
    v_mfma_f32_16x16x32_bf16 v[56:59], v[112:115], v[64:67], v[32:35]
    v_add_f32 v24, v24, v26
    v_add_f32 v28, v28, v30
    v_mfma_f32_16x16x32_bf16 v[56:59], v[116:119], v[68:71], v[56:59]
    v_add_f32 v19, v24, v28
    v_mfma_f32_16x16x32_bf16 v[56:59], v[120:123], v[72:75], v[56:59]
    v_cmp_lt_f32 vcc, s65, v19
    s_cbranch_vccnz m_a2_c9_1_slow
m_a2_c9_1_back:
    v_add_f32 v17, v17, v19
    v_mfma_f32_16x16x32_bf16 v[56:59], v[124:127], v[76:79], v[56:59]
    v_mfma_f32_16x16x32_bf16 v[164:167], v[128:131], v[44:47], v[164:167]
    ds_read_b64_tr_b16 v[128:129], v4 offset:40960
    ds_read_b64_tr_b16 v[130:131], v4 offset:45056
    v_mfma_f32_16x16x32_bf16 v[172:175], v[132:135], v[44:47], v[172:175]
    ds_read_b64_tr_b16 v[132:133], v5 offset:40960
    ds_read_b64_tr_b16 v[134:135], v5 offset:45056
    v_mfma_f32_16x16x32_bf16 v[180:183], v[136:139], v[44:47], v[180:183]
    ds_read_b64_tr_b16 v[136:137], v6 offset:40960
    ds_read_b64_tr_b16 v[138:139], v6 offset:45056
    v_exp_f32 v24, v48
    v_mfma_f32_16x16x32_bf16 v[188:191], v[140:143], v[44:47], v[188:191]
    ds_read_b64_tr_b16 v[140:141], v7 offset:40960
    ds_read_b64_tr_b16 v[142:143], v7 offset:45056
    v_exp_f32 v25, v49
    v_mfma_f32_16x16x32_bf16 v[196:199], v[144:147], v[44:47], v[196:199]
    v_exp_f32 v26, v50
    v_exp_f32 v27, v51
    v_mfma_f32_16x16x32_bf16 v[204:207], v[148:151], v[44:47], v[204:207]
    v_exp_f32 v28, v56
    v_mfma_f32_16x16x32_bf16 v[212:215], v[152:155], v[44:47], v[212:215]
    v_exp_f32 v29, v57
    v_exp_f32 v30, v58
    v_mfma_f32_16x16x32_bf16 v[220:223], v[156:159], v[44:47], v[220:223]
    v_exp_f32 v31, v59
    v_mfma_f32_16x16x32_bf16 v[52:55], v[96:99], v[80:83], v[36:39]
    ds_read_b64_tr_b16 v[144:145], v8 offset:40960
    ds_read_b64_tr_b16 v[146:147], v8 offset:45056
    v_cvt_pk_bf16_f32 v40, v24, v25
    v_cvt_pk_bf16_f32 v41, v26, v27
    v_mfma_f32_16x16x32_bf16 v[52:55], v[100:103], v[84:87], v[52:55]
    ds_read_b64_tr_b16 v[148:149], v9 offset:40960
    ds_read_b64_tr_b16 v[150:151], v9 offset:45056
    v_cvt_pk_bf16_f32 v42, v28, v29
    v_cvt_pk_bf16_f32 v43, v30, v31
    v_mfma_f32_16x16x32_bf16 v[52:55], v[104:107], v[88:91], v[52:55]
    s_waitcnt lgkmcnt(8)
    ds_read_b64_tr_b16 v[152:153], v10 offset:40960
    ds_read_b64_tr_b16 v[154:155], v10 offset:45056
    v_add_f32 v24, v24, v25
    v_add_f32 v26, v26, v27
    v_mfma_f32_16x16x32_bf16 v[52:55], v[108:111], v[92:95], v[52:55]
    ds_read_b64_tr_b16 v[156:157], v11 offset:40960
    ds_read_b64_tr_b16 v[158:159], v11 offset:45056
    v_add_f32 v28, v28, v29
    v_add_f32 v30, v30, v31
    v_mfma_f32_16x16x32_bf16 v[60:63], v[112:115], v[80:83], v[36:39]
    v_add_f32 v24, v24, v26
    v_add_f32 v28, v28, v30
    v_mfma_f32_16x16x32_bf16 v[60:63], v[116:119], v[84:87], v[60:63]
    v_add_f32 v18, v24, v28
    v_mfma_f32_16x16x32_bf16 v[60:63], v[120:123], v[88:91], v[60:63]
    v_cmp_lt_f32 vcc, s65, v18
    s_cbranch_vccnz m_a2_c10_0_slow
m_a2_c10_0_back:
    v_add_f32 v16, v16, v18
    v_mfma_f32_16x16x32_bf16 v[60:63], v[124:127], v[92:95], v[60:63]
    v_mfma_f32_16x16x32_bf16 v[160:163], v[128:131], v[40:43], v[160:163]
    ds_read_b128 v[96:99], v0 offset:49152
    ds_read_b128 v[100:103], v1 offset:49152
    v_mfma_f32_16x16x32_bf16 v[168:171], v[132:135], v[40:43], v[168:171]
    s_waitcnt lgkmcnt(12)
    ds_read_b128 v[104:107], v2 offset:49152
    ds_read_b128 v[108:111], v3 offset:49152
    v_mfma_f32_16x16x32_bf16 v[176:179], v[136:139], v[40:43], v[176:179]
    s_waitcnt lgkmcnt(12)
    ds_read_b128 v[112:115], v0 offset:53248
    ds_read_b128 v[116:119], v1 offset:53248
    v_exp_f32 v24, v52
    v_mfma_f32_16x16x32_bf16 v[184:187], v[140:143], v[40:43], v[184:187]
    s_waitcnt lgkmcnt(12)
    ds_read_b128 v[120:123], v2 offset:53248
    ds_read_b128 v[124:127], v3 offset:53248
    v_exp_f32 v25, v53
    v_mfma_f32_16x16x32_bf16 v[192:195], v[144:147], v[40:43], v[192:195]
    s_waitcnt lgkmcnt(12)
    v_exp_f32 v26, v54
    v_exp_f32 v27, v55
    v_mfma_f32_16x16x32_bf16 v[200:203], v[148:151], v[40:43], v[200:203]
    s_waitcnt lgkmcnt(10)
    v_exp_f32 v28, v60
    v_mfma_f32_16x16x32_bf16 v[208:211], v[152:155], v[40:43], v[208:211]
    s_waitcnt lgkmcnt(8)
    v_exp_f32 v29, v61
    v_exp_f32 v30, v62
    v_mfma_f32_16x16x32_bf16 v[216:219], v[156:159], v[40:43], v[216:219]
    v_exp_f32 v31, v63
    s_waitcnt lgkmcnt(0)
    s_barrier
    v_mfma_f32_16x16x32_bf16 v[48:51], v[96:99], v[64:67], v[32:35]
    v_cvt_pk_bf16_f32 v44, v24, v25
    v_cvt_pk_bf16_f32 v45, v26, v27
    v_mfma_f32_16x16x32_bf16 v[48:51], v[100:103], v[68:71], v[48:51]
    v_cvt_pk_bf16_f32 v46, v28, v29
    v_cvt_pk_bf16_f32 v47, v30, v31
    v_mfma_f32_16x16x32_bf16 v[48:51], v[104:107], v[72:75], v[48:51]
    v_add_f32 v24, v24, v25
    v_add_f32 v26, v26, v27
    v_mfma_f32_16x16x32_bf16 v[48:51], v[108:111], v[76:79], v[48:51]
    v_add_f32 v28, v28, v29
    v_add_f32 v30, v30, v31
    v_mfma_f32_16x16x32_bf16 v[56:59], v[112:115], v[64:67], v[32:35]
    v_add_f32 v24, v24, v26
    v_add_f32 v28, v28, v30
    v_mfma_f32_16x16x32_bf16 v[56:59], v[116:119], v[68:71], v[56:59]
    v_add_f32 v19, v24, v28
    v_mfma_f32_16x16x32_bf16 v[56:59], v[120:123], v[72:75], v[56:59]
    v_cmp_lt_f32 vcc, s65, v19
    s_cbranch_vccnz m_a2_c10_1_slow
m_a2_c10_1_back:
    v_add_f32 v17, v17, v19
    v_mfma_f32_16x16x32_bf16 v[56:59], v[124:127], v[76:79], v[56:59]
    v_mfma_f32_16x16x32_bf16 v[164:167], v[128:131], v[44:47], v[164:167]
    ds_read_b64_tr_b16 v[128:129], v4 offset:57344
    ds_read_b64_tr_b16 v[130:131], v4 offset:61440
    v_mfma_f32_16x16x32_bf16 v[172:175], v[132:135], v[44:47], v[172:175]
    ds_read_b64_tr_b16 v[132:133], v5 offset:57344
    ds_read_b64_tr_b16 v[134:135], v5 offset:61440
    v_mfma_f32_16x16x32_bf16 v[180:183], v[136:139], v[44:47], v[180:183]
    ds_read_b64_tr_b16 v[136:137], v6 offset:57344
    ds_read_b64_tr_b16 v[138:139], v6 offset:61440
    v_exp_f32 v24, v48
    v_mfma_f32_16x16x32_bf16 v[188:191], v[140:143], v[44:47], v[188:191]
    ds_read_b64_tr_b16 v[140:141], v7 offset:57344
    ds_read_b64_tr_b16 v[142:143], v7 offset:61440
    v_exp_f32 v25, v49
    v_mfma_f32_16x16x32_bf16 v[196:199], v[144:147], v[44:47], v[196:199]
    v_exp_f32 v26, v50
    v_exp_f32 v27, v51
    v_mfma_f32_16x16x32_bf16 v[204:207], v[148:151], v[44:47], v[204:207]
    v_exp_f32 v28, v56
    v_mfma_f32_16x16x32_bf16 v[212:215], v[152:155], v[44:47], v[212:215]
    v_exp_f32 v29, v57
    v_exp_f32 v30, v58
    v_mfma_f32_16x16x32_bf16 v[220:223], v[156:159], v[44:47], v[220:223]
    v_exp_f32 v31, v59
    v_mfma_f32_16x16x32_bf16 v[52:55], v[96:99], v[80:83], v[36:39]
    ds_read_b64_tr_b16 v[144:145], v8 offset:57344
    ds_read_b64_tr_b16 v[146:147], v8 offset:61440
    v_cvt_pk_bf16_f32 v40, v24, v25
    v_cvt_pk_bf16_f32 v41, v26, v27
    v_mfma_f32_16x16x32_bf16 v[52:55], v[100:103], v[84:87], v[52:55]
    ds_read_b64_tr_b16 v[148:149], v9 offset:57344
    ds_read_b64_tr_b16 v[150:151], v9 offset:61440
    v_cvt_pk_bf16_f32 v42, v28, v29
    v_cvt_pk_bf16_f32 v43, v30, v31
    v_mfma_f32_16x16x32_bf16 v[52:55], v[104:107], v[88:91], v[52:55]
    s_waitcnt lgkmcnt(8)
    ds_read_b64_tr_b16 v[152:153], v10 offset:57344
    ds_read_b64_tr_b16 v[154:155], v10 offset:61440
    v_add_f32 v24, v24, v25
    v_add_f32 v26, v26, v27
    v_mfma_f32_16x16x32_bf16 v[52:55], v[108:111], v[92:95], v[52:55]
    ds_read_b64_tr_b16 v[156:157], v11 offset:57344
    ds_read_b64_tr_b16 v[158:159], v11 offset:61440
    v_add_f32 v28, v28, v29
    v_add_f32 v30, v30, v31
    v_mfma_f32_16x16x32_bf16 v[60:63], v[112:115], v[80:83], v[36:39]
    v_add_f32 v24, v24, v26
    v_add_f32 v28, v28, v30
    v_mfma_f32_16x16x32_bf16 v[60:63], v[116:119], v[84:87], v[60:63]
    v_add_f32 v18, v24, v28
    v_mfma_f32_16x16x32_bf16 v[60:63], v[120:123], v[88:91], v[60:63]
    v_cmp_lt_f32 vcc, s65, v18
    s_cbranch_vccnz m_a2_c11_0_slow
m_a2_c11_0_back:
    v_add_f32 v16, v16, v18
    v_mfma_f32_16x16x32_bf16 v[60:63], v[124:127], v[92:95], v[60:63]
    v_mfma_f32_16x16x32_bf16 v[160:163], v[128:131], v[40:43], v[160:163]
    ds_read_b128 v[96:99], v0 offset:0
    ds_read_b128 v[100:103], v1 offset:0
    v_mfma_f32_16x16x32_bf16 v[168:171], v[132:135], v[40:43], v[168:171]
    s_waitcnt lgkmcnt(12)
    ds_read_b128 v[104:107], v2 offset:0
    ds_read_b128 v[108:111], v3 offset:0
    v_mfma_f32_16x16x32_bf16 v[176:179], v[136:139], v[40:43], v[176:179]
    s_waitcnt lgkmcnt(12)
    ds_read_b128 v[112:115], v0 offset:4096
    ds_read_b128 v[116:119], v1 offset:4096
    v_exp_f32 v24, v52
    v_mfma_f32_16x16x32_bf16 v[184:187], v[140:143], v[40:43], v[184:187]
    s_waitcnt lgkmcnt(12)
    ds_read_b128 v[120:123], v2 offset:4096
    ds_read_b128 v[124:127], v3 offset:4096
    v_exp_f32 v25, v53
    v_mfma_f32_16x16x32_bf16 v[192:195], v[144:147], v[40:43], v[192:195]
    s_waitcnt lgkmcnt(12)
    v_exp_f32 v26, v54
    v_exp_f32 v27, v55
    v_mfma_f32_16x16x32_bf16 v[200:203], v[148:151], v[40:43], v[200:203]
    s_waitcnt lgkmcnt(10)
    v_exp_f32 v28, v60
    v_mfma_f32_16x16x32_bf16 v[208:211], v[152:155], v[40:43], v[208:211]
    s_waitcnt lgkmcnt(8)
    v_exp_f32 v29, v61
    v_exp_f32 v30, v62
    v_mfma_f32_16x16x32_bf16 v[216:219], v[156:159], v[40:43], v[216:219]
    v_exp_f32 v31, v63
    s_waitcnt lgkmcnt(0)
    s_barrier
    v_mfma_f32_16x16x32_bf16 v[48:51], v[96:99], v[64:67], v[32:35]
    v_cvt_pk_bf16_f32 v44, v24, v25
    v_cvt_pk_bf16_f32 v45, v26, v27
    v_mfma_f32_16x16x32_bf16 v[48:51], v[100:103], v[68:71], v[48:51]
    v_cvt_pk_bf16_f32 v46, v28, v29
    v_cvt_pk_bf16_f32 v47, v30, v31
    v_mfma_f32_16x16x32_bf16 v[48:51], v[104:107], v[72:75], v[48:51]
    v_add_f32 v24, v24, v25
    v_add_f32 v26, v26, v27
    v_mfma_f32_16x16x32_bf16 v[48:51], v[108:111], v[76:79], v[48:51]
    v_add_f32 v28, v28, v29
    v_add_f32 v30, v30, v31
    v_mfma_f32_16x16x32_bf16 v[56:59], v[112:115], v[64:67], v[32:35]
    v_add_f32 v24, v24, v26
    v_add_f32 v28, v28, v30
    v_mfma_f32_16x16x32_bf16 v[56:59], v[116:119], v[68:71], v[56:59]
    v_add_f32 v19, v24, v28
    v_mfma_f32_16x16x32_bf16 v[56:59], v[120:123], v[72:75], v[56:59]
    v_cmp_lt_f32 vcc, s65, v19
    s_cbranch_vccnz m_a2_c11_1_slow
m_a2_c11_1_back:
    v_add_f32 v17, v17, v19
    v_mfma_f32_16x16x32_bf16 v[56:59], v[124:127], v[76:79], v[56:59]
    v_mfma_f32_16x16x32_bf16 v[164:167], v[128:131], v[44:47], v[164:167]
    ds_read_b64_tr_b16 v[128:129], v4 offset:8192
    ds_read_b64_tr_b16 v[130:131], v4 offset:12288
    v_mfma_f32_16x16x32_bf16 v[172:175], v[132:135], v[44:47], v[172:175]
    ds_read_b64_tr_b16 v[132:133], v5 offset:8192
    ds_read_b64_tr_b16 v[134:135], v5 offset:12288
    v_mfma_f32_16x16x32_bf16 v[180:183], v[136:139], v[44:47], v[180:183]
    ds_read_b64_tr_b16 v[136:137], v6 offset:8192
    ds_read_b64_tr_b16 v[138:139], v6 offset:12288
    v_exp_f32 v24, v48
    v_mfma_f32_16x16x32_bf16 v[188:191], v[140:143], v[44:47], v[188:191]
    ds_read_b64_tr_b16 v[140:141], v7 offset:8192
    ds_read_b64_tr_b16 v[142:143], v7 offset:12288
    v_exp_f32 v25, v49
    v_mfma_f32_16x16x32_bf16 v[196:199], v[144:147], v[44:47], v[196:199]
    v_exp_f32 v26, v50
    v_exp_f32 v27, v51
    v_mfma_f32_16x16x32_bf16 v[204:207], v[148:151], v[44:47], v[204:207]
    v_exp_f32 v28, v56
    v_mfma_f32_16x16x32_bf16 v[212:215], v[152:155], v[44:47], v[212:215]
    v_exp_f32 v29, v57
    v_exp_f32 v30, v58
    v_mfma_f32_16x16x32_bf16 v[220:223], v[156:159], v[44:47], v[220:223]
    v_exp_f32 v31, v59
    v_mfma_f32_16x16x32_bf16 v[52:55], v[96:99], v[80:83], v[36:39]
    ds_read_b64_tr_b16 v[144:145], v8 offset:8192
    ds_read_b64_tr_b16 v[146:147], v8 offset:12288
    v_cvt_pk_bf16_f32 v40, v24, v25
    v_cvt_pk_bf16_f32 v41, v26, v27
    v_mfma_f32_16x16x32_bf16 v[52:55], v[100:103], v[84:87], v[52:55]
    ds_read_b64_tr_b16 v[148:149], v9 offset:8192
    ds_read_b64_tr_b16 v[150:151], v9 offset:12288
    v_cvt_pk_bf16_f32 v42, v28, v29
    v_cvt_pk_bf16_f32 v43, v30, v31
    v_mfma_f32_16x16x32_bf16 v[52:55], v[104:107], v[88:91], v[52:55]
    s_waitcnt lgkmcnt(8)
    ds_read_b64_tr_b16 v[152:153], v10 offset:8192
    ds_read_b64_tr_b16 v[154:155], v10 offset:12288
    v_add_f32 v24, v24, v25
    v_add_f32 v26, v26, v27
    v_mfma_f32_16x16x32_bf16 v[52:55], v[108:111], v[92:95], v[52:55]
    ds_read_b64_tr_b16 v[156:157], v11 offset:8192
    ds_read_b64_tr_b16 v[158:159], v11 offset:12288
    v_add_f32 v28, v28, v29
    v_add_f32 v30, v30, v31
    v_mfma_f32_16x16x32_bf16 v[60:63], v[112:115], v[80:83], v[36:39]
    v_add_f32 v24, v24, v26
    v_add_f32 v28, v28, v30
    v_mfma_f32_16x16x32_bf16 v[60:63], v[116:119], v[84:87], v[60:63]
    v_add_f32 v18, v24, v28
    v_mfma_f32_16x16x32_bf16 v[60:63], v[120:123], v[88:91], v[60:63]
    v_cmp_lt_f32 vcc, s65, v18
    s_cbranch_vccnz m_a2_c12_0_slow
m_a2_c12_0_back:
    v_add_f32 v16, v16, v18
    v_mfma_f32_16x16x32_bf16 v[60:63], v[124:127], v[92:95], v[60:63]
    v_mfma_f32_16x16x32_bf16 v[160:163], v[128:131], v[40:43], v[160:163]
    ds_read_b128 v[96:99], v0 offset:16384
    ds_read_b128 v[100:103], v1 offset:16384
    v_mfma_f32_16x16x32_bf16 v[168:171], v[132:135], v[40:43], v[168:171]
    s_waitcnt lgkmcnt(12)
    ds_read_b128 v[104:107], v2 offset:16384
    ds_read_b128 v[108:111], v3 offset:16384
    v_mfma_f32_16x16x32_bf16 v[176:179], v[136:139], v[40:43], v[176:179]
    s_waitcnt lgkmcnt(12)
    ds_read_b128 v[112:115], v0 offset:20480
    ds_read_b128 v[116:119], v1 offset:20480
    v_exp_f32 v24, v52
    v_mfma_f32_16x16x32_bf16 v[184:187], v[140:143], v[40:43], v[184:187]
    s_waitcnt lgkmcnt(12)
    ds_read_b128 v[120:123], v2 offset:20480
    ds_read_b128 v[124:127], v3 offset:20480
    v_exp_f32 v25, v53
    v_mfma_f32_16x16x32_bf16 v[192:195], v[144:147], v[40:43], v[192:195]
    s_waitcnt lgkmcnt(12)
    v_exp_f32 v26, v54
    v_exp_f32 v27, v55
    v_mfma_f32_16x16x32_bf16 v[200:203], v[148:151], v[40:43], v[200:203]
    s_waitcnt lgkmcnt(10)
    v_exp_f32 v28, v60
    v_mfma_f32_16x16x32_bf16 v[208:211], v[152:155], v[40:43], v[208:211]
    s_waitcnt lgkmcnt(8)
    v_exp_f32 v29, v61
    v_exp_f32 v30, v62
    v_mfma_f32_16x16x32_bf16 v[216:219], v[156:159], v[40:43], v[216:219]
    v_exp_f32 v31, v63
    s_waitcnt lgkmcnt(0)
    s_barrier
    v_mfma_f32_16x16x32_bf16 v[48:51], v[96:99], v[64:67], v[32:35]
    v_cvt_pk_bf16_f32 v44, v24, v25
    v_cvt_pk_bf16_f32 v45, v26, v27
    v_mfma_f32_16x16x32_bf16 v[48:51], v[100:103], v[68:71], v[48:51]
    v_cvt_pk_bf16_f32 v46, v28, v29
    v_cvt_pk_bf16_f32 v47, v30, v31
    v_mfma_f32_16x16x32_bf16 v[48:51], v[104:107], v[72:75], v[48:51]
    v_add_f32 v24, v24, v25
    v_add_f32 v26, v26, v27
    v_mfma_f32_16x16x32_bf16 v[48:51], v[108:111], v[76:79], v[48:51]
    v_add_f32 v28, v28, v29
    v_add_f32 v30, v30, v31
    v_mfma_f32_16x16x32_bf16 v[56:59], v[112:115], v[64:67], v[32:35]
    v_add_f32 v24, v24, v26
    v_add_f32 v28, v28, v30
    v_mfma_f32_16x16x32_bf16 v[56:59], v[116:119], v[68:71], v[56:59]
    v_add_f32 v19, v24, v28
    v_mfma_f32_16x16x32_bf16 v[56:59], v[120:123], v[72:75], v[56:59]
    v_cmp_lt_f32 vcc, s65, v19
    s_cbranch_vccnz m_a2_c12_1_slow
m_a2_c12_1_back:
    v_add_f32 v17, v17, v19
    v_mfma_f32_16x16x32_bf16 v[56:59], v[124:127], v[76:79], v[56:59]
    v_mfma_f32_16x16x32_bf16 v[164:167], v[128:131], v[44:47], v[164:167]
    ds_read_b64_tr_b16 v[128:129], v4 offset:24576
    ds_read_b64_tr_b16 v[130:131], v4 offset:28672
    v_mfma_f32_16x16x32_bf16 v[172:175], v[132:135], v[44:47], v[172:175]
    ds_read_b64_tr_b16 v[132:133], v5 offset:24576
    ds_read_b64_tr_b16 v[134:135], v5 offset:28672
    v_mfma_f32_16x16x32_bf16 v[180:183], v[136:139], v[44:47], v[180:183]
    ds_read_b64_tr_b16 v[136:137], v6 offset:24576
    ds_read_b64_tr_b16 v[138:139], v6 offset:28672
    v_exp_f32 v24, v48
    v_mfma_f32_16x16x32_bf16 v[188:191], v[140:143], v[44:47], v[188:191]
    ds_read_b64_tr_b16 v[140:141], v7 offset:24576
    ds_read_b64_tr_b16 v[142:143], v7 offset:28672
    v_exp_f32 v25, v49
    v_mfma_f32_16x16x32_bf16 v[196:199], v[144:147], v[44:47], v[196:199]
    v_exp_f32 v26, v50
    v_exp_f32 v27, v51
    v_mfma_f32_16x16x32_bf16 v[204:207], v[148:151], v[44:47], v[204:207]
    v_exp_f32 v28, v56
    v_mfma_f32_16x16x32_bf16 v[212:215], v[152:155], v[44:47], v[212:215]
    v_exp_f32 v29, v57
    v_exp_f32 v30, v58
    v_mfma_f32_16x16x32_bf16 v[220:223], v[156:159], v[44:47], v[220:223]
    v_exp_f32 v31, v59
    v_mfma_f32_16x16x32_bf16 v[52:55], v[96:99], v[80:83], v[36:39]
    ds_read_b64_tr_b16 v[144:145], v8 offset:24576
    ds_read_b64_tr_b16 v[146:147], v8 offset:28672
    v_cvt_pk_bf16_f32 v40, v24, v25
    v_cvt_pk_bf16_f32 v41, v26, v27
    v_mfma_f32_16x16x32_bf16 v[52:55], v[100:103], v[84:87], v[52:55]
    ds_read_b64_tr_b16 v[148:149], v9 offset:24576
    ds_read_b64_tr_b16 v[150:151], v9 offset:28672
    v_cvt_pk_bf16_f32 v42, v28, v29
    v_cvt_pk_bf16_f32 v43, v30, v31
    v_mfma_f32_16x16x32_bf16 v[52:55], v[104:107], v[88:91], v[52:55]
    s_waitcnt lgkmcnt(8)
    ds_read_b64_tr_b16 v[152:153], v10 offset:24576
    ds_read_b64_tr_b16 v[154:155], v10 offset:28672
    v_add_f32 v24, v24, v25
    v_add_f32 v26, v26, v27
    v_mfma_f32_16x16x32_bf16 v[52:55], v[108:111], v[92:95], v[52:55]
    ds_read_b64_tr_b16 v[156:157], v11 offset:24576
    ds_read_b64_tr_b16 v[158:159], v11 offset:28672
    v_add_f32 v28, v28, v29
    v_add_f32 v30, v30, v31
    v_mfma_f32_16x16x32_bf16 v[60:63], v[112:115], v[80:83], v[36:39]
    v_add_f32 v24, v24, v26
    v_add_f32 v28, v28, v30
    v_mfma_f32_16x16x32_bf16 v[60:63], v[116:119], v[84:87], v[60:63]
    v_add_f32 v18, v24, v28
    v_mfma_f32_16x16x32_bf16 v[60:63], v[120:123], v[88:91], v[60:63]
    v_cmp_lt_f32 vcc, s65, v18
    s_cbranch_vccnz m_a2_c13_0_slow
m_a2_c13_0_back:
    v_add_f32 v16, v16, v18
    v_mfma_f32_16x16x32_bf16 v[60:63], v[124:127], v[92:95], v[60:63]
    v_mfma_f32_16x16x32_bf16 v[160:163], v[128:131], v[40:43], v[160:163]
    ds_read_b128 v[96:99], v0 offset:32768
    ds_read_b128 v[100:103], v1 offset:32768
    v_mfma_f32_16x16x32_bf16 v[168:171], v[132:135], v[40:43], v[168:171]
    s_waitcnt lgkmcnt(12)
    ds_read_b128 v[104:107], v2 offset:32768
    ds_read_b128 v[108:111], v3 offset:32768
    v_mfma_f32_16x16x32_bf16 v[176:179], v[136:139], v[40:43], v[176:179]
    s_waitcnt lgkmcnt(12)
    ds_read_b128 v[112:115], v0 offset:36864
    ds_read_b128 v[116:119], v1 offset:36864
    v_exp_f32 v24, v52
    v_mfma_f32_16x16x32_bf16 v[184:187], v[140:143], v[40:43], v[184:187]
    s_waitcnt lgkmcnt(12)
    ds_read_b128 v[120:123], v2 offset:36864
    ds_read_b128 v[124:127], v3 offset:36864
    v_exp_f32 v25, v53
    v_mfma_f32_16x16x32_bf16 v[192:195], v[144:147], v[40:43], v[192:195]
    s_waitcnt lgkmcnt(12)
    v_exp_f32 v26, v54
    v_exp_f32 v27, v55
    v_mfma_f32_16x16x32_bf16 v[200:203], v[148:151], v[40:43], v[200:203]
    s_waitcnt lgkmcnt(10)
    v_exp_f32 v28, v60
    v_mfma_f32_16x16x32_bf16 v[208:211], v[152:155], v[40:43], v[208:211]
    s_waitcnt lgkmcnt(8)
    v_exp_f32 v29, v61
    v_exp_f32 v30, v62
    v_mfma_f32_16x16x32_bf16 v[216:219], v[156:159], v[40:43], v[216:219]
    v_exp_f32 v31, v63
    s_waitcnt lgkmcnt(0)
    s_barrier
    v_mfma_f32_16x16x32_bf16 v[48:51], v[96:99], v[64:67], v[32:35]
    v_cvt_pk_bf16_f32 v44, v24, v25
    v_cvt_pk_bf16_f32 v45, v26, v27
    v_mfma_f32_16x16x32_bf16 v[48:51], v[100:103], v[68:71], v[48:51]
    v_cvt_pk_bf16_f32 v46, v28, v29
    v_cvt_pk_bf16_f32 v47, v30, v31
    v_mfma_f32_16x16x32_bf16 v[48:51], v[104:107], v[72:75], v[48:51]
    v_add_f32 v24, v24, v25
    v_add_f32 v26, v26, v27
    v_mfma_f32_16x16x32_bf16 v[48:51], v[108:111], v[76:79], v[48:51]
    v_add_f32 v28, v28, v29
    v_add_f32 v30, v30, v31
    v_mfma_f32_16x16x32_bf16 v[56:59], v[112:115], v[64:67], v[32:35]
    v_add_f32 v24, v24, v26
    v_add_f32 v28, v28, v30
    v_mfma_f32_16x16x32_bf16 v[56:59], v[116:119], v[68:71], v[56:59]
    v_add_f32 v19, v24, v28
    v_mfma_f32_16x16x32_bf16 v[56:59], v[120:123], v[72:75], v[56:59]
    v_cmp_lt_f32 vcc, s65, v19
    s_cbranch_vccnz m_a2_c13_1_slow
m_a2_c13_1_back:
    v_add_f32 v17, v17, v19
    v_mfma_f32_16x16x32_bf16 v[56:59], v[124:127], v[76:79], v[56:59]
    v_mfma_f32_16x16x32_bf16 v[164:167], v[128:131], v[44:47], v[164:167]
    ds_read_b64_tr_b16 v[128:129], v4 offset:40960
    ds_read_b64_tr_b16 v[130:131], v4 offset:45056
    v_mfma_f32_16x16x32_bf16 v[172:175], v[132:135], v[44:47], v[172:175]
    ds_read_b64_tr_b16 v[132:133], v5 offset:40960
    ds_read_b64_tr_b16 v[134:135], v5 offset:45056
    v_mfma_f32_16x16x32_bf16 v[180:183], v[136:139], v[44:47], v[180:183]
    ds_read_b64_tr_b16 v[136:137], v6 offset:40960
    ds_read_b64_tr_b16 v[138:139], v6 offset:45056
    v_exp_f32 v24, v48
    v_mfma_f32_16x16x32_bf16 v[188:191], v[140:143], v[44:47], v[188:191]
    ds_read_b64_tr_b16 v[140:141], v7 offset:40960
    ds_read_b64_tr_b16 v[142:143], v7 offset:45056
    v_exp_f32 v25, v49
    v_mfma_f32_16x16x32_bf16 v[196:199], v[144:147], v[44:47], v[196:199]
    v_exp_f32 v26, v50
    v_exp_f32 v27, v51
    v_mfma_f32_16x16x32_bf16 v[204:207], v[148:151], v[44:47], v[204:207]
    v_exp_f32 v28, v56
    v_mfma_f32_16x16x32_bf16 v[212:215], v[152:155], v[44:47], v[212:215]
    v_exp_f32 v29, v57
    v_exp_f32 v30, v58
    v_mfma_f32_16x16x32_bf16 v[220:223], v[156:159], v[44:47], v[220:223]
    v_exp_f32 v31, v59
    v_mfma_f32_16x16x32_bf16 v[52:55], v[96:99], v[80:83], v[36:39]
    ds_read_b64_tr_b16 v[144:145], v8 offset:40960
    ds_read_b64_tr_b16 v[146:147], v8 offset:45056
    v_cvt_pk_bf16_f32 v40, v24, v25
    v_cvt_pk_bf16_f32 v41, v26, v27
    v_mfma_f32_16x16x32_bf16 v[52:55], v[100:103], v[84:87], v[52:55]
    ds_read_b64_tr_b16 v[148:149], v9 offset:40960
    ds_read_b64_tr_b16 v[150:151], v9 offset:45056
    v_cvt_pk_bf16_f32 v42, v28, v29
    v_cvt_pk_bf16_f32 v43, v30, v31
    v_mfma_f32_16x16x32_bf16 v[52:55], v[104:107], v[88:91], v[52:55]
    s_waitcnt lgkmcnt(8)
    ds_read_b64_tr_b16 v[152:153], v10 offset:40960
    ds_read_b64_tr_b16 v[154:155], v10 offset:45056
    v_add_f32 v24, v24, v25
    v_add_f32 v26, v26, v27
    v_mfma_f32_16x16x32_bf16 v[52:55], v[108:111], v[92:95], v[52:55]
    ds_read_b64_tr_b16 v[156:157], v11 offset:40960
    ds_read_b64_tr_b16 v[158:159], v11 offset:45056
    v_add_f32 v28, v28, v29
    v_add_f32 v30, v30, v31
    v_mfma_f32_16x16x32_bf16 v[60:63], v[112:115], v[80:83], v[36:39]
    v_add_f32 v24, v24, v26
    v_add_f32 v28, v28, v30
    v_mfma_f32_16x16x32_bf16 v[60:63], v[116:119], v[84:87], v[60:63]
    v_add_f32 v18, v24, v28
    v_mfma_f32_16x16x32_bf16 v[60:63], v[120:123], v[88:91], v[60:63]
    v_cmp_lt_f32 vcc, s65, v18
    s_cbranch_vccnz m_a2_c14_0_slow
m_a2_c14_0_back:
    v_add_f32 v16, v16, v18
    v_mfma_f32_16x16x32_bf16 v[60:63], v[124:127], v[92:95], v[60:63]
    v_mfma_f32_16x16x32_bf16 v[160:163], v[128:131], v[40:43], v[160:163]
    ds_read_b128 v[96:99], v0 offset:49152
    ds_read_b128 v[100:103], v1 offset:49152
    v_mfma_f32_16x16x32_bf16 v[168:171], v[132:135], v[40:43], v[168:171]
    s_waitcnt lgkmcnt(12)
    ds_read_b128 v[104:107], v2 offset:49152
    ds_read_b128 v[108:111], v3 offset:49152
    v_mfma_f32_16x16x32_bf16 v[176:179], v[136:139], v[40:43], v[176:179]
    s_waitcnt lgkmcnt(12)
    ds_read_b128 v[112:115], v0 offset:53248
    ds_read_b128 v[116:119], v1 offset:53248
    v_exp_f32 v24, v52
    v_mfma_f32_16x16x32_bf16 v[184:187], v[140:143], v[40:43], v[184:187]
    s_waitcnt lgkmcnt(12)
    ds_read_b128 v[120:123], v2 offset:53248
    ds_read_b128 v[124:127], v3 offset:53248
    v_exp_f32 v25, v53
    v_mfma_f32_16x16x32_bf16 v[192:195], v[144:147], v[40:43], v[192:195]
    s_waitcnt lgkmcnt(12)
    v_exp_f32 v26, v54
    v_exp_f32 v27, v55
    v_mfma_f32_16x16x32_bf16 v[200:203], v[148:151], v[40:43], v[200:203]
    s_waitcnt lgkmcnt(10)
    v_exp_f32 v28, v60
    v_mfma_f32_16x16x32_bf16 v[208:211], v[152:155], v[40:43], v[208:211]
    s_waitcnt lgkmcnt(8)
    v_exp_f32 v29, v61
    v_exp_f32 v30, v62
    v_mfma_f32_16x16x32_bf16 v[216:219], v[156:159], v[40:43], v[216:219]
    v_exp_f32 v31, v63
    s_waitcnt lgkmcnt(0)
    s_barrier
    v_mfma_f32_16x16x32_bf16 v[48:51], v[96:99], v[64:67], v[32:35]
    v_cvt_pk_bf16_f32 v44, v24, v25
    v_cvt_pk_bf16_f32 v45, v26, v27
    v_mfma_f32_16x16x32_bf16 v[48:51], v[100:103], v[68:71], v[48:51]
    v_cvt_pk_bf16_f32 v46, v28, v29
    v_cvt_pk_bf16_f32 v47, v30, v31
    v_mfma_f32_16x16x32_bf16 v[48:51], v[104:107], v[72:75], v[48:51]
    v_add_f32 v24, v24, v25
    v_add_f32 v26, v26, v27
    v_mfma_f32_16x16x32_bf16 v[48:51], v[108:111], v[76:79], v[48:51]
    v_add_f32 v28, v28, v29
    v_add_f32 v30, v30, v31
    v_mfma_f32_16x16x32_bf16 v[56:59], v[112:115], v[64:67], v[32:35]
    v_add_f32 v24, v24, v26
    v_add_f32 v28, v28, v30
    v_mfma_f32_16x16x32_bf16 v[56:59], v[116:119], v[68:71], v[56:59]
    v_add_f32 v19, v24, v28
    v_mfma_f32_16x16x32_bf16 v[56:59], v[120:123], v[72:75], v[56:59]
    v_cmp_lt_f32 vcc, s65, v19
    s_cbranch_vccnz m_a2_c14_1_slow
m_a2_c14_1_back:
    v_add_f32 v17, v17, v19
    v_mfma_f32_16x16x32_bf16 v[56:59], v[124:127], v[76:79], v[56:59]
    v_mfma_f32_16x16x32_bf16 v[164:167], v[128:131], v[44:47], v[164:167]
    ds_read_b64_tr_b16 v[128:129], v4 offset:57344
    ds_read_b64_tr_b16 v[130:131], v4 offset:61440
    v_mfma_f32_16x16x32_bf16 v[172:175], v[132:135], v[44:47], v[172:175]
    ds_read_b64_tr_b16 v[132:133], v5 offset:57344
    ds_read_b64_tr_b16 v[134:135], v5 offset:61440
    v_mfma_f32_16x16x32_bf16 v[180:183], v[136:139], v[44:47], v[180:183]
    ds_read_b64_tr_b16 v[136:137], v6 offset:57344
    ds_read_b64_tr_b16 v[138:139], v6 offset:61440
    v_exp_f32 v24, v48
    v_mfma_f32_16x16x32_bf16 v[188:191], v[140:143], v[44:47], v[188:191]
    ds_read_b64_tr_b16 v[140:141], v7 offset:57344
    ds_read_b64_tr_b16 v[142:143], v7 offset:61440
    v_exp_f32 v25, v49
    v_mfma_f32_16x16x32_bf16 v[196:199], v[144:147], v[44:47], v[196:199]
    v_exp_f32 v26, v50
    v_exp_f32 v27, v51
    v_mfma_f32_16x16x32_bf16 v[204:207], v[148:151], v[44:47], v[204:207]
    v_exp_f32 v28, v56
    v_mfma_f32_16x16x32_bf16 v[212:215], v[152:155], v[44:47], v[212:215]
    v_exp_f32 v29, v57
    v_exp_f32 v30, v58
    v_mfma_f32_16x16x32_bf16 v[220:223], v[156:159], v[44:47], v[220:223]
    v_exp_f32 v31, v59
    v_mfma_f32_16x16x32_bf16 v[52:55], v[96:99], v[80:83], v[36:39]
    ds_read_b64_tr_b16 v[144:145], v8 offset:57344
    ds_read_b64_tr_b16 v[146:147], v8 offset:61440
    v_cvt_pk_bf16_f32 v40, v24, v25
    v_cvt_pk_bf16_f32 v41, v26, v27
    v_mfma_f32_16x16x32_bf16 v[52:55], v[100:103], v[84:87], v[52:55]
    ds_read_b64_tr_b16 v[148:149], v9 offset:57344
    ds_read_b64_tr_b16 v[150:151], v9 offset:61440
    v_cvt_pk_bf16_f32 v42, v28, v29
    v_cvt_pk_bf16_f32 v43, v30, v31
    v_mfma_f32_16x16x32_bf16 v[52:55], v[104:107], v[88:91], v[52:55]
    s_waitcnt lgkmcnt(8)
    ds_read_b64_tr_b16 v[152:153], v10 offset:57344
    ds_read_b64_tr_b16 v[154:155], v10 offset:61440
    v_add_f32 v24, v24, v25
    v_add_f32 v26, v26, v27
    v_mfma_f32_16x16x32_bf16 v[52:55], v[108:111], v[92:95], v[52:55]
    ds_read_b64_tr_b16 v[156:157], v11 offset:57344
    ds_read_b64_tr_b16 v[158:159], v11 offset:61440
    v_add_f32 v28, v28, v29
    v_add_f32 v30, v30, v31
    v_mfma_f32_16x16x32_bf16 v[60:63], v[112:115], v[80:83], v[36:39]
    v_add_f32 v24, v24, v26
    v_add_f32 v28, v28, v30
    v_mfma_f32_16x16x32_bf16 v[60:63], v[116:119], v[84:87], v[60:63]
    v_add_f32 v18, v24, v28
    v_mfma_f32_16x16x32_bf16 v[60:63], v[120:123], v[88:91], v[60:63]
    v_cmp_lt_f32 vcc, s65, v18
    s_cbranch_vccnz m_a2_c15_0_slow
m_a2_c15_0_back:
    v_add_f32 v16, v16, v18
    v_mfma_f32_16x16x32_bf16 v[60:63], v[124:127], v[92:95], v[60:63]
    v_mfma_f32_16x16x32_bf16 v[160:163], v[128:131], v[40:43], v[160:163]
    ds_read_b128 v[96:99], v0 offset:0
    ds_read_b128 v[100:103], v1 offset:0
    v_mfma_f32_16x16x32_bf16 v[168:171], v[132:135], v[40:43], v[168:171]
    s_waitcnt lgkmcnt(12)
    ds_read_b128 v[104:107], v2 offset:0
    ds_read_b128 v[108:111], v3 offset:0
    v_mfma_f32_16x16x32_bf16 v[176:179], v[136:139], v[40:43], v[176:179]
    s_waitcnt lgkmcnt(12)
    ds_read_b128 v[112:115], v0 offset:4096
    ds_read_b128 v[116:119], v1 offset:4096
    v_exp_f32 v24, v52
    v_mfma_f32_16x16x32_bf16 v[184:187], v[140:143], v[40:43], v[184:187]
    s_waitcnt lgkmcnt(12)
    ds_read_b128 v[120:123], v2 offset:4096
    ds_read_b128 v[124:127], v3 offset:4096
    v_exp_f32 v25, v53
    v_mfma_f32_16x16x32_bf16 v[192:195], v[144:147], v[40:43], v[192:195]
    s_waitcnt lgkmcnt(12)
    v_exp_f32 v26, v54
    v_exp_f32 v27, v55
    v_mfma_f32_16x16x32_bf16 v[200:203], v[148:151], v[40:43], v[200:203]
    s_waitcnt lgkmcnt(10)
    v_exp_f32 v28, v60
    v_mfma_f32_16x16x32_bf16 v[208:211], v[152:155], v[40:43], v[208:211]
    s_waitcnt lgkmcnt(8)
    v_exp_f32 v29, v61
    v_exp_f32 v30, v62
    v_mfma_f32_16x16x32_bf16 v[216:219], v[156:159], v[40:43], v[216:219]
    v_exp_f32 v31, v63
    v_cvt_pk_bf16_f32 v44, v24, v25
    v_cvt_pk_bf16_f32 v45, v26, v27
    v_cvt_pk_bf16_f32 v46, v28, v29
    v_cvt_pk_bf16_f32 v47, v30, v31
    v_add_f32 v24, v24, v25
    v_add_f32 v26, v26, v27
    v_add_f32 v28, v28, v29
    v_add_f32 v30, v30, v31
    v_add_f32 v24, v24, v26
    v_add_f32 v28, v28, v30
    v_add_f32 v19, v24, v28
    v_cmp_lt_f32 vcc, s65, v19
    s_cbranch_vccnz m_a2_c15_1_slow
m_a2_c15_1_back:
    v_add_f32 v17, v17, v19
    v_mfma_f32_16x16x32_bf16 v[164:167], v[128:131], v[44:47], v[164:167]
    v_mfma_f32_16x16x32_bf16 v[172:175], v[132:135], v[44:47], v[172:175]
    v_mfma_f32_16x16x32_bf16 v[180:183], v[136:139], v[44:47], v[180:183]
    v_mfma_f32_16x16x32_bf16 v[188:191], v[140:143], v[44:47], v[188:191]
    v_mfma_f32_16x16x32_bf16 v[196:199], v[144:147], v[44:47], v[196:199]
    v_mfma_f32_16x16x32_bf16 v[204:207], v[148:151], v[44:47], v[204:207]
    v_mfma_f32_16x16x32_bf16 v[212:215], v[152:155], v[44:47], v[212:215]
    v_mfma_f32_16x16x32_bf16 v[220:223], v[156:159], v[44:47], v[220:223]
    s_waitcnt lgkmcnt(0)
    v_mov_b32 v22, v16
    s_nop 1
    v_permlane16_swap_b32 v16, v22
    v_add_f32 v16, v16, v22
    v_mov_b32 v22, v16
    s_nop 1
    v_permlane32_swap_b32 v16, v22
    v_add_f32 v16, v16, v22
    v_rcp_f32 v16, v16
    v_mov_b32 v22, v17
    s_nop 1
    v_permlane16_swap_b32 v17, v22
    v_add_f32 v17, v17, v22
    v_mov_b32 v22, v17
    s_nop 1
    v_permlane32_swap_b32 v17, v22
    v_add_f32 v17, v17, v22
    v_rcp_f32 v17, v17
    v_mul_f32 v160, v160, v16
    v_mul_f32 v161, v161, v16
    v_mul_f32 v162, v162, v16
    v_mul_f32 v163, v163, v16
    v_cvt_pk_bf16_f32 v128, v160, v161
    v_cvt_pk_bf16_f32 v129, v162, v163
    v_mul_f32 v168, v168, v16
    v_mul_f32 v169, v169, v16
    v_mul_f32 v170, v170, v16
    v_mul_f32 v171, v171, v16
    v_cvt_pk_bf16_f32 v130, v168, v169
    v_cvt_pk_bf16_f32 v131, v170, v171
    v_mul_f32 v176, v176, v16
    v_mul_f32 v177, v177, v16
    v_mul_f32 v178, v178, v16
    v_mul_f32 v179, v179, v16
    v_cvt_pk_bf16_f32 v132, v176, v177
    v_cvt_pk_bf16_f32 v133, v178, v179
    v_mul_f32 v184, v184, v16
    v_mul_f32 v185, v185, v16
    v_mul_f32 v186, v186, v16
    v_mul_f32 v187, v187, v16
    v_cvt_pk_bf16_f32 v134, v184, v185
    v_cvt_pk_bf16_f32 v135, v186, v187
    v_mul_f32 v192, v192, v16
    v_mul_f32 v193, v193, v16
    v_mul_f32 v194, v194, v16
    v_mul_f32 v195, v195, v16
    v_cvt_pk_bf16_f32 v136, v192, v193
    v_cvt_pk_bf16_f32 v137, v194, v195
    v_mul_f32 v200, v200, v16
    v_mul_f32 v201, v201, v16
    v_mul_f32 v202, v202, v16
    v_mul_f32 v203, v203, v16
    v_cvt_pk_bf16_f32 v138, v200, v201
    v_cvt_pk_bf16_f32 v139, v202, v203
    v_mul_f32 v208, v208, v16
    v_mul_f32 v209, v209, v16
    v_mul_f32 v210, v210, v16
    v_mul_f32 v211, v211, v16
    v_cvt_pk_bf16_f32 v140, v208, v209
    v_cvt_pk_bf16_f32 v141, v210, v211
    v_mul_f32 v216, v216, v16
    v_mul_f32 v217, v217, v16
    v_mul_f32 v218, v218, v16
    v_mul_f32 v219, v219, v16
    v_cvt_pk_bf16_f32 v142, v216, v217
    v_cvt_pk_bf16_f32 v143, v218, v219
    v_mul_f32 v164, v164, v17
    v_mul_f32 v165, v165, v17
    v_mul_f32 v166, v166, v17
    v_mul_f32 v167, v167, v17
    v_cvt_pk_bf16_f32 v144, v164, v165
    v_cvt_pk_bf16_f32 v145, v166, v167
    v_mul_f32 v172, v172, v17
    v_mul_f32 v173, v173, v17
    v_mul_f32 v174, v174, v17
    v_mul_f32 v175, v175, v17
    v_cvt_pk_bf16_f32 v146, v172, v173
    v_cvt_pk_bf16_f32 v147, v174, v175
    v_mul_f32 v180, v180, v17
    v_mul_f32 v181, v181, v17
    v_mul_f32 v182, v182, v17
    v_mul_f32 v183, v183, v17
    v_cvt_pk_bf16_f32 v148, v180, v181
    v_cvt_pk_bf16_f32 v149, v182, v183
    v_mul_f32 v188, v188, v17
    v_mul_f32 v189, v189, v17
    v_mul_f32 v190, v190, v17
    v_mul_f32 v191, v191, v17
    v_cvt_pk_bf16_f32 v150, v188, v189
    v_cvt_pk_bf16_f32 v151, v190, v191
    v_mul_f32 v196, v196, v17
    v_mul_f32 v197, v197, v17
    v_mul_f32 v198, v198, v17
    v_mul_f32 v199, v199, v17
    v_cvt_pk_bf16_f32 v152, v196, v197
    v_cvt_pk_bf16_f32 v153, v198, v199
    v_mul_f32 v204, v204, v17
    v_mul_f32 v205, v205, v17
    v_mul_f32 v206, v206, v17
    v_mul_f32 v207, v207, v17
    v_cvt_pk_bf16_f32 v154, v204, v205
    v_cvt_pk_bf16_f32 v155, v206, v207
    v_mul_f32 v212, v212, v17
    v_mul_f32 v213, v213, v17
    v_mul_f32 v214, v214, v17
    v_mul_f32 v215, v215, v17
    v_cvt_pk_bf16_f32 v156, v212, v213
    v_cvt_pk_bf16_f32 v157, v214, v215
    v_mul_f32 v220, v220, v17
    v_mul_f32 v221, v221, v17
    v_mul_f32 v222, v222, v17
    v_mul_f32 v223, v223, v17
    v_cvt_pk_bf16_f32 v158, v220, v221
    v_cvt_pk_bf16_f32 v159, v222, v223
    s_cmp_eq_u32 s29, 1
    s_cbranch_scc0 m_a2_e2
    v_mov_b32 v224, v128
    v_mov_b32 v225, v129
    v_mov_b32 v226, v130
    v_mov_b32 v227, v131
    v_mov_b32 v228, v132
    v_mov_b32 v229, v133
    v_mov_b32 v230, v134
    v_mov_b32 v231, v135
    v_mov_b32 v232, v136
    v_mov_b32 v233, v137
    v_mov_b32 v234, v138
    v_mov_b32 v235, v139
    v_mov_b32 v236, v140
    v_mov_b32 v237, v141
    v_mov_b32 v238, v142
    v_mov_b32 v239, v143
    v_mov_b32 v240, v144
    v_mov_b32 v241, v145
    v_mov_b32 v242, v146
    v_mov_b32 v243, v147
    v_mov_b32 v244, v148
    v_mov_b32 v245, v149
    v_mov_b32 v246, v150
    v_mov_b32 v247, v151
    v_mov_b32 v248, v152
    v_mov_b32 v249, v153
    v_mov_b32 v250, v154
    v_mov_b32 v251, v155
    v_mov_b32 v252, v156
    v_mov_b32 v253, v157
    v_mov_b32 v254, v158
    v_mov_b32 v255, v159
m_a2_e2:
    s_add_u32 s63, s63, 28672
    s_add_u32 s29, s29, 1
    s_mov_b32 s85, 106496
    s_cmp_eq_u32 s29, 1
    s_cselect_b32 s85, 135168, s85
    s_cmp_eq_u32 s29, 2
    s_cselect_b32 s85, 65536, s85
    s_cmp_lt_u32 s29, 4
    s_cbranch_scc1 m_a2_loop
    v_add_u32 v12, 106496, v13
    s_waitcnt vmcnt(0)
    ds_read_b128 v[160:163], v12 offset:28672
    ds_read_b128 v[164:167], v12 offset:29696
    ds_read_b128 v[168:171], v12 offset:30720
    ds_read_b128 v[172:175], v12 offset:31744
    ds_read_b128 v[176:179], v12 offset:32768
    ds_read_b128 v[180:183], v12 offset:33792
    ds_read_b128 v[184:187], v12 offset:34816
    ds_read_b128 v[188:191], v12 offset:35840
    ds_read_b128 v[192:195], v12 offset:0
    ds_read_b128 v[196:199], v12 offset:1024
    ds_read_b128 v[200:203], v12 offset:2048
    ds_read_b128 v[204:207], v12 offset:3072
    ds_read_b128 v[208:211], v12 offset:4096
    ds_read_b128 v[212:215], v12 offset:5120
    ds_read_b128 v[216:219], v12 offset:6144
    s_waitcnt lgkmcnt(14)
    ds_read_b128 v[220:223], v12 offset:7168
    s_mov_b32 s12, s58
    s_and_b32 s13, s59, 0xffff
    s_mov_b32 s14, 5242880
    s_mov_b32 s15, 0x00020000
    s_lshl_b32 s70, s25, 4
    s_add_u32 s70, s70, s26
    s_lshl_b32 s70, s70, 3
    s_add_u32 s70, s70, s27
    s_mul_i32 s70, s70, 163840
    s_add_u32 s4, s56, s70
    s_addc_u32 s5, s57, 0
    s_and_b32 s5, s5, 0xffff
    s_mov_b32 s6, 163840
    s_mov_b32 s7, 0x00020000
    s_mul_i32 s70, s28, 5120
    s_add_u32 s72, s70, 102400
    s_add_u32 s73, s70, 0
    s_add_u32 s74, s70, 40960
    s_add_u32 s97, s70, 61440
    s_mul_i32 s75, s27, 655360
    s_mov_b32 s76, 0
    v_mbcnt_lo_u32_b32 v0, -1, 0
    v_mbcnt_hi_u32_b32 v0, -1, v0
    s_lshl_b32 s71, s28, 5
    s_mov_b32 s77, 6554
    v_add_u32 v56, 0, v0
    v_mul_lo_u32 v57, v56, s77
    v_lshrrev_b32 v57, 16, v57
    v_mul_u32_u24 v58, 10, v57
    v_sub_u32 v58, v56, v58
    v_add_u32 v57, s71, v57
    v_mul_u32_u24 v57, 1280, v57
    v_lshl_add_u32 v4, v58, 4, v57
    v_add_u32 v56, 64, v0
    v_mul_lo_u32 v57, v56, s77
    v_lshrrev_b32 v57, 16, v57
    v_mul_u32_u24 v58, 10, v57
    v_sub_u32 v58, v56, v58
    v_add_u32 v57, s71, v57
    v_mul_u32_u24 v57, 1280, v57
    v_lshl_add_u32 v5, v58, 4, v57
    v_add_u32 v56, 128, v0
    v_mul_lo_u32 v57, v56, s77
    v_lshrrev_b32 v57, 16, v57
    v_mul_u32_u24 v58, 10, v57
    v_sub_u32 v58, v56, v58
    v_add_u32 v57, s71, v57
    v_mul_u32_u24 v57, 1280, v57
    v_lshl_add_u32 v6, v58, 4, v57
    v_add_u32 v56, 192, v0
    v_mul_lo_u32 v57, v56, s77
    v_lshrrev_b32 v57, 16, v57
    v_mul_u32_u24 v58, 10, v57
    v_sub_u32 v58, v56, v58
    v_add_u32 v57, s71, v57
    v_mul_u32_u24 v57, 1280, v57
    v_lshl_add_u32 v7, v58, 4, v57
    v_add_u32 v56, 256, v0
    v_mul_lo_u32 v57, v56, s77
    v_lshrrev_b32 v57, 16, v57
    v_mul_u32_u24 v58, 10, v57
    v_sub_u32 v58, v56, v58
    v_add_u32 v57, s71, v57
    v_mul_u32_u24 v57, 1280, v57
    v_lshl_add_u32 v8, v58, 4, v57
    v_lshrrev_b32 v56, 4, v0
    v_bfe_u32 v57, v0, 2, 2
    v_lshl_add_u32 v57, v56, 2, v57
    v_mul_u32_u24 v57, 160, v57
    v_and_b32 v58, 3, v0
    v_lshl_add_u32 v57, v58, 3, v57
    v_add_u32 v9, 102400, v57
    v_add_u32 v10, 0, v57
    v_add_u32 v11, 40960, v57
    v_add_u32 v63, 61440, v57
    v_add_u32 v61, 65536, v57
    v_lshlrev_b32 v57, 4, v0
    v_add_u32 v59, s70, v57
    s_lshl_b32 s71, s28, 13
    v_add_u32 v1, s71, v57
    s_lshl_b32 s70, s25, 4
    s_add_u32 s70, s70, s26
    s_lshl_b32 s71, s70, 10
    s_add_u32 s71, s71, 46137344
    s_add_u32 s88, s56, s71
    s_addc_u32 s89, s57, 0
    s_and_b32 s89, s89, 0xffff
    s_mov_b32 s90, 1024
    s_mov_b32 s91, 0x00020000
    s_mov_b32 s92, s86
    s_and_b32 s93, s87, 0xffff
    s_mov_b32 s94, 256
    s_mov_b32 s95, 0x00020000
    s_lshl_b32 s96, s70, 2
    s_add_u32 s96, s96, 128
    s_waitcnt lgkmcnt(0)
    ds_write_b128 v12, v[128:131] offset:0
    ds_write_b128 v12, v[132:135] offset:1024
    ds_write_b128 v12, v[136:139] offset:2048
    ds_write_b128 v12, v[140:143] offset:3072
    ds_write_b128 v12, v[144:147] offset:4096
    ds_write_b128 v12, v[148:151] offset:5120
    ds_write_b128 v12, v[152:155] offset:6144
    ds_write_b128 v12, v[156:159] offset:7168
    s_waitcnt lgkmcnt(0)
    s_barrier
    s_add_u32 s62, s75, 163840
    s_add_u32 m0, s73, 0
    s_nop 0
    buffer_load_dwordx4 v4, s[12:15], s62 offen lds
    s_add_u32 m0, s73, 1024
    s_nop 0
    buffer_load_dwordx4 v5, s[12:15], s62 offen lds
    s_add_u32 m0, s73, 2048
    s_nop 0
    buffer_load_dwordx4 v6, s[12:15], s62 offen lds
    s_add_u32 m0, s73, 3072
    s_nop 0
    buffer_load_dwordx4 v7, s[12:15], s62 offen lds
    s_add_u32 m0, s73, 4096
    s_nop 0
    buffer_load_dwordx4 v8, s[12:15], s62 offen lds
    s_branch m_tail2
m_a2_c1_0_slow:
    s_call_b64 s[30:31], m_a2_slow0
    s_branch m_a2_c1_0_back
m_a2_c1_1_slow:
    s_call_b64 s[30:31], m_a2_slow1
    s_branch m_a2_c1_1_back
m_a2_c2_0_slow:
    s_call_b64 s[30:31], m_a2_slow0
    s_branch m_a2_c2_0_back
m_a2_c2_1_slow:
    s_call_b64 s[30:31], m_a2_slow1
    s_branch m_a2_c2_1_back
m_a2_c3_0_slow:
    s_call_b64 s[30:31], m_a2_slow0
    s_branch m_a2_c3_0_back
m_a2_c3_1_slow:
    s_call_b64 s[30:31], m_a2_slow1
    s_branch m_a2_c3_1_back
m_a2_c4_0_slow:
    s_call_b64 s[30:31], m_a2_slow0
    s_branch m_a2_c4_0_back
m_a2_c4_1_slow:
    s_call_b64 s[30:31], m_a2_slow1
    s_branch m_a2_c4_1_back
m_a2_c5_0_slow:
    s_call_b64 s[30:31], m_a2_slow0
    s_branch m_a2_c5_0_back
m_a2_c5_1_slow:
    s_call_b64 s[30:31], m_a2_slow1
    s_branch m_a2_c5_1_back
m_a2_c6_0_slow:
    s_call_b64 s[30:31], m_a2_slow0
    s_branch m_a2_c6_0_back
m_a2_c6_1_slow:
    s_call_b64 s[30:31], m_a2_slow1
    s_branch m_a2_c6_1_back
m_a2_c7_0_slow:
    s_call_b64 s[30:31], m_a2_slow0
    s_branch m_a2_c7_0_back
m_a2_c7_1_slow:
    s_call_b64 s[30:31], m_a2_slow1
    s_branch m_a2_c7_1_back
m_a2_c8_0_slow:
    s_call_b64 s[30:31], m_a2_slow0
    s_branch m_a2_c8_0_back
m_a2_c8_1_slow:
    s_call_b64 s[30:31], m_a2_slow1
    s_branch m_a2_c8_1_back
m_a2_c9_0_slow:
    s_call_b64 s[30:31], m_a2_slow0
    s_branch m_a2_c9_0_back
m_a2_c9_1_slow:
    s_call_b64 s[30:31], m_a2_slow1
    s_branch m_a2_c9_1_back
m_a2_c10_0_slow:
    s_call_b64 s[30:31], m_a2_slow0
    s_branch m_a2_c10_0_back
m_a2_c10_1_slow:
    s_call_b64 s[30:31], m_a2_slow1
    s_branch m_a2_c10_1_back
m_a2_c11_0_slow:
    s_call_b64 s[30:31], m_a2_slow0
    s_branch m_a2_c11_0_back
m_a2_c11_1_slow:
    s_call_b64 s[30:31], m_a2_slow1
    s_branch m_a2_c11_1_back
m_a2_c12_0_slow:
    s_call_b64 s[30:31], m_a2_slow0
    s_branch m_a2_c12_0_back
m_a2_c12_1_slow:
    s_call_b64 s[30:31], m_a2_slow1
    s_branch m_a2_c12_1_back
m_a2_c13_0_slow:
    s_call_b64 s[30:31], m_a2_slow0
    s_branch m_a2_c13_0_back
m_a2_c13_1_slow:
    s_call_b64 s[30:31], m_a2_slow1
    s_branch m_a2_c13_1_back
m_a2_c14_0_slow:
    s_call_b64 s[30:31], m_a2_slow0
    s_branch m_a2_c14_0_back
m_a2_c14_1_slow:
    s_call_b64 s[30:31], m_a2_slow1
    s_branch m_a2_c14_1_back
m_a2_c15_0_slow:
    s_call_b64 s[30:31], m_a2_slow0
    s_branch m_a2_c15_0_back
m_a2_c15_1_slow:
    s_call_b64 s[30:31], m_a2_slow1
    s_branch m_a2_c15_1_back
m_a2_slow0:
    s_nop 7
    v_max3_f32 v20, v48, v49, v50
    v_max3_f32 v22, v56, v57, v58
    v_max3_f32 v20, v20, v51, v59
    v_max_f32 v20, v20, v22
    v_mov_b32 v22, v20
    s_nop 1
    v_permlane16_swap_b32 v20, v22
    v_max_f32 v20, v20, v22
    v_mov_b32 v22, v20
    s_nop 1
    v_permlane32_swap_b32 v20, v22
    v_max_f32 v20, v20, v22
    v_max_f32 v20, 0, v20
    v_sub_f32 v22, 0, v20
    v_exp_f32 v23, v22
    v_sub_f32 v32, v32, v20
    v_sub_f32 v33, v33, v20
    v_sub_f32 v34, v34, v20
    v_sub_f32 v35, v35, v20
    v_sub_f32 v48, v48, v20
    v_sub_f32 v49, v49, v20
    v_sub_f32 v50, v50, v20
    v_sub_f32 v51, v51, v20
    v_sub_f32 v56, v56, v20
    v_sub_f32 v57, v57, v20
    v_sub_f32 v58, v58, v20
    v_sub_f32 v59, v59, v20
    v_mul_f32 v16, v16, v23
    v_mul_f32 v160, v160, v23
    v_mul_f32 v161, v161, v23
    v_mul_f32 v162, v162, v23
    v_mul_f32 v163, v163, v23
    v_mul_f32 v168, v168, v23
    v_mul_f32 v169, v169, v23
    v_mul_f32 v170, v170, v23
    v_mul_f32 v171, v171, v23
    v_mul_f32 v176, v176, v23
    v_mul_f32 v177, v177, v23
    v_mul_f32 v178, v178, v23
    v_mul_f32 v179, v179, v23
    v_mul_f32 v184, v184, v23
    v_mul_f32 v185, v185, v23
    v_mul_f32 v186, v186, v23
    v_mul_f32 v187, v187, v23
    v_mul_f32 v192, v192, v23
    v_mul_f32 v193, v193, v23
    v_mul_f32 v194, v194, v23
    v_mul_f32 v195, v195, v23
    v_mul_f32 v200, v200, v23
    v_mul_f32 v201, v201, v23
    v_mul_f32 v202, v202, v23
    v_mul_f32 v203, v203, v23
    v_mul_f32 v208, v208, v23
    v_mul_f32 v209, v209, v23
    v_mul_f32 v210, v210, v23
    v_mul_f32 v211, v211, v23
    v_mul_f32 v216, v216, v23
    v_mul_f32 v217, v217, v23
    v_mul_f32 v218, v218, v23
    v_mul_f32 v219, v219, v23
    v_exp_f32 v24, v48
    v_exp_f32 v25, v49
    v_exp_f32 v26, v50
    v_exp_f32 v27, v51
    v_exp_f32 v28, v56
    v_exp_f32 v29, v57
    v_exp_f32 v30, v58
    v_exp_f32 v31, v59
    v_cvt_pk_bf16_f32 v40, v24, v25
    v_cvt_pk_bf16_f32 v41, v26, v27
    v_cvt_pk_bf16_f32 v42, v28, v29
    v_cvt_pk_bf16_f32 v43, v30, v31
    v_add_f32 v24, v24, v25
    v_add_f32 v26, v26, v27
    v_add_f32 v28, v28, v29
    v_add_f32 v30, v30, v31
    v_add_f32 v24, v24, v26
    v_add_f32 v28, v28, v30
    v_add_f32 v18, v24, v28
    s_nop 7
    s_setpc_b64 s[30:31]
m_a2_slow1:
    s_nop 7
    v_max3_f32 v21, v52, v53, v54
    v_max3_f32 v22, v60, v61, v62
    v_max3_f32 v21, v21, v55, v63
    v_max_f32 v21, v21, v22
    v_mov_b32 v22, v21
    s_nop 1
    v_permlane16_swap_b32 v21, v22
    v_max_f32 v21, v21, v22
    v_mov_b32 v22, v21
    s_nop 1
    v_permlane32_swap_b32 v21, v22
    v_max_f32 v21, v21, v22
    v_max_f32 v21, 0, v21
    v_sub_f32 v22, 0, v21
    v_exp_f32 v23, v22
    v_sub_f32 v36, v36, v21
    v_sub_f32 v37, v37, v21
    v_sub_f32 v38, v38, v21
    v_sub_f32 v39, v39, v21
    v_sub_f32 v52, v52, v21
    v_sub_f32 v53, v53, v21
    v_sub_f32 v54, v54, v21
    v_sub_f32 v55, v55, v21
    v_sub_f32 v60, v60, v21
    v_sub_f32 v61, v61, v21
    v_sub_f32 v62, v62, v21
    v_sub_f32 v63, v63, v21
    v_mul_f32 v17, v17, v23
    v_mul_f32 v164, v164, v23
    v_mul_f32 v165, v165, v23
    v_mul_f32 v166, v166, v23
    v_mul_f32 v167, v167, v23
    v_mul_f32 v172, v172, v23
    v_mul_f32 v173, v173, v23
    v_mul_f32 v174, v174, v23
    v_mul_f32 v175, v175, v23
    v_mul_f32 v180, v180, v23
    v_mul_f32 v181, v181, v23
    v_mul_f32 v182, v182, v23
    v_mul_f32 v183, v183, v23
    v_mul_f32 v188, v188, v23
    v_mul_f32 v189, v189, v23
    v_mul_f32 v190, v190, v23
    v_mul_f32 v191, v191, v23
    v_mul_f32 v196, v196, v23
    v_mul_f32 v197, v197, v23
    v_mul_f32 v198, v198, v23
    v_mul_f32 v199, v199, v23
    v_mul_f32 v204, v204, v23
    v_mul_f32 v205, v205, v23
    v_mul_f32 v206, v206, v23
    v_mul_f32 v207, v207, v23
    v_mul_f32 v212, v212, v23
    v_mul_f32 v213, v213, v23
    v_mul_f32 v214, v214, v23
    v_mul_f32 v215, v215, v23
    v_mul_f32 v220, v220, v23
    v_mul_f32 v221, v221, v23
    v_mul_f32 v222, v222, v23
    v_mul_f32 v223, v223, v23
    v_exp_f32 v24, v52
    v_exp_f32 v25, v53
    v_exp_f32 v26, v54
    v_exp_f32 v27, v55
    v_exp_f32 v28, v60
    v_exp_f32 v29, v61
    v_exp_f32 v30, v62
    v_exp_f32 v31, v63
    v_cvt_pk_bf16_f32 v44, v24, v25
    v_cvt_pk_bf16_f32 v45, v26, v27
    v_cvt_pk_bf16_f32 v46, v28, v29
    v_cvt_pk_bf16_f32 v47, v30, v31
    v_add_f32 v24, v24, v25
    v_add_f32 v26, v26, v27
    v_add_f32 v28, v28, v29
    v_add_f32 v30, v30, v31
    v_add_f32 v24, v24, v26
    v_add_f32 v28, v28, v30
    v_add_f32 v19, v24, v28
    s_nop 7
    s_setpc_b64 s[30:31]
m_p2:
    s_sub_u32 s28, s24, 4
    s_setprio 0
    s_lshl_b32 s66, s28, 11
    s_mov_b32 s60, 0
    v_lshrrev_b32 v1, 4, v255
    s_lshl_b32 s70, s28, 3
    v_add_u32 v4, s70, v1
    v_and_b32 v5, 15, v255
    v_add_u32 v6, 0, v4
    v_and_b32 v7, 15, v6
    v_xor_b32 v7, v7, v5
    v_lshlrev_b32 v7, 4, v7
    v_lshl_add_u32 v13, v4, 8, v7
    v_and_b32 v7, 7, v6
    v_lshlrev_b32 v7, 1, v7
    v_xor_b32 v7, v7, v5
    v_lshlrev_b32 v7, 4, v7
    v_lshl_add_u32 v15, v4, 8, v7
    v_add_u32 v6, 4, v4
    v_and_b32 v7, 15, v6
    v_xor_b32 v7, v7, v5
    v_lshlrev_b32 v7, 4, v7
    v_lshl_add_u32 v14, v4, 8, v7
    v_and_b32 v7, 7, v6
    v_lshlrev_b32 v7, 1, v7
    v_xor_b32 v7, v7, v5
    v_lshlrev_b32 v7, 4, v7
    v_lshl_add_u32 v16, v4, 8, v7
    s_waitcnt vmcnt(4)
    s_barrier
    s_add_u32 s62, s84, 32768
    s_and_b32 s62, s62, 0x1ffff
    s_add_u32 s62, s62, s60
    s_add_u32 m0, s66, 0
    s_nop 0
    buffer_load_dwordx4 v13, s[4:7], s62 offen nt lds
    buffer_load_dwordx4 v14, s[4:7], s62 offen offset:1024 nt lds
    s_add_u32 s62, s84, 24576
    s_and_b32 s62, s62, 0x1ffff
    s_add_u32 s62, s62, s60
    s_add_u32 m0, s66, 57344
    s_nop 0
    buffer_load_dwordx4 v15, s[8:11], s62 offen nt lds
    buffer_load_dwordx4 v16, s[8:11], s62 offen offset:1024 nt lds
    s_waitcnt vmcnt(6)
    s_barrier
    s_add_u32 s62, s84, 40960
    s_and_b32 s62, s62, 0x1ffff
    s_add_u32 s62, s62, s60
    s_add_u32 m0, s66, 16384
    s_nop 0
    buffer_load_dwordx4 v13, s[4:7], s62 offen nt lds
    buffer_load_dwordx4 v14, s[4:7], s62 offen offset:1024 nt lds
    s_add_u32 s62, s84, 32768
    s_and_b32 s62, s62, 0x1ffff
    s_add_u32 s62, s62, s60
    s_add_u32 m0, s66, 8192
    s_nop 0
    buffer_load_dwordx4 v15, s[8:11], s62 offen nt lds
    buffer_load_dwordx4 v16, s[8:11], s62 offen offset:1024 nt lds
    s_cmp_lt_u32 s28, 2
    s_cbranch_scc1 m_p2_noq3
    ds_write_b64 v248, v[128:129] offset:0
    ds_write_b64 v248, v[132:133] offset:4096
    ds_write_b64 v248, v[136:137] offset:8192
    ds_write_b64 v248, v[140:141] offset:12288
    ds_write_b64 v248, v[144:145] offset:16384
    ds_write_b64 v248, v[148:149] offset:20480
    ds_write_b64 v248, v[152:153] offset:24576
    ds_write_b64 v248, v[156:157] offset:512
    ds_write_b64 v248, v[160:161] offset:4608
    ds_write_b64 v248, v[164:165] offset:8704
    ds_write_b64 v248, v[168:169] offset:12800
    ds_write_b64 v248, v[172:173] offset:16896
    ds_write_b64 v248, v[176:177] offset:20992
    ds_write_b64 v248, v[180:181] offset:25088
    ds_write_b64 v248, v[184:185] offset:1024
    s_waitcnt lgkmcnt(14)
    ds_write_b64 v248, v[188:189] offset:5120
    s_waitcnt lgkmcnt(14)
    ds_write_b64 v248, v[192:193] offset:9216
    s_waitcnt lgkmcnt(14)
    ds_write_b64 v248, v[196:197] offset:13312
    s_waitcnt lgkmcnt(14)
    ds_write_b64 v248, v[200:201] offset:17408
    s_waitcnt lgkmcnt(14)
    ds_write_b64 v248, v[204:205] offset:21504
    s_waitcnt lgkmcnt(14)
    ds_write_b64 v248, v[208:209] offset:25600
    s_waitcnt lgkmcnt(14)
    ds_write_b64 v248, v[212:213] offset:1536
    s_waitcnt lgkmcnt(14)
    ds_write_b64 v248, v[216:217] offset:5632
    s_waitcnt lgkmcnt(14)
    ds_write_b64 v248, v[220:221] offset:9728
    s_waitcnt lgkmcnt(14)
    ds_write_b64 v248, v[224:225] offset:13824
    s_waitcnt lgkmcnt(14)
    ds_write_b64 v248, v[228:229] offset:17920
    s_waitcnt lgkmcnt(14)
    ds_write_b64 v248, v[232:233] offset:22016
    s_waitcnt lgkmcnt(14)
    ds_write_b64 v248, v[236:237] offset:26112
    s_waitcnt lgkmcnt(0)
m_p2_noq3:
    s_waitcnt vmcnt(8)
    s_barrier
    s_add_u32 s62, s84, 49152
    s_and_b32 s62, s62, 0x1ffff
    s_add_u32 s62, s62, s60
    s_add_u32 m0, s66, 32768
    s_nop 0
    buffer_load_dwordx4 v13, s[4:7], s62 offen nt lds
    buffer_load_dwordx4 v14, s[4:7], s62 offen offset:1024 nt lds
    s_add_u32 s62, s84, 40960
    s_and_b32 s62, s62, 0x1ffff
    s_add_u32 s62, s62, s60
    s_add_u32 m0, s66, 24576
    s_nop 0
    buffer_load_dwordx4 v15, s[8:11], s62 offen nt lds
    buffer_load_dwordx4 v16, s[8:11], s62 offen offset:1024 nt lds
    s_waitcnt vmcnt(8)
    s_barrier
    s_add_u32 s62, s84, 57344
    s_and_b32 s62, s62, 0x1ffff
    s_add_u32 s62, s62, s60
    s_add_u32 m0, s66, 49152
    s_nop 0
    buffer_load_dwordx4 v13, s[4:7], s62 offen nt lds
    buffer_load_dwordx4 v14, s[4:7], s62 offen offset:1024 nt lds
    s_add_u32 s62, s84, 49152
    s_and_b32 s62, s62, 0x1ffff
    s_add_u32 s62, s62, s60
    s_add_u32 m0, s66, 40960
    s_nop 0
    buffer_load_dwordx4 v15, s[8:11], s62 offen nt lds
    buffer_load_dwordx4 v16, s[8:11], s62 offen offset:1024 nt lds
    s_waitcnt vmcnt(8)
    s_barrier
    s_add_u32 s62, s84, 65536
    s_and_b32 s62, s62, 0x1ffff
    s_add_u32 s62, s62, s60
    s_add_u32 m0, s66, 0
    s_nop 0
    buffer_load_dwordx4 v13, s[4:7], s62 offen nt lds
    buffer_load_dwordx4 v14, s[4:7], s62 offen offset:1024 nt lds
    s_add_u32 s62, s84, 57344
    s_and_b32 s62, s62, 0x1ffff
    s_add_u32 s62, s62, s60
    s_add_u32 m0, s66, 57344
    s_nop 0
    buffer_load_dwordx4 v15, s[8:11], s62 offen nt lds
    buffer_load_dwordx4 v16, s[8:11], s62 offen offset:1024 nt lds
    s_waitcnt vmcnt(8)
    s_barrier
    s_add_u32 s62, s84, 73728
    s_and_b32 s62, s62, 0x1ffff
    s_add_u32 s62, s62, s60
    s_add_u32 m0, s66, 16384
    s_nop 0
    buffer_load_dwordx4 v13, s[4:7], s62 offen nt lds
    buffer_load_dwordx4 v14, s[4:7], s62 offen offset:1024 nt lds
    s_add_u32 s62, s84, 65536
    s_and_b32 s62, s62, 0x1ffff
    s_add_u32 s62, s62, s60
    s_add_u32 m0, s66, 8192
    s_nop 0
    buffer_load_dwordx4 v15, s[8:11], s62 offen nt lds
    buffer_load_dwordx4 v16, s[8:11], s62 offen offset:1024 nt lds
    s_waitcnt vmcnt(8)
    s_barrier
    s_add_u32 s62, s84, 81920
    s_and_b32 s62, s62, 0x1ffff
    s_add_u32 s62, s62, s60
    s_add_u32 m0, s66, 32768
    s_nop 0
    buffer_load_dwordx4 v13, s[4:7], s62 offen nt lds
    buffer_load_dwordx4 v14, s[4:7], s62 offen offset:1024 nt lds
    s_add_u32 s62, s84, 73728
    s_and_b32 s62, s62, 0x1ffff
    s_add_u32 s62, s62, s60
    s_add_u32 m0, s66, 24576
    s_nop 0
    buffer_load_dwordx4 v15, s[8:11], s62 offen nt lds
    buffer_load_dwordx4 v16, s[8:11], s62 offen offset:1024 nt lds
    s_waitcnt vmcnt(8)
    s_barrier
    s_add_u32 s62, s84, 90112
    s_and_b32 s62, s62, 0x1ffff
    s_add_u32 s62, s62, s60
    s_add_u32 m0, s66, 49152
    s_nop 0
    buffer_load_dwordx4 v13, s[4:7], s62 offen nt lds
    buffer_load_dwordx4 v14, s[4:7], s62 offen offset:1024 nt lds
    s_add_u32 s62, s84, 81920
    s_and_b32 s62, s62, 0x1ffff
    s_add_u32 s62, s62, s60
    s_add_u32 m0, s66, 40960
    s_nop 0
    buffer_load_dwordx4 v15, s[8:11], s62 offen nt lds
    buffer_load_dwordx4 v16, s[8:11], s62 offen offset:1024 nt lds
    s_waitcnt vmcnt(8)
    s_barrier
    s_add_u32 s62, s84, 98304
    s_and_b32 s62, s62, 0x1ffff
    s_add_u32 s62, s62, s60
    s_add_u32 m0, s66, 0
    s_nop 0
    buffer_load_dwordx4 v13, s[4:7], s62 offen nt lds
    buffer_load_dwordx4 v14, s[4:7], s62 offen offset:1024 nt lds
    s_add_u32 s62, s84, 90112
    s_and_b32 s62, s62, 0x1ffff
    s_add_u32 s62, s62, s60
    s_add_u32 m0, s66, 57344
    s_nop 0
    buffer_load_dwordx4 v15, s[8:11], s62 offen nt lds
    buffer_load_dwordx4 v16, s[8:11], s62 offen offset:1024 nt lds
    s_waitcnt vmcnt(8)
    s_barrier
    s_add_u32 s62, s84, 106496
    s_and_b32 s62, s62, 0x1ffff
    s_add_u32 s62, s62, s60
    s_add_u32 m0, s66, 16384
    s_nop 0
    buffer_load_dwordx4 v13, s[4:7], s62 offen nt lds
    buffer_load_dwordx4 v14, s[4:7], s62 offen offset:1024 nt lds
    s_add_u32 s62, s84, 98304
    s_and_b32 s62, s62, 0x1ffff
    s_add_u32 s62, s62, s60
    s_add_u32 m0, s66, 8192
    s_nop 0
    buffer_load_dwordx4 v15, s[8:11], s62 offen nt lds
    buffer_load_dwordx4 v16, s[8:11], s62 offen offset:1024 nt lds
    s_waitcnt vmcnt(8)
    s_barrier
    s_add_u32 s62, s84, 114688
    s_and_b32 s62, s62, 0x1ffff
    s_add_u32 s62, s62, s60
    s_add_u32 m0, s66, 32768
    s_nop 0
    buffer_load_dwordx4 v13, s[4:7], s62 offen nt lds
    buffer_load_dwordx4 v14, s[4:7], s62 offen offset:1024 nt lds
    s_add_u32 s62, s84, 106496
    s_and_b32 s62, s62, 0x1ffff
    s_add_u32 s62, s62, s60
    s_add_u32 m0, s66, 24576
    s_nop 0
    buffer_load_dwordx4 v15, s[8:11], s62 offen nt lds
    buffer_load_dwordx4 v16, s[8:11], s62 offen offset:1024 nt lds
    s_waitcnt vmcnt(8)
    s_barrier
    s_add_u32 s62, s84, 122880
    s_and_b32 s62, s62, 0x1ffff
    s_add_u32 s62, s62, s60
    s_add_u32 m0, s66, 49152
    s_nop 0
    buffer_load_dwordx4 v13, s[4:7], s62 offen nt lds
    buffer_load_dwordx4 v14, s[4:7], s62 offen offset:1024 nt lds
    s_add_u32 s62, s84, 114688
    s_and_b32 s62, s62, 0x1ffff
    s_add_u32 s62, s62, s60
    s_add_u32 m0, s66, 40960
    s_nop 0
    buffer_load_dwordx4 v15, s[8:11], s62 offen nt lds
    buffer_load_dwordx4 v16, s[8:11], s62 offen offset:1024 nt lds
    s_waitcnt vmcnt(8)
    s_barrier
    s_add_u32 s62, s84, 0
    s_and_b32 s62, s62, 0x1ffff
    s_add_u32 s62, s62, s60
    s_add_u32 s62, s62, 131072
    s_add_u32 m0, s66, 0
    s_nop 0
    buffer_load_dwordx4 v13, s[4:7], s62 offen nt lds
    buffer_load_dwordx4 v14, s[4:7], s62 offen offset:1024 nt lds
    s_add_u32 s62, s84, 122880
    s_and_b32 s62, s62, 0x1ffff
    s_add_u32 s62, s62, s60
    s_add_u32 m0, s66, 57344
    s_nop 0
    buffer_load_dwordx4 v15, s[8:11], s62 offen nt lds
    buffer_load_dwordx4 v16, s[8:11], s62 offen offset:1024 nt lds
    s_waitcnt vmcnt(8)
    s_barrier
    s_add_u32 s62, s84, 8192
    s_and_b32 s62, s62, 0x1ffff
    s_add_u32 s62, s62, s60
    s_add_u32 s62, s62, 131072
    s_add_u32 m0, s66, 16384
    s_nop 0
    buffer_load_dwordx4 v13, s[4:7], s62 offen nt lds
    buffer_load_dwordx4 v14, s[4:7], s62 offen offset:1024 nt lds
    s_add_u32 s62, s84, 0
    s_and_b32 s62, s62, 0x1ffff
    s_add_u32 s62, s62, s60
    s_add_u32 s62, s62, 131072
    s_add_u32 m0, s66, 8192
    s_nop 0
    buffer_load_dwordx4 v15, s[8:11], s62 offen nt lds
    buffer_load_dwordx4 v16, s[8:11], s62 offen offset:1024 nt lds
    s_waitcnt vmcnt(8)
    s_barrier
    s_add_u32 s62, s84, 16384
    s_and_b32 s62, s62, 0x1ffff
    s_add_u32 s62, s62, s60
    s_add_u32 s62, s62, 131072
    s_add_u32 m0, s66, 32768
    s_nop 0
    buffer_load_dwordx4 v13, s[4:7], s62 offen nt lds
    buffer_load_dwordx4 v14, s[4:7], s62 offen offset:1024 nt lds
    s_add_u32 s62, s84, 8192
    s_and_b32 s62, s62, 0x1ffff
    s_add_u32 s62, s62, s60
    s_add_u32 s62, s62, 131072
    s_add_u32 m0, s66, 24576
    s_nop 0
    buffer_load_dwordx4 v15, s[8:11], s62 offen nt lds
    buffer_load_dwordx4 v16, s[8:11], s62 offen offset:1024 nt lds
    s_waitcnt vmcnt(8)
    s_barrier
    s_add_u32 s62, s84, 24576
    s_and_b32 s62, s62, 0x1ffff
    s_add_u32 s62, s62, s60
    s_add_u32 s62, s62, 131072
    s_add_u32 m0, s66, 49152
    s_nop 0
    buffer_load_dwordx4 v13, s[4:7], s62 offen nt lds
    buffer_load_dwordx4 v14, s[4:7], s62 offen offset:1024 nt lds
    s_add_u32 s62, s84, 16384
    s_and_b32 s62, s62, 0x1ffff
    s_add_u32 s62, s62, s60
    s_add_u32 s62, s62, 131072
    s_add_u32 m0, s66, 40960
    s_nop 0
    buffer_load_dwordx4 v15, s[8:11], s62 offen nt lds
    buffer_load_dwordx4 v16, s[8:11], s62 offen offset:1024 nt lds
    s_waitcnt vmcnt(8)
    s_barrier
    s_add_u32 s60, s60, 131072
    s_add_u32 s62, s84, 32768
    s_and_b32 s62, s62, 0x1ffff
    s_add_u32 s62, s62, s60
    s_add_u32 m0, s66, 0
    s_nop 0
    buffer_load_dwordx4 v13, s[4:7], s62 offen nt lds
    buffer_load_dwordx4 v14, s[4:7], s62 offen offset:1024 nt lds
    s_add_u32 s62, s84, 24576
    s_and_b32 s62, s62, 0x1ffff
    s_add_u32 s62, s62, s60
    s_add_u32 m0, s66, 57344
    s_nop 0
    buffer_load_dwordx4 v15, s[8:11], s62 offen nt lds
    buffer_load_dwordx4 v16, s[8:11], s62 offen offset:1024 nt lds
    s_waitcnt vmcnt(8)
    s_barrier
    s_add_u32 s62, s84, 40960
    s_and_b32 s62, s62, 0x1ffff
    s_add_u32 s62, s62, s60
    s_add_u32 m0, s66, 16384
    s_nop 0
    buffer_load_dwordx4 v13, s[4:7], s62 offen nt lds
    buffer_load_dwordx4 v14, s[4:7], s62 offen offset:1024 nt lds
    s_add_u32 s62, s84, 32768
    s_and_b32 s62, s62, 0x1ffff
    s_add_u32 s62, s62, s60
    s_add_u32 m0, s66, 8192
    s_nop 0
    buffer_load_dwordx4 v15, s[8:11], s62 offen nt lds
    buffer_load_dwordx4 v16, s[8:11], s62 offen offset:1024 nt lds
    s_waitcnt vmcnt(8)
    s_barrier
    s_add_u32 s62, s84, 49152
    s_and_b32 s62, s62, 0x1ffff
    s_add_u32 s62, s62, s60
    s_add_u32 m0, s66, 32768
    s_nop 0
    buffer_load_dwordx4 v13, s[4:7], s62 offen nt lds
    buffer_load_dwordx4 v14, s[4:7], s62 offen offset:1024 nt lds
    s_add_u32 s62, s84, 40960
    s_and_b32 s62, s62, 0x1ffff
    s_add_u32 s62, s62, s60
    s_add_u32 m0, s66, 24576
    s_nop 0
    buffer_load_dwordx4 v15, s[8:11], s62 offen nt lds
    buffer_load_dwordx4 v16, s[8:11], s62 offen offset:1024 nt lds
    v_mbcnt_lo_u32_b32 v18, -1, 0
    v_mbcnt_hi_u32_b32 v18, -1, v18
    v_lshlrev_b32 v18, 4, v18
    s_lshl_b32 s70, s28, 13
    s_add_u32 s70, s70, 106496
    v_add_u32 v18, s70, v18
    ds_read_b128 v[160:163], v18 offset:28672
    ds_read_b128 v[164:167], v18 offset:29696
    ds_read_b128 v[168:171], v18 offset:30720
    ds_read_b128 v[172:175], v18 offset:31744
    ds_read_b128 v[176:179], v18 offset:32768
    ds_read_b128 v[180:183], v18 offset:33792
    ds_read_b128 v[184:187], v18 offset:34816
    ds_read_b128 v[188:191], v18 offset:35840
    s_waitcnt lgkmcnt(0)
    s_waitcnt vmcnt(8)
    s_barrier
    s_add_u32 s62, s84, 57344
    s_and_b32 s62, s62, 0x1ffff
    s_add_u32 s62, s62, s60
    s_add_u32 m0, s66, 49152
    s_nop 0
    buffer_load_dwordx4 v13, s[4:7], s62 offen nt lds
    buffer_load_dwordx4 v14, s[4:7], s62 offen offset:1024 nt lds
    s_add_u32 s62, s84, 49152
    s_and_b32 s62, s62, 0x1ffff
    s_add_u32 s62, s62, s60
    s_add_u32 m0, s66, 40960
    s_nop 0
    buffer_load_dwordx4 v15, s[8:11], s62 offen nt lds
    buffer_load_dwordx4 v16, s[8:11], s62 offen offset:1024 nt lds
    s_waitcnt vmcnt(8)
    s_barrier
    s_add_u32 s62, s84, 65536
    s_and_b32 s62, s62, 0x1ffff
    s_add_u32 s62, s62, s60
    s_add_u32 m0, s66, 0
    s_nop 0
    buffer_load_dwordx4 v13, s[4:7], s62 offen nt lds
    buffer_load_dwordx4 v14, s[4:7], s62 offen offset:1024 nt lds
    s_add_u32 s62, s84, 57344
    s_and_b32 s62, s62, 0x1ffff
    s_add_u32 s62, s62, s60
    s_add_u32 m0, s66, 57344
    s_nop 0
    buffer_load_dwordx4 v15, s[8:11], s62 offen nt lds
    buffer_load_dwordx4 v16, s[8:11], s62 offen offset:1024 nt lds
    s_waitcnt vmcnt(8)
    s_barrier
    s_add_u32 s62, s84, 73728
    s_and_b32 s62, s62, 0x1ffff
    s_add_u32 s62, s62, s60
    s_add_u32 m0, s66, 16384
    s_nop 0
    buffer_load_dwordx4 v13, s[4:7], s62 offen nt lds
    buffer_load_dwordx4 v14, s[4:7], s62 offen offset:1024 nt lds
    s_add_u32 s62, s84, 65536
    s_and_b32 s62, s62, 0x1ffff
    s_add_u32 s62, s62, s60
    s_add_u32 m0, s66, 8192
    s_nop 0
    buffer_load_dwordx4 v15, s[8:11], s62 offen nt lds
    buffer_load_dwordx4 v16, s[8:11], s62 offen offset:1024 nt lds
    s_waitcnt vmcnt(8)
    s_barrier
    s_add_u32 s62, s84, 81920
    s_and_b32 s62, s62, 0x1ffff
    s_add_u32 s62, s62, s60
    s_add_u32 m0, s66, 32768
    s_nop 0
    buffer_load_dwordx4 v13, s[4:7], s62 offen nt lds
    buffer_load_dwordx4 v14, s[4:7], s62 offen offset:1024 nt lds
    s_add_u32 s62, s84, 73728
    s_and_b32 s62, s62, 0x1ffff
    s_add_u32 s62, s62, s60
    s_add_u32 m0, s66, 24576
    s_nop 0
    buffer_load_dwordx4 v15, s[8:11], s62 offen nt lds
    buffer_load_dwordx4 v16, s[8:11], s62 offen offset:1024 nt lds
    s_waitcnt vmcnt(8)
    s_barrier
    s_add_u32 s62, s84, 90112
    s_and_b32 s62, s62, 0x1ffff
    s_add_u32 s62, s62, s60
    s_add_u32 m0, s66, 49152
    s_nop 0
    buffer_load_dwordx4 v13, s[4:7], s62 offen nt lds
    buffer_load_dwordx4 v14, s[4:7], s62 offen offset:1024 nt lds
    s_add_u32 s62, s84, 81920
    s_and_b32 s62, s62, 0x1ffff
    s_add_u32 s62, s62, s60
    s_add_u32 m0, s66, 40960
    s_nop 0
    buffer_load_dwordx4 v15, s[8:11], s62 offen nt lds
    buffer_load_dwordx4 v16, s[8:11], s62 offen offset:1024 nt lds
    s_waitcnt vmcnt(8)
    s_barrier
    s_add_u32 s62, s84, 98304
    s_and_b32 s62, s62, 0x1ffff
    s_add_u32 s62, s62, s60
    s_add_u32 m0, s66, 0
    s_nop 0
    buffer_load_dwordx4 v13, s[4:7], s62 offen nt lds
    buffer_load_dwordx4 v14, s[4:7], s62 offen offset:1024 nt lds
    s_add_u32 s62, s84, 90112
    s_and_b32 s62, s62, 0x1ffff
    s_add_u32 s62, s62, s60
    s_add_u32 m0, s66, 57344
    s_nop 0
    buffer_load_dwordx4 v15, s[8:11], s62 offen nt lds
    buffer_load_dwordx4 v16, s[8:11], s62 offen offset:1024 nt lds
    s_waitcnt vmcnt(8)
    s_barrier
    s_add_u32 s62, s84, 106496
    s_and_b32 s62, s62, 0x1ffff
    s_add_u32 s62, s62, s60
    s_add_u32 m0, s66, 16384
    s_nop 0
    buffer_load_dwordx4 v13, s[4:7], s62 offen nt lds
    buffer_load_dwordx4 v14, s[4:7], s62 offen offset:1024 nt lds
    s_add_u32 s62, s84, 98304
    s_and_b32 s62, s62, 0x1ffff
    s_add_u32 s62, s62, s60
    s_add_u32 m0, s66, 8192
    s_nop 0
    buffer_load_dwordx4 v15, s[8:11], s62 offen nt lds
    buffer_load_dwordx4 v16, s[8:11], s62 offen offset:1024 nt lds
    s_waitcnt vmcnt(8)
    s_barrier
    s_add_u32 s62, s84, 114688
    s_and_b32 s62, s62, 0x1ffff
    s_add_u32 s62, s62, s60
    s_add_u32 m0, s66, 32768
    s_nop 0
    buffer_load_dwordx4 v13, s[4:7], s62 offen nt lds
    buffer_load_dwordx4 v14, s[4:7], s62 offen offset:1024 nt lds
    s_add_u32 s62, s84, 106496
    s_and_b32 s62, s62, 0x1ffff
    s_add_u32 s62, s62, s60
    s_add_u32 m0, s66, 24576
    s_nop 0
    buffer_load_dwordx4 v15, s[8:11], s62 offen nt lds
    buffer_load_dwordx4 v16, s[8:11], s62 offen offset:1024 nt lds
    s_waitcnt vmcnt(8)
    s_barrier
    s_add_u32 s62, s84, 122880
    s_and_b32 s62, s62, 0x1ffff
    s_add_u32 s62, s62, s60
    s_add_u32 m0, s66, 49152
    s_nop 0
    buffer_load_dwordx4 v13, s[4:7], s62 offen nt lds
    buffer_load_dwordx4 v14, s[4:7], s62 offen offset:1024 nt lds
    s_add_u32 s62, s84, 114688
    s_and_b32 s62, s62, 0x1ffff
    s_add_u32 s62, s62, s60
    s_add_u32 m0, s66, 40960
    s_nop 0
    buffer_load_dwordx4 v15, s[8:11], s62 offen nt lds
    buffer_load_dwordx4 v16, s[8:11], s62 offen offset:1024 nt lds
    s_waitcnt vmcnt(8)
    s_barrier
    s_add_u32 s62, s84, 0
    s_and_b32 s62, s62, 0x1ffff
    s_add_u32 s62, s62, s60
    s_add_u32 s62, s62, 131072
    s_add_u32 m0, s66, 0
    s_nop 0
    buffer_load_dwordx4 v13, s[4:7], s62 offen nt lds
    buffer_load_dwordx4 v14, s[4:7], s62 offen offset:1024 nt lds
    s_add_u32 s62, s84, 122880
    s_and_b32 s62, s62, 0x1ffff
    s_add_u32 s62, s62, s60
    s_add_u32 m0, s66, 57344
    s_nop 0
    buffer_load_dwordx4 v15, s[8:11], s62 offen nt lds
    buffer_load_dwordx4 v16, s[8:11], s62 offen offset:1024 nt lds
    s_waitcnt vmcnt(8)
    s_barrier
    s_add_u32 s62, s84, 8192
    s_and_b32 s62, s62, 0x1ffff
    s_add_u32 s62, s62, s60
    s_add_u32 s62, s62, 131072
    s_add_u32 m0, s66, 16384
    s_nop 0
    buffer_load_dwordx4 v13, s[4:7], s62 offen nt lds
    buffer_load_dwordx4 v14, s[4:7], s62 offen offset:1024 nt lds
    s_add_u32 s62, s84, 0
    s_and_b32 s62, s62, 0x1ffff
    s_add_u32 s62, s62, s60
    s_add_u32 s62, s62, 131072
    s_add_u32 m0, s66, 8192
    s_nop 0
    buffer_load_dwordx4 v15, s[8:11], s62 offen nt lds
    buffer_load_dwordx4 v16, s[8:11], s62 offen offset:1024 nt lds
    s_waitcnt vmcnt(8)
    s_barrier
    s_add_u32 s62, s84, 16384
    s_and_b32 s62, s62, 0x1ffff
    s_add_u32 s62, s62, s60
    s_add_u32 s62, s62, 131072
    s_add_u32 m0, s66, 32768
    s_nop 0
    buffer_load_dwordx4 v13, s[4:7], s62 offen nt lds
    buffer_load_dwordx4 v14, s[4:7], s62 offen offset:1024 nt lds
    s_add_u32 s62, s84, 8192
    s_and_b32 s62, s62, 0x1ffff
    s_add_u32 s62, s62, s60
    s_add_u32 s62, s62, 131072
    s_add_u32 m0, s66, 24576
    s_nop 0
    buffer_load_dwordx4 v15, s[8:11], s62 offen nt lds
    buffer_load_dwordx4 v16, s[8:11], s62 offen offset:1024 nt lds
    s_waitcnt vmcnt(8)
    s_barrier
    s_add_u32 s62, s84, 24576
    s_and_b32 s62, s62, 0x1ffff
    s_add_u32 s62, s62, s60
    s_add_u32 s62, s62, 131072
    s_add_u32 m0, s66, 49152
    s_nop 0
    buffer_load_dwordx4 v13, s[4:7], s62 offen nt lds
    buffer_load_dwordx4 v14, s[4:7], s62 offen offset:1024 nt lds
    s_add_u32 s62, s84, 16384
    s_and_b32 s62, s62, 0x1ffff
    s_add_u32 s62, s62, s60
    s_add_u32 s62, s62, 131072
    s_add_u32 m0, s66, 40960
    s_nop 0
    buffer_load_dwordx4 v15, s[8:11], s62 offen nt lds
    buffer_load_dwordx4 v16, s[8:11], s62 offen offset:1024 nt lds
    s_waitcnt vmcnt(8)
    s_barrier
    s_add_u32 s60, s60, 131072
    s_add_u32 s62, s84, 32768
    s_and_b32 s62, s62, 0x1ffff
    s_add_u32 s62, s62, s60
    s_add_u32 m0, s66, 0
    s_nop 0
    buffer_load_dwordx4 v13, s[4:7], s62 offen nt lds
    buffer_load_dwordx4 v14, s[4:7], s62 offen offset:1024 nt lds
    s_add_u32 s62, s84, 24576
    s_and_b32 s62, s62, 0x1ffff
    s_add_u32 s62, s62, s60
    s_add_u32 m0, s66, 57344
    s_nop 0
    buffer_load_dwordx4 v15, s[8:11], s62 offen nt lds
    buffer_load_dwordx4 v16, s[8:11], s62 offen offset:1024 nt lds
    s_waitcnt vmcnt(8)
    s_barrier
    s_add_u32 s62, s84, 40960
    s_and_b32 s62, s62, 0x1ffff
    s_add_u32 s62, s62, s60
    s_add_u32 m0, s66, 16384
    s_nop 0
    buffer_load_dwordx4 v13, s[4:7], s62 offen nt lds
    buffer_load_dwordx4 v14, s[4:7], s62 offen offset:1024 nt lds
    s_add_u32 s62, s84, 32768
    s_and_b32 s62, s62, 0x1ffff
    s_add_u32 s62, s62, s60
    s_add_u32 m0, s66, 8192
    s_nop 0
    buffer_load_dwordx4 v15, s[8:11], s62 offen nt lds
    buffer_load_dwordx4 v16, s[8:11], s62 offen offset:1024 nt lds
    s_waitcnt vmcnt(8)
    s_barrier
    s_add_u32 s62, s84, 49152
    s_and_b32 s62, s62, 0x1ffff
    s_add_u32 s62, s62, s60
    s_add_u32 m0, s66, 32768
    s_nop 0
    buffer_load_dwordx4 v13, s[4:7], s62 offen nt lds
    buffer_load_dwordx4 v14, s[4:7], s62 offen offset:1024 nt lds
    s_add_u32 s62, s84, 40960
    s_and_b32 s62, s62, 0x1ffff
    s_add_u32 s62, s62, s60
    s_add_u32 m0, s66, 24576
    s_nop 0
    buffer_load_dwordx4 v15, s[8:11], s62 offen nt lds
    buffer_load_dwordx4 v16, s[8:11], s62 offen offset:1024 nt lds
    v_subrev_u32 v19, 40960, v18
    ds_read_b128 v[224:227], v19 offset:0
    ds_read_b128 v[228:231], v19 offset:1024
    ds_read_b128 v[232:235], v19 offset:2048
    ds_read_b128 v[236:239], v19 offset:3072
    ds_read_b128 v[240:243], v19 offset:4096
    ds_read_b128 v[244:247], v19 offset:5120
    ds_read_b128 v[248:251], v19 offset:6144
    ds_read_b128 v[252:255], v19 offset:7168
    s_waitcnt lgkmcnt(0)
    s_waitcnt vmcnt(8)
    s_barrier
    s_add_u32 s62, s84, 57344
    s_and_b32 s62, s62, 0x1ffff
    s_add_u32 s62, s62, s60
    s_add_u32 m0, s66, 49152
    s_nop 0
    buffer_load_dwordx4 v13, s[4:7], s62 offen nt lds
    buffer_load_dwordx4 v14, s[4:7], s62 offen offset:1024 nt lds
    s_add_u32 s62, s84, 49152
    s_and_b32 s62, s62, 0x1ffff
    s_add_u32 s62, s62, s60
    s_add_u32 m0, s66, 40960
    s_nop 0
    buffer_load_dwordx4 v15, s[8:11], s62 offen nt lds
    buffer_load_dwordx4 v16, s[8:11], s62 offen offset:1024 nt lds
    s_waitcnt vmcnt(8)
    s_barrier
    s_add_u32 s62, s84, 65536
    s_and_b32 s62, s62, 0x1ffff
    s_add_u32 s62, s62, s60
    s_add_u32 m0, s66, 0
    s_nop 0
    buffer_load_dwordx4 v13, s[4:7], s62 offen nt lds
    buffer_load_dwordx4 v14, s[4:7], s62 offen offset:1024 nt lds
    s_add_u32 s62, s84, 57344
    s_and_b32 s62, s62, 0x1ffff
    s_add_u32 s62, s62, s60
    s_add_u32 m0, s66, 57344
    s_nop 0
    buffer_load_dwordx4 v15, s[8:11], s62 offen nt lds
    buffer_load_dwordx4 v16, s[8:11], s62 offen offset:1024 nt lds
    s_waitcnt vmcnt(8)
    s_barrier
    s_add_u32 s62, s84, 73728
    s_and_b32 s62, s62, 0x1ffff
    s_add_u32 s62, s62, s60
    s_add_u32 m0, s66, 16384
    s_nop 0
    buffer_load_dwordx4 v13, s[4:7], s62 offen nt lds
    buffer_load_dwordx4 v14, s[4:7], s62 offen offset:1024 nt lds
    s_add_u32 s62, s84, 65536
    s_and_b32 s62, s62, 0x1ffff
    s_add_u32 s62, s62, s60
    s_add_u32 m0, s66, 8192
    s_nop 0
    buffer_load_dwordx4 v15, s[8:11], s62 offen nt lds
    buffer_load_dwordx4 v16, s[8:11], s62 offen offset:1024 nt lds
    s_waitcnt vmcnt(8)
    s_barrier
    s_add_u32 s62, s84, 81920
    s_and_b32 s62, s62, 0x1ffff
    s_add_u32 s62, s62, s60
    s_add_u32 m0, s66, 32768
    s_nop 0
    buffer_load_dwordx4 v13, s[4:7], s62 offen nt lds
    buffer_load_dwordx4 v14, s[4:7], s62 offen offset:1024 nt lds
    s_add_u32 s62, s84, 73728
    s_and_b32 s62, s62, 0x1ffff
    s_add_u32 s62, s62, s60
    s_add_u32 m0, s66, 24576
    s_nop 0
    buffer_load_dwordx4 v15, s[8:11], s62 offen nt lds
    buffer_load_dwordx4 v16, s[8:11], s62 offen offset:1024 nt lds
    s_waitcnt vmcnt(8)
    s_barrier
    s_add_u32 s62, s84, 90112
    s_and_b32 s62, s62, 0x1ffff
    s_add_u32 s62, s62, s60
    s_add_u32 m0, s66, 49152
    s_nop 0
    buffer_load_dwordx4 v13, s[4:7], s62 offen nt lds
    buffer_load_dwordx4 v14, s[4:7], s62 offen offset:1024 nt lds
    s_add_u32 s62, s84, 81920
    s_and_b32 s62, s62, 0x1ffff
    s_add_u32 s62, s62, s60
    s_add_u32 m0, s66, 40960
    s_nop 0
    buffer_load_dwordx4 v15, s[8:11], s62 offen nt lds
    buffer_load_dwordx4 v16, s[8:11], s62 offen offset:1024 nt lds
    s_waitcnt vmcnt(8)
    s_barrier
    s_add_u32 s62, s84, 98304
    s_and_b32 s62, s62, 0x1ffff
    s_add_u32 s62, s62, s60
    s_add_u32 m0, s66, 0
    s_nop 0
    buffer_load_dwordx4 v13, s[4:7], s62 offen nt lds
    buffer_load_dwordx4 v14, s[4:7], s62 offen offset:1024 nt lds
    s_add_u32 s62, s84, 90112
    s_and_b32 s62, s62, 0x1ffff
    s_add_u32 s62, s62, s60
    s_add_u32 m0, s66, 57344
    s_nop 0
    buffer_load_dwordx4 v15, s[8:11], s62 offen nt lds
    buffer_load_dwordx4 v16, s[8:11], s62 offen offset:1024 nt lds
    s_waitcnt vmcnt(8)
    s_barrier
    s_add_u32 s62, s84, 106496
    s_and_b32 s62, s62, 0x1ffff
    s_add_u32 s62, s62, s60
    s_add_u32 m0, s66, 16384
    s_nop 0
    buffer_load_dwordx4 v13, s[4:7], s62 offen nt lds
    buffer_load_dwordx4 v14, s[4:7], s62 offen offset:1024 nt lds
    s_add_u32 s62, s84, 98304
    s_and_b32 s62, s62, 0x1ffff
    s_add_u32 s62, s62, s60
    s_add_u32 m0, s66, 8192
    s_nop 0
    buffer_load_dwordx4 v15, s[8:11], s62 offen nt lds
    buffer_load_dwordx4 v16, s[8:11], s62 offen offset:1024 nt lds
    s_waitcnt vmcnt(8)
    s_barrier
    s_add_u32 s62, s84, 114688
    s_and_b32 s62, s62, 0x1ffff
    s_add_u32 s62, s62, s60
    s_add_u32 m0, s66, 32768
    s_nop 0
    buffer_load_dwordx4 v13, s[4:7], s62 offen nt lds
    buffer_load_dwordx4 v14, s[4:7], s62 offen offset:1024 nt lds
    s_add_u32 s62, s84, 106496
    s_and_b32 s62, s62, 0x1ffff
    s_add_u32 s62, s62, s60
    s_add_u32 m0, s66, 24576
    s_nop 0
    buffer_load_dwordx4 v15, s[8:11], s62 offen nt lds
    buffer_load_dwordx4 v16, s[8:11], s62 offen offset:1024 nt lds
    s_waitcnt vmcnt(8)
    s_barrier
    s_add_u32 s62, s84, 122880
    s_and_b32 s62, s62, 0x1ffff
    s_add_u32 s62, s62, s60
    s_add_u32 m0, s66, 49152
    s_nop 0
    buffer_load_dwordx4 v13, s[4:7], s62 offen nt lds
    buffer_load_dwordx4 v14, s[4:7], s62 offen offset:1024 nt lds
    s_add_u32 s62, s84, 114688
    s_and_b32 s62, s62, 0x1ffff
    s_add_u32 s62, s62, s60
    s_add_u32 m0, s66, 40960
    s_nop 0
    buffer_load_dwordx4 v15, s[8:11], s62 offen nt lds
    buffer_load_dwordx4 v16, s[8:11], s62 offen offset:1024 nt lds
    s_waitcnt vmcnt(8)
    s_barrier
    s_add_u32 s62, s84, 0
    s_and_b32 s62, s62, 0x1ffff
    s_add_u32 s62, s62, s60
    s_add_u32 s62, s62, 131072
    s_add_u32 m0, s66, 0
    s_nop 0
    buffer_load_dwordx4 v13, s[4:7], s62 offen nt lds
    buffer_load_dwordx4 v14, s[4:7], s62 offen offset:1024 nt lds
    s_add_u32 s62, s84, 122880
    s_and_b32 s62, s62, 0x1ffff
    s_add_u32 s62, s62, s60
    s_add_u32 m0, s66, 57344
    s_nop 0
    buffer_load_dwordx4 v15, s[8:11], s62 offen nt lds
    buffer_load_dwordx4 v16, s[8:11], s62 offen offset:1024 nt lds
    s_waitcnt vmcnt(8)
    s_barrier
    s_add_u32 s62, s84, 8192
    s_and_b32 s62, s62, 0x1ffff
    s_add_u32 s62, s62, s60
    s_add_u32 s62, s62, 131072
    s_add_u32 m0, s66, 16384
    s_nop 0
    buffer_load_dwordx4 v13, s[4:7], s62 offen nt lds
    buffer_load_dwordx4 v14, s[4:7], s62 offen offset:1024 nt lds
    s_add_u32 s62, s84, 0
    s_and_b32 s62, s62, 0x1ffff
    s_add_u32 s62, s62, s60
    s_add_u32 s62, s62, 131072
    s_add_u32 m0, s66, 8192
    s_nop 0
    buffer_load_dwordx4 v15, s[8:11], s62 offen nt lds
    buffer_load_dwordx4 v16, s[8:11], s62 offen offset:1024 nt lds
    s_waitcnt vmcnt(8)
    s_barrier
    s_add_u32 s62, s84, 16384
    s_and_b32 s62, s62, 0x1ffff
    s_add_u32 s62, s62, s60
    s_add_u32 s62, s62, 131072
    s_add_u32 m0, s66, 32768
    s_nop 0
    buffer_load_dwordx4 v13, s[4:7], s62 offen nt lds
    buffer_load_dwordx4 v14, s[4:7], s62 offen offset:1024 nt lds
    s_add_u32 s62, s84, 8192
    s_and_b32 s62, s62, 0x1ffff
    s_add_u32 s62, s62, s60
    s_add_u32 s62, s62, 131072
    s_add_u32 m0, s66, 24576
    s_nop 0
    buffer_load_dwordx4 v15, s[8:11], s62 offen nt lds
    buffer_load_dwordx4 v16, s[8:11], s62 offen offset:1024 nt lds
    s_waitcnt vmcnt(8)
    s_barrier
    s_add_u32 s62, s84, 24576
    s_and_b32 s62, s62, 0x1ffff
    s_add_u32 s62, s62, s60
    s_add_u32 s62, s62, 131072
    s_add_u32 m0, s66, 49152
    s_nop 0
    buffer_load_dwordx4 v13, s[4:7], s62 offen nt lds
    buffer_load_dwordx4 v14, s[4:7], s62 offen offset:1024 nt lds
    s_add_u32 s62, s84, 16384
    s_and_b32 s62, s62, 0x1ffff
    s_add_u32 s62, s62, s60
    s_add_u32 s62, s62, 131072
    s_add_u32 m0, s66, 40960
    s_nop 0
    buffer_load_dwordx4 v15, s[8:11], s62 offen nt lds
    buffer_load_dwordx4 v16, s[8:11], s62 offen offset:1024 nt lds
    s_waitcnt vmcnt(8)
    s_barrier
    s_add_u32 s60, s60, 131072
    s_add_u32 s62, s84, 32768
    s_and_b32 s62, s62, 0x1ffff
    s_add_u32 s62, s62, s60
    s_add_u32 m0, s66, 0
    s_nop 0
    buffer_load_dwordx4 v13, s[4:7], s62 offen nt lds
    buffer_load_dwordx4 v14, s[4:7], s62 offen offset:1024 nt lds
    s_add_u32 s62, s84, 24576
    s_and_b32 s62, s62, 0x1ffff
    s_add_u32 s62, s62, s60
    s_add_u32 m0, s66, 57344
    s_nop 0
    buffer_load_dwordx4 v15, s[8:11], s62 offen nt lds
    buffer_load_dwordx4 v16, s[8:11], s62 offen offset:1024 nt lds
    s_waitcnt vmcnt(8)
    s_barrier
    s_add_u32 s62, s84, 40960
    s_and_b32 s62, s62, 0x1ffff
    s_add_u32 s62, s62, s60
    s_add_u32 m0, s66, 16384
    s_nop 0
    buffer_load_dwordx4 v13, s[4:7], s62 offen nt lds
    buffer_load_dwordx4 v14, s[4:7], s62 offen offset:1024 nt lds
    s_add_u32 s62, s84, 32768
    s_and_b32 s62, s62, 0x1ffff
    s_add_u32 s62, s62, s60
    s_add_u32 m0, s66, 8192
    s_nop 0
    buffer_load_dwordx4 v15, s[8:11], s62 offen nt lds
    buffer_load_dwordx4 v16, s[8:11], s62 offen offset:1024 nt lds
    s_waitcnt vmcnt(8)
    s_barrier
    s_add_u32 s62, s84, 49152
    s_and_b32 s62, s62, 0x1ffff
    s_add_u32 s62, s62, s60
    s_add_u32 m0, s66, 32768
    s_nop 0
    buffer_load_dwordx4 v13, s[4:7], s62 offen nt lds
    buffer_load_dwordx4 v14, s[4:7], s62 offen offset:1024 nt lds
    s_add_u32 s62, s84, 40960
    s_and_b32 s62, s62, 0x1ffff
    s_add_u32 s62, s62, s60
    s_add_u32 m0, s66, 24576
    s_nop 0
    buffer_load_dwordx4 v15, s[8:11], s62 offen nt lds
    buffer_load_dwordx4 v16, s[8:11], s62 offen offset:1024 nt lds
    ds_read_b128 v[192:195], v18 offset:0
    ds_read_b128 v[196:199], v18 offset:1024
    ds_read_b128 v[200:203], v18 offset:2048
    ds_read_b128 v[204:207], v18 offset:3072
    ds_read_b128 v[208:211], v18 offset:4096
    ds_read_b128 v[212:215], v18 offset:5120
    ds_read_b128 v[216:219], v18 offset:6144
    ds_read_b128 v[220:223], v18 offset:7168
    s_waitcnt lgkmcnt(0)
    s_waitcnt vmcnt(8)
    s_barrier
    s_add_u32 s62, s84, 57344
    s_and_b32 s62, s62, 0x1ffff
    s_add_u32 s62, s62, s60
    s_add_u32 m0, s66, 49152
    s_nop 0
    buffer_load_dwordx4 v13, s[4:7], s62 offen nt lds
    buffer_load_dwordx4 v14, s[4:7], s62 offen offset:1024 nt lds
    s_add_u32 s62, s84, 49152
    s_and_b32 s62, s62, 0x1ffff
    s_add_u32 s62, s62, s60
    s_add_u32 m0, s66, 40960
    s_nop 0
    buffer_load_dwordx4 v15, s[8:11], s62 offen nt lds
    buffer_load_dwordx4 v16, s[8:11], s62 offen offset:1024 nt lds
    s_waitcnt vmcnt(8)
    s_barrier
    s_add_u32 s62, s84, 65536
    s_and_b32 s62, s62, 0x1ffff
    s_add_u32 s62, s62, s60
    s_add_u32 m0, s66, 0
    s_nop 0
    buffer_load_dwordx4 v13, s[4:7], s62 offen nt lds
    buffer_load_dwordx4 v14, s[4:7], s62 offen offset:1024 nt lds
    s_add_u32 s62, s84, 57344
    s_and_b32 s62, s62, 0x1ffff
    s_add_u32 s62, s62, s60
    s_add_u32 m0, s66, 57344
    s_nop 0
    buffer_load_dwordx4 v15, s[8:11], s62 offen nt lds
    buffer_load_dwordx4 v16, s[8:11], s62 offen offset:1024 nt lds
    s_waitcnt vmcnt(8)
    s_barrier
    s_add_u32 s62, s84, 73728
    s_and_b32 s62, s62, 0x1ffff
    s_add_u32 s62, s62, s60
    s_add_u32 m0, s66, 16384
    s_nop 0
    buffer_load_dwordx4 v13, s[4:7], s62 offen nt lds
    buffer_load_dwordx4 v14, s[4:7], s62 offen offset:1024 nt lds
    s_add_u32 s62, s84, 65536
    s_and_b32 s62, s62, 0x1ffff
    s_add_u32 s62, s62, s60
    s_add_u32 m0, s66, 8192
    s_nop 0
    buffer_load_dwordx4 v15, s[8:11], s62 offen nt lds
    buffer_load_dwordx4 v16, s[8:11], s62 offen offset:1024 nt lds
    s_waitcnt vmcnt(8)
    s_barrier
    s_add_u32 s62, s84, 81920
    s_and_b32 s62, s62, 0x1ffff
    s_add_u32 s62, s62, s60
    s_add_u32 m0, s66, 32768
    s_nop 0
    buffer_load_dwordx4 v13, s[4:7], s62 offen nt lds
    buffer_load_dwordx4 v14, s[4:7], s62 offen offset:1024 nt lds
    s_add_u32 s62, s84, 73728
    s_and_b32 s62, s62, 0x1ffff
    s_add_u32 s62, s62, s60
    s_add_u32 m0, s66, 24576
    s_nop 0
    buffer_load_dwordx4 v15, s[8:11], s62 offen nt lds
    buffer_load_dwordx4 v16, s[8:11], s62 offen offset:1024 nt lds
    s_waitcnt vmcnt(8)
    s_barrier
    s_add_u32 s62, s84, 90112
    s_and_b32 s62, s62, 0x1ffff
    s_add_u32 s62, s62, s60
    s_add_u32 m0, s66, 49152
    s_nop 0
    buffer_load_dwordx4 v13, s[4:7], s62 offen nt lds
    buffer_load_dwordx4 v14, s[4:7], s62 offen offset:1024 nt lds
    s_add_u32 s62, s84, 81920
    s_and_b32 s62, s62, 0x1ffff
    s_add_u32 s62, s62, s60
    s_add_u32 m0, s66, 40960
    s_nop 0
    buffer_load_dwordx4 v15, s[8:11], s62 offen nt lds
    buffer_load_dwordx4 v16, s[8:11], s62 offen offset:1024 nt lds
    s_waitcnt vmcnt(8)
    s_barrier
    s_add_u32 s62, s84, 98304
    s_and_b32 s62, s62, 0x1ffff
    s_add_u32 s62, s62, s60
    s_add_u32 m0, s66, 0
    s_nop 0
    buffer_load_dwordx4 v13, s[4:7], s62 offen nt lds
    buffer_load_dwordx4 v14, s[4:7], s62 offen offset:1024 nt lds
    s_add_u32 s62, s84, 90112
    s_and_b32 s62, s62, 0x1ffff
    s_add_u32 s62, s62, s60
    s_add_u32 m0, s66, 57344
    s_nop 0
    buffer_load_dwordx4 v15, s[8:11], s62 offen nt lds
    buffer_load_dwordx4 v16, s[8:11], s62 offen offset:1024 nt lds
    s_waitcnt vmcnt(8)
    s_barrier
    s_add_u32 s62, s84, 106496
    s_and_b32 s62, s62, 0x1ffff
    s_add_u32 s62, s62, s60
    s_add_u32 m0, s66, 16384
    s_nop 0
    buffer_load_dwordx4 v13, s[4:7], s62 offen nt lds
    buffer_load_dwordx4 v14, s[4:7], s62 offen offset:1024 nt lds
    s_add_u32 s62, s84, 98304
    s_and_b32 s62, s62, 0x1ffff
    s_add_u32 s62, s62, s60
    s_add_u32 m0, s66, 8192
    s_nop 0
    buffer_load_dwordx4 v15, s[8:11], s62 offen nt lds
    buffer_load_dwordx4 v16, s[8:11], s62 offen offset:1024 nt lds
    s_waitcnt vmcnt(8)
    s_barrier
    s_add_u32 s62, s84, 114688
    s_and_b32 s62, s62, 0x1ffff
    s_add_u32 s62, s62, s60
    s_add_u32 m0, s66, 32768
    s_nop 0
    buffer_load_dwordx4 v13, s[4:7], s62 offen nt lds
    buffer_load_dwordx4 v14, s[4:7], s62 offen offset:1024 nt lds
    s_add_u32 s62, s84, 106496
    s_and_b32 s62, s62, 0x1ffff
    s_add_u32 s62, s62, s60
    s_add_u32 m0, s66, 24576
    s_nop 0
    buffer_load_dwordx4 v15, s[8:11], s62 offen nt lds
    buffer_load_dwordx4 v16, s[8:11], s62 offen offset:1024 nt lds
    s_waitcnt vmcnt(8)
    s_barrier
    s_add_u32 s62, s84, 122880
    s_and_b32 s62, s62, 0x1ffff
    s_add_u32 s62, s62, s60
    s_add_u32 m0, s66, 49152
    s_nop 0
    buffer_load_dwordx4 v13, s[4:7], s62 offen nt lds
    buffer_load_dwordx4 v14, s[4:7], s62 offen offset:1024 nt lds
    s_add_u32 s62, s84, 114688
    s_and_b32 s62, s62, 0x1ffff
    s_add_u32 s62, s62, s60
    s_add_u32 m0, s66, 40960
    s_nop 0
    buffer_load_dwordx4 v15, s[8:11], s62 offen nt lds
    buffer_load_dwordx4 v16, s[8:11], s62 offen offset:1024 nt lds
    s_waitcnt vmcnt(8)
    s_barrier
    s_add_u32 s62, s84, 122880
    s_and_b32 s62, s62, 0x1ffff
    s_add_u32 s62, s62, s60
    s_add_u32 m0, s66, 57344
    s_nop 0
    buffer_load_dwordx4 v15, s[8:11], s62 offen nt lds
    buffer_load_dwordx4 v16, s[8:11], s62 offen offset:1024 nt lds
    s_waitcnt vmcnt(6)
    s_barrier
    s_mov_b32 s12, s58
    s_and_b32 s13, s59, 0xffff
    s_mov_b32 s14, 5242880
    s_mov_b32 s15, 0x00020000
    s_lshl_b32 s70, s25, 4
    s_add_u32 s70, s70, s26
    s_lshl_b32 s70, s70, 3
    s_add_u32 s70, s70, s27
    s_mul_i32 s70, s70, 163840
    s_add_u32 s4, s56, s70
    s_addc_u32 s5, s57, 0
    s_and_b32 s5, s5, 0xffff
    s_mov_b32 s6, 163840
    s_mov_b32 s7, 0x00020000
    s_mul_i32 s70, s28, 5120
    s_add_u32 s72, s70, 122880
    s_add_u32 s73, s70, 20480
    s_add_u32 s74, s70, 143360
    s_add_u32 s97, s70, 81920
    s_mul_i32 s75, s27, 655360
    s_add_u32 s75, s75, 640
    s_mov_b32 s76, 81920
    v_mbcnt_lo_u32_b32 v0, -1, 0
    v_mbcnt_hi_u32_b32 v0, -1, v0
    s_lshl_b32 s71, s28, 5
    s_mov_b32 s77, 6554
    v_add_u32 v56, 0, v0
    v_mul_lo_u32 v57, v56, s77
    v_lshrrev_b32 v57, 16, v57
    v_mul_u32_u24 v58, 10, v57
    v_sub_u32 v58, v56, v58
    v_add_u32 v57, s71, v57
    v_mul_u32_u24 v57, 1280, v57
    v_lshl_add_u32 v4, v58, 4, v57
    v_add_u32 v56, 64, v0
    v_mul_lo_u32 v57, v56, s77
    v_lshrrev_b32 v57, 16, v57
    v_mul_u32_u24 v58, 10, v57
    v_sub_u32 v58, v56, v58
    v_add_u32 v57, s71, v57
    v_mul_u32_u24 v57, 1280, v57
    v_lshl_add_u32 v5, v58, 4, v57
    v_add_u32 v56, 128, v0
    v_mul_lo_u32 v57, v56, s77
    v_lshrrev_b32 v57, 16, v57
    v_mul_u32_u24 v58, 10, v57
    v_sub_u32 v58, v56, v58
    v_add_u32 v57, s71, v57
    v_mul_u32_u24 v57, 1280, v57
    v_lshl_add_u32 v6, v58, 4, v57
    v_add_u32 v56, 192, v0
    v_mul_lo_u32 v57, v56, s77
    v_lshrrev_b32 v57, 16, v57
    v_mul_u32_u24 v58, 10, v57
    v_sub_u32 v58, v56, v58
    v_add_u32 v57, s71, v57
    v_mul_u32_u24 v57, 1280, v57
    v_lshl_add_u32 v7, v58, 4, v57
    v_add_u32 v56, 256, v0
    v_mul_lo_u32 v57, v56, s77
    v_lshrrev_b32 v57, 16, v57
    v_mul_u32_u24 v58, 10, v57
    v_sub_u32 v58, v56, v58
    v_add_u32 v57, s71, v57
    v_mul_u32_u24 v57, 1280, v57
    v_lshl_add_u32 v8, v58, 4, v57
    v_lshrrev_b32 v56, 4, v0
    v_bfe_u32 v57, v0, 2, 2
    v_lshl_add_u32 v57, v56, 2, v57
    v_mul_u32_u24 v57, 160, v57
    v_and_b32 v58, 3, v0
    v_lshl_add_u32 v57, v58, 3, v57
    v_add_u32 v9, 122880, v57
    v_add_u32 v10, 20480, v57
    v_add_u32 v11, 143360, v57
    v_add_u32 v63, 81920, v57
    v_add_u32 v61, 86016, v57
    v_lshlrev_b32 v57, 4, v0
    v_add_u32 v59, s70, v57
    s_lshl_b32 s71, s28, 13
    v_add_u32 v1, s71, v57
    s_lshl_b32 s70, s25, 4
    s_add_u32 s70, s70, s26
    s_lshl_b32 s71, s70, 10
    s_add_u32 s71, s71, 46137344
    s_add_u32 s88, s56, s71
    s_addc_u32 s89, s57, 0
    s_and_b32 s89, s89, 0xffff
    s_mov_b32 s90, 1024
    s_mov_b32 s91, 0x00020000
    s_mov_b32 s92, s86
    s_and_b32 s93, s87, 0xffff
    s_mov_b32 s94, 256
    s_mov_b32 s95, 0x00020000
    s_lshl_b32 s96, s70, 2
    s_add_u32 s96, s96, 128
    s_cmp_lg_u32 s24, 4
    s_cbranch_scc1 m_p2_noclear
    s_lshl_b32 s70, s27, 7
    v_mov_b32 v56, 0
    v_mov_b32 v57, s70
    buffer_store_dword v56, v57, s[88:91], 0 offen sc1
m_p2_noclear:
    s_waitcnt vmcnt(2)
    s_barrier
    s_waitcnt vmcnt(0)
    s_barrier
    s_mul_i32 s70, s28, 5120
    s_add_u32 s78, s70, 65536
    s_mul_i32 s79, s27, 655360
    s_add_u32 s62, s79, 0
    s_add_u32 m0, s78, 0
    s_nop 0
    buffer_load_dwordx4 v4, s[12:15], s62 offen lds
    s_add_u32 m0, s78, 1024
    s_nop 0
    buffer_load_dwordx4 v5, s[12:15], s62 offen lds
    s_add_u32 m0, s78, 2048
    s_nop 0
    buffer_load_dwordx4 v6, s[12:15], s62 offen lds
    s_add_u32 m0, s78, 3072
    s_nop 0
    buffer_load_dwordx4 v7, s[12:15], s62 offen lds
    s_add_u32 m0, s78, 4096
    s_nop 0
    buffer_load_dwordx4 v8, s[12:15], s62 offen lds
    s_mul_i32 s70, s28, 5120
    s_add_u32 s78, s70, 86016
    s_mul_i32 s79, s27, 655360
    s_add_u32 s79, s79, 640
    s_add_u32 s62, s79, 0
    s_add_u32 m0, s78, 0
    s_nop 0
    buffer_load_dwordx4 v4, s[12:15], s62 offen lds
    s_add_u32 m0, s78, 1024
    s_nop 0
    buffer_load_dwordx4 v5, s[12:15], s62 offen lds
    s_add_u32 m0, s78, 2048
    s_nop 0
    buffer_load_dwordx4 v6, s[12:15], s62 offen lds
    s_add_u32 m0, s78, 3072
    s_nop 0
    buffer_load_dwordx4 v7, s[12:15], s62 offen lds
    s_add_u32 m0, s78, 4096
    s_nop 0
    buffer_load_dwordx4 v8, s[12:15], s62 offen lds
    s_mov_b32 s80, s58
    s_and_b32 s81, s59, 0xffff
    s_mov_b32 s82, 5242880
    s_mov_b32 s83, 0x00020000
    s_lshr_b32 s70, s2, 3
    s_mul_i32 s70, s70, 40960
    s_lshr_b32 s71, s27, 1
    s_mul_i32 s71, s71, 1310720
    s_add_u32 s70, s70, s71
    s_mul_i32 s71, s28, 10240
    s_add_u32 s70, s70, s71
    v_mbcnt_lo_u32_b32 v19, -1, 0
    v_mbcnt_hi_u32_b32 v19, -1, v19
    v_lshlrev_b32 v19, 6, v19
    s_add_u32 s71, s70, 0
    buffer_load_dword v20, v19, s[80:83], s71 offen
    s_add_u32 s71, s70, 4096
    buffer_load_dword v21, v19, s[80:83], s71 offen
    s_add_u32 s71, s70, 6144
    buffer_load_dword v22, v19, s[80:83], s71 offen
    s_cmp_lg_u32 s24, 4
    s_cbranch_scc1 m_p2_nocount
    s_waitcnt vmcnt(13)
    v_mov_b32 v56, 1
    v_mov_b32 v57, s96
    s_mov_b64 exec, 1
    buffer_atomic_add v56, v57, s[92:95], 0 offen sc1
    s_mov_b64 exec, -1
m_p2_nocount:
    s_waitcnt vmcnt(3)
    s_barrier
    ds_read_b128 v[128:131], v18 offset:0
    ds_read_b128 v[132:135], v18 offset:1024
    ds_read_b128 v[136:139], v18 offset:2048
    ds_read_b128 v[140:143], v18 offset:3072
    ds_read_b128 v[144:147], v18 offset:4096
    ds_read_b128 v[148:151], v18 offset:5120
    ds_read_b128 v[152:155], v18 offset:6144
    ds_read_b128 v[156:159], v18 offset:7168
    s_add_u32 s62, s75, 163840
    s_add_u32 m0, s73, 0
    s_nop 0
    buffer_load_dwordx4 v4, s[12:15], s62 offen lds
    s_add_u32 m0, s73, 1024
    s_nop 0
    buffer_load_dwordx4 v5, s[12:15], s62 offen lds
    s_add_u32 m0, s73, 2048
    s_nop 0
    buffer_load_dwordx4 v6, s[12:15], s62 offen lds
    s_add_u32 m0, s73, 3072
    s_nop 0
    buffer_load_dwordx4 v7, s[12:15], s62 offen lds
    s_add_u32 m0, s73, 4096
    s_nop 0
    buffer_load_dwordx4 v8, s[12:15], s62 offen lds
    s_waitcnt lgkmcnt(0)
    s_branch m_tail2
m_tail2:
    s_barrier
    ds_read_b64_tr_b16 v[104:105], v61 offset:0
    ds_read_b64_tr_b16 v[106:107], v61 offset:2560
    ds_read_b64_tr_b16 v[108:109], v61 offset:32
    ds_read_b64_tr_b16 v[110:111], v61 offset:2592
    ds_read_b64_tr_b16 v[112:113], v61 offset:64
    ds_read_b64_tr_b16 v[114:115], v61 offset:2624
    ds_read_b64_tr_b16 v[116:117], v61 offset:96
    ds_read_b64_tr_b16 v[118:119], v61 offset:2656
    ds_read_b64_tr_b16 v[120:121], v61 offset:128
    ds_read_b64_tr_b16 v[122:123], v61 offset:2688
    s_waitcnt lgkmcnt(8)
    ds_read_b64_tr_b16 v[32:33], v61 offset:5120
    ds_read_b64_tr_b16 v[34:35], v61 offset:7680
    v_mfma_f32_16x16x32_bf16 v[64:67], v[104:107], v[160:163], 0
    v_mfma_f32_16x16x32_bf16 v[68:71], v[104:107], v[176:179], 0
    s_add_u32 s62, s75, 327680
    s_add_u32 m0, s74, 0
    s_nop 0
    buffer_load_dwordx4 v4, s[12:15], s62 offen lds
    s_waitcnt lgkmcnt(8)
    ds_read_b64_tr_b16 v[36:37], v61 offset:5152
    ds_read_b64_tr_b16 v[38:39], v61 offset:7712
    v_mfma_f32_16x16x32_bf16 v[72:75], v[108:111], v[160:163], 0
    v_mfma_f32_16x16x32_bf16 v[76:79], v[108:111], v[176:179], 0
    s_waitcnt lgkmcnt(8)
    ds_read_b64_tr_b16 v[40:41], v61 offset:5184
    ds_read_b64_tr_b16 v[42:43], v61 offset:7744
    v_mfma_f32_16x16x32_bf16 v[80:83], v[112:115], v[160:163], 0
    v_mfma_f32_16x16x32_bf16 v[84:87], v[112:115], v[176:179], 0
    s_add_u32 m0, s74, 1024
    s_nop 0
    buffer_load_dwordx4 v5, s[12:15], s62 offen lds
    s_waitcnt lgkmcnt(8)
    ds_read_b64_tr_b16 v[44:45], v61 offset:5216
    ds_read_b64_tr_b16 v[46:47], v61 offset:7776
    v_mfma_f32_16x16x32_bf16 v[88:91], v[116:119], v[160:163], 0
    v_mfma_f32_16x16x32_bf16 v[92:95], v[116:119], v[176:179], 0
    s_waitcnt lgkmcnt(8)
    ds_read_b64_tr_b16 v[48:49], v61 offset:5248
    ds_read_b64_tr_b16 v[50:51], v61 offset:7808
    v_mfma_f32_16x16x32_bf16 v[96:99], v[120:123], v[160:163], 0
    v_mfma_f32_16x16x32_bf16 v[100:103], v[120:123], v[176:179], 0
    s_add_u32 m0, s74, 2048
    s_nop 0
    buffer_load_dwordx4 v6, s[12:15], s62 offen lds
    s_waitcnt lgkmcnt(8)
    ds_read_b64_tr_b16 v[104:105], v61 offset:10240
    ds_read_b64_tr_b16 v[106:107], v61 offset:12800
    v_mfma_f32_16x16x32_bf16 v[64:67], v[32:35], v[164:167], v[64:67]
    v_mfma_f32_16x16x32_bf16 v[68:71], v[32:35], v[180:183], v[68:71]
    s_add_u32 m0, s74, 3072
    s_nop 0
    buffer_load_dwordx4 v7, s[12:15], s62 offen lds
    s_waitcnt lgkmcnt(8)
    ds_read_b64_tr_b16 v[108:109], v61 offset:10272
    ds_read_b64_tr_b16 v[110:111], v61 offset:12832
    v_mfma_f32_16x16x32_bf16 v[72:75], v[36:39], v[164:167], v[72:75]
    v_mfma_f32_16x16x32_bf16 v[76:79], v[36:39], v[180:183], v[76:79]
    s_waitcnt lgkmcnt(8)
    ds_read_b64_tr_b16 v[112:113], v61 offset:10304
    ds_read_b64_tr_b16 v[114:115], v61 offset:12864
    v_mfma_f32_16x16x32_bf16 v[80:83], v[40:43], v[164:167], v[80:83]
    v_mfma_f32_16x16x32_bf16 v[84:87], v[40:43], v[180:183], v[84:87]
    s_add_u32 m0, s74, 4096
    s_nop 0
    buffer_load_dwordx4 v8, s[12:15], s62 offen lds
    s_waitcnt lgkmcnt(8)
    ds_read_b64_tr_b16 v[116:117], v61 offset:10336
    ds_read_b64_tr_b16 v[118:119], v61 offset:12896
    v_mfma_f32_16x16x32_bf16 v[88:91], v[44:47], v[164:167], v[88:91]
    v_mfma_f32_16x16x32_bf16 v[92:95], v[44:47], v[180:183], v[92:95]
    s_waitcnt lgkmcnt(8)
    ds_read_b64_tr_b16 v[120:121], v61 offset:10368
    ds_read_b64_tr_b16 v[122:123], v61 offset:12928
    v_mfma_f32_16x16x32_bf16 v[96:99], v[48:51], v[164:167], v[96:99]
    v_mfma_f32_16x16x32_bf16 v[100:103], v[48:51], v[180:183], v[100:103]
    s_waitcnt lgkmcnt(8)
    ds_read_b64_tr_b16 v[32:33], v61 offset:15360
    ds_read_b64_tr_b16 v[34:35], v61 offset:17920
    v_mfma_f32_16x16x32_bf16 v[64:67], v[104:107], v[168:171], v[64:67]
    v_mfma_f32_16x16x32_bf16 v[68:71], v[104:107], v[184:187], v[68:71]
    s_waitcnt lgkmcnt(8)
    ds_read_b64_tr_b16 v[36:37], v61 offset:15392
    ds_read_b64_tr_b16 v[38:39], v61 offset:17952
    v_mfma_f32_16x16x32_bf16 v[72:75], v[108:111], v[168:171], v[72:75]
    v_mfma_f32_16x16x32_bf16 v[76:79], v[108:111], v[184:187], v[76:79]
    s_waitcnt lgkmcnt(8)
    ds_read_b64_tr_b16 v[40:41], v61 offset:15424
    ds_read_b64_tr_b16 v[42:43], v61 offset:17984
    v_mfma_f32_16x16x32_bf16 v[80:83], v[112:115], v[168:171], v[80:83]
    v_mfma_f32_16x16x32_bf16 v[84:87], v[112:115], v[184:187], v[84:87]
    s_waitcnt lgkmcnt(8)
    ds_read_b64_tr_b16 v[44:45], v61 offset:15456
    ds_read_b64_tr_b16 v[46:47], v61 offset:18016
    v_mfma_f32_16x16x32_bf16 v[88:91], v[116:119], v[168:171], v[88:91]
    v_mfma_f32_16x16x32_bf16 v[92:95], v[116:119], v[184:187], v[92:95]
    s_waitcnt lgkmcnt(8)
    ds_read_b64_tr_b16 v[48:49], v61 offset:15488
    ds_read_b64_tr_b16 v[50:51], v61 offset:18048
    v_mfma_f32_16x16x32_bf16 v[96:99], v[120:123], v[168:171], v[96:99]
    v_mfma_f32_16x16x32_bf16 v[100:103], v[120:123], v[184:187], v[100:103]
    s_waitcnt lgkmcnt(8)
    v_mfma_f32_16x16x32_bf16 v[64:67], v[32:35], v[172:175], v[64:67]
    v_mfma_f32_16x16x32_bf16 v[68:71], v[32:35], v[188:191], v[68:71]
    s_waitcnt lgkmcnt(6)
    v_mfma_f32_16x16x32_bf16 v[72:75], v[36:39], v[172:175], v[72:75]
    v_mfma_f32_16x16x32_bf16 v[76:79], v[36:39], v[188:191], v[76:79]
    s_waitcnt lgkmcnt(4)
    v_mfma_f32_16x16x32_bf16 v[80:83], v[40:43], v[172:175], v[80:83]
    v_mfma_f32_16x16x32_bf16 v[84:87], v[40:43], v[188:191], v[84:87]
    s_waitcnt lgkmcnt(2)
    v_mfma_f32_16x16x32_bf16 v[88:91], v[44:47], v[172:175], v[88:91]
    v_mfma_f32_16x16x32_bf16 v[92:95], v[44:47], v[188:191], v[92:95]
    s_waitcnt lgkmcnt(0)
    v_mfma_f32_16x16x32_bf16 v[96:99], v[48:51], v[172:175], v[96:99]
    v_mfma_f32_16x16x32_bf16 v[100:103], v[48:51], v[188:191], v[100:103]
    s_waitcnt vmcnt(0)
    s_barrier
    ds_read_b64_tr_b16 v[104:105], v10 offset:0
    ds_read_b64_tr_b16 v[106:107], v10 offset:2560
    ds_read_b64_tr_b16 v[108:109], v10 offset:32
    ds_read_b64_tr_b16 v[110:111], v10 offset:2592
    ds_read_b64_tr_b16 v[112:113], v10 offset:64
    ds_read_b64_tr_b16 v[114:115], v10 offset:2624
    ds_read_b64_tr_b16 v[116:117], v10 offset:96
    ds_read_b64_tr_b16 v[118:119], v10 offset:2656
    ds_read_b64_tr_b16 v[120:121], v10 offset:128
    ds_read_b64_tr_b16 v[122:123], v10 offset:2688
    s_waitcnt lgkmcnt(8)
    ds_read_b64_tr_b16 v[32:33], v10 offset:5120
    ds_read_b64_tr_b16 v[34:35], v10 offset:7680
    v_mfma_f32_16x16x32_bf16 v[64:67], v[104:107], v[224:227], v[64:67]
    v_mfma_f32_16x16x32_bf16 v[68:71], v[104:107], v[240:243], v[68:71]
    s_add_u32 s62, s75, 491520
    s_add_u32 m0, s97, 0
    s_nop 0
    buffer_load_dwordx4 v4, s[12:15], s62 offen lds
    s_waitcnt lgkmcnt(8)
    ds_read_b64_tr_b16 v[36:37], v10 offset:5152
    ds_read_b64_tr_b16 v[38:39], v10 offset:7712
    v_mfma_f32_16x16x32_bf16 v[72:75], v[108:111], v[224:227], v[72:75]
    v_mfma_f32_16x16x32_bf16 v[76:79], v[108:111], v[240:243], v[76:79]
    s_waitcnt lgkmcnt(8)
    ds_read_b64_tr_b16 v[40:41], v10 offset:5184
    ds_read_b64_tr_b16 v[42:43], v10 offset:7744
    v_mfma_f32_16x16x32_bf16 v[80:83], v[112:115], v[224:227], v[80:83]
    v_mfma_f32_16x16x32_bf16 v[84:87], v[112:115], v[240:243], v[84:87]
    s_add_u32 m0, s97, 1024
    s_nop 0
    buffer_load_dwordx4 v5, s[12:15], s62 offen lds
    s_waitcnt lgkmcnt(8)
    ds_read_b64_tr_b16 v[44:45], v10 offset:5216
    ds_read_b64_tr_b16 v[46:47], v10 offset:7776
    v_mfma_f32_16x16x32_bf16 v[88:91], v[116:119], v[224:227], v[88:91]
    v_mfma_f32_16x16x32_bf16 v[92:95], v[116:119], v[240:243], v[92:95]
    s_waitcnt lgkmcnt(8)
    ds_read_b64_tr_b16 v[48:49], v10 offset:5248
    ds_read_b64_tr_b16 v[50:51], v10 offset:7808
    v_mfma_f32_16x16x32_bf16 v[96:99], v[120:123], v[224:227], v[96:99]
    v_mfma_f32_16x16x32_bf16 v[100:103], v[120:123], v[240:243], v[100:103]
    s_add_u32 m0, s97, 2048
    s_nop 0
    buffer_load_dwordx4 v6, s[12:15], s62 offen lds
    s_waitcnt lgkmcnt(8)
    ds_read_b64_tr_b16 v[104:105], v10 offset:10240
    ds_read_b64_tr_b16 v[106:107], v10 offset:12800
    v_mfma_f32_16x16x32_bf16 v[64:67], v[32:35], v[228:231], v[64:67]
    v_mfma_f32_16x16x32_bf16 v[68:71], v[32:35], v[244:247], v[68:71]
    s_add_u32 m0, s97, 3072
    s_nop 0
    buffer_load_dwordx4 v7, s[12:15], s62 offen lds
    s_waitcnt lgkmcnt(8)
    ds_read_b64_tr_b16 v[108:109], v10 offset:10272
    ds_read_b64_tr_b16 v[110:111], v10 offset:12832
    v_mfma_f32_16x16x32_bf16 v[72:75], v[36:39], v[228:231], v[72:75]
    v_mfma_f32_16x16x32_bf16 v[76:79], v[36:39], v[244:247], v[76:79]
    s_waitcnt lgkmcnt(8)
    ds_read_b64_tr_b16 v[112:113], v10 offset:10304
    ds_read_b64_tr_b16 v[114:115], v10 offset:12864
    v_mfma_f32_16x16x32_bf16 v[80:83], v[40:43], v[228:231], v[80:83]
    v_mfma_f32_16x16x32_bf16 v[84:87], v[40:43], v[244:247], v[84:87]
    s_add_u32 m0, s97, 4096
    s_nop 0
    buffer_load_dwordx4 v8, s[12:15], s62 offen lds
    s_waitcnt lgkmcnt(8)
    ds_read_b64_tr_b16 v[116:117], v10 offset:10336
    ds_read_b64_tr_b16 v[118:119], v10 offset:12896
    v_mfma_f32_16x16x32_bf16 v[88:91], v[44:47], v[228:231], v[88:91]
    v_mfma_f32_16x16x32_bf16 v[92:95], v[44:47], v[244:247], v[92:95]
    s_waitcnt lgkmcnt(8)
    ds_read_b64_tr_b16 v[120:121], v10 offset:10368
    ds_read_b64_tr_b16 v[122:123], v10 offset:12928
    v_mfma_f32_16x16x32_bf16 v[96:99], v[48:51], v[228:231], v[96:99]
    v_mfma_f32_16x16x32_bf16 v[100:103], v[48:51], v[244:247], v[100:103]
    s_add_u32 s62, s75, 160
    s_add_u32 m0, s72, 0
    s_nop 0
    buffer_load_dwordx4 v4, s[12:15], s62 offen lds
    s_waitcnt lgkmcnt(8)
    ds_read_b64_tr_b16 v[32:33], v10 offset:15360
    ds_read_b64_tr_b16 v[34:35], v10 offset:17920
    v_mfma_f32_16x16x32_bf16 v[64:67], v[104:107], v[232:235], v[64:67]
    v_mfma_f32_16x16x32_bf16 v[68:71], v[104:107], v[248:251], v[68:71]
    s_add_u32 m0, s72, 1024
    s_nop 0
    buffer_load_dwordx4 v5, s[12:15], s62 offen lds
    s_waitcnt lgkmcnt(8)
    ds_read_b64_tr_b16 v[36:37], v10 offset:15392
    ds_read_b64_tr_b16 v[38:39], v10 offset:17952
    v_mfma_f32_16x16x32_bf16 v[72:75], v[108:111], v[232:235], v[72:75]
    v_mfma_f32_16x16x32_bf16 v[76:79], v[108:111], v[248:251], v[76:79]
    s_waitcnt lgkmcnt(8)
    ds_read_b64_tr_b16 v[40:41], v10 offset:15424
    ds_read_b64_tr_b16 v[42:43], v10 offset:17984
    v_mfma_f32_16x16x32_bf16 v[80:83], v[112:115], v[232:235], v[80:83]
    v_mfma_f32_16x16x32_bf16 v[84:87], v[112:115], v[248:251], v[84:87]
    s_add_u32 m0, s72, 2048
    s_nop 0
    buffer_load_dwordx4 v6, s[12:15], s62 offen lds
    s_waitcnt lgkmcnt(8)
    ds_read_b64_tr_b16 v[44:45], v10 offset:15456
    ds_read_b64_tr_b16 v[46:47], v10 offset:18016
    v_mfma_f32_16x16x32_bf16 v[88:91], v[116:119], v[232:235], v[88:91]
    v_mfma_f32_16x16x32_bf16 v[92:95], v[116:119], v[248:251], v[92:95]
    s_waitcnt lgkmcnt(8)
    ds_read_b64_tr_b16 v[48:49], v10 offset:15488
    ds_read_b64_tr_b16 v[50:51], v10 offset:18048
    v_mfma_f32_16x16x32_bf16 v[96:99], v[120:123], v[232:235], v[96:99]
    v_mfma_f32_16x16x32_bf16 v[100:103], v[120:123], v[248:251], v[100:103]
    s_add_u32 m0, s72, 3072
    s_nop 0
    buffer_load_dwordx4 v7, s[12:15], s62 offen lds
    s_waitcnt lgkmcnt(8)
    ds_read_b64_tr_b16 v[104:105], v11 offset:0
    ds_read_b64_tr_b16 v[106:107], v11 offset:2560
    v_mfma_f32_16x16x32_bf16 v[64:67], v[32:35], v[236:239], v[64:67]
    v_mfma_f32_16x16x32_bf16 v[68:71], v[32:35], v[252:255], v[68:71]
    s_add_u32 m0, s72, 4096
    s_nop 0
    buffer_load_dwordx4 v8, s[12:15], s62 offen lds
    s_waitcnt lgkmcnt(8)
    ds_read_b64_tr_b16 v[108:109], v11 offset:32
    ds_read_b64_tr_b16 v[110:111], v11 offset:2592
    v_mfma_f32_16x16x32_bf16 v[72:75], v[36:39], v[236:239], v[72:75]
    v_mfma_f32_16x16x32_bf16 v[76:79], v[36:39], v[252:255], v[76:79]
    s_waitcnt lgkmcnt(8)
    ds_read_b64_tr_b16 v[112:113], v11 offset:64
    ds_read_b64_tr_b16 v[114:115], v11 offset:2624
    v_mfma_f32_16x16x32_bf16 v[80:83], v[40:43], v[236:239], v[80:83]
    v_mfma_f32_16x16x32_bf16 v[84:87], v[40:43], v[252:255], v[84:87]
    s_waitcnt lgkmcnt(8)
    ds_read_b64_tr_b16 v[116:117], v11 offset:96
    ds_read_b64_tr_b16 v[118:119], v11 offset:2656
    v_mfma_f32_16x16x32_bf16 v[88:91], v[44:47], v[236:239], v[88:91]
    v_mfma_f32_16x16x32_bf16 v[92:95], v[44:47], v[252:255], v[92:95]
    s_waitcnt lgkmcnt(8)
    ds_read_b64_tr_b16 v[120:121], v11 offset:128
    ds_read_b64_tr_b16 v[122:123], v11 offset:2688
    v_mfma_f32_16x16x32_bf16 v[96:99], v[48:51], v[236:239], v[96:99]
    v_mfma_f32_16x16x32_bf16 v[100:103], v[48:51], v[252:255], v[100:103]
    s_waitcnt vmcnt(5)
    s_barrier
    s_waitcnt lgkmcnt(8)
    ds_read_b64_tr_b16 v[32:33], v11 offset:5120
    ds_read_b64_tr_b16 v[34:35], v11 offset:7680
    v_mfma_f32_16x16x32_bf16 v[64:67], v[104:107], v[192:195], v[64:67]
    v_mfma_f32_16x16x32_bf16 v[68:71], v[104:107], v[208:211], v[68:71]
    s_add_u32 s62, s75, 164000
    s_add_u32 m0, s73, 0
    s_nop 0
    buffer_load_dwordx4 v4, s[12:15], s62 offen lds
    s_waitcnt lgkmcnt(8)
    ds_read_b64_tr_b16 v[36:37], v11 offset:5152
    ds_read_b64_tr_b16 v[38:39], v11 offset:7712
    v_mfma_f32_16x16x32_bf16 v[72:75], v[108:111], v[192:195], v[72:75]
    v_mfma_f32_16x16x32_bf16 v[76:79], v[108:111], v[208:211], v[76:79]
    s_waitcnt lgkmcnt(8)
    ds_read_b64_tr_b16 v[40:41], v11 offset:5184
    ds_read_b64_tr_b16 v[42:43], v11 offset:7744
    v_mfma_f32_16x16x32_bf16 v[80:83], v[112:115], v[192:195], v[80:83]
    v_mfma_f32_16x16x32_bf16 v[84:87], v[112:115], v[208:211], v[84:87]
    s_add_u32 m0, s73, 1024
    s_nop 0
    buffer_load_dwordx4 v5, s[12:15], s62 offen lds
    s_waitcnt lgkmcnt(8)
    ds_read_b64_tr_b16 v[44:45], v11 offset:5216
    ds_read_b64_tr_b16 v[46:47], v11 offset:7776
    v_mfma_f32_16x16x32_bf16 v[88:91], v[116:119], v[192:195], v[88:91]
    v_mfma_f32_16x16x32_bf16 v[92:95], v[116:119], v[208:211], v[92:95]
    s_waitcnt lgkmcnt(8)
    ds_read_b64_tr_b16 v[48:49], v11 offset:5248
    ds_read_b64_tr_b16 v[50:51], v11 offset:7808
    v_mfma_f32_16x16x32_bf16 v[96:99], v[120:123], v[192:195], v[96:99]
    v_mfma_f32_16x16x32_bf16 v[100:103], v[120:123], v[208:211], v[100:103]
    s_add_u32 m0, s73, 2048
    s_nop 0
    buffer_load_dwordx4 v6, s[12:15], s62 offen lds
    s_waitcnt lgkmcnt(8)
    ds_read_b64_tr_b16 v[104:105], v11 offset:10240
    ds_read_b64_tr_b16 v[106:107], v11 offset:12800
    v_mfma_f32_16x16x32_bf16 v[64:67], v[32:35], v[196:199], v[64:67]
    v_mfma_f32_16x16x32_bf16 v[68:71], v[32:35], v[212:215], v[68:71]
    s_add_u32 m0, s73, 3072
    s_nop 0
    buffer_load_dwordx4 v7, s[12:15], s62 offen lds
    s_waitcnt lgkmcnt(8)
    ds_read_b64_tr_b16 v[108:109], v11 offset:10272
    ds_read_b64_tr_b16 v[110:111], v11 offset:12832
    v_mfma_f32_16x16x32_bf16 v[72:75], v[36:39], v[196:199], v[72:75]
    v_mfma_f32_16x16x32_bf16 v[76:79], v[36:39], v[212:215], v[76:79]
    s_waitcnt lgkmcnt(8)
    ds_read_b64_tr_b16 v[112:113], v11 offset:10304
    ds_read_b64_tr_b16 v[114:115], v11 offset:12864
    v_mfma_f32_16x16x32_bf16 v[80:83], v[40:43], v[196:199], v[80:83]
    v_mfma_f32_16x16x32_bf16 v[84:87], v[40:43], v[212:215], v[84:87]
    s_add_u32 m0, s73, 4096
    s_nop 0
    buffer_load_dwordx4 v8, s[12:15], s62 offen lds
    s_waitcnt lgkmcnt(8)
    ds_read_b64_tr_b16 v[116:117], v11 offset:10336
    ds_read_b64_tr_b16 v[118:119], v11 offset:12896
    v_mfma_f32_16x16x32_bf16 v[88:91], v[44:47], v[196:199], v[88:91]
    v_mfma_f32_16x16x32_bf16 v[92:95], v[44:47], v[212:215], v[92:95]
    s_waitcnt lgkmcnt(8)
    ds_read_b64_tr_b16 v[120:121], v11 offset:10368
    ds_read_b64_tr_b16 v[122:123], v11 offset:12928
    v_mfma_f32_16x16x32_bf16 v[96:99], v[48:51], v[196:199], v[96:99]
    v_mfma_f32_16x16x32_bf16 v[100:103], v[48:51], v[212:215], v[100:103]
    s_waitcnt lgkmcnt(8)
    ds_read_b64_tr_b16 v[32:33], v11 offset:15360
    ds_read_b64_tr_b16 v[34:35], v11 offset:17920
    v_mfma_f32_16x16x32_bf16 v[64:67], v[104:107], v[200:203], v[64:67]
    v_mfma_f32_16x16x32_bf16 v[68:71], v[104:107], v[216:219], v[68:71]
    s_waitcnt lgkmcnt(8)
    ds_read_b64_tr_b16 v[36:37], v11 offset:15392
    ds_read_b64_tr_b16 v[38:39], v11 offset:17952
    v_mfma_f32_16x16x32_bf16 v[72:75], v[108:111], v[200:203], v[72:75]
    v_mfma_f32_16x16x32_bf16 v[76:79], v[108:111], v[216:219], v[76:79]
    s_waitcnt lgkmcnt(8)
    ds_read_b64_tr_b16 v[40:41], v11 offset:15424
    ds_read_b64_tr_b16 v[42:43], v11 offset:17984
    v_mfma_f32_16x16x32_bf16 v[80:83], v[112:115], v[200:203], v[80:83]
    v_mfma_f32_16x16x32_bf16 v[84:87], v[112:115], v[216:219], v[84:87]
    s_waitcnt lgkmcnt(8)
    ds_read_b64_tr_b16 v[44:45], v11 offset:15456
    ds_read_b64_tr_b16 v[46:47], v11 offset:18016
    v_mfma_f32_16x16x32_bf16 v[88:91], v[116:119], v[200:203], v[88:91]
    v_mfma_f32_16x16x32_bf16 v[92:95], v[116:119], v[216:219], v[92:95]
    s_waitcnt lgkmcnt(8)
    ds_read_b64_tr_b16 v[48:49], v11 offset:15488
    ds_read_b64_tr_b16 v[50:51], v11 offset:18048
    v_mfma_f32_16x16x32_bf16 v[96:99], v[120:123], v[200:203], v[96:99]
    v_mfma_f32_16x16x32_bf16 v[100:103], v[120:123], v[216:219], v[100:103]
    s_waitcnt lgkmcnt(8)
    ds_read_b64_tr_b16 v[104:105], v63 offset:0
    ds_read_b64_tr_b16 v[106:107], v63 offset:2560
    v_mfma_f32_16x16x32_bf16 v[64:67], v[32:35], v[204:207], v[64:67]
    v_mfma_f32_16x16x32_bf16 v[68:71], v[32:35], v[220:223], v[68:71]
    s_waitcnt lgkmcnt(8)
    ds_read_b64_tr_b16 v[108:109], v63 offset:32
    ds_read_b64_tr_b16 v[110:111], v63 offset:2592
    v_mfma_f32_16x16x32_bf16 v[72:75], v[36:39], v[204:207], v[72:75]
    v_mfma_f32_16x16x32_bf16 v[76:79], v[36:39], v[220:223], v[76:79]
    s_waitcnt lgkmcnt(8)
    ds_read_b64_tr_b16 v[112:113], v63 offset:64
    ds_read_b64_tr_b16 v[114:115], v63 offset:2624
    v_mfma_f32_16x16x32_bf16 v[80:83], v[40:43], v[204:207], v[80:83]
    v_mfma_f32_16x16x32_bf16 v[84:87], v[40:43], v[220:223], v[84:87]
    s_waitcnt lgkmcnt(8)
    ds_read_b64_tr_b16 v[116:117], v63 offset:96
    ds_read_b64_tr_b16 v[118:119], v63 offset:2656
    v_mfma_f32_16x16x32_bf16 v[88:91], v[44:47], v[204:207], v[88:91]
    v_mfma_f32_16x16x32_bf16 v[92:95], v[44:47], v[220:223], v[92:95]
    s_waitcnt lgkmcnt(8)
    ds_read_b64_tr_b16 v[120:121], v63 offset:128
    ds_read_b64_tr_b16 v[122:123], v63 offset:2688
    v_mfma_f32_16x16x32_bf16 v[96:99], v[48:51], v[204:207], v[96:99]
    v_mfma_f32_16x16x32_bf16 v[100:103], v[48:51], v[220:223], v[100:103]
    s_waitcnt vmcnt(5)
    s_barrier
    s_waitcnt lgkmcnt(8)
    ds_read_b64_tr_b16 v[32:33], v63 offset:5120
    ds_read_b64_tr_b16 v[34:35], v63 offset:7680
    v_mfma_f32_16x16x32_bf16 v[64:67], v[104:107], v[128:131], v[64:67]
    v_mfma_f32_16x16x32_bf16 v[68:71], v[104:107], v[144:147], v[68:71]
    s_add_u32 s62, s75, 327840
    s_add_u32 m0, s74, 0
    s_nop 0
    buffer_load_dwordx4 v4, s[12:15], s62 offen lds
    s_waitcnt lgkmcnt(8)
    ds_read_b64_tr_b16 v[36:37], v63 offset:5152
    ds_read_b64_tr_b16 v[38:39], v63 offset:7712
    v_mfma_f32_16x16x32_bf16 v[72:75], v[108:111], v[128:131], v[72:75]
    v_mfma_f32_16x16x32_bf16 v[76:79], v[108:111], v[144:147], v[76:79]
    s_waitcnt lgkmcnt(8)
    ds_read_b64_tr_b16 v[40:41], v63 offset:5184
    ds_read_b64_tr_b16 v[42:43], v63 offset:7744
    v_mfma_f32_16x16x32_bf16 v[80:83], v[112:115], v[128:131], v[80:83]
    v_mfma_f32_16x16x32_bf16 v[84:87], v[112:115], v[144:147], v[84:87]
    s_add_u32 m0, s74, 1024
    s_nop 0
    buffer_load_dwordx4 v5, s[12:15], s62 offen lds
    s_waitcnt lgkmcnt(8)
    ds_read_b64_tr_b16 v[44:45], v63 offset:5216
    ds_read_b64_tr_b16 v[46:47], v63 offset:7776
    v_mfma_f32_16x16x32_bf16 v[88:91], v[116:119], v[128:131], v[88:91]
    v_mfma_f32_16x16x32_bf16 v[92:95], v[116:119], v[144:147], v[92:95]
    s_waitcnt lgkmcnt(8)
    ds_read_b64_tr_b16 v[48:49], v63 offset:5248
    ds_read_b64_tr_b16 v[50:51], v63 offset:7808
    v_mfma_f32_16x16x32_bf16 v[96:99], v[120:123], v[128:131], v[96:99]
    v_mfma_f32_16x16x32_bf16 v[100:103], v[120:123], v[144:147], v[100:103]
    s_add_u32 m0, s74, 2048
    s_nop 0
    buffer_load_dwordx4 v6, s[12:15], s62 offen lds
    s_waitcnt lgkmcnt(8)
    ds_read_b64_tr_b16 v[104:105], v63 offset:10240
    ds_read_b64_tr_b16 v[106:107], v63 offset:12800
    v_mfma_f32_16x16x32_bf16 v[64:67], v[32:35], v[132:135], v[64:67]
    v_mfma_f32_16x16x32_bf16 v[68:71], v[32:35], v[148:151], v[68:71]
    s_add_u32 m0, s74, 3072
    s_nop 0
    buffer_load_dwordx4 v7, s[12:15], s62 offen lds
    s_waitcnt lgkmcnt(8)
    ds_read_b64_tr_b16 v[108:109], v63 offset:10272
    ds_read_b64_tr_b16 v[110:111], v63 offset:12832
    v_mfma_f32_16x16x32_bf16 v[72:75], v[36:39], v[132:135], v[72:75]
    v_mfma_f32_16x16x32_bf16 v[76:79], v[36:39], v[148:151], v[76:79]
    s_waitcnt lgkmcnt(8)
    ds_read_b64_tr_b16 v[112:113], v63 offset:10304
    ds_read_b64_tr_b16 v[114:115], v63 offset:12864
    v_mfma_f32_16x16x32_bf16 v[80:83], v[40:43], v[132:135], v[80:83]
    v_mfma_f32_16x16x32_bf16 v[84:87], v[40:43], v[148:151], v[84:87]
    s_add_u32 m0, s74, 4096
    s_nop 0
    buffer_load_dwordx4 v8, s[12:15], s62 offen lds
    s_waitcnt lgkmcnt(8)
    ds_read_b64_tr_b16 v[116:117], v63 offset:10336
    ds_read_b64_tr_b16 v[118:119], v63 offset:12896
    v_mfma_f32_16x16x32_bf16 v[88:91], v[44:47], v[132:135], v[88:91]
    v_mfma_f32_16x16x32_bf16 v[92:95], v[44:47], v[148:151], v[92:95]
    s_waitcnt lgkmcnt(8)
    ds_read_b64_tr_b16 v[120:121], v63 offset:10368
    ds_read_b64_tr_b16 v[122:123], v63 offset:12928
    v_mfma_f32_16x16x32_bf16 v[96:99], v[48:51], v[132:135], v[96:99]
    v_mfma_f32_16x16x32_bf16 v[100:103], v[48:51], v[148:151], v[100:103]
    s_waitcnt lgkmcnt(8)
    ds_read_b64_tr_b16 v[32:33], v63 offset:15360
    ds_read_b64_tr_b16 v[34:35], v63 offset:17920
    v_mfma_f32_16x16x32_bf16 v[64:67], v[104:107], v[136:139], v[64:67]
    v_mfma_f32_16x16x32_bf16 v[68:71], v[104:107], v[152:155], v[68:71]
    s_waitcnt lgkmcnt(8)
    ds_read_b64_tr_b16 v[36:37], v63 offset:15392
    ds_read_b64_tr_b16 v[38:39], v63 offset:17952
    v_mfma_f32_16x16x32_bf16 v[72:75], v[108:111], v[136:139], v[72:75]
    v_mfma_f32_16x16x32_bf16 v[76:79], v[108:111], v[152:155], v[76:79]
    s_waitcnt lgkmcnt(8)
    ds_read_b64_tr_b16 v[40:41], v63 offset:15424
    ds_read_b64_tr_b16 v[42:43], v63 offset:17984
    v_mfma_f32_16x16x32_bf16 v[80:83], v[112:115], v[136:139], v[80:83]
    v_mfma_f32_16x16x32_bf16 v[84:87], v[112:115], v[152:155], v[84:87]
    s_waitcnt lgkmcnt(8)
    ds_read_b64_tr_b16 v[44:45], v63 offset:15456
    ds_read_b64_tr_b16 v[46:47], v63 offset:18016
    v_mfma_f32_16x16x32_bf16 v[88:91], v[116:119], v[136:139], v[88:91]
    v_mfma_f32_16x16x32_bf16 v[92:95], v[116:119], v[152:155], v[92:95]
    s_waitcnt lgkmcnt(8)
    ds_read_b64_tr_b16 v[48:49], v63 offset:15488
    ds_read_b64_tr_b16 v[50:51], v63 offset:18048
    v_mfma_f32_16x16x32_bf16 v[96:99], v[120:123], v[136:139], v[96:99]
    v_mfma_f32_16x16x32_bf16 v[100:103], v[120:123], v[152:155], v[100:103]
    s_waitcnt lgkmcnt(8)
    ds_read_b64_tr_b16 v[104:105], v9 offset:0
    ds_read_b64_tr_b16 v[106:107], v9 offset:2560
    v_mfma_f32_16x16x32_bf16 v[64:67], v[32:35], v[140:143], v[64:67]
    v_mfma_f32_16x16x32_bf16 v[68:71], v[32:35], v[156:159], v[68:71]
    s_waitcnt lgkmcnt(8)
    ds_read_b64_tr_b16 v[108:109], v9 offset:32
    ds_read_b64_tr_b16 v[110:111], v9 offset:2592
    v_mfma_f32_16x16x32_bf16 v[72:75], v[36:39], v[140:143], v[72:75]
    v_mfma_f32_16x16x32_bf16 v[76:79], v[36:39], v[156:159], v[76:79]
    s_waitcnt lgkmcnt(8)
    ds_read_b64_tr_b16 v[112:113], v9 offset:64
    ds_read_b64_tr_b16 v[114:115], v9 offset:2624
    v_mfma_f32_16x16x32_bf16 v[80:83], v[40:43], v[140:143], v[80:83]
    v_mfma_f32_16x16x32_bf16 v[84:87], v[40:43], v[156:159], v[84:87]
    s_waitcnt lgkmcnt(8)
    ds_read_b64_tr_b16 v[116:117], v9 offset:96
    ds_read_b64_tr_b16 v[118:119], v9 offset:2656
    v_mfma_f32_16x16x32_bf16 v[88:91], v[44:47], v[140:143], v[88:91]
    v_mfma_f32_16x16x32_bf16 v[92:95], v[44:47], v[156:159], v[92:95]
    s_waitcnt lgkmcnt(8)
    ds_read_b64_tr_b16 v[120:121], v9 offset:128
    ds_read_b64_tr_b16 v[122:123], v9 offset:2688
    v_mfma_f32_16x16x32_bf16 v[96:99], v[48:51], v[140:143], v[96:99]
    v_mfma_f32_16x16x32_bf16 v[100:103], v[48:51], v[156:159], v[100:103]
    v_cvt_pk_bf16_f32 v16, v64, v65
    v_cvt_pk_bf16_f32 v17, v66, v67
    v_cvt_pk_bf16_f32 v18, v68, v69
    v_cvt_pk_bf16_f32 v19, v70, v71
    v_cvt_pk_bf16_f32 v20, v72, v73
    v_cvt_pk_bf16_f32 v21, v74, v75
    v_cvt_pk_bf16_f32 v22, v76, v77
    v_cvt_pk_bf16_f32 v23, v78, v79
    v_cvt_pk_bf16_f32 v24, v80, v81
    v_cvt_pk_bf16_f32 v25, v82, v83
    v_cvt_pk_bf16_f32 v26, v84, v85
    v_cvt_pk_bf16_f32 v27, v86, v87
    v_cvt_pk_bf16_f32 v28, v88, v89
    v_cvt_pk_bf16_f32 v29, v90, v91
    v_cvt_pk_bf16_f32 v30, v92, v93
    v_cvt_pk_bf16_f32 v31, v94, v95
    v_cvt_pk_bf16_f32 v52, v96, v97
    v_cvt_pk_bf16_f32 v53, v98, v99
    v_cvt_pk_bf16_f32 v54, v100, v101
    v_cvt_pk_bf16_f32 v55, v102, v103
    s_add_u32 s69, s76, 0
    buffer_store_dwordx4 v[16:19], v59, s[4:7], s69 offen offset:0 sc1
    s_add_u32 s69, s76, 0
    buffer_store_dwordx4 v[20:23], v59, s[4:7], s69 offen offset:1024 sc1
    s_add_u32 s69, s76, 0
    buffer_store_dwordx4 v[24:27], v59, s[4:7], s69 offen offset:2048 sc1
    s_add_u32 s69, s76, 0
    buffer_store_dwordx4 v[28:31], v59, s[4:7], s69 offen offset:3072 sc1
    s_add_u32 s69, s76, 4096
    buffer_store_dwordx4 v[52:55], v59, s[4:7], s69 offen offset:0 sc1
    s_waitcnt vmcnt(10)
    s_barrier
    s_waitcnt lgkmcnt(8)
    ds_read_b64_tr_b16 v[32:33], v9 offset:5120
    ds_read_b64_tr_b16 v[34:35], v9 offset:7680
    v_mfma_f32_16x16x32_bf16 v[64:67], v[104:107], v[160:163], 0
    v_mfma_f32_16x16x32_bf16 v[68:71], v[104:107], v[176:179], 0
    s_add_u32 s62, s75, 491680
    s_add_u32 m0, s97, 0
    s_nop 0
    buffer_load_dwordx4 v4, s[12:15], s62 offen lds
    s_waitcnt lgkmcnt(8)
    ds_read_b64_tr_b16 v[36:37], v9 offset:5152
    ds_read_b64_tr_b16 v[38:39], v9 offset:7712
    v_mfma_f32_16x16x32_bf16 v[72:75], v[108:111], v[160:163], 0
    v_mfma_f32_16x16x32_bf16 v[76:79], v[108:111], v[176:179], 0
    s_waitcnt lgkmcnt(8)
    ds_read_b64_tr_b16 v[40:41], v9 offset:5184
    ds_read_b64_tr_b16 v[42:43], v9 offset:7744
    v_mfma_f32_16x16x32_bf16 v[80:83], v[112:115], v[160:163], 0
    v_mfma_f32_16x16x32_bf16 v[84:87], v[112:115], v[176:179], 0
    s_add_u32 m0, s97, 1024
    s_nop 0
    buffer_load_dwordx4 v5, s[12:15], s62 offen lds
    s_waitcnt lgkmcnt(8)
    ds_read_b64_tr_b16 v[44:45], v9 offset:5216
    ds_read_b64_tr_b16 v[46:47], v9 offset:7776
    v_mfma_f32_16x16x32_bf16 v[88:91], v[116:119], v[160:163], 0
    v_mfma_f32_16x16x32_bf16 v[92:95], v[116:119], v[176:179], 0
    s_waitcnt lgkmcnt(8)
    ds_read_b64_tr_b16 v[48:49], v9 offset:5248
    ds_read_b64_tr_b16 v[50:51], v9 offset:7808
    v_mfma_f32_16x16x32_bf16 v[96:99], v[120:123], v[160:163], 0
    v_mfma_f32_16x16x32_bf16 v[100:103], v[120:123], v[176:179], 0
    s_add_u32 m0, s97, 2048
    s_nop 0
    buffer_load_dwordx4 v6, s[12:15], s62 offen lds
    s_waitcnt lgkmcnt(8)
    ds_read_b64_tr_b16 v[104:105], v9 offset:10240
    ds_read_b64_tr_b16 v[106:107], v9 offset:12800
    v_mfma_f32_16x16x32_bf16 v[64:67], v[32:35], v[164:167], v[64:67]
    v_mfma_f32_16x16x32_bf16 v[68:71], v[32:35], v[180:183], v[68:71]
    s_add_u32 m0, s97, 3072
    s_nop 0
    buffer_load_dwordx4 v7, s[12:15], s62 offen lds
    s_waitcnt lgkmcnt(8)
    ds_read_b64_tr_b16 v[108:109], v9 offset:10272
    ds_read_b64_tr_b16 v[110:111], v9 offset:12832
    v_mfma_f32_16x16x32_bf16 v[72:75], v[36:39], v[164:167], v[72:75]
    v_mfma_f32_16x16x32_bf16 v[76:79], v[36:39], v[180:183], v[76:79]
    s_waitcnt lgkmcnt(8)
    ds_read_b64_tr_b16 v[112:113], v9 offset:10304
    ds_read_b64_tr_b16 v[114:115], v9 offset:12864
    v_mfma_f32_16x16x32_bf16 v[80:83], v[40:43], v[164:167], v[80:83]
    v_mfma_f32_16x16x32_bf16 v[84:87], v[40:43], v[180:183], v[84:87]
    s_add_u32 m0, s97, 4096
    s_nop 0
    buffer_load_dwordx4 v8, s[12:15], s62 offen lds
    s_waitcnt lgkmcnt(8)
    ds_read_b64_tr_b16 v[116:117], v9 offset:10336
    ds_read_b64_tr_b16 v[118:119], v9 offset:12896
    v_mfma_f32_16x16x32_bf16 v[88:91], v[44:47], v[164:167], v[88:91]
    v_mfma_f32_16x16x32_bf16 v[92:95], v[44:47], v[180:183], v[92:95]
    s_waitcnt lgkmcnt(8)
    ds_read_b64_tr_b16 v[120:121], v9 offset:10368
    ds_read_b64_tr_b16 v[122:123], v9 offset:12928
    v_mfma_f32_16x16x32_bf16 v[96:99], v[48:51], v[164:167], v[96:99]
    v_mfma_f32_16x16x32_bf16 v[100:103], v[48:51], v[180:183], v[100:103]
    s_waitcnt lgkmcnt(8)
    ds_read_b64_tr_b16 v[32:33], v9 offset:15360
    ds_read_b64_tr_b16 v[34:35], v9 offset:17920
    v_mfma_f32_16x16x32_bf16 v[64:67], v[104:107], v[168:171], v[64:67]
    v_mfma_f32_16x16x32_bf16 v[68:71], v[104:107], v[184:187], v[68:71]
    s_waitcnt lgkmcnt(8)
    ds_read_b64_tr_b16 v[36:37], v9 offset:15392
    ds_read_b64_tr_b16 v[38:39], v9 offset:17952
    v_mfma_f32_16x16x32_bf16 v[72:75], v[108:111], v[168:171], v[72:75]
    v_mfma_f32_16x16x32_bf16 v[76:79], v[108:111], v[184:187], v[76:79]
    s_waitcnt lgkmcnt(8)
    ds_read_b64_tr_b16 v[40:41], v9 offset:15424
    ds_read_b64_tr_b16 v[42:43], v9 offset:17984
    v_mfma_f32_16x16x32_bf16 v[80:83], v[112:115], v[168:171], v[80:83]
    v_mfma_f32_16x16x32_bf16 v[84:87], v[112:115], v[184:187], v[84:87]
    s_waitcnt lgkmcnt(8)
    ds_read_b64_tr_b16 v[44:45], v9 offset:15456
    ds_read_b64_tr_b16 v[46:47], v9 offset:18016
    v_mfma_f32_16x16x32_bf16 v[88:91], v[116:119], v[168:171], v[88:91]
    v_mfma_f32_16x16x32_bf16 v[92:95], v[116:119], v[184:187], v[92:95]
    s_waitcnt lgkmcnt(8)
    ds_read_b64_tr_b16 v[48:49], v9 offset:15488
    ds_read_b64_tr_b16 v[50:51], v9 offset:18048
    v_mfma_f32_16x16x32_bf16 v[96:99], v[120:123], v[168:171], v[96:99]
    v_mfma_f32_16x16x32_bf16 v[100:103], v[120:123], v[184:187], v[100:103]
    s_waitcnt lgkmcnt(8)
    ds_read_b64_tr_b16 v[104:105], v10 offset:0
    ds_read_b64_tr_b16 v[106:107], v10 offset:2560
    v_mfma_f32_16x16x32_bf16 v[64:67], v[32:35], v[172:175], v[64:67]
    v_mfma_f32_16x16x32_bf16 v[68:71], v[32:35], v[188:191], v[68:71]
    s_waitcnt lgkmcnt(8)
    ds_read_b64_tr_b16 v[108:109], v10 offset:32
    ds_read_b64_tr_b16 v[110:111], v10 offset:2592
    v_mfma_f32_16x16x32_bf16 v[72:75], v[36:39], v[172:175], v[72:75]
    v_mfma_f32_16x16x32_bf16 v[76:79], v[36:39], v[188:191], v[76:79]
    s_waitcnt lgkmcnt(8)
    ds_read_b64_tr_b16 v[112:113], v10 offset:64
    ds_read_b64_tr_b16 v[114:115], v10 offset:2624
    v_mfma_f32_16x16x32_bf16 v[80:83], v[40:43], v[172:175], v[80:83]
    v_mfma_f32_16x16x32_bf16 v[84:87], v[40:43], v[188:191], v[84:87]
    s_waitcnt lgkmcnt(8)
    ds_read_b64_tr_b16 v[116:117], v10 offset:96
    ds_read_b64_tr_b16 v[118:119], v10 offset:2656
    v_mfma_f32_16x16x32_bf16 v[88:91], v[44:47], v[172:175], v[88:91]
    v_mfma_f32_16x16x32_bf16 v[92:95], v[44:47], v[188:191], v[92:95]
    s_waitcnt lgkmcnt(8)
    ds_read_b64_tr_b16 v[120:121], v10 offset:128
    ds_read_b64_tr_b16 v[122:123], v10 offset:2688
    v_mfma_f32_16x16x32_bf16 v[96:99], v[48:51], v[172:175], v[96:99]
    v_mfma_f32_16x16x32_bf16 v[100:103], v[48:51], v[188:191], v[100:103]
    s_waitcnt vmcnt(10)
    s_barrier
    s_cmp_lg_u32 s24, 7
    s_cbranch_scc1 m_epc2
    v_mov_b32 v57, s96
    buffer_load_dword v56, v57, s[92:95], 0 offen sc1
m_epc2:
    s_waitcnt lgkmcnt(8)
    ds_read_b64_tr_b16 v[32:33], v10 offset:5120
    ds_read_b64_tr_b16 v[34:35], v10 offset:7680
    v_mfma_f32_16x16x32_bf16 v[64:67], v[104:107], v[224:227], v[64:67]
    v_mfma_f32_16x16x32_bf16 v[68:71], v[104:107], v[240:243], v[68:71]
    s_add_u32 s62, s75, 320
    s_add_u32 m0, s72, 0
    s_nop 0
    buffer_load_dwordx4 v4, s[12:15], s62 offen lds
    s_waitcnt lgkmcnt(8)
    ds_read_b64_tr_b16 v[36:37], v10 offset:5152
    ds_read_b64_tr_b16 v[38:39], v10 offset:7712
    v_mfma_f32_16x16x32_bf16 v[72:75], v[108:111], v[224:227], v[72:75]
    v_mfma_f32_16x16x32_bf16 v[76:79], v[108:111], v[240:243], v[76:79]
    s_waitcnt lgkmcnt(8)
    ds_read_b64_tr_b16 v[40:41], v10 offset:5184
    ds_read_b64_tr_b16 v[42:43], v10 offset:7744
    v_mfma_f32_16x16x32_bf16 v[80:83], v[112:115], v[224:227], v[80:83]
    v_mfma_f32_16x16x32_bf16 v[84:87], v[112:115], v[240:243], v[84:87]
    s_add_u32 m0, s72, 1024
    s_nop 0
    buffer_load_dwordx4 v5, s[12:15], s62 offen lds
    s_waitcnt lgkmcnt(8)
    ds_read_b64_tr_b16 v[44:45], v10 offset:5216
    ds_read_b64_tr_b16 v[46:47], v10 offset:7776
    v_mfma_f32_16x16x32_bf16 v[88:91], v[116:119], v[224:227], v[88:91]
    v_mfma_f32_16x16x32_bf16 v[92:95], v[116:119], v[240:243], v[92:95]
    s_waitcnt lgkmcnt(8)
    ds_read_b64_tr_b16 v[48:49], v10 offset:5248
    ds_read_b64_tr_b16 v[50:51], v10 offset:7808
    v_mfma_f32_16x16x32_bf16 v[96:99], v[120:123], v[224:227], v[96:99]
    v_mfma_f32_16x16x32_bf16 v[100:103], v[120:123], v[240:243], v[100:103]
    s_add_u32 m0, s72, 2048
    s_nop 0
    buffer_load_dwordx4 v6, s[12:15], s62 offen lds
    s_waitcnt lgkmcnt(8)
    ds_read_b64_tr_b16 v[104:105], v10 offset:10240
    ds_read_b64_tr_b16 v[106:107], v10 offset:12800
    v_mfma_f32_16x16x32_bf16 v[64:67], v[32:35], v[228:231], v[64:67]
    v_mfma_f32_16x16x32_bf16 v[68:71], v[32:35], v[244:247], v[68:71]
    s_add_u32 m0, s72, 3072
    s_nop 0
    buffer_load_dwordx4 v7, s[12:15], s62 offen lds
    s_waitcnt lgkmcnt(8)
    ds_read_b64_tr_b16 v[108:109], v10 offset:10272
    ds_read_b64_tr_b16 v[110:111], v10 offset:12832
    v_mfma_f32_16x16x32_bf16 v[72:75], v[36:39], v[228:231], v[72:75]
    v_mfma_f32_16x16x32_bf16 v[76:79], v[36:39], v[244:247], v[76:79]
    s_waitcnt lgkmcnt(8)
    ds_read_b64_tr_b16 v[112:113], v10 offset:10304
    ds_read_b64_tr_b16 v[114:115], v10 offset:12864
    v_mfma_f32_16x16x32_bf16 v[80:83], v[40:43], v[228:231], v[80:83]
    v_mfma_f32_16x16x32_bf16 v[84:87], v[40:43], v[244:247], v[84:87]
    s_add_u32 m0, s72, 4096
    s_nop 0
    buffer_load_dwordx4 v8, s[12:15], s62 offen lds
    s_waitcnt lgkmcnt(8)
    ds_read_b64_tr_b16 v[116:117], v10 offset:10336
    ds_read_b64_tr_b16 v[118:119], v10 offset:12896
    v_mfma_f32_16x16x32_bf16 v[88:91], v[44:47], v[228:231], v[88:91]
    v_mfma_f32_16x16x32_bf16 v[92:95], v[44:47], v[244:247], v[92:95]
    s_waitcnt lgkmcnt(8)
    ds_read_b64_tr_b16 v[120:121], v10 offset:10368
    ds_read_b64_tr_b16 v[122:123], v10 offset:12928
    v_mfma_f32_16x16x32_bf16 v[96:99], v[48:51], v[228:231], v[96:99]
    v_mfma_f32_16x16x32_bf16 v[100:103], v[48:51], v[244:247], v[100:103]
    s_waitcnt lgkmcnt(8)
    ds_read_b64_tr_b16 v[32:33], v10 offset:15360
    ds_read_b64_tr_b16 v[34:35], v10 offset:17920
    v_mfma_f32_16x16x32_bf16 v[64:67], v[104:107], v[232:235], v[64:67]
    v_mfma_f32_16x16x32_bf16 v[68:71], v[104:107], v[248:251], v[68:71]
    s_waitcnt lgkmcnt(8)
    ds_read_b64_tr_b16 v[36:37], v10 offset:15392
    ds_read_b64_tr_b16 v[38:39], v10 offset:17952
    v_mfma_f32_16x16x32_bf16 v[72:75], v[108:111], v[232:235], v[72:75]
    v_mfma_f32_16x16x32_bf16 v[76:79], v[108:111], v[248:251], v[76:79]
    s_waitcnt lgkmcnt(8)
    ds_read_b64_tr_b16 v[40:41], v10 offset:15424
    ds_read_b64_tr_b16 v[42:43], v10 offset:17984
    v_mfma_f32_16x16x32_bf16 v[80:83], v[112:115], v[232:235], v[80:83]
    v_mfma_f32_16x16x32_bf16 v[84:87], v[112:115], v[248:251], v[84:87]
    s_waitcnt lgkmcnt(8)
    ds_read_b64_tr_b16 v[44:45], v10 offset:15456
    ds_read_b64_tr_b16 v[46:47], v10 offset:18016
    v_mfma_f32_16x16x32_bf16 v[88:91], v[116:119], v[232:235], v[88:91]
    v_mfma_f32_16x16x32_bf16 v[92:95], v[116:119], v[248:251], v[92:95]
    s_waitcnt lgkmcnt(8)
    ds_read_b64_tr_b16 v[48:49], v10 offset:15488
    ds_read_b64_tr_b16 v[50:51], v10 offset:18048
    v_mfma_f32_16x16x32_bf16 v[96:99], v[120:123], v[232:235], v[96:99]
    v_mfma_f32_16x16x32_bf16 v[100:103], v[120:123], v[248:251], v[100:103]
    s_waitcnt lgkmcnt(8)
    ds_read_b64_tr_b16 v[104:105], v11 offset:0
    ds_read_b64_tr_b16 v[106:107], v11 offset:2560
    v_mfma_f32_16x16x32_bf16 v[64:67], v[32:35], v[236:239], v[64:67]
    v_mfma_f32_16x16x32_bf16 v[68:71], v[32:35], v[252:255], v[68:71]
    s_waitcnt lgkmcnt(8)
    ds_read_b64_tr_b16 v[108:109], v11 offset:32
    ds_read_b64_tr_b16 v[110:111], v11 offset:2592
    v_mfma_f32_16x16x32_bf16 v[72:75], v[36:39], v[236:239], v[72:75]
    v_mfma_f32_16x16x32_bf16 v[76:79], v[36:39], v[252:255], v[76:79]
    s_waitcnt lgkmcnt(8)
    ds_read_b64_tr_b16 v[112:113], v11 offset:64
    ds_read_b64_tr_b16 v[114:115], v11 offset:2624
    v_mfma_f32_16x16x32_bf16 v[80:83], v[40:43], v[236:239], v[80:83]
    v_mfma_f32_16x16x32_bf16 v[84:87], v[40:43], v[252:255], v[84:87]
    s_waitcnt lgkmcnt(8)
    ds_read_b64_tr_b16 v[116:117], v11 offset:96
    ds_read_b64_tr_b16 v[118:119], v11 offset:2656
    v_mfma_f32_16x16x32_bf16 v[88:91], v[44:47], v[236:239], v[88:91]
    v_mfma_f32_16x16x32_bf16 v[92:95], v[44:47], v[252:255], v[92:95]
    s_waitcnt lgkmcnt(8)
    ds_read_b64_tr_b16 v[120:121], v11 offset:128
    ds_read_b64_tr_b16 v[122:123], v11 offset:2688
    v_mfma_f32_16x16x32_bf16 v[96:99], v[48:51], v[236:239], v[96:99]
    v_mfma_f32_16x16x32_bf16 v[100:103], v[48:51], v[252:255], v[100:103]
    s_waitcnt vmcnt(5)
    s_barrier
    s_waitcnt lgkmcnt(8)
    ds_read_b64_tr_b16 v[32:33], v11 offset:5120
    ds_read_b64_tr_b16 v[34:35], v11 offset:7680
    v_mfma_f32_16x16x32_bf16 v[64:67], v[104:107], v[192:195], v[64:67]
    v_mfma_f32_16x16x32_bf16 v[68:71], v[104:107], v[208:211], v[68:71]
    s_add_u32 s62, s75, 164160
    s_add_u32 m0, s73, 0
    s_nop 0
    buffer_load_dwordx4 v4, s[12:15], s62 offen lds
    s_waitcnt lgkmcnt(8)
    ds_read_b64_tr_b16 v[36:37], v11 offset:5152
    ds_read_b64_tr_b16 v[38:39], v11 offset:7712
    v_mfma_f32_16x16x32_bf16 v[72:75], v[108:111], v[192:195], v[72:75]
    v_mfma_f32_16x16x32_bf16 v[76:79], v[108:111], v[208:211], v[76:79]
    s_waitcnt lgkmcnt(8)
    ds_read_b64_tr_b16 v[40:41], v11 offset:5184
    ds_read_b64_tr_b16 v[42:43], v11 offset:7744
    v_mfma_f32_16x16x32_bf16 v[80:83], v[112:115], v[192:195], v[80:83]
    v_mfma_f32_16x16x32_bf16 v[84:87], v[112:115], v[208:211], v[84:87]
    s_add_u32 m0, s73, 1024
    s_nop 0
    buffer_load_dwordx4 v5, s[12:15], s62 offen lds
    s_waitcnt lgkmcnt(8)
    ds_read_b64_tr_b16 v[44:45], v11 offset:5216
    ds_read_b64_tr_b16 v[46:47], v11 offset:7776
    v_mfma_f32_16x16x32_bf16 v[88:91], v[116:119], v[192:195], v[88:91]
    v_mfma_f32_16x16x32_bf16 v[92:95], v[116:119], v[208:211], v[92:95]
    s_waitcnt lgkmcnt(8)
    ds_read_b64_tr_b16 v[48:49], v11 offset:5248
    ds_read_b64_tr_b16 v[50:51], v11 offset:7808
    v_mfma_f32_16x16x32_bf16 v[96:99], v[120:123], v[192:195], v[96:99]
    v_mfma_f32_16x16x32_bf16 v[100:103], v[120:123], v[208:211], v[100:103]
    s_add_u32 m0, s73, 2048
    s_nop 0
    buffer_load_dwordx4 v6, s[12:15], s62 offen lds
    s_waitcnt lgkmcnt(8)
    ds_read_b64_tr_b16 v[104:105], v11 offset:10240
    ds_read_b64_tr_b16 v[106:107], v11 offset:12800
    v_mfma_f32_16x16x32_bf16 v[64:67], v[32:35], v[196:199], v[64:67]
    v_mfma_f32_16x16x32_bf16 v[68:71], v[32:35], v[212:215], v[68:71]
    s_add_u32 m0, s73, 3072
    s_nop 0
    buffer_load_dwordx4 v7, s[12:15], s62 offen lds
    s_waitcnt lgkmcnt(8)
    ds_read_b64_tr_b16 v[108:109], v11 offset:10272
    ds_read_b64_tr_b16 v[110:111], v11 offset:12832
    v_mfma_f32_16x16x32_bf16 v[72:75], v[36:39], v[196:199], v[72:75]
    v_mfma_f32_16x16x32_bf16 v[76:79], v[36:39], v[212:215], v[76:79]
    s_waitcnt lgkmcnt(8)
    ds_read_b64_tr_b16 v[112:113], v11 offset:10304
    ds_read_b64_tr_b16 v[114:115], v11 offset:12864
    v_mfma_f32_16x16x32_bf16 v[80:83], v[40:43], v[196:199], v[80:83]
    v_mfma_f32_16x16x32_bf16 v[84:87], v[40:43], v[212:215], v[84:87]
    s_add_u32 m0, s73, 4096
    s_nop 0
    buffer_load_dwordx4 v8, s[12:15], s62 offen lds
    s_waitcnt lgkmcnt(8)
    ds_read_b64_tr_b16 v[116:117], v11 offset:10336
    ds_read_b64_tr_b16 v[118:119], v11 offset:12896
    v_mfma_f32_16x16x32_bf16 v[88:91], v[44:47], v[196:199], v[88:91]
    v_mfma_f32_16x16x32_bf16 v[92:95], v[44:47], v[212:215], v[92:95]
    s_waitcnt lgkmcnt(8)
    ds_read_b64_tr_b16 v[120:121], v11 offset:10368
    ds_read_b64_tr_b16 v[122:123], v11 offset:12928
    v_mfma_f32_16x16x32_bf16 v[96:99], v[48:51], v[196:199], v[96:99]
    v_mfma_f32_16x16x32_bf16 v[100:103], v[48:51], v[212:215], v[100:103]
    s_waitcnt lgkmcnt(8)
    ds_read_b64_tr_b16 v[32:33], v11 offset:15360
    ds_read_b64_tr_b16 v[34:35], v11 offset:17920
    v_mfma_f32_16x16x32_bf16 v[64:67], v[104:107], v[200:203], v[64:67]
    v_mfma_f32_16x16x32_bf16 v[68:71], v[104:107], v[216:219], v[68:71]
    s_waitcnt lgkmcnt(8)
    ds_read_b64_tr_b16 v[36:37], v11 offset:15392
    ds_read_b64_tr_b16 v[38:39], v11 offset:17952
    v_mfma_f32_16x16x32_bf16 v[72:75], v[108:111], v[200:203], v[72:75]
    v_mfma_f32_16x16x32_bf16 v[76:79], v[108:111], v[216:219], v[76:79]
    s_waitcnt lgkmcnt(8)
    ds_read_b64_tr_b16 v[40:41], v11 offset:15424
    ds_read_b64_tr_b16 v[42:43], v11 offset:17984
    v_mfma_f32_16x16x32_bf16 v[80:83], v[112:115], v[200:203], v[80:83]
    v_mfma_f32_16x16x32_bf16 v[84:87], v[112:115], v[216:219], v[84:87]
    s_waitcnt lgkmcnt(8)
    ds_read_b64_tr_b16 v[44:45], v11 offset:15456
    ds_read_b64_tr_b16 v[46:47], v11 offset:18016
    v_mfma_f32_16x16x32_bf16 v[88:91], v[116:119], v[200:203], v[88:91]
    v_mfma_f32_16x16x32_bf16 v[92:95], v[116:119], v[216:219], v[92:95]
    s_waitcnt lgkmcnt(8)
    ds_read_b64_tr_b16 v[48:49], v11 offset:15488
    ds_read_b64_tr_b16 v[50:51], v11 offset:18048
    v_mfma_f32_16x16x32_bf16 v[96:99], v[120:123], v[200:203], v[96:99]
    v_mfma_f32_16x16x32_bf16 v[100:103], v[120:123], v[216:219], v[100:103]
    s_waitcnt lgkmcnt(8)
    ds_read_b64_tr_b16 v[104:105], v63 offset:0
    ds_read_b64_tr_b16 v[106:107], v63 offset:2560
    v_mfma_f32_16x16x32_bf16 v[64:67], v[32:35], v[204:207], v[64:67]
    v_mfma_f32_16x16x32_bf16 v[68:71], v[32:35], v[220:223], v[68:71]
    s_waitcnt lgkmcnt(8)
    ds_read_b64_tr_b16 v[108:109], v63 offset:32
    ds_read_b64_tr_b16 v[110:111], v63 offset:2592
    v_mfma_f32_16x16x32_bf16 v[72:75], v[36:39], v[204:207], v[72:75]
    v_mfma_f32_16x16x32_bf16 v[76:79], v[36:39], v[220:223], v[76:79]
    s_waitcnt lgkmcnt(8)
    ds_read_b64_tr_b16 v[112:113], v63 offset:64
    ds_read_b64_tr_b16 v[114:115], v63 offset:2624
    v_mfma_f32_16x16x32_bf16 v[80:83], v[40:43], v[204:207], v[80:83]
    v_mfma_f32_16x16x32_bf16 v[84:87], v[40:43], v[220:223], v[84:87]
    s_waitcnt lgkmcnt(8)
    ds_read_b64_tr_b16 v[116:117], v63 offset:96
    ds_read_b64_tr_b16 v[118:119], v63 offset:2656
    v_mfma_f32_16x16x32_bf16 v[88:91], v[44:47], v[204:207], v[88:91]
    v_mfma_f32_16x16x32_bf16 v[92:95], v[44:47], v[220:223], v[92:95]
    s_waitcnt lgkmcnt(8)
    ds_read_b64_tr_b16 v[120:121], v63 offset:128
    ds_read_b64_tr_b16 v[122:123], v63 offset:2688
    v_mfma_f32_16x16x32_bf16 v[96:99], v[48:51], v[204:207], v[96:99]
    v_mfma_f32_16x16x32_bf16 v[100:103], v[48:51], v[220:223], v[100:103]
    s_waitcnt vmcnt(5)
    s_barrier
    s_waitcnt lgkmcnt(8)
    ds_read_b64_tr_b16 v[32:33], v63 offset:5120
    ds_read_b64_tr_b16 v[34:35], v63 offset:7680
    v_mfma_f32_16x16x32_bf16 v[64:67], v[104:107], v[128:131], v[64:67]
    v_mfma_f32_16x16x32_bf16 v[68:71], v[104:107], v[144:147], v[68:71]
    s_add_u32 s62, s75, 328000
    s_add_u32 m0, s74, 0
    s_nop 0
    buffer_load_dwordx4 v4, s[12:15], s62 offen lds
    s_waitcnt lgkmcnt(8)
    ds_read_b64_tr_b16 v[36:37], v63 offset:5152
    ds_read_b64_tr_b16 v[38:39], v63 offset:7712
    v_mfma_f32_16x16x32_bf16 v[72:75], v[108:111], v[128:131], v[72:75]
    v_mfma_f32_16x16x32_bf16 v[76:79], v[108:111], v[144:147], v[76:79]
    s_waitcnt lgkmcnt(8)
    ds_read_b64_tr_b16 v[40:41], v63 offset:5184
    ds_read_b64_tr_b16 v[42:43], v63 offset:7744
    v_mfma_f32_16x16x32_bf16 v[80:83], v[112:115], v[128:131], v[80:83]
    v_mfma_f32_16x16x32_bf16 v[84:87], v[112:115], v[144:147], v[84:87]
    s_add_u32 m0, s74, 1024
    s_nop 0
    buffer_load_dwordx4 v5, s[12:15], s62 offen lds
    s_waitcnt lgkmcnt(8)
    ds_read_b64_tr_b16 v[44:45], v63 offset:5216
    ds_read_b64_tr_b16 v[46:47], v63 offset:7776
    v_mfma_f32_16x16x32_bf16 v[88:91], v[116:119], v[128:131], v[88:91]
    v_mfma_f32_16x16x32_bf16 v[92:95], v[116:119], v[144:147], v[92:95]
    s_waitcnt lgkmcnt(8)
    ds_read_b64_tr_b16 v[48:49], v63 offset:5248
    ds_read_b64_tr_b16 v[50:51], v63 offset:7808
    v_mfma_f32_16x16x32_bf16 v[96:99], v[120:123], v[128:131], v[96:99]
    v_mfma_f32_16x16x32_bf16 v[100:103], v[120:123], v[144:147], v[100:103]
    s_add_u32 m0, s74, 2048
    s_nop 0
    buffer_load_dwordx4 v6, s[12:15], s62 offen lds
    s_waitcnt lgkmcnt(8)
    ds_read_b64_tr_b16 v[104:105], v63 offset:10240
    ds_read_b64_tr_b16 v[106:107], v63 offset:12800
    v_mfma_f32_16x16x32_bf16 v[64:67], v[32:35], v[132:135], v[64:67]
    v_mfma_f32_16x16x32_bf16 v[68:71], v[32:35], v[148:151], v[68:71]
    s_add_u32 m0, s74, 3072
    s_nop 0
    buffer_load_dwordx4 v7, s[12:15], s62 offen lds
    s_waitcnt lgkmcnt(8)
    ds_read_b64_tr_b16 v[108:109], v63 offset:10272
    ds_read_b64_tr_b16 v[110:111], v63 offset:12832
    v_mfma_f32_16x16x32_bf16 v[72:75], v[36:39], v[132:135], v[72:75]
    v_mfma_f32_16x16x32_bf16 v[76:79], v[36:39], v[148:151], v[76:79]
    s_waitcnt lgkmcnt(8)
    ds_read_b64_tr_b16 v[112:113], v63 offset:10304
    ds_read_b64_tr_b16 v[114:115], v63 offset:12864
    v_mfma_f32_16x16x32_bf16 v[80:83], v[40:43], v[132:135], v[80:83]
    v_mfma_f32_16x16x32_bf16 v[84:87], v[40:43], v[148:151], v[84:87]
    s_add_u32 m0, s74, 4096
    s_nop 0
    buffer_load_dwordx4 v8, s[12:15], s62 offen lds
    s_waitcnt lgkmcnt(8)
    ds_read_b64_tr_b16 v[116:117], v63 offset:10336
    ds_read_b64_tr_b16 v[118:119], v63 offset:12896
    v_mfma_f32_16x16x32_bf16 v[88:91], v[44:47], v[132:135], v[88:91]
    v_mfma_f32_16x16x32_bf16 v[92:95], v[44:47], v[148:151], v[92:95]
    s_waitcnt lgkmcnt(8)
    ds_read_b64_tr_b16 v[120:121], v63 offset:10368
    ds_read_b64_tr_b16 v[122:123], v63 offset:12928
    v_mfma_f32_16x16x32_bf16 v[96:99], v[48:51], v[132:135], v[96:99]
    v_mfma_f32_16x16x32_bf16 v[100:103], v[48:51], v[148:151], v[100:103]
    s_waitcnt lgkmcnt(8)
    ds_read_b64_tr_b16 v[32:33], v63 offset:15360
    ds_read_b64_tr_b16 v[34:35], v63 offset:17920
    v_mfma_f32_16x16x32_bf16 v[64:67], v[104:107], v[136:139], v[64:67]
    v_mfma_f32_16x16x32_bf16 v[68:71], v[104:107], v[152:155], v[68:71]
    s_waitcnt lgkmcnt(8)
    ds_read_b64_tr_b16 v[36:37], v63 offset:15392
    ds_read_b64_tr_b16 v[38:39], v63 offset:17952
    v_mfma_f32_16x16x32_bf16 v[72:75], v[108:111], v[136:139], v[72:75]
    v_mfma_f32_16x16x32_bf16 v[76:79], v[108:111], v[152:155], v[76:79]
    s_waitcnt lgkmcnt(8)
    ds_read_b64_tr_b16 v[40:41], v63 offset:15424
    ds_read_b64_tr_b16 v[42:43], v63 offset:17984
    v_mfma_f32_16x16x32_bf16 v[80:83], v[112:115], v[136:139], v[80:83]
    v_mfma_f32_16x16x32_bf16 v[84:87], v[112:115], v[152:155], v[84:87]
    s_waitcnt lgkmcnt(8)
    ds_read_b64_tr_b16 v[44:45], v63 offset:15456
    ds_read_b64_tr_b16 v[46:47], v63 offset:18016
    v_mfma_f32_16x16x32_bf16 v[88:91], v[116:119], v[136:139], v[88:91]
    v_mfma_f32_16x16x32_bf16 v[92:95], v[116:119], v[152:155], v[92:95]
    s_waitcnt lgkmcnt(8)
    ds_read_b64_tr_b16 v[48:49], v63 offset:15488
    ds_read_b64_tr_b16 v[50:51], v63 offset:18048
    v_mfma_f32_16x16x32_bf16 v[96:99], v[120:123], v[136:139], v[96:99]
    v_mfma_f32_16x16x32_bf16 v[100:103], v[120:123], v[152:155], v[100:103]
    s_waitcnt lgkmcnt(8)
    ds_read_b64_tr_b16 v[104:105], v9 offset:0
    ds_read_b64_tr_b16 v[106:107], v9 offset:2560
    v_mfma_f32_16x16x32_bf16 v[64:67], v[32:35], v[140:143], v[64:67]
    v_mfma_f32_16x16x32_bf16 v[68:71], v[32:35], v[156:159], v[68:71]
    s_waitcnt lgkmcnt(8)
    ds_read_b64_tr_b16 v[108:109], v9 offset:32
    ds_read_b64_tr_b16 v[110:111], v9 offset:2592
    v_mfma_f32_16x16x32_bf16 v[72:75], v[36:39], v[140:143], v[72:75]
    v_mfma_f32_16x16x32_bf16 v[76:79], v[36:39], v[156:159], v[76:79]
    s_waitcnt lgkmcnt(8)
    ds_read_b64_tr_b16 v[112:113], v9 offset:64
    ds_read_b64_tr_b16 v[114:115], v9 offset:2624
    v_mfma_f32_16x16x32_bf16 v[80:83], v[40:43], v[140:143], v[80:83]
    v_mfma_f32_16x16x32_bf16 v[84:87], v[40:43], v[156:159], v[84:87]
    s_waitcnt lgkmcnt(8)
    ds_read_b64_tr_b16 v[116:117], v9 offset:96
    ds_read_b64_tr_b16 v[118:119], v9 offset:2656
    v_mfma_f32_16x16x32_bf16 v[88:91], v[44:47], v[140:143], v[88:91]
    v_mfma_f32_16x16x32_bf16 v[92:95], v[44:47], v[156:159], v[92:95]
    s_waitcnt lgkmcnt(8)
    ds_read_b64_tr_b16 v[120:121], v9 offset:128
    ds_read_b64_tr_b16 v[122:123], v9 offset:2688
    v_mfma_f32_16x16x32_bf16 v[96:99], v[48:51], v[140:143], v[96:99]
    v_mfma_f32_16x16x32_bf16 v[100:103], v[48:51], v[156:159], v[100:103]
    v_cvt_pk_bf16_f32 v16, v64, v65
    v_cvt_pk_bf16_f32 v17, v66, v67
    v_cvt_pk_bf16_f32 v18, v68, v69
    v_cvt_pk_bf16_f32 v19, v70, v71
    v_cvt_pk_bf16_f32 v20, v72, v73
    v_cvt_pk_bf16_f32 v21, v74, v75
    v_cvt_pk_bf16_f32 v22, v76, v77
    v_cvt_pk_bf16_f32 v23, v78, v79
    v_cvt_pk_bf16_f32 v24, v80, v81
    v_cvt_pk_bf16_f32 v25, v82, v83
    v_cvt_pk_bf16_f32 v26, v84, v85
    v_cvt_pk_bf16_f32 v27, v86, v87
    v_cvt_pk_bf16_f32 v28, v88, v89
    v_cvt_pk_bf16_f32 v29, v90, v91
    v_cvt_pk_bf16_f32 v30, v92, v93
    v_cvt_pk_bf16_f32 v31, v94, v95
    v_cvt_pk_bf16_f32 v52, v96, v97
    v_cvt_pk_bf16_f32 v53, v98, v99
    v_cvt_pk_bf16_f32 v54, v100, v101
    v_cvt_pk_bf16_f32 v55, v102, v103
    s_add_u32 s69, s76, 20480
    buffer_store_dwordx4 v[16:19], v59, s[4:7], s69 offen offset:0 sc1
    s_add_u32 s69, s76, 20480
    buffer_store_dwordx4 v[20:23], v59, s[4:7], s69 offen offset:1024 sc1
    s_add_u32 s69, s76, 20480
    buffer_store_dwordx4 v[24:27], v59, s[4:7], s69 offen offset:2048 sc1
    s_add_u32 s69, s76, 20480
    buffer_store_dwordx4 v[28:31], v59, s[4:7], s69 offen offset:3072 sc1
    s_add_u32 s69, s76, 24576
    buffer_store_dwordx4 v[52:55], v59, s[4:7], s69 offen offset:0 sc1
    s_waitcnt vmcnt(10)
    s_barrier
    s_waitcnt lgkmcnt(8)
    ds_read_b64_tr_b16 v[32:33], v9 offset:5120
    ds_read_b64_tr_b16 v[34:35], v9 offset:7680
    v_mfma_f32_16x16x32_bf16 v[64:67], v[104:107], v[160:163], 0
    v_mfma_f32_16x16x32_bf16 v[68:71], v[104:107], v[176:179], 0
    s_add_u32 s62, s75, 491840
    s_add_u32 m0, s97, 0
    s_nop 0
    buffer_load_dwordx4 v4, s[12:15], s62 offen lds
    s_waitcnt lgkmcnt(8)
    ds_read_b64_tr_b16 v[36:37], v9 offset:5152
    ds_read_b64_tr_b16 v[38:39], v9 offset:7712
    v_mfma_f32_16x16x32_bf16 v[72:75], v[108:111], v[160:163], 0
    v_mfma_f32_16x16x32_bf16 v[76:79], v[108:111], v[176:179], 0
    s_waitcnt lgkmcnt(8)
    ds_read_b64_tr_b16 v[40:41], v9 offset:5184
    ds_read_b64_tr_b16 v[42:43], v9 offset:7744
    v_mfma_f32_16x16x32_bf16 v[80:83], v[112:115], v[160:163], 0
    v_mfma_f32_16x16x32_bf16 v[84:87], v[112:115], v[176:179], 0
    s_add_u32 m0, s97, 1024
    s_nop 0
    buffer_load_dwordx4 v5, s[12:15], s62 offen lds
    s_waitcnt lgkmcnt(8)
    ds_read_b64_tr_b16 v[44:45], v9 offset:5216
    ds_read_b64_tr_b16 v[46:47], v9 offset:7776
    v_mfma_f32_16x16x32_bf16 v[88:91], v[116:119], v[160:163], 0
    v_mfma_f32_16x16x32_bf16 v[92:95], v[116:119], v[176:179], 0
    s_waitcnt lgkmcnt(8)
    ds_read_b64_tr_b16 v[48:49], v9 offset:5248
    ds_read_b64_tr_b16 v[50:51], v9 offset:7808
    v_mfma_f32_16x16x32_bf16 v[96:99], v[120:123], v[160:163], 0
    v_mfma_f32_16x16x32_bf16 v[100:103], v[120:123], v[176:179], 0
    s_add_u32 m0, s97, 2048
    s_nop 0
    buffer_load_dwordx4 v6, s[12:15], s62 offen lds
    s_waitcnt lgkmcnt(8)
    ds_read_b64_tr_b16 v[104:105], v9 offset:10240
    ds_read_b64_tr_b16 v[106:107], v9 offset:12800
    v_mfma_f32_16x16x32_bf16 v[64:67], v[32:35], v[164:167], v[64:67]
    v_mfma_f32_16x16x32_bf16 v[68:71], v[32:35], v[180:183], v[68:71]
    s_add_u32 m0, s97, 3072
    s_nop 0
    buffer_load_dwordx4 v7, s[12:15], s62 offen lds
    s_waitcnt lgkmcnt(8)
    ds_read_b64_tr_b16 v[108:109], v9 offset:10272
    ds_read_b64_tr_b16 v[110:111], v9 offset:12832
    v_mfma_f32_16x16x32_bf16 v[72:75], v[36:39], v[164:167], v[72:75]
    v_mfma_f32_16x16x32_bf16 v[76:79], v[36:39], v[180:183], v[76:79]
    s_waitcnt lgkmcnt(8)
    ds_read_b64_tr_b16 v[112:113], v9 offset:10304
    ds_read_b64_tr_b16 v[114:115], v9 offset:12864
    v_mfma_f32_16x16x32_bf16 v[80:83], v[40:43], v[164:167], v[80:83]
    v_mfma_f32_16x16x32_bf16 v[84:87], v[40:43], v[180:183], v[84:87]
    s_add_u32 m0, s97, 4096
    s_nop 0
    buffer_load_dwordx4 v8, s[12:15], s62 offen lds
    s_waitcnt lgkmcnt(8)
    ds_read_b64_tr_b16 v[116:117], v9 offset:10336
    ds_read_b64_tr_b16 v[118:119], v9 offset:12896
    v_mfma_f32_16x16x32_bf16 v[88:91], v[44:47], v[164:167], v[88:91]
    v_mfma_f32_16x16x32_bf16 v[92:95], v[44:47], v[180:183], v[92:95]
    s_waitcnt lgkmcnt(8)
    ds_read_b64_tr_b16 v[120:121], v9 offset:10368
    ds_read_b64_tr_b16 v[122:123], v9 offset:12928
    v_mfma_f32_16x16x32_bf16 v[96:99], v[48:51], v[164:167], v[96:99]
    v_mfma_f32_16x16x32_bf16 v[100:103], v[48:51], v[180:183], v[100:103]
    s_waitcnt lgkmcnt(8)
    ds_read_b64_tr_b16 v[32:33], v9 offset:15360
    ds_read_b64_tr_b16 v[34:35], v9 offset:17920
    v_mfma_f32_16x16x32_bf16 v[64:67], v[104:107], v[168:171], v[64:67]
    v_mfma_f32_16x16x32_bf16 v[68:71], v[104:107], v[184:187], v[68:71]
    s_waitcnt lgkmcnt(8)
    ds_read_b64_tr_b16 v[36:37], v9 offset:15392
    ds_read_b64_tr_b16 v[38:39], v9 offset:17952
    v_mfma_f32_16x16x32_bf16 v[72:75], v[108:111], v[168:171], v[72:75]
    v_mfma_f32_16x16x32_bf16 v[76:79], v[108:111], v[184:187], v[76:79]
    s_waitcnt lgkmcnt(8)
    ds_read_b64_tr_b16 v[40:41], v9 offset:15424
    ds_read_b64_tr_b16 v[42:43], v9 offset:17984
    v_mfma_f32_16x16x32_bf16 v[80:83], v[112:115], v[168:171], v[80:83]
    v_mfma_f32_16x16x32_bf16 v[84:87], v[112:115], v[184:187], v[84:87]
    s_waitcnt lgkmcnt(8)
    ds_read_b64_tr_b16 v[44:45], v9 offset:15456
    ds_read_b64_tr_b16 v[46:47], v9 offset:18016
    v_mfma_f32_16x16x32_bf16 v[88:91], v[116:119], v[168:171], v[88:91]
    v_mfma_f32_16x16x32_bf16 v[92:95], v[116:119], v[184:187], v[92:95]
    s_waitcnt lgkmcnt(8)
    ds_read_b64_tr_b16 v[48:49], v9 offset:15488
    ds_read_b64_tr_b16 v[50:51], v9 offset:18048
    v_mfma_f32_16x16x32_bf16 v[96:99], v[120:123], v[168:171], v[96:99]
    v_mfma_f32_16x16x32_bf16 v[100:103], v[120:123], v[184:187], v[100:103]
    s_waitcnt lgkmcnt(8)
    ds_read_b64_tr_b16 v[104:105], v10 offset:0
    ds_read_b64_tr_b16 v[106:107], v10 offset:2560
    v_mfma_f32_16x16x32_bf16 v[64:67], v[32:35], v[172:175], v[64:67]
    v_mfma_f32_16x16x32_bf16 v[68:71], v[32:35], v[188:191], v[68:71]
    s_waitcnt lgkmcnt(8)
    ds_read_b64_tr_b16 v[108:109], v10 offset:32
    ds_read_b64_tr_b16 v[110:111], v10 offset:2592
    v_mfma_f32_16x16x32_bf16 v[72:75], v[36:39], v[172:175], v[72:75]
    v_mfma_f32_16x16x32_bf16 v[76:79], v[36:39], v[188:191], v[76:79]
    s_waitcnt lgkmcnt(8)
    ds_read_b64_tr_b16 v[112:113], v10 offset:64
    ds_read_b64_tr_b16 v[114:115], v10 offset:2624
    v_mfma_f32_16x16x32_bf16 v[80:83], v[40:43], v[172:175], v[80:83]
    v_mfma_f32_16x16x32_bf16 v[84:87], v[40:43], v[188:191], v[84:87]
    s_waitcnt lgkmcnt(8)
    ds_read_b64_tr_b16 v[116:117], v10 offset:96
    ds_read_b64_tr_b16 v[118:119], v10 offset:2656
    v_mfma_f32_16x16x32_bf16 v[88:91], v[44:47], v[172:175], v[88:91]
    v_mfma_f32_16x16x32_bf16 v[92:95], v[44:47], v[188:191], v[92:95]
    s_waitcnt lgkmcnt(8)
    ds_read_b64_tr_b16 v[120:121], v10 offset:128
    ds_read_b64_tr_b16 v[122:123], v10 offset:2688
    v_mfma_f32_16x16x32_bf16 v[96:99], v[48:51], v[172:175], v[96:99]
    v_mfma_f32_16x16x32_bf16 v[100:103], v[48:51], v[188:191], v[100:103]
    s_waitcnt vmcnt(10)
    s_barrier
    s_waitcnt lgkmcnt(8)
    ds_read_b64_tr_b16 v[32:33], v10 offset:5120
    ds_read_b64_tr_b16 v[34:35], v10 offset:7680
    v_mfma_f32_16x16x32_bf16 v[64:67], v[104:107], v[224:227], v[64:67]
    v_mfma_f32_16x16x32_bf16 v[68:71], v[104:107], v[240:243], v[68:71]
    s_add_u32 s62, s75, 480
    s_add_u32 m0, s72, 0
    s_nop 0
    buffer_load_dwordx4 v4, s[12:15], s62 offen lds
    s_waitcnt lgkmcnt(8)
    ds_read_b64_tr_b16 v[36:37], v10 offset:5152
    ds_read_b64_tr_b16 v[38:39], v10 offset:7712
    v_mfma_f32_16x16x32_bf16 v[72:75], v[108:111], v[224:227], v[72:75]
    v_mfma_f32_16x16x32_bf16 v[76:79], v[108:111], v[240:243], v[76:79]
    s_waitcnt lgkmcnt(8)
    ds_read_b64_tr_b16 v[40:41], v10 offset:5184
    ds_read_b64_tr_b16 v[42:43], v10 offset:7744
    v_mfma_f32_16x16x32_bf16 v[80:83], v[112:115], v[224:227], v[80:83]
    v_mfma_f32_16x16x32_bf16 v[84:87], v[112:115], v[240:243], v[84:87]
    s_add_u32 m0, s72, 1024
    s_nop 0
    buffer_load_dwordx4 v5, s[12:15], s62 offen lds
    s_waitcnt lgkmcnt(8)
    ds_read_b64_tr_b16 v[44:45], v10 offset:5216
    ds_read_b64_tr_b16 v[46:47], v10 offset:7776
    v_mfma_f32_16x16x32_bf16 v[88:91], v[116:119], v[224:227], v[88:91]
    v_mfma_f32_16x16x32_bf16 v[92:95], v[116:119], v[240:243], v[92:95]
    s_waitcnt lgkmcnt(8)
    ds_read_b64_tr_b16 v[48:49], v10 offset:5248
    ds_read_b64_tr_b16 v[50:51], v10 offset:7808
    v_mfma_f32_16x16x32_bf16 v[96:99], v[120:123], v[224:227], v[96:99]
    v_mfma_f32_16x16x32_bf16 v[100:103], v[120:123], v[240:243], v[100:103]
    s_add_u32 m0, s72, 2048
    s_nop 0
    buffer_load_dwordx4 v6, s[12:15], s62 offen lds
    s_waitcnt lgkmcnt(8)
    ds_read_b64_tr_b16 v[104:105], v10 offset:10240
    ds_read_b64_tr_b16 v[106:107], v10 offset:12800
    v_mfma_f32_16x16x32_bf16 v[64:67], v[32:35], v[228:231], v[64:67]
    v_mfma_f32_16x16x32_bf16 v[68:71], v[32:35], v[244:247], v[68:71]
    s_add_u32 m0, s72, 3072
    s_nop 0
    buffer_load_dwordx4 v7, s[12:15], s62 offen lds
    s_waitcnt lgkmcnt(8)
    ds_read_b64_tr_b16 v[108:109], v10 offset:10272
    ds_read_b64_tr_b16 v[110:111], v10 offset:12832
    v_mfma_f32_16x16x32_bf16 v[72:75], v[36:39], v[228:231], v[72:75]
    v_mfma_f32_16x16x32_bf16 v[76:79], v[36:39], v[244:247], v[76:79]
    s_waitcnt lgkmcnt(8)
    ds_read_b64_tr_b16 v[112:113], v10 offset:10304
    ds_read_b64_tr_b16 v[114:115], v10 offset:12864
    v_mfma_f32_16x16x32_bf16 v[80:83], v[40:43], v[228:231], v[80:83]
    v_mfma_f32_16x16x32_bf16 v[84:87], v[40:43], v[244:247], v[84:87]
    s_add_u32 m0, s72, 4096
    s_nop 0
    buffer_load_dwordx4 v8, s[12:15], s62 offen lds
    s_waitcnt lgkmcnt(8)
    ds_read_b64_tr_b16 v[116:117], v10 offset:10336
    ds_read_b64_tr_b16 v[118:119], v10 offset:12896
    v_mfma_f32_16x16x32_bf16 v[88:91], v[44:47], v[228:231], v[88:91]
    v_mfma_f32_16x16x32_bf16 v[92:95], v[44:47], v[244:247], v[92:95]
    s_waitcnt lgkmcnt(8)
    ds_read_b64_tr_b16 v[120:121], v10 offset:10368
    ds_read_b64_tr_b16 v[122:123], v10 offset:12928
    v_mfma_f32_16x16x32_bf16 v[96:99], v[48:51], v[228:231], v[96:99]
    v_mfma_f32_16x16x32_bf16 v[100:103], v[48:51], v[244:247], v[100:103]
    s_waitcnt lgkmcnt(8)
    ds_read_b64_tr_b16 v[32:33], v10 offset:15360
    ds_read_b64_tr_b16 v[34:35], v10 offset:17920
    v_mfma_f32_16x16x32_bf16 v[64:67], v[104:107], v[232:235], v[64:67]
    v_mfma_f32_16x16x32_bf16 v[68:71], v[104:107], v[248:251], v[68:71]
    s_waitcnt lgkmcnt(8)
    ds_read_b64_tr_b16 v[36:37], v10 offset:15392
    ds_read_b64_tr_b16 v[38:39], v10 offset:17952
    v_mfma_f32_16x16x32_bf16 v[72:75], v[108:111], v[232:235], v[72:75]
    v_mfma_f32_16x16x32_bf16 v[76:79], v[108:111], v[248:251], v[76:79]
    s_waitcnt lgkmcnt(8)
    ds_read_b64_tr_b16 v[40:41], v10 offset:15424
    ds_read_b64_tr_b16 v[42:43], v10 offset:17984
    v_mfma_f32_16x16x32_bf16 v[80:83], v[112:115], v[232:235], v[80:83]
    v_mfma_f32_16x16x32_bf16 v[84:87], v[112:115], v[248:251], v[84:87]
    s_waitcnt lgkmcnt(8)
    ds_read_b64_tr_b16 v[44:45], v10 offset:15456
    ds_read_b64_tr_b16 v[46:47], v10 offset:18016
    v_mfma_f32_16x16x32_bf16 v[88:91], v[116:119], v[232:235], v[88:91]
    v_mfma_f32_16x16x32_bf16 v[92:95], v[116:119], v[248:251], v[92:95]
    s_waitcnt lgkmcnt(8)
    ds_read_b64_tr_b16 v[48:49], v10 offset:15488
    ds_read_b64_tr_b16 v[50:51], v10 offset:18048
    v_mfma_f32_16x16x32_bf16 v[96:99], v[120:123], v[232:235], v[96:99]
    v_mfma_f32_16x16x32_bf16 v[100:103], v[120:123], v[248:251], v[100:103]
    s_waitcnt lgkmcnt(8)
    ds_read_b64_tr_b16 v[104:105], v11 offset:0
    ds_read_b64_tr_b16 v[106:107], v11 offset:2560
    v_mfma_f32_16x16x32_bf16 v[64:67], v[32:35], v[236:239], v[64:67]
    v_mfma_f32_16x16x32_bf16 v[68:71], v[32:35], v[252:255], v[68:71]
    s_waitcnt lgkmcnt(8)
    ds_read_b64_tr_b16 v[108:109], v11 offset:32
    ds_read_b64_tr_b16 v[110:111], v11 offset:2592
    v_mfma_f32_16x16x32_bf16 v[72:75], v[36:39], v[236:239], v[72:75]
    v_mfma_f32_16x16x32_bf16 v[76:79], v[36:39], v[252:255], v[76:79]
    s_waitcnt lgkmcnt(8)
    ds_read_b64_tr_b16 v[112:113], v11 offset:64
    ds_read_b64_tr_b16 v[114:115], v11 offset:2624
    v_mfma_f32_16x16x32_bf16 v[80:83], v[40:43], v[236:239], v[80:83]
    v_mfma_f32_16x16x32_bf16 v[84:87], v[40:43], v[252:255], v[84:87]
    s_waitcnt lgkmcnt(8)
    ds_read_b64_tr_b16 v[116:117], v11 offset:96
    ds_read_b64_tr_b16 v[118:119], v11 offset:2656
    v_mfma_f32_16x16x32_bf16 v[88:91], v[44:47], v[236:239], v[88:91]
    v_mfma_f32_16x16x32_bf16 v[92:95], v[44:47], v[252:255], v[92:95]
    s_waitcnt lgkmcnt(8)
    ds_read_b64_tr_b16 v[120:121], v11 offset:128
    ds_read_b64_tr_b16 v[122:123], v11 offset:2688
    v_mfma_f32_16x16x32_bf16 v[96:99], v[48:51], v[236:239], v[96:99]
    v_mfma_f32_16x16x32_bf16 v[100:103], v[48:51], v[252:255], v[100:103]
    s_waitcnt vmcnt(5)
    s_barrier
    s_waitcnt lgkmcnt(8)
    ds_read_b64_tr_b16 v[32:33], v11 offset:5120
    ds_read_b64_tr_b16 v[34:35], v11 offset:7680
    v_mfma_f32_16x16x32_bf16 v[64:67], v[104:107], v[192:195], v[64:67]
    v_mfma_f32_16x16x32_bf16 v[68:71], v[104:107], v[208:211], v[68:71]
    s_add_u32 s62, s75, 164320
    s_add_u32 m0, s73, 0
    s_nop 0
    buffer_load_dwordx4 v4, s[12:15], s62 offen lds
    s_waitcnt lgkmcnt(8)
    ds_read_b64_tr_b16 v[36:37], v11 offset:5152
    ds_read_b64_tr_b16 v[38:39], v11 offset:7712
    v_mfma_f32_16x16x32_bf16 v[72:75], v[108:111], v[192:195], v[72:75]
    v_mfma_f32_16x16x32_bf16 v[76:79], v[108:111], v[208:211], v[76:79]
    s_waitcnt lgkmcnt(8)
    ds_read_b64_tr_b16 v[40:41], v11 offset:5184
    ds_read_b64_tr_b16 v[42:43], v11 offset:7744
    v_mfma_f32_16x16x32_bf16 v[80:83], v[112:115], v[192:195], v[80:83]
    v_mfma_f32_16x16x32_bf16 v[84:87], v[112:115], v[208:211], v[84:87]
    s_add_u32 m0, s73, 1024
    s_nop 0
    buffer_load_dwordx4 v5, s[12:15], s62 offen lds
    s_waitcnt lgkmcnt(8)
    ds_read_b64_tr_b16 v[44:45], v11 offset:5216
    ds_read_b64_tr_b16 v[46:47], v11 offset:7776
    v_mfma_f32_16x16x32_bf16 v[88:91], v[116:119], v[192:195], v[88:91]
    v_mfma_f32_16x16x32_bf16 v[92:95], v[116:119], v[208:211], v[92:95]
    s_waitcnt lgkmcnt(8)
    ds_read_b64_tr_b16 v[48:49], v11 offset:5248
    ds_read_b64_tr_b16 v[50:51], v11 offset:7808
    v_mfma_f32_16x16x32_bf16 v[96:99], v[120:123], v[192:195], v[96:99]
    v_mfma_f32_16x16x32_bf16 v[100:103], v[120:123], v[208:211], v[100:103]
    s_add_u32 m0, s73, 2048
    s_nop 0
    buffer_load_dwordx4 v6, s[12:15], s62 offen lds
    s_waitcnt lgkmcnt(8)
    ds_read_b64_tr_b16 v[104:105], v11 offset:10240
    ds_read_b64_tr_b16 v[106:107], v11 offset:12800
    v_mfma_f32_16x16x32_bf16 v[64:67], v[32:35], v[196:199], v[64:67]
    v_mfma_f32_16x16x32_bf16 v[68:71], v[32:35], v[212:215], v[68:71]
    s_add_u32 m0, s73, 3072
    s_nop 0
    buffer_load_dwordx4 v7, s[12:15], s62 offen lds
    s_waitcnt lgkmcnt(8)
    ds_read_b64_tr_b16 v[108:109], v11 offset:10272
    ds_read_b64_tr_b16 v[110:111], v11 offset:12832
    v_mfma_f32_16x16x32_bf16 v[72:75], v[36:39], v[196:199], v[72:75]
    v_mfma_f32_16x16x32_bf16 v[76:79], v[36:39], v[212:215], v[76:79]
    s_waitcnt lgkmcnt(8)
    ds_read_b64_tr_b16 v[112:113], v11 offset:10304
    ds_read_b64_tr_b16 v[114:115], v11 offset:12864
    v_mfma_f32_16x16x32_bf16 v[80:83], v[40:43], v[196:199], v[80:83]
    v_mfma_f32_16x16x32_bf16 v[84:87], v[40:43], v[212:215], v[84:87]
    s_add_u32 m0, s73, 4096
    s_nop 0
    buffer_load_dwordx4 v8, s[12:15], s62 offen lds
    s_waitcnt lgkmcnt(8)
    ds_read_b64_tr_b16 v[116:117], v11 offset:10336
    ds_read_b64_tr_b16 v[118:119], v11 offset:12896
    v_mfma_f32_16x16x32_bf16 v[88:91], v[44:47], v[196:199], v[88:91]
    v_mfma_f32_16x16x32_bf16 v[92:95], v[44:47], v[212:215], v[92:95]
    s_waitcnt lgkmcnt(8)
    ds_read_b64_tr_b16 v[120:121], v11 offset:10368
    ds_read_b64_tr_b16 v[122:123], v11 offset:12928
    v_mfma_f32_16x16x32_bf16 v[96:99], v[48:51], v[196:199], v[96:99]
    v_mfma_f32_16x16x32_bf16 v[100:103], v[48:51], v[212:215], v[100:103]
    s_waitcnt lgkmcnt(8)
    ds_read_b64_tr_b16 v[32:33], v11 offset:15360
    ds_read_b64_tr_b16 v[34:35], v11 offset:17920
    v_mfma_f32_16x16x32_bf16 v[64:67], v[104:107], v[200:203], v[64:67]
    v_mfma_f32_16x16x32_bf16 v[68:71], v[104:107], v[216:219], v[68:71]
    s_waitcnt lgkmcnt(8)
    ds_read_b64_tr_b16 v[36:37], v11 offset:15392
    ds_read_b64_tr_b16 v[38:39], v11 offset:17952
    v_mfma_f32_16x16x32_bf16 v[72:75], v[108:111], v[200:203], v[72:75]
    v_mfma_f32_16x16x32_bf16 v[76:79], v[108:111], v[216:219], v[76:79]
    s_waitcnt lgkmcnt(8)
    ds_read_b64_tr_b16 v[40:41], v11 offset:15424
    ds_read_b64_tr_b16 v[42:43], v11 offset:17984
    v_mfma_f32_16x16x32_bf16 v[80:83], v[112:115], v[200:203], v[80:83]
    v_mfma_f32_16x16x32_bf16 v[84:87], v[112:115], v[216:219], v[84:87]
    s_waitcnt lgkmcnt(8)
    ds_read_b64_tr_b16 v[44:45], v11 offset:15456
    ds_read_b64_tr_b16 v[46:47], v11 offset:18016
    v_mfma_f32_16x16x32_bf16 v[88:91], v[116:119], v[200:203], v[88:91]
    v_mfma_f32_16x16x32_bf16 v[92:95], v[116:119], v[216:219], v[92:95]
    s_waitcnt lgkmcnt(8)
    ds_read_b64_tr_b16 v[48:49], v11 offset:15488
    ds_read_b64_tr_b16 v[50:51], v11 offset:18048
    v_mfma_f32_16x16x32_bf16 v[96:99], v[120:123], v[200:203], v[96:99]
    v_mfma_f32_16x16x32_bf16 v[100:103], v[120:123], v[216:219], v[100:103]
    s_waitcnt lgkmcnt(8)
    ds_read_b64_tr_b16 v[104:105], v63 offset:0
    ds_read_b64_tr_b16 v[106:107], v63 offset:2560
    v_mfma_f32_16x16x32_bf16 v[64:67], v[32:35], v[204:207], v[64:67]
    v_mfma_f32_16x16x32_bf16 v[68:71], v[32:35], v[220:223], v[68:71]
    s_waitcnt lgkmcnt(8)
    ds_read_b64_tr_b16 v[108:109], v63 offset:32
    ds_read_b64_tr_b16 v[110:111], v63 offset:2592
    v_mfma_f32_16x16x32_bf16 v[72:75], v[36:39], v[204:207], v[72:75]
    v_mfma_f32_16x16x32_bf16 v[76:79], v[36:39], v[220:223], v[76:79]
    s_waitcnt lgkmcnt(8)
    ds_read_b64_tr_b16 v[112:113], v63 offset:64
    ds_read_b64_tr_b16 v[114:115], v63 offset:2624
    v_mfma_f32_16x16x32_bf16 v[80:83], v[40:43], v[204:207], v[80:83]
    v_mfma_f32_16x16x32_bf16 v[84:87], v[40:43], v[220:223], v[84:87]
    s_waitcnt lgkmcnt(8)
    ds_read_b64_tr_b16 v[116:117], v63 offset:96
    ds_read_b64_tr_b16 v[118:119], v63 offset:2656
    v_mfma_f32_16x16x32_bf16 v[88:91], v[44:47], v[204:207], v[88:91]
    v_mfma_f32_16x16x32_bf16 v[92:95], v[44:47], v[220:223], v[92:95]
    s_waitcnt lgkmcnt(8)
    ds_read_b64_tr_b16 v[120:121], v63 offset:128
    ds_read_b64_tr_b16 v[122:123], v63 offset:2688
    v_mfma_f32_16x16x32_bf16 v[96:99], v[48:51], v[204:207], v[96:99]
    v_mfma_f32_16x16x32_bf16 v[100:103], v[48:51], v[220:223], v[100:103]
    s_cmp_lg_u32 s24, 3
    s_cbranch_scc1 m_nf10_2
    s_lshl_b32 s70, s27, 7
    v_mov_b32 v56, 1
    v_mov_b32 v57, s70
    buffer_store_dword v56, v57, s[88:91], 0 offen sc1
m_nf10_2:
    s_waitcnt vmcnt(5)
    s_barrier
    s_waitcnt lgkmcnt(8)
    ds_read_b64_tr_b16 v[32:33], v63 offset:5120
    ds_read_b64_tr_b16 v[34:35], v63 offset:7680
    v_mfma_f32_16x16x32_bf16 v[64:67], v[104:107], v[128:131], v[64:67]
    v_mfma_f32_16x16x32_bf16 v[68:71], v[104:107], v[144:147], v[68:71]
    s_add_u32 s62, s75, 328160
    s_add_u32 m0, s74, 0
    s_nop 0
    buffer_load_dwordx4 v4, s[12:15], s62 offen lds
    s_waitcnt lgkmcnt(8)
    ds_read_b64_tr_b16 v[36:37], v63 offset:5152
    ds_read_b64_tr_b16 v[38:39], v63 offset:7712
    v_mfma_f32_16x16x32_bf16 v[72:75], v[108:111], v[128:131], v[72:75]
    v_mfma_f32_16x16x32_bf16 v[76:79], v[108:111], v[144:147], v[76:79]
    s_waitcnt lgkmcnt(8)
    ds_read_b64_tr_b16 v[40:41], v63 offset:5184
    ds_read_b64_tr_b16 v[42:43], v63 offset:7744
    v_mfma_f32_16x16x32_bf16 v[80:83], v[112:115], v[128:131], v[80:83]
    v_mfma_f32_16x16x32_bf16 v[84:87], v[112:115], v[144:147], v[84:87]
    s_add_u32 m0, s74, 1024
    s_nop 0
    buffer_load_dwordx4 v5, s[12:15], s62 offen lds
    s_waitcnt lgkmcnt(8)
    ds_read_b64_tr_b16 v[44:45], v63 offset:5216
    ds_read_b64_tr_b16 v[46:47], v63 offset:7776
    v_mfma_f32_16x16x32_bf16 v[88:91], v[116:119], v[128:131], v[88:91]
    v_mfma_f32_16x16x32_bf16 v[92:95], v[116:119], v[144:147], v[92:95]
    s_waitcnt lgkmcnt(8)
    ds_read_b64_tr_b16 v[48:49], v63 offset:5248
    ds_read_b64_tr_b16 v[50:51], v63 offset:7808
    v_mfma_f32_16x16x32_bf16 v[96:99], v[120:123], v[128:131], v[96:99]
    v_mfma_f32_16x16x32_bf16 v[100:103], v[120:123], v[144:147], v[100:103]
    s_add_u32 m0, s74, 2048
    s_nop 0
    buffer_load_dwordx4 v6, s[12:15], s62 offen lds
    s_waitcnt lgkmcnt(8)
    ds_read_b64_tr_b16 v[104:105], v63 offset:10240
    ds_read_b64_tr_b16 v[106:107], v63 offset:12800
    v_mfma_f32_16x16x32_bf16 v[64:67], v[32:35], v[132:135], v[64:67]
    v_mfma_f32_16x16x32_bf16 v[68:71], v[32:35], v[148:151], v[68:71]
    s_add_u32 m0, s74, 3072
    s_nop 0
    buffer_load_dwordx4 v7, s[12:15], s62 offen lds
    s_waitcnt lgkmcnt(8)
    ds_read_b64_tr_b16 v[108:109], v63 offset:10272
    ds_read_b64_tr_b16 v[110:111], v63 offset:12832
    v_mfma_f32_16x16x32_bf16 v[72:75], v[36:39], v[132:135], v[72:75]
    v_mfma_f32_16x16x32_bf16 v[76:79], v[36:39], v[148:151], v[76:79]
    s_waitcnt lgkmcnt(8)
    ds_read_b64_tr_b16 v[112:113], v63 offset:10304
    ds_read_b64_tr_b16 v[114:115], v63 offset:12864
    v_mfma_f32_16x16x32_bf16 v[80:83], v[40:43], v[132:135], v[80:83]
    v_mfma_f32_16x16x32_bf16 v[84:87], v[40:43], v[148:151], v[84:87]
    s_add_u32 m0, s74, 4096
    s_nop 0
    buffer_load_dwordx4 v8, s[12:15], s62 offen lds
    s_waitcnt lgkmcnt(8)
    ds_read_b64_tr_b16 v[116:117], v63 offset:10336
    ds_read_b64_tr_b16 v[118:119], v63 offset:12896
    v_mfma_f32_16x16x32_bf16 v[88:91], v[44:47], v[132:135], v[88:91]
    v_mfma_f32_16x16x32_bf16 v[92:95], v[44:47], v[148:151], v[92:95]
    s_waitcnt lgkmcnt(8)
    ds_read_b64_tr_b16 v[120:121], v63 offset:10368
    ds_read_b64_tr_b16 v[122:123], v63 offset:12928
    v_mfma_f32_16x16x32_bf16 v[96:99], v[48:51], v[132:135], v[96:99]
    v_mfma_f32_16x16x32_bf16 v[100:103], v[48:51], v[148:151], v[100:103]
    s_waitcnt lgkmcnt(8)
    ds_read_b64_tr_b16 v[32:33], v63 offset:15360
    ds_read_b64_tr_b16 v[34:35], v63 offset:17920
    v_mfma_f32_16x16x32_bf16 v[64:67], v[104:107], v[136:139], v[64:67]
    v_mfma_f32_16x16x32_bf16 v[68:71], v[104:107], v[152:155], v[68:71]
    s_waitcnt lgkmcnt(8)
    ds_read_b64_tr_b16 v[36:37], v63 offset:15392
    ds_read_b64_tr_b16 v[38:39], v63 offset:17952
    v_mfma_f32_16x16x32_bf16 v[72:75], v[108:111], v[136:139], v[72:75]
    v_mfma_f32_16x16x32_bf16 v[76:79], v[108:111], v[152:155], v[76:79]
    s_waitcnt lgkmcnt(8)
    ds_read_b64_tr_b16 v[40:41], v63 offset:15424
    ds_read_b64_tr_b16 v[42:43], v63 offset:17984
    v_mfma_f32_16x16x32_bf16 v[80:83], v[112:115], v[136:139], v[80:83]
    v_mfma_f32_16x16x32_bf16 v[84:87], v[112:115], v[152:155], v[84:87]
    s_waitcnt lgkmcnt(8)
    ds_read_b64_tr_b16 v[44:45], v63 offset:15456
    ds_read_b64_tr_b16 v[46:47], v63 offset:18016
    v_mfma_f32_16x16x32_bf16 v[88:91], v[116:119], v[136:139], v[88:91]
    v_mfma_f32_16x16x32_bf16 v[92:95], v[116:119], v[152:155], v[92:95]
    s_waitcnt lgkmcnt(8)
    ds_read_b64_tr_b16 v[48:49], v63 offset:15488
    ds_read_b64_tr_b16 v[50:51], v63 offset:18048
    v_mfma_f32_16x16x32_bf16 v[96:99], v[120:123], v[136:139], v[96:99]
    v_mfma_f32_16x16x32_bf16 v[100:103], v[120:123], v[152:155], v[100:103]
    s_waitcnt lgkmcnt(8)
    ds_read_b64_tr_b16 v[104:105], v9 offset:0
    ds_read_b64_tr_b16 v[106:107], v9 offset:2560
    v_mfma_f32_16x16x32_bf16 v[64:67], v[32:35], v[140:143], v[64:67]
    v_mfma_f32_16x16x32_bf16 v[68:71], v[32:35], v[156:159], v[68:71]
    s_waitcnt lgkmcnt(8)
    ds_read_b64_tr_b16 v[108:109], v9 offset:32
    ds_read_b64_tr_b16 v[110:111], v9 offset:2592
    v_mfma_f32_16x16x32_bf16 v[72:75], v[36:39], v[140:143], v[72:75]
    v_mfma_f32_16x16x32_bf16 v[76:79], v[36:39], v[156:159], v[76:79]
    s_waitcnt lgkmcnt(8)
    ds_read_b64_tr_b16 v[112:113], v9 offset:64
    ds_read_b64_tr_b16 v[114:115], v9 offset:2624
    v_mfma_f32_16x16x32_bf16 v[80:83], v[40:43], v[140:143], v[80:83]
    v_mfma_f32_16x16x32_bf16 v[84:87], v[40:43], v[156:159], v[84:87]
    s_waitcnt lgkmcnt(8)
    ds_read_b64_tr_b16 v[116:117], v9 offset:96
    ds_read_b64_tr_b16 v[118:119], v9 offset:2656
    v_mfma_f32_16x16x32_bf16 v[88:91], v[44:47], v[140:143], v[88:91]
    v_mfma_f32_16x16x32_bf16 v[92:95], v[44:47], v[156:159], v[92:95]
    s_waitcnt lgkmcnt(8)
    ds_read_b64_tr_b16 v[120:121], v9 offset:128
    ds_read_b64_tr_b16 v[122:123], v9 offset:2688
    v_mfma_f32_16x16x32_bf16 v[96:99], v[48:51], v[140:143], v[96:99]
    v_mfma_f32_16x16x32_bf16 v[100:103], v[48:51], v[156:159], v[100:103]
    v_cvt_pk_bf16_f32 v16, v64, v65
    v_cvt_pk_bf16_f32 v17, v66, v67
    v_cvt_pk_bf16_f32 v18, v68, v69
    v_cvt_pk_bf16_f32 v19, v70, v71
    v_cvt_pk_bf16_f32 v20, v72, v73
    v_cvt_pk_bf16_f32 v21, v74, v75
    v_cvt_pk_bf16_f32 v22, v76, v77
    v_cvt_pk_bf16_f32 v23, v78, v79
    v_cvt_pk_bf16_f32 v24, v80, v81
    v_cvt_pk_bf16_f32 v25, v82, v83
    v_cvt_pk_bf16_f32 v26, v84, v85
    v_cvt_pk_bf16_f32 v27, v86, v87
    v_cvt_pk_bf16_f32 v28, v88, v89
    v_cvt_pk_bf16_f32 v29, v90, v91
    v_cvt_pk_bf16_f32 v30, v92, v93
    v_cvt_pk_bf16_f32 v31, v94, v95
    v_cvt_pk_bf16_f32 v52, v96, v97
    v_cvt_pk_bf16_f32 v53, v98, v99
    v_cvt_pk_bf16_f32 v54, v100, v101
    v_cvt_pk_bf16_f32 v55, v102, v103
    s_add_u32 s69, s76, 40960
    buffer_store_dwordx4 v[16:19], v59, s[4:7], s69 offen offset:0 sc1
    s_add_u32 s69, s76, 40960
    buffer_store_dwordx4 v[20:23], v59, s[4:7], s69 offen offset:1024 sc1
    s_add_u32 s69, s76, 40960
    buffer_store_dwordx4 v[24:27], v59, s[4:7], s69 offen offset:2048 sc1
    s_add_u32 s69, s76, 40960
    buffer_store_dwordx4 v[28:31], v59, s[4:7], s69 offen offset:3072 sc1
    s_add_u32 s69, s76, 45056
    buffer_store_dwordx4 v[52:55], v59, s[4:7], s69 offen offset:0 sc1
    s_waitcnt vmcnt(10)
    s_barrier
    s_waitcnt lgkmcnt(8)
    ds_read_b64_tr_b16 v[32:33], v9 offset:5120
    ds_read_b64_tr_b16 v[34:35], v9 offset:7680
    v_mfma_f32_16x16x32_bf16 v[64:67], v[104:107], v[160:163], 0
    v_mfma_f32_16x16x32_bf16 v[68:71], v[104:107], v[176:179], 0
    s_add_u32 s62, s75, 492000
    s_add_u32 m0, s97, 0
    s_nop 0
    buffer_load_dwordx4 v4, s[12:15], s62 offen lds
    s_waitcnt lgkmcnt(8)
    ds_read_b64_tr_b16 v[36:37], v9 offset:5152
    ds_read_b64_tr_b16 v[38:39], v9 offset:7712
    v_mfma_f32_16x16x32_bf16 v[72:75], v[108:111], v[160:163], 0
    v_mfma_f32_16x16x32_bf16 v[76:79], v[108:111], v[176:179], 0
    s_waitcnt lgkmcnt(8)
    ds_read_b64_tr_b16 v[40:41], v9 offset:5184
    ds_read_b64_tr_b16 v[42:43], v9 offset:7744
    v_mfma_f32_16x16x32_bf16 v[80:83], v[112:115], v[160:163], 0
    v_mfma_f32_16x16x32_bf16 v[84:87], v[112:115], v[176:179], 0
    s_add_u32 m0, s97, 1024
    s_nop 0
    buffer_load_dwordx4 v5, s[12:15], s62 offen lds
    s_waitcnt lgkmcnt(8)
    ds_read_b64_tr_b16 v[44:45], v9 offset:5216
    ds_read_b64_tr_b16 v[46:47], v9 offset:7776
    v_mfma_f32_16x16x32_bf16 v[88:91], v[116:119], v[160:163], 0
    v_mfma_f32_16x16x32_bf16 v[92:95], v[116:119], v[176:179], 0
    s_waitcnt lgkmcnt(8)
    ds_read_b64_tr_b16 v[48:49], v9 offset:5248
    ds_read_b64_tr_b16 v[50:51], v9 offset:7808
    v_mfma_f32_16x16x32_bf16 v[96:99], v[120:123], v[160:163], 0
    v_mfma_f32_16x16x32_bf16 v[100:103], v[120:123], v[176:179], 0
    s_add_u32 m0, s97, 2048
    s_nop 0
    buffer_load_dwordx4 v6, s[12:15], s62 offen lds
    s_waitcnt lgkmcnt(8)
    ds_read_b64_tr_b16 v[104:105], v9 offset:10240
    ds_read_b64_tr_b16 v[106:107], v9 offset:12800
    v_mfma_f32_16x16x32_bf16 v[64:67], v[32:35], v[164:167], v[64:67]
    v_mfma_f32_16x16x32_bf16 v[68:71], v[32:35], v[180:183], v[68:71]
    s_add_u32 m0, s97, 3072
    s_nop 0
    buffer_load_dwordx4 v7, s[12:15], s62 offen lds
    s_waitcnt lgkmcnt(8)
    ds_read_b64_tr_b16 v[108:109], v9 offset:10272
    ds_read_b64_tr_b16 v[110:111], v9 offset:12832
    v_mfma_f32_16x16x32_bf16 v[72:75], v[36:39], v[164:167], v[72:75]
    v_mfma_f32_16x16x32_bf16 v[76:79], v[36:39], v[180:183], v[76:79]
    s_waitcnt lgkmcnt(8)
    ds_read_b64_tr_b16 v[112:113], v9 offset:10304
    ds_read_b64_tr_b16 v[114:115], v9 offset:12864
    v_mfma_f32_16x16x32_bf16 v[80:83], v[40:43], v[164:167], v[80:83]
    v_mfma_f32_16x16x32_bf16 v[84:87], v[40:43], v[180:183], v[84:87]
    s_add_u32 m0, s97, 4096
    s_nop 0
    buffer_load_dwordx4 v8, s[12:15], s62 offen lds
    s_waitcnt lgkmcnt(8)
    ds_read_b64_tr_b16 v[116:117], v9 offset:10336
    ds_read_b64_tr_b16 v[118:119], v9 offset:12896
    v_mfma_f32_16x16x32_bf16 v[88:91], v[44:47], v[164:167], v[88:91]
    v_mfma_f32_16x16x32_bf16 v[92:95], v[44:47], v[180:183], v[92:95]
    s_waitcnt lgkmcnt(8)
    ds_read_b64_tr_b16 v[120:121], v9 offset:10368
    ds_read_b64_tr_b16 v[122:123], v9 offset:12928
    v_mfma_f32_16x16x32_bf16 v[96:99], v[48:51], v[164:167], v[96:99]
    v_mfma_f32_16x16x32_bf16 v[100:103], v[48:51], v[180:183], v[100:103]
    s_waitcnt lgkmcnt(8)
    ds_read_b64_tr_b16 v[32:33], v9 offset:15360
    ds_read_b64_tr_b16 v[34:35], v9 offset:17920
    v_mfma_f32_16x16x32_bf16 v[64:67], v[104:107], v[168:171], v[64:67]
    v_mfma_f32_16x16x32_bf16 v[68:71], v[104:107], v[184:187], v[68:71]
    s_waitcnt lgkmcnt(8)
    ds_read_b64_tr_b16 v[36:37], v9 offset:15392
    ds_read_b64_tr_b16 v[38:39], v9 offset:17952
    v_mfma_f32_16x16x32_bf16 v[72:75], v[108:111], v[168:171], v[72:75]
    v_mfma_f32_16x16x32_bf16 v[76:79], v[108:111], v[184:187], v[76:79]
    s_waitcnt lgkmcnt(8)
    ds_read_b64_tr_b16 v[40:41], v9 offset:15424
    ds_read_b64_tr_b16 v[42:43], v9 offset:17984
    v_mfma_f32_16x16x32_bf16 v[80:83], v[112:115], v[168:171], v[80:83]
    v_mfma_f32_16x16x32_bf16 v[84:87], v[112:115], v[184:187], v[84:87]
    s_waitcnt lgkmcnt(8)
    ds_read_b64_tr_b16 v[44:45], v9 offset:15456
    ds_read_b64_tr_b16 v[46:47], v9 offset:18016
    v_mfma_f32_16x16x32_bf16 v[88:91], v[116:119], v[168:171], v[88:91]
    v_mfma_f32_16x16x32_bf16 v[92:95], v[116:119], v[184:187], v[92:95]
    s_waitcnt lgkmcnt(8)
    ds_read_b64_tr_b16 v[48:49], v9 offset:15488
    ds_read_b64_tr_b16 v[50:51], v9 offset:18048
    v_mfma_f32_16x16x32_bf16 v[96:99], v[120:123], v[168:171], v[96:99]
    v_mfma_f32_16x16x32_bf16 v[100:103], v[120:123], v[184:187], v[100:103]
    s_waitcnt lgkmcnt(8)
    ds_read_b64_tr_b16 v[104:105], v10 offset:0
    ds_read_b64_tr_b16 v[106:107], v10 offset:2560
    v_mfma_f32_16x16x32_bf16 v[64:67], v[32:35], v[172:175], v[64:67]
    v_mfma_f32_16x16x32_bf16 v[68:71], v[32:35], v[188:191], v[68:71]
    s_waitcnt lgkmcnt(8)
    ds_read_b64_tr_b16 v[108:109], v10 offset:32
    ds_read_b64_tr_b16 v[110:111], v10 offset:2592
    v_mfma_f32_16x16x32_bf16 v[72:75], v[36:39], v[172:175], v[72:75]
    v_mfma_f32_16x16x32_bf16 v[76:79], v[36:39], v[188:191], v[76:79]
    s_waitcnt lgkmcnt(8)
    ds_read_b64_tr_b16 v[112:113], v10 offset:64
    ds_read_b64_tr_b16 v[114:115], v10 offset:2624
    v_mfma_f32_16x16x32_bf16 v[80:83], v[40:43], v[172:175], v[80:83]
    v_mfma_f32_16x16x32_bf16 v[84:87], v[40:43], v[188:191], v[84:87]
    s_waitcnt lgkmcnt(8)
    ds_read_b64_tr_b16 v[116:117], v10 offset:96
    ds_read_b64_tr_b16 v[118:119], v10 offset:2656
    v_mfma_f32_16x16x32_bf16 v[88:91], v[44:47], v[172:175], v[88:91]
    v_mfma_f32_16x16x32_bf16 v[92:95], v[44:47], v[188:191], v[92:95]
    s_waitcnt lgkmcnt(8)
    ds_read_b64_tr_b16 v[120:121], v10 offset:128
    ds_read_b64_tr_b16 v[122:123], v10 offset:2688
    v_mfma_f32_16x16x32_bf16 v[96:99], v[48:51], v[172:175], v[96:99]
    v_mfma_f32_16x16x32_bf16 v[100:103], v[48:51], v[188:191], v[100:103]
    s_waitcnt vmcnt(10)
    s_barrier
    s_cmp_lg_u32 s24, 7
    s_cbranch_scc1 m_ep2
    v_mbcnt_lo_u32_b32 v57, -1, 0
    v_mbcnt_hi_u32_b32 v57, -1, v57
    v_and_b32 v57, 7, v57
    v_lshlrev_b32 v57, 7, v57
    buffer_load_dword v58, v57, s[88:91], 0 offen sc1
m_ep2:
    s_waitcnt lgkmcnt(8)
    ds_read_b64_tr_b16 v[32:33], v10 offset:5120
    ds_read_b64_tr_b16 v[34:35], v10 offset:7680
    v_mfma_f32_16x16x32_bf16 v[64:67], v[104:107], v[224:227], v[64:67]
    v_mfma_f32_16x16x32_bf16 v[68:71], v[104:107], v[240:243], v[68:71]
    s_waitcnt lgkmcnt(8)
    ds_read_b64_tr_b16 v[36:37], v10 offset:5152
    ds_read_b64_tr_b16 v[38:39], v10 offset:7712
    v_mfma_f32_16x16x32_bf16 v[72:75], v[108:111], v[224:227], v[72:75]
    v_mfma_f32_16x16x32_bf16 v[76:79], v[108:111], v[240:243], v[76:79]
    s_waitcnt lgkmcnt(8)
    ds_read_b64_tr_b16 v[40:41], v10 offset:5184
    ds_read_b64_tr_b16 v[42:43], v10 offset:7744
    v_mfma_f32_16x16x32_bf16 v[80:83], v[112:115], v[224:227], v[80:83]
    v_mfma_f32_16x16x32_bf16 v[84:87], v[112:115], v[240:243], v[84:87]
    s_waitcnt lgkmcnt(8)
    ds_read_b64_tr_b16 v[44:45], v10 offset:5216
    ds_read_b64_tr_b16 v[46:47], v10 offset:7776
    v_mfma_f32_16x16x32_bf16 v[88:91], v[116:119], v[224:227], v[88:91]
    v_mfma_f32_16x16x32_bf16 v[92:95], v[116:119], v[240:243], v[92:95]
    s_waitcnt lgkmcnt(8)
    ds_read_b64_tr_b16 v[48:49], v10 offset:5248
    ds_read_b64_tr_b16 v[50:51], v10 offset:7808
    v_mfma_f32_16x16x32_bf16 v[96:99], v[120:123], v[224:227], v[96:99]
    v_mfma_f32_16x16x32_bf16 v[100:103], v[120:123], v[240:243], v[100:103]
    s_waitcnt lgkmcnt(8)
    ds_read_b64_tr_b16 v[104:105], v10 offset:10240
    ds_read_b64_tr_b16 v[106:107], v10 offset:12800
    v_mfma_f32_16x16x32_bf16 v[64:67], v[32:35], v[228:231], v[64:67]
    v_mfma_f32_16x16x32_bf16 v[68:71], v[32:35], v[244:247], v[68:71]
    s_waitcnt lgkmcnt(8)
    ds_read_b64_tr_b16 v[108:109], v10 offset:10272
    ds_read_b64_tr_b16 v[110:111], v10 offset:12832
    v_mfma_f32_16x16x32_bf16 v[72:75], v[36:39], v[228:231], v[72:75]
    v_mfma_f32_16x16x32_bf16 v[76:79], v[36:39], v[244:247], v[76:79]
    s_waitcnt lgkmcnt(8)
    ds_read_b64_tr_b16 v[112:113], v10 offset:10304
    ds_read_b64_tr_b16 v[114:115], v10 offset:12864
    v_mfma_f32_16x16x32_bf16 v[80:83], v[40:43], v[228:231], v[80:83]
    v_mfma_f32_16x16x32_bf16 v[84:87], v[40:43], v[244:247], v[84:87]
    s_waitcnt lgkmcnt(8)
    ds_read_b64_tr_b16 v[116:117], v10 offset:10336
    ds_read_b64_tr_b16 v[118:119], v10 offset:12896
    v_mfma_f32_16x16x32_bf16 v[88:91], v[44:47], v[228:231], v[88:91]
    v_mfma_f32_16x16x32_bf16 v[92:95], v[44:47], v[244:247], v[92:95]
    s_waitcnt lgkmcnt(8)
    ds_read_b64_tr_b16 v[120:121], v10 offset:10368
    ds_read_b64_tr_b16 v[122:123], v10 offset:12928
    v_mfma_f32_16x16x32_bf16 v[96:99], v[48:51], v[228:231], v[96:99]
    v_mfma_f32_16x16x32_bf16 v[100:103], v[48:51], v[244:247], v[100:103]
    s_waitcnt lgkmcnt(8)
    ds_read_b64_tr_b16 v[32:33], v10 offset:15360
    ds_read_b64_tr_b16 v[34:35], v10 offset:17920
    v_mfma_f32_16x16x32_bf16 v[64:67], v[104:107], v[232:235], v[64:67]
    v_mfma_f32_16x16x32_bf16 v[68:71], v[104:107], v[248:251], v[68:71]
    s_waitcnt lgkmcnt(8)
    ds_read_b64_tr_b16 v[36:37], v10 offset:15392
    ds_read_b64_tr_b16 v[38:39], v10 offset:17952
    v_mfma_f32_16x16x32_bf16 v[72:75], v[108:111], v[232:235], v[72:75]
    v_mfma_f32_16x16x32_bf16 v[76:79], v[108:111], v[248:251], v[76:79]
    s_waitcnt lgkmcnt(8)
    ds_read_b64_tr_b16 v[40:41], v10 offset:15424
    ds_read_b64_tr_b16 v[42:43], v10 offset:17984
    v_mfma_f32_16x16x32_bf16 v[80:83], v[112:115], v[232:235], v[80:83]
    v_mfma_f32_16x16x32_bf16 v[84:87], v[112:115], v[248:251], v[84:87]
    s_waitcnt lgkmcnt(8)
    ds_read_b64_tr_b16 v[44:45], v10 offset:15456
    ds_read_b64_tr_b16 v[46:47], v10 offset:18016
    v_mfma_f32_16x16x32_bf16 v[88:91], v[116:119], v[232:235], v[88:91]
    v_mfma_f32_16x16x32_bf16 v[92:95], v[116:119], v[248:251], v[92:95]
    s_waitcnt lgkmcnt(8)
    ds_read_b64_tr_b16 v[48:49], v10 offset:15488
    ds_read_b64_tr_b16 v[50:51], v10 offset:18048
    v_mfma_f32_16x16x32_bf16 v[96:99], v[120:123], v[232:235], v[96:99]
    v_mfma_f32_16x16x32_bf16 v[100:103], v[120:123], v[248:251], v[100:103]
    s_waitcnt lgkmcnt(8)
    ds_read_b64_tr_b16 v[104:105], v11 offset:0
    ds_read_b64_tr_b16 v[106:107], v11 offset:2560
    v_mfma_f32_16x16x32_bf16 v[64:67], v[32:35], v[236:239], v[64:67]
    v_mfma_f32_16x16x32_bf16 v[68:71], v[32:35], v[252:255], v[68:71]
    s_waitcnt lgkmcnt(8)
    ds_read_b64_tr_b16 v[108:109], v11 offset:32
    ds_read_b64_tr_b16 v[110:111], v11 offset:2592
    v_mfma_f32_16x16x32_bf16 v[72:75], v[36:39], v[236:239], v[72:75]
    v_mfma_f32_16x16x32_bf16 v[76:79], v[36:39], v[252:255], v[76:79]
    s_waitcnt lgkmcnt(8)
    ds_read_b64_tr_b16 v[112:113], v11 offset:64
    ds_read_b64_tr_b16 v[114:115], v11 offset:2624
    v_mfma_f32_16x16x32_bf16 v[80:83], v[40:43], v[236:239], v[80:83]
    v_mfma_f32_16x16x32_bf16 v[84:87], v[40:43], v[252:255], v[84:87]
    s_waitcnt lgkmcnt(8)
    ds_read_b64_tr_b16 v[116:117], v11 offset:96
    ds_read_b64_tr_b16 v[118:119], v11 offset:2656
    v_mfma_f32_16x16x32_bf16 v[88:91], v[44:47], v[236:239], v[88:91]
    v_mfma_f32_16x16x32_bf16 v[92:95], v[44:47], v[252:255], v[92:95]
    s_waitcnt lgkmcnt(8)
    ds_read_b64_tr_b16 v[120:121], v11 offset:128
    ds_read_b64_tr_b16 v[122:123], v11 offset:2688
    v_mfma_f32_16x16x32_bf16 v[96:99], v[48:51], v[236:239], v[96:99]
    v_mfma_f32_16x16x32_bf16 v[100:103], v[48:51], v[252:255], v[100:103]
    s_waitcnt vmcnt(0)
    s_waitcnt vmcnt(0)
    s_cmp_lg_u32 s24, 7
    s_cbranch_scc1 m_ec2_x
    v_cmp_gt_u32 vcc, 8, v56
    s_cbranch_vccnz m_ec2_slow
    v_cmp_gt_u32 vcc, 1, v58
    s_cbranch_vccz m_ec2_x
m_ec2_slow:
    s_mov_b32 s72, 0
    v_mov_b32 v57, s96
m_ec2_c:
    buffer_load_dword v56, v57, s[92:95], 0 offen sc1
    s_waitcnt vmcnt(0)
    v_cmp_gt_u32 vcc, 8, v56
    s_add_u32 s72, s72, 1
    s_cmp_ge_u32 s72, 0x40000
    s_cbranch_scc1 m_ec2_cx
    s_cbranch_vccz m_ec2_cx
    s_sleep 1
    s_branch m_ec2_c
m_ec2_cx:
    s_mov_b32 s72, 0
    v_mbcnt_lo_u32_b32 v57, -1, 0
    v_mbcnt_hi_u32_b32 v57, -1, v57
    v_and_b32 v57, 7, v57
    v_lshlrev_b32 v57, 7, v57
m_ec2_f:
    buffer_load_dword v56, v57, s[88:91], 0 offen sc1
    s_waitcnt vmcnt(0)
    v_cmp_gt_u32 vcc, 1, v56
    s_add_u32 s72, s72, 1
    s_cmp_ge_u32 s72, 0x40000
    s_cbranch_scc1 m_ec2_fx
    s_cbranch_vccz m_ec2_fx
    s_sleep 1
    s_branch m_ec2_f
m_ec2_fx:
m_ec2_x:
    s_barrier
    s_cmp_lg_u32 s24, 0
    s_cbranch_scc1 m_nf14_2
    s_lshl_b32 s70, s27, 7
    v_mov_b32 v56, 2
    v_mov_b32 v57, s70
    buffer_store_dword v56, v57, s[88:91], 0 offen sc1
m_nf14_2:
    s_mov_b32 s8, s98
    s_and_b32 s9, s99, 0xffff
    s_mov_b32 s10, 4587520
    s_mov_b32 s11, 0x00020000
    s_lshl_b32 s70, s25, 4
    s_add_u32 s70, s70, s26
    s_mul_i32 s70, s70, 1310720
    s_add_u32 s16, s56, s70
    s_addc_u32 s17, s57, 0
    s_and_b32 s17, s17, 0xffff
    s_mov_b32 s18, 1310720
    s_mov_b32 s19, 0x00020000
    s_lshr_b32 s72, s27, 2
    s_and_b32 s73, s27, 3
    s_mul_i32 s77, s72, 81920
    s_mul_i32 s74, s73, 5120
    s_add_u32 s77, s77, s74
    s_mul_i32 s75, s26, 286720
    s_mul_i32 s74, s25, 1280
    s_add_u32 s75, s75, s74
    s_mul_i32 s74, s72, 640
    s_add_u32 s75, s75, s74
    v_mbcnt_lo_u32_b32 v0, -1, 0
    v_mbcnt_hi_u32_b32 v0, -1, v0
    v_lshlrev_b32 v1, 4, v0
    s_mov_b32 s70, s24
    s_mul_i32 s71, s70, 52
    s_lshr_b32 s71, s71, 8
    s_mul_i32 s74, s71, 5
    s_sub_u32 s74, s70, s74
    s_mul_i32 s78, s71, 20480
    s_lshl_b32 s79, s74, 10
    s_add_u32 s78, s78, s79
    s_add_u32 s64, s78, s77
    s_mul_i32 s78, s71, 160
    s_lshl_b32 s79, s74, 5
    s_add_u32 s78, s78, s79
    s_add_u32 s65, s78, s75
    s_add_u32 s62, s64, 0
    buffer_load_dwordx4 v[160:163], v1, s[16:19], s62 offen sc1
    s_add_u32 s62, s64, 163840
    buffer_load_dwordx4 v[164:167], v1, s[16:19], s62 offen sc1
    s_add_u32 s62, s64, 327680
    buffer_load_dwordx4 v[168:171], v1, s[16:19], s62 offen sc1
    s_add_u32 s62, s64, 491520
    buffer_load_dwordx4 v[172:175], v1, s[16:19], s62 offen sc1
    s_add_u32 s62, s64, 655360
    buffer_load_dwordx4 v[176:179], v1, s[16:19], s62 offen sc1
    s_add_u32 s62, s64, 819200
    buffer_load_dwordx4 v[180:183], v1, s[16:19], s62 offen sc1
    s_add_u32 s62, s64, 983040
    buffer_load_dwordx4 v[184:187], v1, s[16:19], s62 offen sc1
    s_add_u32 s62, s64, 1146880
    buffer_load_dwordx4 v[188:191], v1, s[16:19], s62 offen sc1
    s_cmp_ge_u32 s24, 2
    s_cbranch_scc1 m_pl2
    s_add_u32 s70, s24, 8
    s_mul_i32 s71, s70, 52
    s_lshr_b32 s71, s71, 8
    s_mul_i32 s74, s71, 5
    s_sub_u32 s74, s70, s74
    s_mul_i32 s78, s71, 20480
    s_lshl_b32 s79, s74, 10
    s_add_u32 s78, s78, s79
    s_add_u32 s64, s78, s77
    s_mul_i32 s78, s71, 160
    s_lshl_b32 s79, s74, 5
    s_add_u32 s78, s78, s79
    s_add_u32 s66, s78, s75
    s_add_u32 s62, s64, 0
    buffer_load_dwordx4 v[224:227], v1, s[16:19], s62 offen sc1
    s_add_u32 s62, s64, 163840
    buffer_load_dwordx4 v[228:231], v1, s[16:19], s62 offen sc1
    s_add_u32 s62, s64, 327680
    buffer_load_dwordx4 v[232:235], v1, s[16:19], s62 offen sc1
    s_add_u32 s62, s64, 491520
    buffer_load_dwordx4 v[236:239], v1, s[16:19], s62 offen sc1
    s_add_u32 s62, s64, 655360
    buffer_load_dwordx4 v[240:243], v1, s[16:19], s62 offen sc1
    s_add_u32 s62, s64, 819200
    buffer_load_dwordx4 v[244:247], v1, s[16:19], s62 offen sc1
    s_add_u32 s62, s64, 983040
    buffer_load_dwordx4 v[248:251], v1, s[16:19], s62 offen sc1
    s_add_u32 s62, s64, 1146880
    buffer_load_dwordx4 v[252:255], v1, s[16:19], s62 offen sc1
m_pl2:
    s_waitcnt lgkmcnt(8)
    ds_read_b64_tr_b16 v[32:33], v11 offset:5120
    ds_read_b64_tr_b16 v[34:35], v11 offset:7680
    v_mfma_f32_16x16x32_bf16 v[64:67], v[104:107], v[192:195], v[64:67]
    v_mfma_f32_16x16x32_bf16 v[68:71], v[104:107], v[208:211], v[68:71]
    s_waitcnt lgkmcnt(8)
    ds_read_b64_tr_b16 v[36:37], v11 offset:5152
    ds_read_b64_tr_b16 v[38:39], v11 offset:7712
    v_mfma_f32_16x16x32_bf16 v[72:75], v[108:111], v[192:195], v[72:75]
    v_mfma_f32_16x16x32_bf16 v[76:79], v[108:111], v[208:211], v[76:79]
    s_waitcnt lgkmcnt(8)
    ds_read_b64_tr_b16 v[40:41], v11 offset:5184
    ds_read_b64_tr_b16 v[42:43], v11 offset:7744
    v_mfma_f32_16x16x32_bf16 v[80:83], v[112:115], v[192:195], v[80:83]
    v_mfma_f32_16x16x32_bf16 v[84:87], v[112:115], v[208:211], v[84:87]
    s_waitcnt lgkmcnt(8)
    ds_read_b64_tr_b16 v[44:45], v11 offset:5216
    ds_read_b64_tr_b16 v[46:47], v11 offset:7776
    v_mfma_f32_16x16x32_bf16 v[88:91], v[116:119], v[192:195], v[88:91]
    v_mfma_f32_16x16x32_bf16 v[92:95], v[116:119], v[208:211], v[92:95]
    s_waitcnt lgkmcnt(8)
    ds_read_b64_tr_b16 v[48:49], v11 offset:5248
    ds_read_b64_tr_b16 v[50:51], v11 offset:7808
    v_mfma_f32_16x16x32_bf16 v[96:99], v[120:123], v[192:195], v[96:99]
    v_mfma_f32_16x16x32_bf16 v[100:103], v[120:123], v[208:211], v[100:103]
    s_waitcnt lgkmcnt(8)
    ds_read_b64_tr_b16 v[104:105], v11 offset:10240
    ds_read_b64_tr_b16 v[106:107], v11 offset:12800
    v_mfma_f32_16x16x32_bf16 v[64:67], v[32:35], v[196:199], v[64:67]
    v_mfma_f32_16x16x32_bf16 v[68:71], v[32:35], v[212:215], v[68:71]
    s_waitcnt lgkmcnt(8)
    ds_read_b64_tr_b16 v[108:109], v11 offset:10272
    ds_read_b64_tr_b16 v[110:111], v11 offset:12832
    v_mfma_f32_16x16x32_bf16 v[72:75], v[36:39], v[196:199], v[72:75]
    v_mfma_f32_16x16x32_bf16 v[76:79], v[36:39], v[212:215], v[76:79]
    s_waitcnt lgkmcnt(8)
    ds_read_b64_tr_b16 v[112:113], v11 offset:10304
    ds_read_b64_tr_b16 v[114:115], v11 offset:12864
    v_mfma_f32_16x16x32_bf16 v[80:83], v[40:43], v[196:199], v[80:83]
    v_mfma_f32_16x16x32_bf16 v[84:87], v[40:43], v[212:215], v[84:87]
    s_waitcnt lgkmcnt(8)
    ds_read_b64_tr_b16 v[116:117], v11 offset:10336
    ds_read_b64_tr_b16 v[118:119], v11 offset:12896
    v_mfma_f32_16x16x32_bf16 v[88:91], v[44:47], v[196:199], v[88:91]
    v_mfma_f32_16x16x32_bf16 v[92:95], v[44:47], v[212:215], v[92:95]
    s_waitcnt lgkmcnt(8)
    ds_read_b64_tr_b16 v[120:121], v11 offset:10368
    ds_read_b64_tr_b16 v[122:123], v11 offset:12928
    v_mfma_f32_16x16x32_bf16 v[96:99], v[48:51], v[196:199], v[96:99]
    v_mfma_f32_16x16x32_bf16 v[100:103], v[48:51], v[212:215], v[100:103]
    s_waitcnt lgkmcnt(8)
    ds_read_b64_tr_b16 v[32:33], v11 offset:15360
    ds_read_b64_tr_b16 v[34:35], v11 offset:17920
    v_mfma_f32_16x16x32_bf16 v[64:67], v[104:107], v[200:203], v[64:67]
    v_mfma_f32_16x16x32_bf16 v[68:71], v[104:107], v[216:219], v[68:71]
    s_waitcnt lgkmcnt(8)
    ds_read_b64_tr_b16 v[36:37], v11 offset:15392
    ds_read_b64_tr_b16 v[38:39], v11 offset:17952
    v_mfma_f32_16x16x32_bf16 v[72:75], v[108:111], v[200:203], v[72:75]
    v_mfma_f32_16x16x32_bf16 v[76:79], v[108:111], v[216:219], v[76:79]
    s_waitcnt lgkmcnt(8)
    ds_read_b64_tr_b16 v[40:41], v11 offset:15424
    ds_read_b64_tr_b16 v[42:43], v11 offset:17984
    v_mfma_f32_16x16x32_bf16 v[80:83], v[112:115], v[200:203], v[80:83]
    v_mfma_f32_16x16x32_bf16 v[84:87], v[112:115], v[216:219], v[84:87]
    s_waitcnt lgkmcnt(8)
    ds_read_b64_tr_b16 v[44:45], v11 offset:15456
    ds_read_b64_tr_b16 v[46:47], v11 offset:18016
    v_mfma_f32_16x16x32_bf16 v[88:91], v[116:119], v[200:203], v[88:91]
    v_mfma_f32_16x16x32_bf16 v[92:95], v[116:119], v[216:219], v[92:95]
    s_waitcnt lgkmcnt(8)
    ds_read_b64_tr_b16 v[48:49], v11 offset:15488
    ds_read_b64_tr_b16 v[50:51], v11 offset:18048
    v_mfma_f32_16x16x32_bf16 v[96:99], v[120:123], v[200:203], v[96:99]
    v_mfma_f32_16x16x32_bf16 v[100:103], v[120:123], v[216:219], v[100:103]
    s_waitcnt lgkmcnt(8)
    ds_read_b64_tr_b16 v[104:105], v63 offset:0
    ds_read_b64_tr_b16 v[106:107], v63 offset:2560
    v_mfma_f32_16x16x32_bf16 v[64:67], v[32:35], v[204:207], v[64:67]
    v_mfma_f32_16x16x32_bf16 v[68:71], v[32:35], v[220:223], v[68:71]
    s_waitcnt lgkmcnt(8)
    ds_read_b64_tr_b16 v[108:109], v63 offset:32
    ds_read_b64_tr_b16 v[110:111], v63 offset:2592
    v_mfma_f32_16x16x32_bf16 v[72:75], v[36:39], v[204:207], v[72:75]
    v_mfma_f32_16x16x32_bf16 v[76:79], v[36:39], v[220:223], v[76:79]
    s_waitcnt lgkmcnt(8)
    ds_read_b64_tr_b16 v[112:113], v63 offset:64
    ds_read_b64_tr_b16 v[114:115], v63 offset:2624
    v_mfma_f32_16x16x32_bf16 v[80:83], v[40:43], v[204:207], v[80:83]
    v_mfma_f32_16x16x32_bf16 v[84:87], v[40:43], v[220:223], v[84:87]
    s_waitcnt lgkmcnt(8)
    ds_read_b64_tr_b16 v[116:117], v63 offset:96
    ds_read_b64_tr_b16 v[118:119], v63 offset:2656
    v_mfma_f32_16x16x32_bf16 v[88:91], v[44:47], v[204:207], v[88:91]
    v_mfma_f32_16x16x32_bf16 v[92:95], v[44:47], v[220:223], v[92:95]
    s_waitcnt lgkmcnt(8)
    ds_read_b64_tr_b16 v[120:121], v63 offset:128
    ds_read_b64_tr_b16 v[122:123], v63 offset:2688
    v_mfma_f32_16x16x32_bf16 v[96:99], v[48:51], v[204:207], v[96:99]
    v_mfma_f32_16x16x32_bf16 v[100:103], v[48:51], v[220:223], v[100:103]
    s_barrier
    s_waitcnt lgkmcnt(8)
    ds_read_b64_tr_b16 v[32:33], v63 offset:5120
    ds_read_b64_tr_b16 v[34:35], v63 offset:7680
    v_mfma_f32_16x16x32_bf16 v[64:67], v[104:107], v[128:131], v[64:67]
    v_mfma_f32_16x16x32_bf16 v[68:71], v[104:107], v[144:147], v[68:71]
    s_waitcnt lgkmcnt(8)
    ds_read_b64_tr_b16 v[36:37], v63 offset:5152
    ds_read_b64_tr_b16 v[38:39], v63 offset:7712
    v_mfma_f32_16x16x32_bf16 v[72:75], v[108:111], v[128:131], v[72:75]
    v_mfma_f32_16x16x32_bf16 v[76:79], v[108:111], v[144:147], v[76:79]
    s_waitcnt lgkmcnt(8)
    ds_read_b64_tr_b16 v[40:41], v63 offset:5184
    ds_read_b64_tr_b16 v[42:43], v63 offset:7744
    v_mfma_f32_16x16x32_bf16 v[80:83], v[112:115], v[128:131], v[80:83]
    v_mfma_f32_16x16x32_bf16 v[84:87], v[112:115], v[144:147], v[84:87]
    s_waitcnt lgkmcnt(8)
    ds_read_b64_tr_b16 v[44:45], v63 offset:5216
    ds_read_b64_tr_b16 v[46:47], v63 offset:7776
    v_mfma_f32_16x16x32_bf16 v[88:91], v[116:119], v[128:131], v[88:91]
    v_mfma_f32_16x16x32_bf16 v[92:95], v[116:119], v[144:147], v[92:95]
    s_waitcnt lgkmcnt(8)
    ds_read_b64_tr_b16 v[48:49], v63 offset:5248
    ds_read_b64_tr_b16 v[50:51], v63 offset:7808
    v_mfma_f32_16x16x32_bf16 v[96:99], v[120:123], v[128:131], v[96:99]
    v_mfma_f32_16x16x32_bf16 v[100:103], v[120:123], v[144:147], v[100:103]
    s_waitcnt lgkmcnt(8)
    ds_read_b64_tr_b16 v[104:105], v63 offset:10240
    ds_read_b64_tr_b16 v[106:107], v63 offset:12800
    v_mfma_f32_16x16x32_bf16 v[64:67], v[32:35], v[132:135], v[64:67]
    v_mfma_f32_16x16x32_bf16 v[68:71], v[32:35], v[148:151], v[68:71]
    s_waitcnt lgkmcnt(8)
    ds_read_b64_tr_b16 v[108:109], v63 offset:10272
    ds_read_b64_tr_b16 v[110:111], v63 offset:12832
    v_mfma_f32_16x16x32_bf16 v[72:75], v[36:39], v[132:135], v[72:75]
    v_mfma_f32_16x16x32_bf16 v[76:79], v[36:39], v[148:151], v[76:79]
    s_waitcnt lgkmcnt(8)
    ds_read_b64_tr_b16 v[112:113], v63 offset:10304
    ds_read_b64_tr_b16 v[114:115], v63 offset:12864
    v_mfma_f32_16x16x32_bf16 v[80:83], v[40:43], v[132:135], v[80:83]
    v_mfma_f32_16x16x32_bf16 v[84:87], v[40:43], v[148:151], v[84:87]
    s_waitcnt lgkmcnt(8)
    ds_read_b64_tr_b16 v[116:117], v63 offset:10336
    ds_read_b64_tr_b16 v[118:119], v63 offset:12896
    v_mfma_f32_16x16x32_bf16 v[88:91], v[44:47], v[132:135], v[88:91]
    v_mfma_f32_16x16x32_bf16 v[92:95], v[44:47], v[148:151], v[92:95]
    s_waitcnt lgkmcnt(8)
    ds_read_b64_tr_b16 v[120:121], v63 offset:10368
    ds_read_b64_tr_b16 v[122:123], v63 offset:12928
    v_mfma_f32_16x16x32_bf16 v[96:99], v[48:51], v[132:135], v[96:99]
    v_mfma_f32_16x16x32_bf16 v[100:103], v[48:51], v[148:151], v[100:103]
    s_waitcnt lgkmcnt(8)
    ds_read_b64_tr_b16 v[32:33], v63 offset:15360
    ds_read_b64_tr_b16 v[34:35], v63 offset:17920
    v_mfma_f32_16x16x32_bf16 v[64:67], v[104:107], v[136:139], v[64:67]
    v_mfma_f32_16x16x32_bf16 v[68:71], v[104:107], v[152:155], v[68:71]
    s_waitcnt lgkmcnt(8)
    ds_read_b64_tr_b16 v[36:37], v63 offset:15392
    ds_read_b64_tr_b16 v[38:39], v63 offset:17952
    v_mfma_f32_16x16x32_bf16 v[72:75], v[108:111], v[136:139], v[72:75]
    v_mfma_f32_16x16x32_bf16 v[76:79], v[108:111], v[152:155], v[76:79]
    s_waitcnt lgkmcnt(8)
    ds_read_b64_tr_b16 v[40:41], v63 offset:15424
    ds_read_b64_tr_b16 v[42:43], v63 offset:17984
    v_mfma_f32_16x16x32_bf16 v[80:83], v[112:115], v[136:139], v[80:83]
    v_mfma_f32_16x16x32_bf16 v[84:87], v[112:115], v[152:155], v[84:87]
    s_waitcnt lgkmcnt(8)
    ds_read_b64_tr_b16 v[44:45], v63 offset:15456
    ds_read_b64_tr_b16 v[46:47], v63 offset:18016
    v_mfma_f32_16x16x32_bf16 v[88:91], v[116:119], v[136:139], v[88:91]
    v_mfma_f32_16x16x32_bf16 v[92:95], v[116:119], v[152:155], v[92:95]
    s_waitcnt lgkmcnt(8)
    ds_read_b64_tr_b16 v[48:49], v63 offset:15488
    ds_read_b64_tr_b16 v[50:51], v63 offset:18048
    v_mfma_f32_16x16x32_bf16 v[96:99], v[120:123], v[136:139], v[96:99]
    v_mfma_f32_16x16x32_bf16 v[100:103], v[120:123], v[152:155], v[100:103]
    s_waitcnt lgkmcnt(8)
    v_mfma_f32_16x16x32_bf16 v[64:67], v[32:35], v[140:143], v[64:67]
    v_mfma_f32_16x16x32_bf16 v[68:71], v[32:35], v[156:159], v[68:71]
    s_waitcnt lgkmcnt(6)
    v_mfma_f32_16x16x32_bf16 v[72:75], v[36:39], v[140:143], v[72:75]
    v_mfma_f32_16x16x32_bf16 v[76:79], v[36:39], v[156:159], v[76:79]
    s_waitcnt lgkmcnt(4)
    v_mfma_f32_16x16x32_bf16 v[80:83], v[40:43], v[140:143], v[80:83]
    v_mfma_f32_16x16x32_bf16 v[84:87], v[40:43], v[156:159], v[84:87]
    s_waitcnt lgkmcnt(2)
    v_mfma_f32_16x16x32_bf16 v[88:91], v[44:47], v[140:143], v[88:91]
    v_mfma_f32_16x16x32_bf16 v[92:95], v[44:47], v[156:159], v[92:95]
    s_waitcnt lgkmcnt(0)
    v_mfma_f32_16x16x32_bf16 v[96:99], v[48:51], v[140:143], v[96:99]
    v_mfma_f32_16x16x32_bf16 v[100:103], v[48:51], v[156:159], v[100:103]
    v_cvt_pk_bf16_f32 v16, v64, v65
    v_cvt_pk_bf16_f32 v17, v66, v67
    v_cvt_pk_bf16_f32 v18, v68, v69
    v_cvt_pk_bf16_f32 v19, v70, v71
    v_cvt_pk_bf16_f32 v20, v72, v73
    v_cvt_pk_bf16_f32 v21, v74, v75
    v_cvt_pk_bf16_f32 v22, v76, v77
    v_cvt_pk_bf16_f32 v23, v78, v79
    v_cvt_pk_bf16_f32 v24, v80, v81
    v_cvt_pk_bf16_f32 v25, v82, v83
    v_cvt_pk_bf16_f32 v26, v84, v85
    v_cvt_pk_bf16_f32 v27, v86, v87
    v_cvt_pk_bf16_f32 v28, v88, v89
    v_cvt_pk_bf16_f32 v29, v90, v91
    v_cvt_pk_bf16_f32 v30, v92, v93
    v_cvt_pk_bf16_f32 v31, v94, v95
    v_cvt_pk_bf16_f32 v52, v96, v97
    v_cvt_pk_bf16_f32 v53, v98, v99
    v_cvt_pk_bf16_f32 v54, v100, v101
    v_cvt_pk_bf16_f32 v55, v102, v103
    s_add_u32 s69, s76, 61440
    buffer_store_dwordx4 v[16:19], v59, s[4:7], s69 offen offset:0 sc1
    s_add_u32 s69, s76, 61440
    buffer_store_dwordx4 v[20:23], v59, s[4:7], s69 offen offset:1024 sc1
    s_add_u32 s69, s76, 61440
    buffer_store_dwordx4 v[24:27], v59, s[4:7], s69 offen offset:2048 sc1
    s_add_u32 s69, s76, 61440
    buffer_store_dwordx4 v[28:31], v59, s[4:7], s69 offen offset:3072 sc1
    s_add_u32 s69, s76, 65536
    buffer_store_dwordx4 v[52:55], v59, s[4:7], s69 offen offset:0 sc1
    v_and_b32 v4, 15, v0
    s_lshl_b32 s74, s73, 5
    v_add_u32 v4, s74, v4
    v_mul_u32_u24 v4, 2560, v4
    v_lshrrev_b32 v5, 4, v0
    v_lshl_add_u32 v4, v5, 3, v4
    v_add_u32 v5, 40960, v4
    s_waitcnt vmcnt(5)
    s_mov_b32 s78, 0x00003f80
    s_mov_b32 s79, 0x3f800000
    v_dot2_f32_bf16 v64, v160, s78, 0
    v_dot2_f32_bf16 v65, v160, s79, 0
    v_dot2_f32_bf16 v66, v161, s78, 0
    v_dot2_f32_bf16 v67, v161, s79, 0
    v_dot2_f32_bf16 v68, v162, s78, 0
    v_dot2_f32_bf16 v69, v162, s79, 0
    v_dot2_f32_bf16 v70, v163, s78, 0
    v_dot2_f32_bf16 v71, v163, s79, 0
    v_dot2_f32_bf16 v64, v164, s78, v64
    v_dot2_f32_bf16 v65, v164, s79, v65
    v_dot2_f32_bf16 v66, v165, s78, v66
    v_dot2_f32_bf16 v67, v165, s79, v67
    v_dot2_f32_bf16 v68, v166, s78, v68
    v_dot2_f32_bf16 v69, v166, s79, v69
    v_dot2_f32_bf16 v70, v167, s78, v70
    v_dot2_f32_bf16 v71, v167, s79, v71
    v_dot2_f32_bf16 v64, v168, s78, v64
    v_dot2_f32_bf16 v65, v168, s79, v65
    v_dot2_f32_bf16 v66, v169, s78, v66
    v_dot2_f32_bf16 v67, v169, s79, v67
    v_dot2_f32_bf16 v68, v170, s78, v68
    v_dot2_f32_bf16 v69, v170, s79, v69
    v_dot2_f32_bf16 v70, v171, s78, v70
    v_dot2_f32_bf16 v71, v171, s79, v71
    v_dot2_f32_bf16 v64, v172, s78, v64
    v_dot2_f32_bf16 v65, v172, s79, v65
    v_dot2_f32_bf16 v66, v173, s78, v66
    v_dot2_f32_bf16 v67, v173, s79, v67
    v_dot2_f32_bf16 v68, v174, s78, v68
    v_dot2_f32_bf16 v69, v174, s79, v69
    v_dot2_f32_bf16 v70, v175, s78, v70
    v_dot2_f32_bf16 v71, v175, s79, v71
    v_dot2_f32_bf16 v64, v176, s78, v64
    v_dot2_f32_bf16 v65, v176, s79, v65
    v_dot2_f32_bf16 v66, v177, s78, v66
    v_dot2_f32_bf16 v67, v177, s79, v67
    v_dot2_f32_bf16 v68, v178, s78, v68
    v_dot2_f32_bf16 v69, v178, s79, v69
    v_dot2_f32_bf16 v70, v179, s78, v70
    v_dot2_f32_bf16 v71, v179, s79, v71
    v_dot2_f32_bf16 v64, v180, s78, v64
    v_dot2_f32_bf16 v65, v180, s79, v65
    v_dot2_f32_bf16 v66, v181, s78, v66
    v_dot2_f32_bf16 v67, v181, s79, v67
    v_dot2_f32_bf16 v68, v182, s78, v68
    v_dot2_f32_bf16 v69, v182, s79, v69
    v_dot2_f32_bf16 v70, v183, s78, v70
    v_dot2_f32_bf16 v71, v183, s79, v71
    v_dot2_f32_bf16 v64, v184, s78, v64
    v_dot2_f32_bf16 v65, v184, s79, v65
    v_dot2_f32_bf16 v66, v185, s78, v66
    v_dot2_f32_bf16 v67, v185, s79, v67
    v_dot2_f32_bf16 v68, v186, s78, v68
    v_dot2_f32_bf16 v69, v186, s79, v69
    v_dot2_f32_bf16 v70, v187, s78, v70
    v_dot2_f32_bf16 v71, v187, s79, v71
    v_dot2_f32_bf16 v64, v188, s78, v64
    v_dot2_f32_bf16 v65, v188, s79, v65
    v_dot2_f32_bf16 v66, v189, s78, v66
    v_dot2_f32_bf16 v67, v189, s79, v67
    v_dot2_f32_bf16 v68, v190, s78, v68
    v_dot2_f32_bf16 v69, v190, s79, v69
    v_dot2_f32_bf16 v70, v191, s78, v70
    v_dot2_f32_bf16 v71, v191, s79, v71
    v_cvt_pk_bf16_f32 v80, v64, v65
    v_cvt_pk_bf16_f32 v81, v66, v67
    v_cvt_pk_bf16_f32 v82, v68, v69
    v_cvt_pk_bf16_f32 v83, v70, v71
    s_cmp_ge_u32 s24, 2
    s_cbranch_scc1 m_fin2_k1
    s_mov_b32 s78, 0x00003f80
    s_mov_b32 s79, 0x3f800000
    v_dot2_f32_bf16 v64, v224, s78, 0
    v_dot2_f32_bf16 v65, v224, s79, 0
    v_dot2_f32_bf16 v66, v225, s78, 0
    v_dot2_f32_bf16 v67, v225, s79, 0
    v_dot2_f32_bf16 v68, v226, s78, 0
    v_dot2_f32_bf16 v69, v226, s79, 0
    v_dot2_f32_bf16 v70, v227, s78, 0
    v_dot2_f32_bf16 v71, v227, s79, 0
    v_dot2_f32_bf16 v64, v228, s78, v64
    v_dot2_f32_bf16 v65, v228, s79, v65
    v_dot2_f32_bf16 v66, v229, s78, v66
    v_dot2_f32_bf16 v67, v229, s79, v67
    v_dot2_f32_bf16 v68, v230, s78, v68
    v_dot2_f32_bf16 v69, v230, s79, v69
    v_dot2_f32_bf16 v70, v231, s78, v70
    v_dot2_f32_bf16 v71, v231, s79, v71
    v_dot2_f32_bf16 v64, v232, s78, v64
    v_dot2_f32_bf16 v65, v232, s79, v65
    v_dot2_f32_bf16 v66, v233, s78, v66
    v_dot2_f32_bf16 v67, v233, s79, v67
    v_dot2_f32_bf16 v68, v234, s78, v68
    v_dot2_f32_bf16 v69, v234, s79, v69
    v_dot2_f32_bf16 v70, v235, s78, v70
    v_dot2_f32_bf16 v71, v235, s79, v71
    v_dot2_f32_bf16 v64, v236, s78, v64
    v_dot2_f32_bf16 v65, v236, s79, v65
    v_dot2_f32_bf16 v66, v237, s78, v66
    v_dot2_f32_bf16 v67, v237, s79, v67
    v_dot2_f32_bf16 v68, v238, s78, v68
    v_dot2_f32_bf16 v69, v238, s79, v69
    v_dot2_f32_bf16 v70, v239, s78, v70
    v_dot2_f32_bf16 v71, v239, s79, v71
    v_dot2_f32_bf16 v64, v240, s78, v64
    v_dot2_f32_bf16 v65, v240, s79, v65
    v_dot2_f32_bf16 v66, v241, s78, v66
    v_dot2_f32_bf16 v67, v241, s79, v67
    v_dot2_f32_bf16 v68, v242, s78, v68
    v_dot2_f32_bf16 v69, v242, s79, v69
    v_dot2_f32_bf16 v70, v243, s78, v70
    v_dot2_f32_bf16 v71, v243, s79, v71
    v_dot2_f32_bf16 v64, v244, s78, v64
    v_dot2_f32_bf16 v65, v244, s79, v65
    v_dot2_f32_bf16 v66, v245, s78, v66
    v_dot2_f32_bf16 v67, v245, s79, v67
    v_dot2_f32_bf16 v68, v246, s78, v68
    v_dot2_f32_bf16 v69, v246, s79, v69
    v_dot2_f32_bf16 v70, v247, s78, v70
    v_dot2_f32_bf16 v71, v247, s79, v71
    v_dot2_f32_bf16 v64, v248, s78, v64
    v_dot2_f32_bf16 v65, v248, s79, v65
    v_dot2_f32_bf16 v66, v249, s78, v66
    v_dot2_f32_bf16 v67, v249, s79, v67
    v_dot2_f32_bf16 v68, v250, s78, v68
    v_dot2_f32_bf16 v69, v250, s79, v69
    v_dot2_f32_bf16 v70, v251, s78, v70
    v_dot2_f32_bf16 v71, v251, s79, v71
    v_dot2_f32_bf16 v64, v252, s78, v64
    v_dot2_f32_bf16 v65, v252, s79, v65
    v_dot2_f32_bf16 v66, v253, s78, v66
    v_dot2_f32_bf16 v67, v253, s79, v67
    v_dot2_f32_bf16 v68, v254, s78, v68
    v_dot2_f32_bf16 v69, v254, s79, v69
    v_dot2_f32_bf16 v70, v255, s78, v70
    v_dot2_f32_bf16 v71, v255, s79, v71
    v_cvt_pk_bf16_f32 v84, v64, v65
    v_cvt_pk_bf16_f32 v85, v66, v67
    v_cvt_pk_bf16_f32 v86, v68, v69
    v_cvt_pk_bf16_f32 v87, v70, v71
m_fin2_k1:
    s_cmp_lg_u32 s24, 7
    s_cbranch_scc1 m_fin2_np1
    s_mov_b32 s72, 0
    v_mbcnt_lo_u32_b32 v57, -1, 0
    v_mbcnt_hi_u32_b32 v57, -1, v57
    v_and_b32 v57, 7, v57
    v_lshlrev_b32 v57, 7, v57
m_fin2_f2:
    buffer_load_dword v56, v57, s[88:91], 0 offen sc1
    s_waitcnt vmcnt(0)
    v_cmp_gt_u32 vcc, 2, v56
    s_add_u32 s72, s72, 1
    s_cmp_ge_u32 s72, 0x40000
    s_cbranch_scc1 m_fin2_f2x
    s_cbranch_vccz m_fin2_f2x
    s_sleep 1
    s_branch m_fin2_f2
m_fin2_f2x:
m_fin2_np1:
    s_waitcnt vmcnt(0)
    s_barrier
    s_cmp_lg_u32 s24, 0
    s_cbranch_scc1 m_fin2_nf3
    s_lshl_b32 s70, s27, 7
    v_mov_b32 v56, 3
    v_mov_b32 v57, s70
    buffer_store_dword v56, v57, s[88:91], 0 offen sc1
m_fin2_nf3:
    s_cmp_eq_u32 s24, 7
    s_cbranch_scc1 m_fin2_a2
    s_cmp_lt_u32 s24, 2
    s_cbranch_scc1 m_fin2_a3
    s_add_u32 s70, s24, 8
    s_mul_i32 s71, s70, 52
    s_lshr_b32 s71, s71, 8
    s_mul_i32 s74, s71, 5
    s_sub_u32 s74, s70, s74
    s_mul_i32 s78, s71, 20480
    s_lshl_b32 s79, s74, 10
    s_add_u32 s78, s78, s79
    s_add_u32 s64, s78, s77
    s_mul_i32 s78, s71, 160
    s_lshl_b32 s79, s74, 5
    s_add_u32 s78, s78, s79
    s_add_u32 s66, s78, s75
    s_add_u32 s62, s64, 0
    buffer_load_dwordx4 v[224:227], v1, s[16:19], s62 offen sc1
    s_add_u32 s62, s64, 163840
    buffer_load_dwordx4 v[228:231], v1, s[16:19], s62 offen sc1
    s_add_u32 s62, s64, 327680
    buffer_load_dwordx4 v[232:235], v1, s[16:19], s62 offen sc1
    s_add_u32 s62, s64, 491520
    buffer_load_dwordx4 v[236:239], v1, s[16:19], s62 offen sc1
    s_add_u32 s62, s64, 655360
    buffer_load_dwordx4 v[240:243], v1, s[16:19], s62 offen sc1
    s_add_u32 s62, s64, 819200
    buffer_load_dwordx4 v[244:247], v1, s[16:19], s62 offen sc1
    s_add_u32 s62, s64, 983040
    buffer_load_dwordx4 v[248:251], v1, s[16:19], s62 offen sc1
    s_add_u32 s62, s64, 1146880
    buffer_load_dwordx4 v[252:255], v1, s[16:19], s62 offen sc1
    s_waitcnt vmcnt(0)
    s_mov_b32 s78, 0x00003f80
    s_mov_b32 s79, 0x3f800000
    v_dot2_f32_bf16 v64, v224, s78, 0
    v_dot2_f32_bf16 v65, v224, s79, 0
    v_dot2_f32_bf16 v66, v225, s78, 0
    v_dot2_f32_bf16 v67, v225, s79, 0
    v_dot2_f32_bf16 v68, v226, s78, 0
    v_dot2_f32_bf16 v69, v226, s79, 0
    v_dot2_f32_bf16 v70, v227, s78, 0
    v_dot2_f32_bf16 v71, v227, s79, 0
    v_dot2_f32_bf16 v64, v228, s78, v64
    v_dot2_f32_bf16 v65, v228, s79, v65
    v_dot2_f32_bf16 v66, v229, s78, v66
    v_dot2_f32_bf16 v67, v229, s79, v67
    v_dot2_f32_bf16 v68, v230, s78, v68
    v_dot2_f32_bf16 v69, v230, s79, v69
    v_dot2_f32_bf16 v70, v231, s78, v70
    v_dot2_f32_bf16 v71, v231, s79, v71
    v_dot2_f32_bf16 v64, v232, s78, v64
    v_dot2_f32_bf16 v65, v232, s79, v65
    v_dot2_f32_bf16 v66, v233, s78, v66
    v_dot2_f32_bf16 v67, v233, s79, v67
    v_dot2_f32_bf16 v68, v234, s78, v68
    v_dot2_f32_bf16 v69, v234, s79, v69
    v_dot2_f32_bf16 v70, v235, s78, v70
    v_dot2_f32_bf16 v71, v235, s79, v71
    v_dot2_f32_bf16 v64, v236, s78, v64
    v_dot2_f32_bf16 v65, v236, s79, v65
    v_dot2_f32_bf16 v66, v237, s78, v66
    v_dot2_f32_bf16 v67, v237, s79, v67
    v_dot2_f32_bf16 v68, v238, s78, v68
    v_dot2_f32_bf16 v69, v238, s79, v69
    v_dot2_f32_bf16 v70, v239, s78, v70
    v_dot2_f32_bf16 v71, v239, s79, v71
    v_dot2_f32_bf16 v64, v240, s78, v64
    v_dot2_f32_bf16 v65, v240, s79, v65
    v_dot2_f32_bf16 v66, v241, s78, v66
    v_dot2_f32_bf16 v67, v241, s79, v67
    v_dot2_f32_bf16 v68, v242, s78, v68
    v_dot2_f32_bf16 v69, v242, s79, v69
    v_dot2_f32_bf16 v70, v243, s78, v70
    v_dot2_f32_bf16 v71, v243, s79, v71
    v_dot2_f32_bf16 v64, v244, s78, v64
    v_dot2_f32_bf16 v65, v244, s79, v65
    v_dot2_f32_bf16 v66, v245, s78, v66
    v_dot2_f32_bf16 v67, v245, s79, v67
    v_dot2_f32_bf16 v68, v246, s78, v68
    v_dot2_f32_bf16 v69, v246, s79, v69
    v_dot2_f32_bf16 v70, v247, s78, v70
    v_dot2_f32_bf16 v71, v247, s79, v71
    v_dot2_f32_bf16 v64, v248, s78, v64
    v_dot2_f32_bf16 v65, v248, s79, v65
    v_dot2_f32_bf16 v66, v249, s78, v66
    v_dot2_f32_bf16 v67, v249, s79, v67
    v_dot2_f32_bf16 v68, v250, s78, v68
    v_dot2_f32_bf16 v69, v250, s79, v69
    v_dot2_f32_bf16 v70, v251, s78, v70
    v_dot2_f32_bf16 v71, v251, s79, v71
    v_dot2_f32_bf16 v64, v252, s78, v64
    v_dot2_f32_bf16 v65, v252, s79, v65
    v_dot2_f32_bf16 v66, v253, s78, v66
    v_dot2_f32_bf16 v67, v253, s79, v67
    v_dot2_f32_bf16 v68, v254, s78, v68
    v_dot2_f32_bf16 v69, v254, s79, v69
    v_dot2_f32_bf16 v70, v255, s78, v70
    v_dot2_f32_bf16 v71, v255, s79, v71
    v_cvt_pk_bf16_f32 v84, v64, v65
    v_cvt_pk_bf16_f32 v85, v66, v67
    v_cvt_pk_bf16_f32 v86, v68, v69
    v_cvt_pk_bf16_f32 v87, v70, v71
    s_branch m_fin2_a3
m_fin2_a2:
    s_mov_b32 s72, 0
    v_mbcnt_lo_u32_b32 v57, -1, 0
    v_mbcnt_hi_u32_b32 v57, -1, v57
    v_and_b32 v57, 7, v57
    v_lshlrev_b32 v57, 7, v57
m_fin2_f3:
    buffer_load_dword v56, v57, s[88:91], 0 offen sc1
    s_waitcnt vmcnt(0)
    v_cmp_gt_u32 vcc, 3, v56
    s_add_u32 s72, s72, 1
    s_cmp_ge_u32 s72, 0x40000
    s_cbranch_scc1 m_fin2_f3x
    s_cbranch_vccz m_fin2_f3x
    s_sleep 1
    s_branch m_fin2_f3
m_fin2_f3x:
m_fin2_a3:
    s_barrier
    s_cmp_lt_u32 s24, 3
    s_cbranch_scc1 m_fin2_b0
    s_sub_u32 s70, 22, s24
    s_mul_i32 s71, s70, 52
    s_lshr_b32 s71, s71, 8
    s_mul_i32 s74, s71, 5
    s_sub_u32 s74, s70, s74
    s_mul_i32 s78, s71, 20480
    s_lshl_b32 s79, s74, 10
    s_add_u32 s78, s78, s79
    s_add_u32 s64, s78, s77
    s_mul_i32 s78, s71, 160
    s_lshl_b32 s79, s74, 5
    s_add_u32 s78, s78, s79
    s_add_u32 s67, s78, s75
    s_add_u32 s62, s64, 0
    buffer_load_dwordx4 v[128:131], v1, s[16:19], s62 offen sc1
    s_add_u32 s62, s64, 163840
    buffer_load_dwordx4 v[132:135], v1, s[16:19], s62 offen sc1
    s_add_u32 s62, s64, 327680
    buffer_load_dwordx4 v[136:139], v1, s[16:19], s62 offen sc1
    s_add_u32 s62, s64, 491520
    buffer_load_dwordx4 v[140:143], v1, s[16:19], s62 offen sc1
    s_add_u32 s62, s64, 655360
    buffer_load_dwordx4 v[144:147], v1, s[16:19], s62 offen sc1
    s_add_u32 s62, s64, 819200
    buffer_load_dwordx4 v[148:151], v1, s[16:19], s62 offen sc1
    s_add_u32 s62, s64, 983040
    buffer_load_dwordx4 v[152:155], v1, s[16:19], s62 offen sc1
    s_add_u32 s62, s64, 1146880
    buffer_load_dwordx4 v[156:159], v1, s[16:19], s62 offen sc1
    s_waitcnt vmcnt(0)
    s_mov_b32 s78, 0x00003f80
    s_mov_b32 s79, 0x3f800000
    v_dot2_f32_bf16 v64, v128, s78, 0
    v_dot2_f32_bf16 v65, v128, s79, 0
    v_dot2_f32_bf16 v66, v129, s78, 0
    v_dot2_f32_bf16 v67, v129, s79, 0
    v_dot2_f32_bf16 v68, v130, s78, 0
    v_dot2_f32_bf16 v69, v130, s79, 0
    v_dot2_f32_bf16 v70, v131, s78, 0
    v_dot2_f32_bf16 v71, v131, s79, 0
    v_dot2_f32_bf16 v64, v132, s78, v64
    v_dot2_f32_bf16 v65, v132, s79, v65
    v_dot2_f32_bf16 v66, v133, s78, v66
    v_dot2_f32_bf16 v67, v133, s79, v67
    v_dot2_f32_bf16 v68, v134, s78, v68
    v_dot2_f32_bf16 v69, v134, s79, v69
    v_dot2_f32_bf16 v70, v135, s78, v70
    v_dot2_f32_bf16 v71, v135, s79, v71
    v_dot2_f32_bf16 v64, v136, s78, v64
    v_dot2_f32_bf16 v65, v136, s79, v65
    v_dot2_f32_bf16 v66, v137, s78, v66
    v_dot2_f32_bf16 v67, v137, s79, v67
    v_dot2_f32_bf16 v68, v138, s78, v68
    v_dot2_f32_bf16 v69, v138, s79, v69
    v_dot2_f32_bf16 v70, v139, s78, v70
    v_dot2_f32_bf16 v71, v139, s79, v71
    v_dot2_f32_bf16 v64, v140, s78, v64
    v_dot2_f32_bf16 v65, v140, s79, v65
    v_dot2_f32_bf16 v66, v141, s78, v66
    v_dot2_f32_bf16 v67, v141, s79, v67
    v_dot2_f32_bf16 v68, v142, s78, v68
    v_dot2_f32_bf16 v69, v142, s79, v69
    v_dot2_f32_bf16 v70, v143, s78, v70
    v_dot2_f32_bf16 v71, v143, s79, v71
    v_dot2_f32_bf16 v64, v144, s78, v64
    v_dot2_f32_bf16 v65, v144, s79, v65
    v_dot2_f32_bf16 v66, v145, s78, v66
    v_dot2_f32_bf16 v67, v145, s79, v67
    v_dot2_f32_bf16 v68, v146, s78, v68
    v_dot2_f32_bf16 v69, v146, s79, v69
    v_dot2_f32_bf16 v70, v147, s78, v70
    v_dot2_f32_bf16 v71, v147, s79, v71
    v_dot2_f32_bf16 v64, v148, s78, v64
    v_dot2_f32_bf16 v65, v148, s79, v65
    v_dot2_f32_bf16 v66, v149, s78, v66
    v_dot2_f32_bf16 v67, v149, s79, v67
    v_dot2_f32_bf16 v68, v150, s78, v68
    v_dot2_f32_bf16 v69, v150, s79, v69
    v_dot2_f32_bf16 v70, v151, s78, v70
    v_dot2_f32_bf16 v71, v151, s79, v71
    v_dot2_f32_bf16 v64, v152, s78, v64
    v_dot2_f32_bf16 v65, v152, s79, v65
    v_dot2_f32_bf16 v66, v153, s78, v66
    v_dot2_f32_bf16 v67, v153, s79, v67
    v_dot2_f32_bf16 v68, v154, s78, v68
    v_dot2_f32_bf16 v69, v154, s79, v69
    v_dot2_f32_bf16 v70, v155, s78, v70
    v_dot2_f32_bf16 v71, v155, s79, v71
    v_dot2_f32_bf16 v64, v156, s78, v64
    v_dot2_f32_bf16 v65, v156, s79, v65
    v_dot2_f32_bf16 v66, v157, s78, v66
    v_dot2_f32_bf16 v67, v157, s79, v67
    v_dot2_f32_bf16 v68, v158, s78, v68
    v_dot2_f32_bf16 v69, v158, s79, v69
    v_dot2_f32_bf16 v70, v159, s78, v70
    v_dot2_f32_bf16 v71, v159, s79, v71
    v_cvt_pk_bf16_f32 v88, v64, v65
    v_cvt_pk_bf16_f32 v89, v66, v67
    v_cvt_pk_bf16_f32 v90, v68, v69
    v_cvt_pk_bf16_f32 v91, v70, v71
m_fin2_b0:
    buffer_store_dwordx2 v[80:81], v4, s[8:11], s65 offen
    s_cmp_eq_u32 s73, 3
    s_cbranch_scc1 m_fin2_s0
    buffer_store_dwordx2 v[82:83], v5, s[8:11], s65 offen
m_fin2_s0:
    s_cmp_eq_u32 s24, 7
    s_cbranch_scc1 m_fin2_s1
    buffer_store_dwordx2 v[84:85], v4, s[8:11], s66 offen
    s_cmp_eq_u32 s73, 3
    s_cbranch_scc1 m_fin2_s1
    buffer_store_dwordx2 v[86:87], v5, s[8:11], s66 offen
m_fin2_s1:
    s_cmp_lt_u32 s24, 3
    s_cbranch_scc1 m_fin2_end
    buffer_store_dwordx2 v[88:89], v4, s[8:11], s67 offen
    s_cmp_eq_u32 s73, 3
    s_cbranch_scc1 m_fin2_s2
    buffer_store_dwordx2 v[90:91], v5, s[8:11], s67 offen
m_fin2_s2:
m_fin2_end:
    s_endpgm
m_a1:
    ds_read_b128 v[96:99], v0 offset:0
    ds_read_b128 v[100:103], v1 offset:0
    ds_read_b128 v[104:107], v2 offset:0
    ds_read_b128 v[108:111], v3 offset:0
    ds_read_b128 v[112:115], v0 offset:4096
    ds_read_b128 v[116:119], v1 offset:4096
    ds_read_b128 v[120:123], v2 offset:4096
    ds_read_b128 v[124:127], v3 offset:4096
    s_setprio 2
    s_mov_b32 s28, s24
    s_mov_b32 s65, 1149239296
    s_mov_b32 s29, 0
    s_mov_b32 s63, 0
    s_mov_b32 s85, 106496
    s_waitcnt lgkmcnt(0)
    s_waitcnt vmcnt(3)
m_a1_loop:
    v_add_u32 v12, s85, v13
    s_barrier
    ds_read_b128 v[64:67], v12 offset:0
    ds_read_b128 v[68:71], v12 offset:1024
    ds_read_b128 v[72:75], v12 offset:2048
    ds_read_b128 v[76:79], v12 offset:3072
    s_waitcnt lgkmcnt(0)
    s_cmp_ge_u32 s29, 1
    s_cbranch_scc0 m_a1_nopark
    ds_write_b128 v12, v[128:131] offset:0
    ds_write_b128 v12, v[132:135] offset:1024
    ds_write_b128 v12, v[136:139] offset:2048
    ds_write_b128 v12, v[140:143] offset:3072
    s_waitcnt lgkmcnt(0)
m_a1_nopark:
    v_mfma_f32_16x16x32_bf16 v[48:51], v[96:99], v[64:67], 0
    ds_read_b64_tr_b16 v[128:129], v4 offset:8192
    ds_read_b64_tr_b16 v[130:131], v4 offset:12288
    v_mfma_f32_16x16x32_bf16 v[48:51], v[100:103], v[68:71], v[48:51]
    ds_read_b64_tr_b16 v[132:133], v5 offset:8192
    ds_read_b64_tr_b16 v[134:135], v5 offset:12288
    v_mfma_f32_16x16x32_bf16 v[48:51], v[104:107], v[72:75], v[48:51]
    ds_read_b64_tr_b16 v[136:137], v6 offset:8192
    ds_read_b64_tr_b16 v[138:139], v6 offset:12288
    v_mfma_f32_16x16x32_bf16 v[48:51], v[108:111], v[76:79], v[48:51]
    ds_read_b64_tr_b16 v[140:141], v7 offset:8192
    ds_read_b64_tr_b16 v[142:143], v7 offset:12288
    v_mfma_f32_16x16x32_bf16 v[56:59], v[112:115], v[64:67], 0
    ds_read_b64_tr_b16 v[144:145], v8 offset:8192
    ds_read_b64_tr_b16 v[146:147], v8 offset:12288
    v_mfma_f32_16x16x32_bf16 v[56:59], v[116:119], v[68:71], v[56:59]
    ds_read_b64_tr_b16 v[148:149], v9 offset:8192
    ds_read_b64_tr_b16 v[150:151], v9 offset:12288
    v_mfma_f32_16x16x32_bf16 v[56:59], v[120:123], v[72:75], v[56:59]
    ds_read_b64_tr_b16 v[152:153], v10 offset:8192
    ds_read_b64_tr_b16 v[154:155], v10 offset:12288
    v_mfma_f32_16x16x32_bf16 v[56:59], v[124:127], v[76:79], v[56:59]
    s_waitcnt lgkmcnt(12)
    ds_read_b64_tr_b16 v[156:157], v11 offset:8192
    ds_read_b64_tr_b16 v[158:159], v11 offset:12288
    v_max3_f32 v20, v48, v49, v50
    s_nop 3
    v_max3_f32 v22, v56, v57, v58
    v_max3_f32 v20, v20, v51, v59
    v_max_f32 v20, v20, v22
    v_mov_b32 v22, v20
    s_nop 1
    v_permlane16_swap_b32 v20, v22
    v_max_f32 v20, v20, v22
    v_mov_b32 v22, v20
    s_nop 1
    v_permlane32_swap_b32 v20, v22
    v_max_f32 v20, v20, v22
    v_sub_f32 v32, 0, v20
    v_sub_f32 v33, 0, v20
    v_sub_f32 v34, 0, v20
    v_sub_f32 v35, 0, v20
    v_sub_f32 v48, v48, v20
    v_sub_f32 v49, v49, v20
    v_sub_f32 v50, v50, v20
    v_sub_f32 v51, v51, v20
    v_sub_f32 v56, v56, v20
    v_sub_f32 v57, v57, v20
    v_sub_f32 v58, v58, v20
    v_sub_f32 v59, v59, v20
    v_exp_f32 v24, v48
    v_exp_f32 v25, v49
    v_exp_f32 v26, v50
    v_exp_f32 v27, v51
    v_exp_f32 v28, v56
    v_exp_f32 v29, v57
    v_exp_f32 v30, v58
    v_exp_f32 v31, v59
    v_cvt_pk_bf16_f32 v40, v24, v25
    v_cvt_pk_bf16_f32 v41, v26, v27
    v_cvt_pk_bf16_f32 v42, v28, v29
    v_cvt_pk_bf16_f32 v43, v30, v31
    v_add_f32 v24, v24, v25
    v_add_f32 v26, v26, v27
    v_add_f32 v28, v28, v29
    v_add_f32 v30, v30, v31
    v_add_f32 v24, v24, v26
    v_add_f32 v28, v28, v30
    v_add_f32 v18, v24, v28
    v_mov_b32 v16, v18
    s_waitcnt lgkmcnt(0)
    v_mfma_f32_16x16x32_bf16 v[160:163], v[128:131], v[40:43], 0
    ds_read_b128 v[96:99], v0 offset:16384
    ds_read_b128 v[100:103], v1 offset:16384
    v_mfma_f32_16x16x32_bf16 v[168:171], v[132:135], v[40:43], 0
    ds_read_b128 v[104:107], v2 offset:16384
    ds_read_b128 v[108:111], v3 offset:16384
    v_mfma_f32_16x16x32_bf16 v[176:179], v[136:139], v[40:43], 0
    ds_read_b128 v[112:115], v0 offset:20480
    ds_read_b128 v[116:119], v1 offset:20480
    v_mfma_f32_16x16x32_bf16 v[184:187], v[140:143], v[40:43], 0
    ds_read_b128 v[120:123], v2 offset:20480
    ds_read_b128 v[124:127], v3 offset:20480
    v_mfma_f32_16x16x32_bf16 v[192:195], v[144:147], v[40:43], 0
    v_mfma_f32_16x16x32_bf16 v[200:203], v[148:151], v[40:43], 0
    v_mfma_f32_16x16x32_bf16 v[208:211], v[152:155], v[40:43], 0
    v_mfma_f32_16x16x32_bf16 v[216:219], v[156:159], v[40:43], 0
    s_waitcnt lgkmcnt(0)
    s_waitcnt vmcnt(0)
    s_barrier
    v_mfma_f32_16x16x32_bf16 v[48:51], v[96:99], v[64:67], v[32:35]
    ds_read_b64_tr_b16 v[128:129], v4 offset:24576
    ds_read_b64_tr_b16 v[130:131], v4 offset:28672
    v_mfma_f32_16x16x32_bf16 v[48:51], v[100:103], v[68:71], v[48:51]
    ds_read_b64_tr_b16 v[132:133], v5 offset:24576
    ds_read_b64_tr_b16 v[134:135], v5 offset:28672
    v_mfma_f32_16x16x32_bf16 v[48:51], v[104:107], v[72:75], v[48:51]
    ds_read_b64_tr_b16 v[136:137], v6 offset:24576
    ds_read_b64_tr_b16 v[138:139], v6 offset:28672
    v_mfma_f32_16x16x32_bf16 v[48:51], v[108:111], v[76:79], v[48:51]
    ds_read_b64_tr_b16 v[140:141], v7 offset:24576
    ds_read_b64_tr_b16 v[142:143], v7 offset:28672
    v_mfma_f32_16x16x32_bf16 v[56:59], v[112:115], v[64:67], v[32:35]
    ds_read_b64_tr_b16 v[144:145], v8 offset:24576
    ds_read_b64_tr_b16 v[146:147], v8 offset:28672
    v_mfma_f32_16x16x32_bf16 v[56:59], v[116:119], v[68:71], v[56:59]
    ds_read_b64_tr_b16 v[148:149], v9 offset:24576
    ds_read_b64_tr_b16 v[150:151], v9 offset:28672
    v_mfma_f32_16x16x32_bf16 v[56:59], v[120:123], v[72:75], v[56:59]
    ds_read_b64_tr_b16 v[152:153], v10 offset:24576
    ds_read_b64_tr_b16 v[154:155], v10 offset:28672
    v_mfma_f32_16x16x32_bf16 v[56:59], v[124:127], v[76:79], v[56:59]
    s_waitcnt lgkmcnt(12)
    ds_read_b64_tr_b16 v[156:157], v11 offset:24576
    ds_read_b64_tr_b16 v[158:159], v11 offset:28672
    v_exp_f32 v24, v48
    v_exp_f32 v25, v49
    v_exp_f32 v26, v50
    v_exp_f32 v27, v51
    s_nop 0
    v_exp_f32 v28, v56
    v_exp_f32 v29, v57
    v_exp_f32 v30, v58
    v_exp_f32 v31, v59
    v_cvt_pk_bf16_f32 v40, v24, v25
    v_cvt_pk_bf16_f32 v41, v26, v27
    v_cvt_pk_bf16_f32 v42, v28, v29
    v_cvt_pk_bf16_f32 v43, v30, v31
    v_add_f32 v24, v24, v25
    v_add_f32 v26, v26, v27
    v_add_f32 v28, v28, v29
    v_add_f32 v30, v30, v31
    v_add_f32 v24, v24, v26
    v_add_f32 v28, v28, v30
    v_add_f32 v18, v24, v28
    v_cmp_lt_f32 vcc, s65, v18
    s_cbranch_vccnz m_a1_c1_0_slow
m_a1_c1_0_back:
    v_add_f32 v16, v16, v18
    s_waitcnt lgkmcnt(0)
    v_mfma_f32_16x16x32_bf16 v[160:163], v[128:131], v[40:43], v[160:163]
    ds_read_b128 v[96:99], v0 offset:32768
    ds_read_b128 v[100:103], v1 offset:32768
    v_mfma_f32_16x16x32_bf16 v[168:171], v[132:135], v[40:43], v[168:171]
    ds_read_b128 v[104:107], v2 offset:32768
    ds_read_b128 v[108:111], v3 offset:32768
    v_mfma_f32_16x16x32_bf16 v[176:179], v[136:139], v[40:43], v[176:179]
    ds_read_b128 v[112:115], v0 offset:36864
    ds_read_b128 v[116:119], v1 offset:36864
    v_mfma_f32_16x16x32_bf16 v[184:187], v[140:143], v[40:43], v[184:187]
    ds_read_b128 v[120:123], v2 offset:36864
    ds_read_b128 v[124:127], v3 offset:36864
    v_mfma_f32_16x16x32_bf16 v[192:195], v[144:147], v[40:43], v[192:195]
    v_mfma_f32_16x16x32_bf16 v[200:203], v[148:151], v[40:43], v[200:203]
    v_mfma_f32_16x16x32_bf16 v[208:211], v[152:155], v[40:43], v[208:211]
    v_mfma_f32_16x16x32_bf16 v[216:219], v[156:159], v[40:43], v[216:219]
    s_waitcnt lgkmcnt(0)
    s_barrier
    v_mfma_f32_16x16x32_bf16 v[48:51], v[96:99], v[64:67], v[32:35]
    ds_read_b64_tr_b16 v[128:129], v4 offset:40960
    ds_read_b64_tr_b16 v[130:131], v4 offset:45056
    v_mfma_f32_16x16x32_bf16 v[48:51], v[100:103], v[68:71], v[48:51]
    ds_read_b64_tr_b16 v[132:133], v5 offset:40960
    ds_read_b64_tr_b16 v[134:135], v5 offset:45056
    v_mfma_f32_16x16x32_bf16 v[48:51], v[104:107], v[72:75], v[48:51]
    ds_read_b64_tr_b16 v[136:137], v6 offset:40960
    ds_read_b64_tr_b16 v[138:139], v6 offset:45056
    v_mfma_f32_16x16x32_bf16 v[48:51], v[108:111], v[76:79], v[48:51]
    ds_read_b64_tr_b16 v[140:141], v7 offset:40960
    ds_read_b64_tr_b16 v[142:143], v7 offset:45056
    v_mfma_f32_16x16x32_bf16 v[56:59], v[112:115], v[64:67], v[32:35]
    ds_read_b64_tr_b16 v[144:145], v8 offset:40960
    ds_read_b64_tr_b16 v[146:147], v8 offset:45056
    v_mfma_f32_16x16x32_bf16 v[56:59], v[116:119], v[68:71], v[56:59]
    ds_read_b64_tr_b16 v[148:149], v9 offset:40960
    ds_read_b64_tr_b16 v[150:151], v9 offset:45056
    v_mfma_f32_16x16x32_bf16 v[56:59], v[120:123], v[72:75], v[56:59]
    ds_read_b64_tr_b16 v[152:153], v10 offset:40960
    ds_read_b64_tr_b16 v[154:155], v10 offset:45056
    v_mfma_f32_16x16x32_bf16 v[56:59], v[124:127], v[76:79], v[56:59]
    s_waitcnt lgkmcnt(12)
    ds_read_b64_tr_b16 v[156:157], v11 offset:40960
    ds_read_b64_tr_b16 v[158:159], v11 offset:45056
    v_exp_f32 v24, v48
    v_exp_f32 v25, v49
    v_exp_f32 v26, v50
    v_exp_f32 v27, v51
    s_nop 0
    v_exp_f32 v28, v56
    v_exp_f32 v29, v57
    v_exp_f32 v30, v58
    v_exp_f32 v31, v59
    v_cvt_pk_bf16_f32 v40, v24, v25
    v_cvt_pk_bf16_f32 v41, v26, v27
    v_cvt_pk_bf16_f32 v42, v28, v29
    v_cvt_pk_bf16_f32 v43, v30, v31
    v_add_f32 v24, v24, v25
    v_add_f32 v26, v26, v27
    v_add_f32 v28, v28, v29
    v_add_f32 v30, v30, v31
    v_add_f32 v24, v24, v26
    v_add_f32 v28, v28, v30
    v_add_f32 v18, v24, v28
    v_cmp_lt_f32 vcc, s65, v18
    s_cbranch_vccnz m_a1_c2_0_slow
m_a1_c2_0_back:
    v_add_f32 v16, v16, v18
    s_waitcnt lgkmcnt(0)
    v_mfma_f32_16x16x32_bf16 v[160:163], v[128:131], v[40:43], v[160:163]
    ds_read_b128 v[96:99], v0 offset:49152
    ds_read_b128 v[100:103], v1 offset:49152
    v_mfma_f32_16x16x32_bf16 v[168:171], v[132:135], v[40:43], v[168:171]
    ds_read_b128 v[104:107], v2 offset:49152
    ds_read_b128 v[108:111], v3 offset:49152
    v_mfma_f32_16x16x32_bf16 v[176:179], v[136:139], v[40:43], v[176:179]
    ds_read_b128 v[112:115], v0 offset:53248
    ds_read_b128 v[116:119], v1 offset:53248
    v_mfma_f32_16x16x32_bf16 v[184:187], v[140:143], v[40:43], v[184:187]
    ds_read_b128 v[120:123], v2 offset:53248
    ds_read_b128 v[124:127], v3 offset:53248
    v_mfma_f32_16x16x32_bf16 v[192:195], v[144:147], v[40:43], v[192:195]
    v_mfma_f32_16x16x32_bf16 v[200:203], v[148:151], v[40:43], v[200:203]
    v_mfma_f32_16x16x32_bf16 v[208:211], v[152:155], v[40:43], v[208:211]
    v_mfma_f32_16x16x32_bf16 v[216:219], v[156:159], v[40:43], v[216:219]
    s_waitcnt lgkmcnt(0)
    s_barrier
    v_mfma_f32_16x16x32_bf16 v[48:51], v[96:99], v[64:67], v[32:35]
    ds_read_b64_tr_b16 v[128:129], v4 offset:57344
    ds_read_b64_tr_b16 v[130:131], v4 offset:61440
    v_mfma_f32_16x16x32_bf16 v[48:51], v[100:103], v[68:71], v[48:51]
    ds_read_b64_tr_b16 v[132:133], v5 offset:57344
    ds_read_b64_tr_b16 v[134:135], v5 offset:61440
    v_mfma_f32_16x16x32_bf16 v[48:51], v[104:107], v[72:75], v[48:51]
    ds_read_b64_tr_b16 v[136:137], v6 offset:57344
    ds_read_b64_tr_b16 v[138:139], v6 offset:61440
    v_mfma_f32_16x16x32_bf16 v[48:51], v[108:111], v[76:79], v[48:51]
    ds_read_b64_tr_b16 v[140:141], v7 offset:57344
    ds_read_b64_tr_b16 v[142:143], v7 offset:61440
    v_mfma_f32_16x16x32_bf16 v[56:59], v[112:115], v[64:67], v[32:35]
    ds_read_b64_tr_b16 v[144:145], v8 offset:57344
    ds_read_b64_tr_b16 v[146:147], v8 offset:61440
    v_mfma_f32_16x16x32_bf16 v[56:59], v[116:119], v[68:71], v[56:59]
    ds_read_b64_tr_b16 v[148:149], v9 offset:57344
    ds_read_b64_tr_b16 v[150:151], v9 offset:61440
    v_mfma_f32_16x16x32_bf16 v[56:59], v[120:123], v[72:75], v[56:59]
    ds_read_b64_tr_b16 v[152:153], v10 offset:57344
    ds_read_b64_tr_b16 v[154:155], v10 offset:61440
    v_mfma_f32_16x16x32_bf16 v[56:59], v[124:127], v[76:79], v[56:59]
    s_waitcnt lgkmcnt(12)
    ds_read_b64_tr_b16 v[156:157], v11 offset:57344
    ds_read_b64_tr_b16 v[158:159], v11 offset:61440
    v_exp_f32 v24, v48
    v_exp_f32 v25, v49
    v_exp_f32 v26, v50
    v_exp_f32 v27, v51
    s_nop 0
    v_exp_f32 v28, v56
    v_exp_f32 v29, v57
    v_exp_f32 v30, v58
    v_exp_f32 v31, v59
    v_cvt_pk_bf16_f32 v40, v24, v25
    v_cvt_pk_bf16_f32 v41, v26, v27
    v_cvt_pk_bf16_f32 v42, v28, v29
    v_cvt_pk_bf16_f32 v43, v30, v31
    v_add_f32 v24, v24, v25
    v_add_f32 v26, v26, v27
    v_add_f32 v28, v28, v29
    v_add_f32 v30, v30, v31
    v_add_f32 v24, v24, v26
    v_add_f32 v28, v28, v30
    v_add_f32 v18, v24, v28
    v_cmp_lt_f32 vcc, s65, v18
    s_cbranch_vccnz m_a1_c3_0_slow
m_a1_c3_0_back:
    v_add_f32 v16, v16, v18
    s_waitcnt lgkmcnt(0)
    v_mfma_f32_16x16x32_bf16 v[160:163], v[128:131], v[40:43], v[160:163]
    ds_read_b128 v[96:99], v0 offset:0
    ds_read_b128 v[100:103], v1 offset:0
    v_mfma_f32_16x16x32_bf16 v[168:171], v[132:135], v[40:43], v[168:171]
    ds_read_b128 v[104:107], v2 offset:0
    ds_read_b128 v[108:111], v3 offset:0
    v_mfma_f32_16x16x32_bf16 v[176:179], v[136:139], v[40:43], v[176:179]
    ds_read_b128 v[112:115], v0 offset:4096
    ds_read_b128 v[116:119], v1 offset:4096
    v_mfma_f32_16x16x32_bf16 v[184:187], v[140:143], v[40:43], v[184:187]
    ds_read_b128 v[120:123], v2 offset:4096
    ds_read_b128 v[124:127], v3 offset:4096
    v_mfma_f32_16x16x32_bf16 v[192:195], v[144:147], v[40:43], v[192:195]
    v_mfma_f32_16x16x32_bf16 v[200:203], v[148:151], v[40:43], v[200:203]
    v_mfma_f32_16x16x32_bf16 v[208:211], v[152:155], v[40:43], v[208:211]
    v_mfma_f32_16x16x32_bf16 v[216:219], v[156:159], v[40:43], v[216:219]
    s_waitcnt lgkmcnt(0)
    s_barrier
    v_mfma_f32_16x16x32_bf16 v[48:51], v[96:99], v[64:67], v[32:35]
    ds_read_b64_tr_b16 v[128:129], v4 offset:8192
    ds_read_b64_tr_b16 v[130:131], v4 offset:12288
    v_mfma_f32_16x16x32_bf16 v[48:51], v[100:103], v[68:71], v[48:51]
    ds_read_b64_tr_b16 v[132:133], v5 offset:8192
    ds_read_b64_tr_b16 v[134:135], v5 offset:12288
    v_mfma_f32_16x16x32_bf16 v[48:51], v[104:107], v[72:75], v[48:51]
    ds_read_b64_tr_b16 v[136:137], v6 offset:8192
    ds_read_b64_tr_b16 v[138:139], v6 offset:12288
    v_mfma_f32_16x16x32_bf16 v[48:51], v[108:111], v[76:79], v[48:51]
    ds_read_b64_tr_b16 v[140:141], v7 offset:8192
    ds_read_b64_tr_b16 v[142:143], v7 offset:12288
    v_mfma_f32_16x16x32_bf16 v[56:59], v[112:115], v[64:67], v[32:35]
    ds_read_b64_tr_b16 v[144:145], v8 offset:8192
    ds_read_b64_tr_b16 v[146:147], v8 offset:12288
    v_mfma_f32_16x16x32_bf16 v[56:59], v[116:119], v[68:71], v[56:59]
    ds_read_b64_tr_b16 v[148:149], v9 offset:8192
    ds_read_b64_tr_b16 v[150:151], v9 offset:12288
    v_mfma_f32_16x16x32_bf16 v[56:59], v[120:123], v[72:75], v[56:59]
    ds_read_b64_tr_b16 v[152:153], v10 offset:8192
    ds_read_b64_tr_b16 v[154:155], v10 offset:12288
    v_mfma_f32_16x16x32_bf16 v[56:59], v[124:127], v[76:79], v[56:59]
    s_waitcnt lgkmcnt(12)
    ds_read_b64_tr_b16 v[156:157], v11 offset:8192
    ds_read_b64_tr_b16 v[158:159], v11 offset:12288
    v_exp_f32 v24, v48
    v_exp_f32 v25, v49
    v_exp_f32 v26, v50
    v_exp_f32 v27, v51
    s_nop 0
    v_exp_f32 v28, v56
    v_exp_f32 v29, v57
    v_exp_f32 v30, v58
    v_exp_f32 v31, v59
    v_cvt_pk_bf16_f32 v40, v24, v25
    v_cvt_pk_bf16_f32 v41, v26, v27
    v_cvt_pk_bf16_f32 v42, v28, v29
    v_cvt_pk_bf16_f32 v43, v30, v31
    v_add_f32 v24, v24, v25
    v_add_f32 v26, v26, v27
    v_add_f32 v28, v28, v29
    v_add_f32 v30, v30, v31
    v_add_f32 v24, v24, v26
    v_add_f32 v28, v28, v30
    v_add_f32 v18, v24, v28
    v_cmp_lt_f32 vcc, s65, v18
    s_cbranch_vccnz m_a1_c4_0_slow
m_a1_c4_0_back:
    v_add_f32 v16, v16, v18
    s_waitcnt lgkmcnt(0)
    v_mfma_f32_16x16x32_bf16 v[160:163], v[128:131], v[40:43], v[160:163]
    ds_read_b128 v[96:99], v0 offset:16384
    ds_read_b128 v[100:103], v1 offset:16384
    v_mfma_f32_16x16x32_bf16 v[168:171], v[132:135], v[40:43], v[168:171]
    ds_read_b128 v[104:107], v2 offset:16384
    ds_read_b128 v[108:111], v3 offset:16384
    v_mfma_f32_16x16x32_bf16 v[176:179], v[136:139], v[40:43], v[176:179]
    ds_read_b128 v[112:115], v0 offset:20480
    ds_read_b128 v[116:119], v1 offset:20480
    v_mfma_f32_16x16x32_bf16 v[184:187], v[140:143], v[40:43], v[184:187]
    ds_read_b128 v[120:123], v2 offset:20480
    ds_read_b128 v[124:127], v3 offset:20480
    v_mfma_f32_16x16x32_bf16 v[192:195], v[144:147], v[40:43], v[192:195]
    v_mfma_f32_16x16x32_bf16 v[200:203], v[148:151], v[40:43], v[200:203]
    v_mfma_f32_16x16x32_bf16 v[208:211], v[152:155], v[40:43], v[208:211]
    v_mfma_f32_16x16x32_bf16 v[216:219], v[156:159], v[40:43], v[216:219]
    s_waitcnt lgkmcnt(0)
    s_barrier
    v_mfma_f32_16x16x32_bf16 v[48:51], v[96:99], v[64:67], v[32:35]
    ds_read_b64_tr_b16 v[128:129], v4 offset:24576
    ds_read_b64_tr_b16 v[130:131], v4 offset:28672
    v_mfma_f32_16x16x32_bf16 v[48:51], v[100:103], v[68:71], v[48:51]
    ds_read_b64_tr_b16 v[132:133], v5 offset:24576
    ds_read_b64_tr_b16 v[134:135], v5 offset:28672
    v_mfma_f32_16x16x32_bf16 v[48:51], v[104:107], v[72:75], v[48:51]
    ds_read_b64_tr_b16 v[136:137], v6 offset:24576
    ds_read_b64_tr_b16 v[138:139], v6 offset:28672
    v_mfma_f32_16x16x32_bf16 v[48:51], v[108:111], v[76:79], v[48:51]
    ds_read_b64_tr_b16 v[140:141], v7 offset:24576
    ds_read_b64_tr_b16 v[142:143], v7 offset:28672
    v_mfma_f32_16x16x32_bf16 v[56:59], v[112:115], v[64:67], v[32:35]
    ds_read_b64_tr_b16 v[144:145], v8 offset:24576
    ds_read_b64_tr_b16 v[146:147], v8 offset:28672
    v_mfma_f32_16x16x32_bf16 v[56:59], v[116:119], v[68:71], v[56:59]
    ds_read_b64_tr_b16 v[148:149], v9 offset:24576
    ds_read_b64_tr_b16 v[150:151], v9 offset:28672
    v_mfma_f32_16x16x32_bf16 v[56:59], v[120:123], v[72:75], v[56:59]
    ds_read_b64_tr_b16 v[152:153], v10 offset:24576
    ds_read_b64_tr_b16 v[154:155], v10 offset:28672
    v_mfma_f32_16x16x32_bf16 v[56:59], v[124:127], v[76:79], v[56:59]
    s_waitcnt lgkmcnt(12)
    ds_read_b64_tr_b16 v[156:157], v11 offset:24576
    ds_read_b64_tr_b16 v[158:159], v11 offset:28672
    v_exp_f32 v24, v48
    v_exp_f32 v25, v49
    v_exp_f32 v26, v50
    v_exp_f32 v27, v51
    s_nop 0
    v_exp_f32 v28, v56
    v_exp_f32 v29, v57
    v_exp_f32 v30, v58
    v_exp_f32 v31, v59
    v_cvt_pk_bf16_f32 v40, v24, v25
    v_cvt_pk_bf16_f32 v41, v26, v27
    v_cvt_pk_bf16_f32 v42, v28, v29
    v_cvt_pk_bf16_f32 v43, v30, v31
    v_add_f32 v24, v24, v25
    v_add_f32 v26, v26, v27
    v_add_f32 v28, v28, v29
    v_add_f32 v30, v30, v31
    v_add_f32 v24, v24, v26
    v_add_f32 v28, v28, v30
    v_add_f32 v18, v24, v28
    v_cmp_lt_f32 vcc, s65, v18
    s_cbranch_vccnz m_a1_c5_0_slow
m_a1_c5_0_back:
    v_add_f32 v16, v16, v18
    s_waitcnt lgkmcnt(0)
    v_mfma_f32_16x16x32_bf16 v[160:163], v[128:131], v[40:43], v[160:163]
    ds_read_b128 v[96:99], v0 offset:32768
    ds_read_b128 v[100:103], v1 offset:32768
    v_mfma_f32_16x16x32_bf16 v[168:171], v[132:135], v[40:43], v[168:171]
    ds_read_b128 v[104:107], v2 offset:32768
    ds_read_b128 v[108:111], v3 offset:32768
    v_mfma_f32_16x16x32_bf16 v[176:179], v[136:139], v[40:43], v[176:179]
    ds_read_b128 v[112:115], v0 offset:36864
    ds_read_b128 v[116:119], v1 offset:36864
    v_mfma_f32_16x16x32_bf16 v[184:187], v[140:143], v[40:43], v[184:187]
    ds_read_b128 v[120:123], v2 offset:36864
    ds_read_b128 v[124:127], v3 offset:36864
    v_mfma_f32_16x16x32_bf16 v[192:195], v[144:147], v[40:43], v[192:195]
    v_mfma_f32_16x16x32_bf16 v[200:203], v[148:151], v[40:43], v[200:203]
    v_mfma_f32_16x16x32_bf16 v[208:211], v[152:155], v[40:43], v[208:211]
    v_mfma_f32_16x16x32_bf16 v[216:219], v[156:159], v[40:43], v[216:219]
    s_waitcnt lgkmcnt(0)
    s_barrier
    v_mfma_f32_16x16x32_bf16 v[48:51], v[96:99], v[64:67], v[32:35]
    ds_read_b64_tr_b16 v[128:129], v4 offset:40960
    ds_read_b64_tr_b16 v[130:131], v4 offset:45056
    v_mfma_f32_16x16x32_bf16 v[48:51], v[100:103], v[68:71], v[48:51]
    ds_read_b64_tr_b16 v[132:133], v5 offset:40960
    ds_read_b64_tr_b16 v[134:135], v5 offset:45056
    v_mfma_f32_16x16x32_bf16 v[48:51], v[104:107], v[72:75], v[48:51]
    ds_read_b64_tr_b16 v[136:137], v6 offset:40960
    ds_read_b64_tr_b16 v[138:139], v6 offset:45056
    v_mfma_f32_16x16x32_bf16 v[48:51], v[108:111], v[76:79], v[48:51]
    ds_read_b64_tr_b16 v[140:141], v7 offset:40960
    ds_read_b64_tr_b16 v[142:143], v7 offset:45056
    v_mfma_f32_16x16x32_bf16 v[56:59], v[112:115], v[64:67], v[32:35]
    ds_read_b64_tr_b16 v[144:145], v8 offset:40960
    ds_read_b64_tr_b16 v[146:147], v8 offset:45056
    v_mfma_f32_16x16x32_bf16 v[56:59], v[116:119], v[68:71], v[56:59]
    ds_read_b64_tr_b16 v[148:149], v9 offset:40960
    ds_read_b64_tr_b16 v[150:151], v9 offset:45056
    v_mfma_f32_16x16x32_bf16 v[56:59], v[120:123], v[72:75], v[56:59]
    ds_read_b64_tr_b16 v[152:153], v10 offset:40960
    ds_read_b64_tr_b16 v[154:155], v10 offset:45056
    v_mfma_f32_16x16x32_bf16 v[56:59], v[124:127], v[76:79], v[56:59]
    s_waitcnt lgkmcnt(12)
    ds_read_b64_tr_b16 v[156:157], v11 offset:40960
    ds_read_b64_tr_b16 v[158:159], v11 offset:45056
    v_exp_f32 v24, v48
    v_exp_f32 v25, v49
    v_exp_f32 v26, v50
    v_exp_f32 v27, v51
    s_nop 0
    v_exp_f32 v28, v56
    v_exp_f32 v29, v57
    v_exp_f32 v30, v58
    v_exp_f32 v31, v59
    v_cvt_pk_bf16_f32 v40, v24, v25
    v_cvt_pk_bf16_f32 v41, v26, v27
    v_cvt_pk_bf16_f32 v42, v28, v29
    v_cvt_pk_bf16_f32 v43, v30, v31
    v_add_f32 v24, v24, v25
    v_add_f32 v26, v26, v27
    v_add_f32 v28, v28, v29
    v_add_f32 v30, v30, v31
    v_add_f32 v24, v24, v26
    v_add_f32 v28, v28, v30
    v_add_f32 v18, v24, v28
    v_cmp_lt_f32 vcc, s65, v18
    s_cbranch_vccnz m_a1_c6_0_slow
m_a1_c6_0_back:
    v_add_f32 v16, v16, v18
    s_waitcnt lgkmcnt(0)
    v_mfma_f32_16x16x32_bf16 v[160:163], v[128:131], v[40:43], v[160:163]
    ds_read_b128 v[96:99], v0 offset:49152
    ds_read_b128 v[100:103], v1 offset:49152
    v_mfma_f32_16x16x32_bf16 v[168:171], v[132:135], v[40:43], v[168:171]
    ds_read_b128 v[104:107], v2 offset:49152
    ds_read_b128 v[108:111], v3 offset:49152
    v_mfma_f32_16x16x32_bf16 v[176:179], v[136:139], v[40:43], v[176:179]
    ds_read_b128 v[112:115], v0 offset:53248
    ds_read_b128 v[116:119], v1 offset:53248
    v_mfma_f32_16x16x32_bf16 v[184:187], v[140:143], v[40:43], v[184:187]
    ds_read_b128 v[120:123], v2 offset:53248
    ds_read_b128 v[124:127], v3 offset:53248
    v_mfma_f32_16x16x32_bf16 v[192:195], v[144:147], v[40:43], v[192:195]
    v_mfma_f32_16x16x32_bf16 v[200:203], v[148:151], v[40:43], v[200:203]
    v_mfma_f32_16x16x32_bf16 v[208:211], v[152:155], v[40:43], v[208:211]
    v_mfma_f32_16x16x32_bf16 v[216:219], v[156:159], v[40:43], v[216:219]
    s_waitcnt lgkmcnt(0)
    s_barrier
    v_mfma_f32_16x16x32_bf16 v[48:51], v[96:99], v[64:67], v[32:35]
    ds_read_b64_tr_b16 v[128:129], v4 offset:57344
    ds_read_b64_tr_b16 v[130:131], v4 offset:61440
    v_mfma_f32_16x16x32_bf16 v[48:51], v[100:103], v[68:71], v[48:51]
    ds_read_b64_tr_b16 v[132:133], v5 offset:57344
    ds_read_b64_tr_b16 v[134:135], v5 offset:61440
    v_mfma_f32_16x16x32_bf16 v[48:51], v[104:107], v[72:75], v[48:51]
    ds_read_b64_tr_b16 v[136:137], v6 offset:57344
    ds_read_b64_tr_b16 v[138:139], v6 offset:61440
    v_mfma_f32_16x16x32_bf16 v[48:51], v[108:111], v[76:79], v[48:51]
    ds_read_b64_tr_b16 v[140:141], v7 offset:57344
    ds_read_b64_tr_b16 v[142:143], v7 offset:61440
    v_mfma_f32_16x16x32_bf16 v[56:59], v[112:115], v[64:67], v[32:35]
    ds_read_b64_tr_b16 v[144:145], v8 offset:57344
    ds_read_b64_tr_b16 v[146:147], v8 offset:61440
    v_mfma_f32_16x16x32_bf16 v[56:59], v[116:119], v[68:71], v[56:59]
    ds_read_b64_tr_b16 v[148:149], v9 offset:57344
    ds_read_b64_tr_b16 v[150:151], v9 offset:61440
    v_mfma_f32_16x16x32_bf16 v[56:59], v[120:123], v[72:75], v[56:59]
    ds_read_b64_tr_b16 v[152:153], v10 offset:57344
    ds_read_b64_tr_b16 v[154:155], v10 offset:61440
    v_mfma_f32_16x16x32_bf16 v[56:59], v[124:127], v[76:79], v[56:59]
    s_waitcnt lgkmcnt(12)
    ds_read_b64_tr_b16 v[156:157], v11 offset:57344
    ds_read_b64_tr_b16 v[158:159], v11 offset:61440
    v_exp_f32 v24, v48
    v_exp_f32 v25, v49
    v_exp_f32 v26, v50
    v_exp_f32 v27, v51
    s_nop 0
    v_exp_f32 v28, v56
    v_exp_f32 v29, v57
    v_exp_f32 v30, v58
    v_exp_f32 v31, v59
    v_cvt_pk_bf16_f32 v40, v24, v25
    v_cvt_pk_bf16_f32 v41, v26, v27
    v_cvt_pk_bf16_f32 v42, v28, v29
    v_cvt_pk_bf16_f32 v43, v30, v31
    v_add_f32 v24, v24, v25
    v_add_f32 v26, v26, v27
    v_add_f32 v28, v28, v29
    v_add_f32 v30, v30, v31
    v_add_f32 v24, v24, v26
    v_add_f32 v28, v28, v30
    v_add_f32 v18, v24, v28
    v_cmp_lt_f32 vcc, s65, v18
    s_cbranch_vccnz m_a1_c7_0_slow
m_a1_c7_0_back:
    v_add_f32 v16, v16, v18
    s_waitcnt lgkmcnt(0)
    v_mfma_f32_16x16x32_bf16 v[160:163], v[128:131], v[40:43], v[160:163]
    ds_read_b128 v[96:99], v0 offset:0
    ds_read_b128 v[100:103], v1 offset:0
    v_mfma_f32_16x16x32_bf16 v[168:171], v[132:135], v[40:43], v[168:171]
    ds_read_b128 v[104:107], v2 offset:0
    ds_read_b128 v[108:111], v3 offset:0
    v_mfma_f32_16x16x32_bf16 v[176:179], v[136:139], v[40:43], v[176:179]
    ds_read_b128 v[112:115], v0 offset:4096
    ds_read_b128 v[116:119], v1 offset:4096
    v_mfma_f32_16x16x32_bf16 v[184:187], v[140:143], v[40:43], v[184:187]
    ds_read_b128 v[120:123], v2 offset:4096
    ds_read_b128 v[124:127], v3 offset:4096
    v_mfma_f32_16x16x32_bf16 v[192:195], v[144:147], v[40:43], v[192:195]
    v_mfma_f32_16x16x32_bf16 v[200:203], v[148:151], v[40:43], v[200:203]
    v_mfma_f32_16x16x32_bf16 v[208:211], v[152:155], v[40:43], v[208:211]
    v_mfma_f32_16x16x32_bf16 v[216:219], v[156:159], v[40:43], v[216:219]
    s_waitcnt lgkmcnt(0)
    s_barrier
    v_mfma_f32_16x16x32_bf16 v[48:51], v[96:99], v[64:67], v[32:35]
    ds_read_b64_tr_b16 v[128:129], v4 offset:8192
    ds_read_b64_tr_b16 v[130:131], v4 offset:12288
    v_mfma_f32_16x16x32_bf16 v[48:51], v[100:103], v[68:71], v[48:51]
    ds_read_b64_tr_b16 v[132:133], v5 offset:8192
    ds_read_b64_tr_b16 v[134:135], v5 offset:12288
    v_mfma_f32_16x16x32_bf16 v[48:51], v[104:107], v[72:75], v[48:51]
    ds_read_b64_tr_b16 v[136:137], v6 offset:8192
    ds_read_b64_tr_b16 v[138:139], v6 offset:12288
    v_mfma_f32_16x16x32_bf16 v[48:51], v[108:111], v[76:79], v[48:51]
    ds_read_b64_tr_b16 v[140:141], v7 offset:8192
    ds_read_b64_tr_b16 v[142:143], v7 offset:12288
    v_mfma_f32_16x16x32_bf16 v[56:59], v[112:115], v[64:67], v[32:35]
    ds_read_b64_tr_b16 v[144:145], v8 offset:8192
    ds_read_b64_tr_b16 v[146:147], v8 offset:12288
    v_mfma_f32_16x16x32_bf16 v[56:59], v[116:119], v[68:71], v[56:59]
    ds_read_b64_tr_b16 v[148:149], v9 offset:8192
    ds_read_b64_tr_b16 v[150:151], v9 offset:12288
    v_mfma_f32_16x16x32_bf16 v[56:59], v[120:123], v[72:75], v[56:59]
    ds_read_b64_tr_b16 v[152:153], v10 offset:8192
    ds_read_b64_tr_b16 v[154:155], v10 offset:12288
    v_mfma_f32_16x16x32_bf16 v[56:59], v[124:127], v[76:79], v[56:59]
    s_waitcnt lgkmcnt(12)
    ds_read_b64_tr_b16 v[156:157], v11 offset:8192
    ds_read_b64_tr_b16 v[158:159], v11 offset:12288
    v_exp_f32 v24, v48
    v_exp_f32 v25, v49
    v_exp_f32 v26, v50
    v_exp_f32 v27, v51
    s_nop 0
    v_exp_f32 v28, v56
    v_exp_f32 v29, v57
    v_exp_f32 v30, v58
    v_exp_f32 v31, v59
    v_cvt_pk_bf16_f32 v40, v24, v25
    v_cvt_pk_bf16_f32 v41, v26, v27
    v_cvt_pk_bf16_f32 v42, v28, v29
    v_cvt_pk_bf16_f32 v43, v30, v31
    v_add_f32 v24, v24, v25
    v_add_f32 v26, v26, v27
    v_add_f32 v28, v28, v29
    v_add_f32 v30, v30, v31
    v_add_f32 v24, v24, v26
    v_add_f32 v28, v28, v30
    v_add_f32 v18, v24, v28
    v_cmp_lt_f32 vcc, s65, v18
    s_cbranch_vccnz m_a1_c8_0_slow
m_a1_c8_0_back:
    v_add_f32 v16, v16, v18
    s_waitcnt lgkmcnt(0)
    v_mfma_f32_16x16x32_bf16 v[160:163], v[128:131], v[40:43], v[160:163]
    ds_read_b128 v[96:99], v0 offset:16384
    ds_read_b128 v[100:103], v1 offset:16384
    v_mfma_f32_16x16x32_bf16 v[168:171], v[132:135], v[40:43], v[168:171]
    ds_read_b128 v[104:107], v2 offset:16384
    ds_read_b128 v[108:111], v3 offset:16384
    v_mfma_f32_16x16x32_bf16 v[176:179], v[136:139], v[40:43], v[176:179]
    ds_read_b128 v[112:115], v0 offset:20480
    ds_read_b128 v[116:119], v1 offset:20480
    v_mfma_f32_16x16x32_bf16 v[184:187], v[140:143], v[40:43], v[184:187]
    ds_read_b128 v[120:123], v2 offset:20480
    ds_read_b128 v[124:127], v3 offset:20480
    v_mfma_f32_16x16x32_bf16 v[192:195], v[144:147], v[40:43], v[192:195]
    v_mfma_f32_16x16x32_bf16 v[200:203], v[148:151], v[40:43], v[200:203]
    v_mfma_f32_16x16x32_bf16 v[208:211], v[152:155], v[40:43], v[208:211]
    v_mfma_f32_16x16x32_bf16 v[216:219], v[156:159], v[40:43], v[216:219]
    s_waitcnt lgkmcnt(0)
    s_barrier
    v_mfma_f32_16x16x32_bf16 v[48:51], v[96:99], v[64:67], v[32:35]
    ds_read_b64_tr_b16 v[128:129], v4 offset:24576
    ds_read_b64_tr_b16 v[130:131], v4 offset:28672
    v_mfma_f32_16x16x32_bf16 v[48:51], v[100:103], v[68:71], v[48:51]
    ds_read_b64_tr_b16 v[132:133], v5 offset:24576
    ds_read_b64_tr_b16 v[134:135], v5 offset:28672
    v_mfma_f32_16x16x32_bf16 v[48:51], v[104:107], v[72:75], v[48:51]
    ds_read_b64_tr_b16 v[136:137], v6 offset:24576
    ds_read_b64_tr_b16 v[138:139], v6 offset:28672
    v_mfma_f32_16x16x32_bf16 v[48:51], v[108:111], v[76:79], v[48:51]
    ds_read_b64_tr_b16 v[140:141], v7 offset:24576
    ds_read_b64_tr_b16 v[142:143], v7 offset:28672
    v_mfma_f32_16x16x32_bf16 v[56:59], v[112:115], v[64:67], v[32:35]
    ds_read_b64_tr_b16 v[144:145], v8 offset:24576
    ds_read_b64_tr_b16 v[146:147], v8 offset:28672
    v_mfma_f32_16x16x32_bf16 v[56:59], v[116:119], v[68:71], v[56:59]
    ds_read_b64_tr_b16 v[148:149], v9 offset:24576
    ds_read_b64_tr_b16 v[150:151], v9 offset:28672
    v_mfma_f32_16x16x32_bf16 v[56:59], v[120:123], v[72:75], v[56:59]
    ds_read_b64_tr_b16 v[152:153], v10 offset:24576
    ds_read_b64_tr_b16 v[154:155], v10 offset:28672
    v_mfma_f32_16x16x32_bf16 v[56:59], v[124:127], v[76:79], v[56:59]
    s_waitcnt lgkmcnt(12)
    ds_read_b64_tr_b16 v[156:157], v11 offset:24576
    ds_read_b64_tr_b16 v[158:159], v11 offset:28672
    v_exp_f32 v24, v48
    v_exp_f32 v25, v49
    v_exp_f32 v26, v50
    v_exp_f32 v27, v51
    s_nop 0
    v_exp_f32 v28, v56
    v_exp_f32 v29, v57
    v_exp_f32 v30, v58
    v_exp_f32 v31, v59
    v_cvt_pk_bf16_f32 v40, v24, v25
    v_cvt_pk_bf16_f32 v41, v26, v27
    v_cvt_pk_bf16_f32 v42, v28, v29
    v_cvt_pk_bf16_f32 v43, v30, v31
    v_add_f32 v24, v24, v25
    v_add_f32 v26, v26, v27
    v_add_f32 v28, v28, v29
    v_add_f32 v30, v30, v31
    v_add_f32 v24, v24, v26
    v_add_f32 v28, v28, v30
    v_add_f32 v18, v24, v28
    v_cmp_lt_f32 vcc, s65, v18
    s_cbranch_vccnz m_a1_c9_0_slow
m_a1_c9_0_back:
    v_add_f32 v16, v16, v18
    s_waitcnt lgkmcnt(0)
    v_mfma_f32_16x16x32_bf16 v[160:163], v[128:131], v[40:43], v[160:163]
    ds_read_b128 v[96:99], v0 offset:32768
    ds_read_b128 v[100:103], v1 offset:32768
    v_mfma_f32_16x16x32_bf16 v[168:171], v[132:135], v[40:43], v[168:171]
    ds_read_b128 v[104:107], v2 offset:32768
    ds_read_b128 v[108:111], v3 offset:32768
    v_mfma_f32_16x16x32_bf16 v[176:179], v[136:139], v[40:43], v[176:179]
    ds_read_b128 v[112:115], v0 offset:36864
    ds_read_b128 v[116:119], v1 offset:36864
    v_mfma_f32_16x16x32_bf16 v[184:187], v[140:143], v[40:43], v[184:187]
    ds_read_b128 v[120:123], v2 offset:36864
    ds_read_b128 v[124:127], v3 offset:36864
    v_mfma_f32_16x16x32_bf16 v[192:195], v[144:147], v[40:43], v[192:195]
    v_mfma_f32_16x16x32_bf16 v[200:203], v[148:151], v[40:43], v[200:203]
    v_mfma_f32_16x16x32_bf16 v[208:211], v[152:155], v[40:43], v[208:211]
    v_mfma_f32_16x16x32_bf16 v[216:219], v[156:159], v[40:43], v[216:219]
    s_waitcnt lgkmcnt(0)
    s_barrier
    v_mfma_f32_16x16x32_bf16 v[48:51], v[96:99], v[64:67], v[32:35]
    ds_read_b64_tr_b16 v[128:129], v4 offset:40960
    ds_read_b64_tr_b16 v[130:131], v4 offset:45056
    v_mfma_f32_16x16x32_bf16 v[48:51], v[100:103], v[68:71], v[48:51]
    ds_read_b64_tr_b16 v[132:133], v5 offset:40960
    ds_read_b64_tr_b16 v[134:135], v5 offset:45056
    v_mfma_f32_16x16x32_bf16 v[48:51], v[104:107], v[72:75], v[48:51]
    ds_read_b64_tr_b16 v[136:137], v6 offset:40960
    ds_read_b64_tr_b16 v[138:139], v6 offset:45056
    v_mfma_f32_16x16x32_bf16 v[48:51], v[108:111], v[76:79], v[48:51]
    ds_read_b64_tr_b16 v[140:141], v7 offset:40960
    ds_read_b64_tr_b16 v[142:143], v7 offset:45056
    v_mfma_f32_16x16x32_bf16 v[56:59], v[112:115], v[64:67], v[32:35]
    ds_read_b64_tr_b16 v[144:145], v8 offset:40960
    ds_read_b64_tr_b16 v[146:147], v8 offset:45056
    v_mfma_f32_16x16x32_bf16 v[56:59], v[116:119], v[68:71], v[56:59]
    ds_read_b64_tr_b16 v[148:149], v9 offset:40960
    ds_read_b64_tr_b16 v[150:151], v9 offset:45056
    v_mfma_f32_16x16x32_bf16 v[56:59], v[120:123], v[72:75], v[56:59]
    ds_read_b64_tr_b16 v[152:153], v10 offset:40960
    ds_read_b64_tr_b16 v[154:155], v10 offset:45056
    v_mfma_f32_16x16x32_bf16 v[56:59], v[124:127], v[76:79], v[56:59]
    s_waitcnt lgkmcnt(12)
    ds_read_b64_tr_b16 v[156:157], v11 offset:40960
    ds_read_b64_tr_b16 v[158:159], v11 offset:45056
    v_exp_f32 v24, v48
    v_exp_f32 v25, v49
    v_exp_f32 v26, v50
    v_exp_f32 v27, v51
    s_nop 0
    v_exp_f32 v28, v56
    v_exp_f32 v29, v57
    v_exp_f32 v30, v58
    v_exp_f32 v31, v59
    v_cvt_pk_bf16_f32 v40, v24, v25
    v_cvt_pk_bf16_f32 v41, v26, v27
    v_cvt_pk_bf16_f32 v42, v28, v29
    v_cvt_pk_bf16_f32 v43, v30, v31
    v_add_f32 v24, v24, v25
    v_add_f32 v26, v26, v27
    v_add_f32 v28, v28, v29
    v_add_f32 v30, v30, v31
    v_add_f32 v24, v24, v26
    v_add_f32 v28, v28, v30
    v_add_f32 v18, v24, v28
    v_cmp_lt_f32 vcc, s65, v18
    s_cbranch_vccnz m_a1_c10_0_slow
m_a1_c10_0_back:
    v_add_f32 v16, v16, v18
    s_waitcnt lgkmcnt(0)
    v_mfma_f32_16x16x32_bf16 v[160:163], v[128:131], v[40:43], v[160:163]
    ds_read_b128 v[96:99], v0 offset:49152
    ds_read_b128 v[100:103], v1 offset:49152
    v_mfma_f32_16x16x32_bf16 v[168:171], v[132:135], v[40:43], v[168:171]
    ds_read_b128 v[104:107], v2 offset:49152
    ds_read_b128 v[108:111], v3 offset:49152
    v_mfma_f32_16x16x32_bf16 v[176:179], v[136:139], v[40:43], v[176:179]
    ds_read_b128 v[112:115], v0 offset:53248
    ds_read_b128 v[116:119], v1 offset:53248
    v_mfma_f32_16x16x32_bf16 v[184:187], v[140:143], v[40:43], v[184:187]
    ds_read_b128 v[120:123], v2 offset:53248
    ds_read_b128 v[124:127], v3 offset:53248
    v_mfma_f32_16x16x32_bf16 v[192:195], v[144:147], v[40:43], v[192:195]
    v_mfma_f32_16x16x32_bf16 v[200:203], v[148:151], v[40:43], v[200:203]
    v_mfma_f32_16x16x32_bf16 v[208:211], v[152:155], v[40:43], v[208:211]
    v_mfma_f32_16x16x32_bf16 v[216:219], v[156:159], v[40:43], v[216:219]
    s_waitcnt lgkmcnt(0)
    s_barrier
    v_mfma_f32_16x16x32_bf16 v[48:51], v[96:99], v[64:67], v[32:35]
    ds_read_b64_tr_b16 v[128:129], v4 offset:57344
    ds_read_b64_tr_b16 v[130:131], v4 offset:61440
    v_mfma_f32_16x16x32_bf16 v[48:51], v[100:103], v[68:71], v[48:51]
    ds_read_b64_tr_b16 v[132:133], v5 offset:57344
    ds_read_b64_tr_b16 v[134:135], v5 offset:61440
    v_mfma_f32_16x16x32_bf16 v[48:51], v[104:107], v[72:75], v[48:51]
    ds_read_b64_tr_b16 v[136:137], v6 offset:57344
    ds_read_b64_tr_b16 v[138:139], v6 offset:61440
    v_mfma_f32_16x16x32_bf16 v[48:51], v[108:111], v[76:79], v[48:51]
    ds_read_b64_tr_b16 v[140:141], v7 offset:57344
    ds_read_b64_tr_b16 v[142:143], v7 offset:61440
    v_mfma_f32_16x16x32_bf16 v[56:59], v[112:115], v[64:67], v[32:35]
    ds_read_b64_tr_b16 v[144:145], v8 offset:57344
    ds_read_b64_tr_b16 v[146:147], v8 offset:61440
    v_mfma_f32_16x16x32_bf16 v[56:59], v[116:119], v[68:71], v[56:59]
    ds_read_b64_tr_b16 v[148:149], v9 offset:57344
    ds_read_b64_tr_b16 v[150:151], v9 offset:61440
    v_mfma_f32_16x16x32_bf16 v[56:59], v[120:123], v[72:75], v[56:59]
    ds_read_b64_tr_b16 v[152:153], v10 offset:57344
    ds_read_b64_tr_b16 v[154:155], v10 offset:61440
    v_mfma_f32_16x16x32_bf16 v[56:59], v[124:127], v[76:79], v[56:59]
    s_waitcnt lgkmcnt(12)
    ds_read_b64_tr_b16 v[156:157], v11 offset:57344
    ds_read_b64_tr_b16 v[158:159], v11 offset:61440
    v_exp_f32 v24, v48
    v_exp_f32 v25, v49
    v_exp_f32 v26, v50
    v_exp_f32 v27, v51
    s_nop 0
    v_exp_f32 v28, v56
    v_exp_f32 v29, v57
    v_exp_f32 v30, v58
    v_exp_f32 v31, v59
    v_cvt_pk_bf16_f32 v40, v24, v25
    v_cvt_pk_bf16_f32 v41, v26, v27
    v_cvt_pk_bf16_f32 v42, v28, v29
    v_cvt_pk_bf16_f32 v43, v30, v31
    v_add_f32 v24, v24, v25
    v_add_f32 v26, v26, v27
    v_add_f32 v28, v28, v29
    v_add_f32 v30, v30, v31
    v_add_f32 v24, v24, v26
    v_add_f32 v28, v28, v30
    v_add_f32 v18, v24, v28
    v_cmp_lt_f32 vcc, s65, v18
    s_cbranch_vccnz m_a1_c11_0_slow
m_a1_c11_0_back:
    v_add_f32 v16, v16, v18
    s_waitcnt lgkmcnt(0)
    v_mfma_f32_16x16x32_bf16 v[160:163], v[128:131], v[40:43], v[160:163]
    ds_read_b128 v[96:99], v0 offset:0
    ds_read_b128 v[100:103], v1 offset:0
    v_mfma_f32_16x16x32_bf16 v[168:171], v[132:135], v[40:43], v[168:171]
    ds_read_b128 v[104:107], v2 offset:0
    ds_read_b128 v[108:111], v3 offset:0
    v_mfma_f32_16x16x32_bf16 v[176:179], v[136:139], v[40:43], v[176:179]
    ds_read_b128 v[112:115], v0 offset:4096
    ds_read_b128 v[116:119], v1 offset:4096
    v_mfma_f32_16x16x32_bf16 v[184:187], v[140:143], v[40:43], v[184:187]
    ds_read_b128 v[120:123], v2 offset:4096
    ds_read_b128 v[124:127], v3 offset:4096
    v_mfma_f32_16x16x32_bf16 v[192:195], v[144:147], v[40:43], v[192:195]
    v_mfma_f32_16x16x32_bf16 v[200:203], v[148:151], v[40:43], v[200:203]
    v_mfma_f32_16x16x32_bf16 v[208:211], v[152:155], v[40:43], v[208:211]
    v_mfma_f32_16x16x32_bf16 v[216:219], v[156:159], v[40:43], v[216:219]
    s_waitcnt lgkmcnt(0)
    s_barrier
    v_mfma_f32_16x16x32_bf16 v[48:51], v[96:99], v[64:67], v[32:35]
    ds_read_b64_tr_b16 v[128:129], v4 offset:8192
    ds_read_b64_tr_b16 v[130:131], v4 offset:12288
    v_mfma_f32_16x16x32_bf16 v[48:51], v[100:103], v[68:71], v[48:51]
    ds_read_b64_tr_b16 v[132:133], v5 offset:8192
    ds_read_b64_tr_b16 v[134:135], v5 offset:12288
    v_mfma_f32_16x16x32_bf16 v[48:51], v[104:107], v[72:75], v[48:51]
    ds_read_b64_tr_b16 v[136:137], v6 offset:8192
    ds_read_b64_tr_b16 v[138:139], v6 offset:12288
    v_mfma_f32_16x16x32_bf16 v[48:51], v[108:111], v[76:79], v[48:51]
    ds_read_b64_tr_b16 v[140:141], v7 offset:8192
    ds_read_b64_tr_b16 v[142:143], v7 offset:12288
    v_mfma_f32_16x16x32_bf16 v[56:59], v[112:115], v[64:67], v[32:35]
    ds_read_b64_tr_b16 v[144:145], v8 offset:8192
    ds_read_b64_tr_b16 v[146:147], v8 offset:12288
    v_mfma_f32_16x16x32_bf16 v[56:59], v[116:119], v[68:71], v[56:59]
    ds_read_b64_tr_b16 v[148:149], v9 offset:8192
    ds_read_b64_tr_b16 v[150:151], v9 offset:12288
    v_mfma_f32_16x16x32_bf16 v[56:59], v[120:123], v[72:75], v[56:59]
    ds_read_b64_tr_b16 v[152:153], v10 offset:8192
    ds_read_b64_tr_b16 v[154:155], v10 offset:12288
    v_mfma_f32_16x16x32_bf16 v[56:59], v[124:127], v[76:79], v[56:59]
    s_waitcnt lgkmcnt(12)
    ds_read_b64_tr_b16 v[156:157], v11 offset:8192
    ds_read_b64_tr_b16 v[158:159], v11 offset:12288
    v_exp_f32 v24, v48
    v_exp_f32 v25, v49
    v_exp_f32 v26, v50
    v_exp_f32 v27, v51
    s_nop 0
    v_exp_f32 v28, v56
    v_exp_f32 v29, v57
    v_exp_f32 v30, v58
    v_exp_f32 v31, v59
    v_cvt_pk_bf16_f32 v40, v24, v25
    v_cvt_pk_bf16_f32 v41, v26, v27
    v_cvt_pk_bf16_f32 v42, v28, v29
    v_cvt_pk_bf16_f32 v43, v30, v31
    v_add_f32 v24, v24, v25
    v_add_f32 v26, v26, v27
    v_add_f32 v28, v28, v29
    v_add_f32 v30, v30, v31
    v_add_f32 v24, v24, v26
    v_add_f32 v28, v28, v30
    v_add_f32 v18, v24, v28
    v_cmp_lt_f32 vcc, s65, v18
    s_cbranch_vccnz m_a1_c12_0_slow
m_a1_c12_0_back:
    v_add_f32 v16, v16, v18
    s_waitcnt lgkmcnt(0)
    v_mfma_f32_16x16x32_bf16 v[160:163], v[128:131], v[40:43], v[160:163]
    ds_read_b128 v[96:99], v0 offset:16384
    ds_read_b128 v[100:103], v1 offset:16384
    v_mfma_f32_16x16x32_bf16 v[168:171], v[132:135], v[40:43], v[168:171]
    ds_read_b128 v[104:107], v2 offset:16384
    ds_read_b128 v[108:111], v3 offset:16384
    v_mfma_f32_16x16x32_bf16 v[176:179], v[136:139], v[40:43], v[176:179]
    ds_read_b128 v[112:115], v0 offset:20480
    ds_read_b128 v[116:119], v1 offset:20480
    v_mfma_f32_16x16x32_bf16 v[184:187], v[140:143], v[40:43], v[184:187]
    ds_read_b128 v[120:123], v2 offset:20480
    ds_read_b128 v[124:127], v3 offset:20480
    v_mfma_f32_16x16x32_bf16 v[192:195], v[144:147], v[40:43], v[192:195]
    v_mfma_f32_16x16x32_bf16 v[200:203], v[148:151], v[40:43], v[200:203]
    v_mfma_f32_16x16x32_bf16 v[208:211], v[152:155], v[40:43], v[208:211]
    v_mfma_f32_16x16x32_bf16 v[216:219], v[156:159], v[40:43], v[216:219]
    s_waitcnt lgkmcnt(0)
    s_barrier
    v_mfma_f32_16x16x32_bf16 v[48:51], v[96:99], v[64:67], v[32:35]
    ds_read_b64_tr_b16 v[128:129], v4 offset:24576
    ds_read_b64_tr_b16 v[130:131], v4 offset:28672
    v_mfma_f32_16x16x32_bf16 v[48:51], v[100:103], v[68:71], v[48:51]
    ds_read_b64_tr_b16 v[132:133], v5 offset:24576
    ds_read_b64_tr_b16 v[134:135], v5 offset:28672
    v_mfma_f32_16x16x32_bf16 v[48:51], v[104:107], v[72:75], v[48:51]
    ds_read_b64_tr_b16 v[136:137], v6 offset:24576
    ds_read_b64_tr_b16 v[138:139], v6 offset:28672
    v_mfma_f32_16x16x32_bf16 v[48:51], v[108:111], v[76:79], v[48:51]
    ds_read_b64_tr_b16 v[140:141], v7 offset:24576
    ds_read_b64_tr_b16 v[142:143], v7 offset:28672
    v_mfma_f32_16x16x32_bf16 v[56:59], v[112:115], v[64:67], v[32:35]
    ds_read_b64_tr_b16 v[144:145], v8 offset:24576
    ds_read_b64_tr_b16 v[146:147], v8 offset:28672
    v_mfma_f32_16x16x32_bf16 v[56:59], v[116:119], v[68:71], v[56:59]
    ds_read_b64_tr_b16 v[148:149], v9 offset:24576
    ds_read_b64_tr_b16 v[150:151], v9 offset:28672
    v_mfma_f32_16x16x32_bf16 v[56:59], v[120:123], v[72:75], v[56:59]
    ds_read_b64_tr_b16 v[152:153], v10 offset:24576
    ds_read_b64_tr_b16 v[154:155], v10 offset:28672
    v_mfma_f32_16x16x32_bf16 v[56:59], v[124:127], v[76:79], v[56:59]
    s_waitcnt lgkmcnt(12)
    ds_read_b64_tr_b16 v[156:157], v11 offset:24576
    ds_read_b64_tr_b16 v[158:159], v11 offset:28672
    v_exp_f32 v24, v48
    v_exp_f32 v25, v49
    v_exp_f32 v26, v50
    v_exp_f32 v27, v51
    s_nop 0
    v_exp_f32 v28, v56
    v_exp_f32 v29, v57
    v_exp_f32 v30, v58
    v_exp_f32 v31, v59
    v_cvt_pk_bf16_f32 v40, v24, v25
    v_cvt_pk_bf16_f32 v41, v26, v27
    v_cvt_pk_bf16_f32 v42, v28, v29
    v_cvt_pk_bf16_f32 v43, v30, v31
    v_add_f32 v24, v24, v25
    v_add_f32 v26, v26, v27
    v_add_f32 v28, v28, v29
    v_add_f32 v30, v30, v31
    v_add_f32 v24, v24, v26
    v_add_f32 v28, v28, v30
    v_add_f32 v18, v24, v28
    v_cmp_lt_f32 vcc, s65, v18
    s_cbranch_vccnz m_a1_c13_0_slow
m_a1_c13_0_back:
    v_add_f32 v16, v16, v18
    s_waitcnt lgkmcnt(0)
    v_mfma_f32_16x16x32_bf16 v[160:163], v[128:131], v[40:43], v[160:163]
    ds_read_b128 v[96:99], v0 offset:32768
    ds_read_b128 v[100:103], v1 offset:32768
    v_mfma_f32_16x16x32_bf16 v[168:171], v[132:135], v[40:43], v[168:171]
    ds_read_b128 v[104:107], v2 offset:32768
    ds_read_b128 v[108:111], v3 offset:32768
    v_mfma_f32_16x16x32_bf16 v[176:179], v[136:139], v[40:43], v[176:179]
    ds_read_b128 v[112:115], v0 offset:36864
    ds_read_b128 v[116:119], v1 offset:36864
    v_mfma_f32_16x16x32_bf16 v[184:187], v[140:143], v[40:43], v[184:187]
    ds_read_b128 v[120:123], v2 offset:36864
    ds_read_b128 v[124:127], v3 offset:36864
    v_mfma_f32_16x16x32_bf16 v[192:195], v[144:147], v[40:43], v[192:195]
    v_mfma_f32_16x16x32_bf16 v[200:203], v[148:151], v[40:43], v[200:203]
    v_mfma_f32_16x16x32_bf16 v[208:211], v[152:155], v[40:43], v[208:211]
    v_mfma_f32_16x16x32_bf16 v[216:219], v[156:159], v[40:43], v[216:219]
    s_waitcnt lgkmcnt(0)
    s_barrier
    v_mfma_f32_16x16x32_bf16 v[48:51], v[96:99], v[64:67], v[32:35]
    ds_read_b64_tr_b16 v[128:129], v4 offset:40960
    ds_read_b64_tr_b16 v[130:131], v4 offset:45056
    v_mfma_f32_16x16x32_bf16 v[48:51], v[100:103], v[68:71], v[48:51]
    ds_read_b64_tr_b16 v[132:133], v5 offset:40960
    ds_read_b64_tr_b16 v[134:135], v5 offset:45056
    v_mfma_f32_16x16x32_bf16 v[48:51], v[104:107], v[72:75], v[48:51]
    ds_read_b64_tr_b16 v[136:137], v6 offset:40960
    ds_read_b64_tr_b16 v[138:139], v6 offset:45056
    v_mfma_f32_16x16x32_bf16 v[48:51], v[108:111], v[76:79], v[48:51]
    ds_read_b64_tr_b16 v[140:141], v7 offset:40960
    ds_read_b64_tr_b16 v[142:143], v7 offset:45056
    v_mfma_f32_16x16x32_bf16 v[56:59], v[112:115], v[64:67], v[32:35]
    ds_read_b64_tr_b16 v[144:145], v8 offset:40960
    ds_read_b64_tr_b16 v[146:147], v8 offset:45056
    v_mfma_f32_16x16x32_bf16 v[56:59], v[116:119], v[68:71], v[56:59]
    ds_read_b64_tr_b16 v[148:149], v9 offset:40960
    ds_read_b64_tr_b16 v[150:151], v9 offset:45056
    v_mfma_f32_16x16x32_bf16 v[56:59], v[120:123], v[72:75], v[56:59]
    ds_read_b64_tr_b16 v[152:153], v10 offset:40960
    ds_read_b64_tr_b16 v[154:155], v10 offset:45056
    v_mfma_f32_16x16x32_bf16 v[56:59], v[124:127], v[76:79], v[56:59]
    s_waitcnt lgkmcnt(12)
    ds_read_b64_tr_b16 v[156:157], v11 offset:40960
    ds_read_b64_tr_b16 v[158:159], v11 offset:45056
    v_exp_f32 v24, v48
    v_exp_f32 v25, v49
    v_exp_f32 v26, v50
    v_exp_f32 v27, v51
    s_nop 0
    v_exp_f32 v28, v56
    v_exp_f32 v29, v57
    v_exp_f32 v30, v58
    v_exp_f32 v31, v59
    v_cvt_pk_bf16_f32 v40, v24, v25
    v_cvt_pk_bf16_f32 v41, v26, v27
    v_cvt_pk_bf16_f32 v42, v28, v29
    v_cvt_pk_bf16_f32 v43, v30, v31
    v_add_f32 v24, v24, v25
    v_add_f32 v26, v26, v27
    v_add_f32 v28, v28, v29
    v_add_f32 v30, v30, v31
    v_add_f32 v24, v24, v26
    v_add_f32 v28, v28, v30
    v_add_f32 v18, v24, v28
    v_cmp_lt_f32 vcc, s65, v18
    s_cbranch_vccnz m_a1_c14_0_slow
m_a1_c14_0_back:
    v_add_f32 v16, v16, v18
    s_waitcnt lgkmcnt(0)
    v_mfma_f32_16x16x32_bf16 v[160:163], v[128:131], v[40:43], v[160:163]
    ds_read_b128 v[96:99], v0 offset:49152
    ds_read_b128 v[100:103], v1 offset:49152
    v_mfma_f32_16x16x32_bf16 v[168:171], v[132:135], v[40:43], v[168:171]
    ds_read_b128 v[104:107], v2 offset:49152
    ds_read_b128 v[108:111], v3 offset:49152
    v_mfma_f32_16x16x32_bf16 v[176:179], v[136:139], v[40:43], v[176:179]
    ds_read_b128 v[112:115], v0 offset:53248
    ds_read_b128 v[116:119], v1 offset:53248
    v_mfma_f32_16x16x32_bf16 v[184:187], v[140:143], v[40:43], v[184:187]
    ds_read_b128 v[120:123], v2 offset:53248
    ds_read_b128 v[124:127], v3 offset:53248
    v_mfma_f32_16x16x32_bf16 v[192:195], v[144:147], v[40:43], v[192:195]
    v_mfma_f32_16x16x32_bf16 v[200:203], v[148:151], v[40:43], v[200:203]
    v_mfma_f32_16x16x32_bf16 v[208:211], v[152:155], v[40:43], v[208:211]
    v_mfma_f32_16x16x32_bf16 v[216:219], v[156:159], v[40:43], v[216:219]
    s_waitcnt lgkmcnt(0)
    s_barrier
    v_mfma_f32_16x16x32_bf16 v[48:51], v[96:99], v[64:67], v[32:35]
    ds_read_b64_tr_b16 v[128:129], v4 offset:57344
    ds_read_b64_tr_b16 v[130:131], v4 offset:61440
    v_mfma_f32_16x16x32_bf16 v[48:51], v[100:103], v[68:71], v[48:51]
    ds_read_b64_tr_b16 v[132:133], v5 offset:57344
    ds_read_b64_tr_b16 v[134:135], v5 offset:61440
    v_mfma_f32_16x16x32_bf16 v[48:51], v[104:107], v[72:75], v[48:51]
    ds_read_b64_tr_b16 v[136:137], v6 offset:57344
    ds_read_b64_tr_b16 v[138:139], v6 offset:61440
    v_mfma_f32_16x16x32_bf16 v[48:51], v[108:111], v[76:79], v[48:51]
    ds_read_b64_tr_b16 v[140:141], v7 offset:57344
    ds_read_b64_tr_b16 v[142:143], v7 offset:61440
    v_mfma_f32_16x16x32_bf16 v[56:59], v[112:115], v[64:67], v[32:35]
    ds_read_b64_tr_b16 v[144:145], v8 offset:57344
    ds_read_b64_tr_b16 v[146:147], v8 offset:61440
    v_mfma_f32_16x16x32_bf16 v[56:59], v[116:119], v[68:71], v[56:59]
    ds_read_b64_tr_b16 v[148:149], v9 offset:57344
    ds_read_b64_tr_b16 v[150:151], v9 offset:61440
    v_mfma_f32_16x16x32_bf16 v[56:59], v[120:123], v[72:75], v[56:59]
    ds_read_b64_tr_b16 v[152:153], v10 offset:57344
    ds_read_b64_tr_b16 v[154:155], v10 offset:61440
    v_mfma_f32_16x16x32_bf16 v[56:59], v[124:127], v[76:79], v[56:59]
    s_waitcnt lgkmcnt(12)
    ds_read_b64_tr_b16 v[156:157], v11 offset:57344
    ds_read_b64_tr_b16 v[158:159], v11 offset:61440
    v_exp_f32 v24, v48
    v_exp_f32 v25, v49
    v_exp_f32 v26, v50
    v_exp_f32 v27, v51
    s_nop 0
    v_exp_f32 v28, v56
    v_exp_f32 v29, v57
    v_exp_f32 v30, v58
    v_exp_f32 v31, v59
    v_cvt_pk_bf16_f32 v40, v24, v25
    v_cvt_pk_bf16_f32 v41, v26, v27
    v_cvt_pk_bf16_f32 v42, v28, v29
    v_cvt_pk_bf16_f32 v43, v30, v31
    v_add_f32 v24, v24, v25
    v_add_f32 v26, v26, v27
    v_add_f32 v28, v28, v29
    v_add_f32 v30, v30, v31
    v_add_f32 v24, v24, v26
    v_add_f32 v28, v28, v30
    v_add_f32 v18, v24, v28
    v_cmp_lt_f32 vcc, s65, v18
    s_cbranch_vccnz m_a1_c15_0_slow
m_a1_c15_0_back:
    v_add_f32 v16, v16, v18
    s_waitcnt lgkmcnt(0)
    v_mfma_f32_16x16x32_bf16 v[160:163], v[128:131], v[40:43], v[160:163]
    ds_read_b128 v[96:99], v0 offset:0
    ds_read_b128 v[100:103], v1 offset:0
    v_mfma_f32_16x16x32_bf16 v[168:171], v[132:135], v[40:43], v[168:171]
    ds_read_b128 v[104:107], v2 offset:0
    ds_read_b128 v[108:111], v3 offset:0
    v_mfma_f32_16x16x32_bf16 v[176:179], v[136:139], v[40:43], v[176:179]
    ds_read_b128 v[112:115], v0 offset:4096
    ds_read_b128 v[116:119], v1 offset:4096
    v_mfma_f32_16x16x32_bf16 v[184:187], v[140:143], v[40:43], v[184:187]
    ds_read_b128 v[120:123], v2 offset:4096
    ds_read_b128 v[124:127], v3 offset:4096
    v_mfma_f32_16x16x32_bf16 v[192:195], v[144:147], v[40:43], v[192:195]
    v_mfma_f32_16x16x32_bf16 v[200:203], v[148:151], v[40:43], v[200:203]
    v_mfma_f32_16x16x32_bf16 v[208:211], v[152:155], v[40:43], v[208:211]
    v_mfma_f32_16x16x32_bf16 v[216:219], v[156:159], v[40:43], v[216:219]
    s_waitcnt lgkmcnt(0)
    v_mov_b32 v22, v16
    s_nop 1
    v_permlane16_swap_b32 v16, v22
    v_add_f32 v16, v16, v22
    v_mov_b32 v22, v16
    s_nop 1
    v_permlane32_swap_b32 v16, v22
    v_add_f32 v16, v16, v22
    v_rcp_f32 v16, v16
    s_nop 0
    v_mul_f32 v160, v160, v16
    v_mul_f32 v161, v161, v16
    v_mul_f32 v162, v162, v16
    v_mul_f32 v163, v163, v16
    v_cvt_pk_bf16_f32 v128, v160, v161
    v_cvt_pk_bf16_f32 v129, v162, v163
    v_mul_f32 v168, v168, v16
    v_mul_f32 v169, v169, v16
    v_mul_f32 v170, v170, v16
    v_mul_f32 v171, v171, v16
    v_cvt_pk_bf16_f32 v130, v168, v169
    v_cvt_pk_bf16_f32 v131, v170, v171
    v_mul_f32 v176, v176, v16
    v_mul_f32 v177, v177, v16
    v_mul_f32 v178, v178, v16
    v_mul_f32 v179, v179, v16
    v_cvt_pk_bf16_f32 v132, v176, v177
    v_cvt_pk_bf16_f32 v133, v178, v179
    v_mul_f32 v184, v184, v16
    v_mul_f32 v185, v185, v16
    v_mul_f32 v186, v186, v16
    v_mul_f32 v187, v187, v16
    v_cvt_pk_bf16_f32 v134, v184, v185
    v_cvt_pk_bf16_f32 v135, v186, v187
    v_mul_f32 v192, v192, v16
    v_mul_f32 v193, v193, v16
    v_mul_f32 v194, v194, v16
    v_mul_f32 v195, v195, v16
    v_cvt_pk_bf16_f32 v136, v192, v193
    v_cvt_pk_bf16_f32 v137, v194, v195
    v_mul_f32 v200, v200, v16
    v_mul_f32 v201, v201, v16
    v_mul_f32 v202, v202, v16
    v_mul_f32 v203, v203, v16
    v_cvt_pk_bf16_f32 v138, v200, v201
    v_cvt_pk_bf16_f32 v139, v202, v203
    v_mul_f32 v208, v208, v16
    v_mul_f32 v209, v209, v16
    v_mul_f32 v210, v210, v16
    v_mul_f32 v211, v211, v16
    v_cvt_pk_bf16_f32 v140, v208, v209
    v_cvt_pk_bf16_f32 v141, v210, v211
    v_mul_f32 v216, v216, v16
    v_mul_f32 v217, v217, v16
    v_mul_f32 v218, v218, v16
    v_mul_f32 v219, v219, v16
    v_cvt_pk_bf16_f32 v142, v216, v217
    v_cvt_pk_bf16_f32 v143, v218, v219
    s_cmp_eq_u32 s29, 1
    s_cbranch_scc0 m_a1_e2
    v_mov_b32 v224, v128
    v_mov_b32 v225, v129
    v_mov_b32 v226, v130
    v_mov_b32 v227, v131
    v_mov_b32 v228, v132
    v_mov_b32 v229, v133
    v_mov_b32 v230, v134
    v_mov_b32 v231, v135
    v_mov_b32 v232, v136
    v_mov_b32 v233, v137
    v_mov_b32 v234, v138
    v_mov_b32 v235, v139
    v_mov_b32 v236, v140
    v_mov_b32 v237, v141
    v_mov_b32 v238, v142
    v_mov_b32 v239, v143
m_a1_e2:
    s_add_u32 s63, s63, 28672
    s_add_u32 s29, s29, 1
    s_mov_b32 s85, 106496
    s_cmp_eq_u32 s29, 1
    s_cselect_b32 s85, 135168, s85
    s_cmp_eq_u32 s29, 2
    s_cselect_b32 s85, 65536, s85
    s_cmp_lt_u32 s29, 4
    s_cbranch_scc1 m_a1_loop
    v_add_u32 v12, 106496, v13
    s_waitcnt vmcnt(0)
    ds_read_b128 v[160:163], v12 offset:28672
    ds_read_b128 v[164:167], v12 offset:29696
    ds_read_b128 v[168:171], v12 offset:30720
    ds_read_b128 v[172:175], v12 offset:31744
    ds_read_b128 v[192:195], v12 offset:0
    ds_read_b128 v[196:199], v12 offset:1024
    ds_read_b128 v[200:203], v12 offset:2048
    ds_read_b128 v[204:207], v12 offset:3072
    s_mov_b32 s12, s58
    s_and_b32 s13, s59, 0xffff
    s_mov_b32 s14, 5242880
    s_mov_b32 s15, 0x00020000
    s_lshl_b32 s70, s25, 4
    s_add_u32 s70, s70, s26
    s_lshl_b32 s70, s70, 3
    s_add_u32 s70, s70, s27
    s_mul_i32 s70, s70, 163840
    s_add_u32 s4, s56, s70
    s_addc_u32 s5, s57, 0
    s_and_b32 s5, s5, 0xffff
    s_mov_b32 s6, 163840
    s_mov_b32 s7, 0x00020000
    s_mul_i32 s70, s28, 5120
    s_add_u32 s72, s70, 102400
    s_add_u32 s73, s70, 0
    s_add_u32 s74, s70, 40960
    s_add_u32 s97, s70, 61440
    s_mul_i32 s75, s27, 655360
    s_mov_b32 s76, 0
    v_mbcnt_lo_u32_b32 v0, -1, 0
    v_mbcnt_hi_u32_b32 v0, -1, v0
    s_lshl_b32 s71, s28, 5
    s_mov_b32 s77, 6554
    v_add_u32 v56, 0, v0
    v_mul_lo_u32 v57, v56, s77
    v_lshrrev_b32 v57, 16, v57
    v_mul_u32_u24 v58, 10, v57
    v_sub_u32 v58, v56, v58
    v_add_u32 v57, s71, v57
    v_mul_u32_u24 v57, 1280, v57
    v_lshl_add_u32 v4, v58, 4, v57
    v_add_u32 v56, 64, v0
    v_mul_lo_u32 v57, v56, s77
    v_lshrrev_b32 v57, 16, v57
    v_mul_u32_u24 v58, 10, v57
    v_sub_u32 v58, v56, v58
    v_add_u32 v57, s71, v57
    v_mul_u32_u24 v57, 1280, v57
    v_lshl_add_u32 v5, v58, 4, v57
    v_add_u32 v56, 128, v0
    v_mul_lo_u32 v57, v56, s77
    v_lshrrev_b32 v57, 16, v57
    v_mul_u32_u24 v58, 10, v57
    v_sub_u32 v58, v56, v58
    v_add_u32 v57, s71, v57
    v_mul_u32_u24 v57, 1280, v57
    v_lshl_add_u32 v6, v58, 4, v57
    v_add_u32 v56, 192, v0
    v_mul_lo_u32 v57, v56, s77
    v_lshrrev_b32 v57, 16, v57
    v_mul_u32_u24 v58, 10, v57
    v_sub_u32 v58, v56, v58
    v_add_u32 v57, s71, v57
    v_mul_u32_u24 v57, 1280, v57
    v_lshl_add_u32 v7, v58, 4, v57
    v_add_u32 v56, 256, v0
    v_mul_lo_u32 v57, v56, s77
    v_lshrrev_b32 v57, 16, v57
    v_mul_u32_u24 v58, 10, v57
    v_sub_u32 v58, v56, v58
    v_add_u32 v57, s71, v57
    v_mul_u32_u24 v57, 1280, v57
    v_lshl_add_u32 v8, v58, 4, v57
    v_lshrrev_b32 v56, 4, v0
    v_bfe_u32 v57, v0, 2, 2
    v_lshl_add_u32 v57, v56, 2, v57
    v_mul_u32_u24 v57, 160, v57
    v_and_b32 v58, 3, v0
    v_lshl_add_u32 v57, v58, 3, v57
    v_add_u32 v9, 102400, v57
    v_add_u32 v10, 0, v57
    v_add_u32 v11, 40960, v57
    v_add_u32 v63, 61440, v57
    v_add_u32 v61, 65536, v57
    v_lshlrev_b32 v57, 4, v0
    v_add_u32 v59, s70, v57
    s_lshl_b32 s71, s28, 13
    v_add_u32 v1, s71, v57
    s_lshl_b32 s70, s25, 4
    s_add_u32 s70, s70, s26
    s_lshl_b32 s71, s70, 10
    s_add_u32 s71, s71, 46137344
    s_add_u32 s88, s56, s71
    s_addc_u32 s89, s57, 0
    s_and_b32 s89, s89, 0xffff
    s_mov_b32 s90, 1024
    s_mov_b32 s91, 0x00020000
    s_mov_b32 s92, s86
    s_and_b32 s93, s87, 0xffff
    s_mov_b32 s94, 256
    s_mov_b32 s95, 0x00020000
    s_lshl_b32 s96, s70, 2
    s_add_u32 s96, s96, 128
    s_waitcnt lgkmcnt(0)
    ds_write_b128 v12, v[128:131] offset:0
    ds_write_b128 v12, v[132:135] offset:1024
    ds_write_b128 v12, v[136:139] offset:2048
    ds_write_b128 v12, v[140:143] offset:3072
    s_waitcnt lgkmcnt(0)
    s_barrier
    s_add_u32 s62, s75, 163840
    s_add_u32 m0, s73, 0
    s_nop 0
    buffer_load_dwordx4 v4, s[12:15], s62 offen lds
    s_add_u32 m0, s73, 1024
    s_nop 0
    buffer_load_dwordx4 v5, s[12:15], s62 offen lds
    s_add_u32 m0, s73, 2048
    s_nop 0
    buffer_load_dwordx4 v6, s[12:15], s62 offen lds
    s_add_u32 m0, s73, 3072
    s_nop 0
    buffer_load_dwordx4 v7, s[12:15], s62 offen lds
    s_add_u32 m0, s73, 4096
    s_nop 0
    buffer_load_dwordx4 v8, s[12:15], s62 offen lds
    s_branch m_tail1
m_a1_c1_0_slow:
    s_call_b64 s[30:31], m_a1_slow0
    s_branch m_a1_c1_0_back
m_a1_c2_0_slow:
    s_call_b64 s[30:31], m_a1_slow0
    s_branch m_a1_c2_0_back
m_a1_c3_0_slow:
    s_call_b64 s[30:31], m_a1_slow0
    s_branch m_a1_c3_0_back
m_a1_c4_0_slow:
    s_call_b64 s[30:31], m_a1_slow0
    s_branch m_a1_c4_0_back
m_a1_c5_0_slow:
    s_call_b64 s[30:31], m_a1_slow0
    s_branch m_a1_c5_0_back
m_a1_c6_0_slow:
    s_call_b64 s[30:31], m_a1_slow0
    s_branch m_a1_c6_0_back
m_a1_c7_0_slow:
    s_call_b64 s[30:31], m_a1_slow0
    s_branch m_a1_c7_0_back
m_a1_c8_0_slow:
    s_call_b64 s[30:31], m_a1_slow0
    s_branch m_a1_c8_0_back
m_a1_c9_0_slow:
    s_call_b64 s[30:31], m_a1_slow0
    s_branch m_a1_c9_0_back
m_a1_c10_0_slow:
    s_call_b64 s[30:31], m_a1_slow0
    s_branch m_a1_c10_0_back
m_a1_c11_0_slow:
    s_call_b64 s[30:31], m_a1_slow0
    s_branch m_a1_c11_0_back
m_a1_c12_0_slow:
    s_call_b64 s[30:31], m_a1_slow0
    s_branch m_a1_c12_0_back
m_a1_c13_0_slow:
    s_call_b64 s[30:31], m_a1_slow0
    s_branch m_a1_c13_0_back
m_a1_c14_0_slow:
    s_call_b64 s[30:31], m_a1_slow0
    s_branch m_a1_c14_0_back
m_a1_c15_0_slow:
    s_call_b64 s[30:31], m_a1_slow0
    s_branch m_a1_c15_0_back
m_a1_slow0:
    s_nop 7
    v_max3_f32 v20, v48, v49, v50
    v_max3_f32 v22, v56, v57, v58
    v_max3_f32 v20, v20, v51, v59
    v_max_f32 v20, v20, v22
    v_mov_b32 v22, v20
    s_nop 1
    v_permlane16_swap_b32 v20, v22
    v_max_f32 v20, v20, v22
    v_mov_b32 v22, v20
    s_nop 1
    v_permlane32_swap_b32 v20, v22
    v_max_f32 v20, v20, v22
    v_max_f32 v20, 0, v20
    v_sub_f32 v22, 0, v20
    v_exp_f32 v23, v22
    v_sub_f32 v32, v32, v20
    v_sub_f32 v33, v33, v20
    v_sub_f32 v34, v34, v20
    v_sub_f32 v35, v35, v20
    v_sub_f32 v48, v48, v20
    v_sub_f32 v49, v49, v20
    v_sub_f32 v50, v50, v20
    v_sub_f32 v51, v51, v20
    v_sub_f32 v56, v56, v20
    v_sub_f32 v57, v57, v20
    v_sub_f32 v58, v58, v20
    v_sub_f32 v59, v59, v20
    v_mul_f32 v16, v16, v23
    v_mul_f32 v160, v160, v23
    v_mul_f32 v161, v161, v23
    v_mul_f32 v162, v162, v23
    v_mul_f32 v163, v163, v23
    v_mul_f32 v168, v168, v23
    v_mul_f32 v169, v169, v23
    v_mul_f32 v170, v170, v23
    v_mul_f32 v171, v171, v23
    v_mul_f32 v176, v176, v23
    v_mul_f32 v177, v177, v23
    v_mul_f32 v178, v178, v23
    v_mul_f32 v179, v179, v23
    v_mul_f32 v184, v184, v23
    v_mul_f32 v185, v185, v23
    v_mul_f32 v186, v186, v23
    v_mul_f32 v187, v187, v23
    v_mul_f32 v192, v192, v23
    v_mul_f32 v193, v193, v23
    v_mul_f32 v194, v194, v23
    v_mul_f32 v195, v195, v23
    v_mul_f32 v200, v200, v23
    v_mul_f32 v201, v201, v23
    v_mul_f32 v202, v202, v23
    v_mul_f32 v203, v203, v23
    v_mul_f32 v208, v208, v23
    v_mul_f32 v209, v209, v23
    v_mul_f32 v210, v210, v23
    v_mul_f32 v211, v211, v23
    v_mul_f32 v216, v216, v23
    v_mul_f32 v217, v217, v23
    v_mul_f32 v218, v218, v23
    v_mul_f32 v219, v219, v23
    v_exp_f32 v24, v48
    v_exp_f32 v25, v49
    v_exp_f32 v26, v50
    v_exp_f32 v27, v51
    v_exp_f32 v28, v56
    v_exp_f32 v29, v57
    v_exp_f32 v30, v58
    v_exp_f32 v31, v59
    v_cvt_pk_bf16_f32 v40, v24, v25
    v_cvt_pk_bf16_f32 v41, v26, v27
    v_cvt_pk_bf16_f32 v42, v28, v29
    v_cvt_pk_bf16_f32 v43, v30, v31
    v_add_f32 v24, v24, v25
    v_add_f32 v26, v26, v27
    v_add_f32 v28, v28, v29
    v_add_f32 v30, v30, v31
    v_add_f32 v24, v24, v26
    v_add_f32 v28, v28, v30
    v_add_f32 v18, v24, v28
    s_nop 7
    s_setpc_b64 s[30:31]
m_p1:
    s_sub_u32 s28, s24, 4
    s_setprio 0
    s_lshl_b32 s66, s28, 11
    s_mov_b32 s60, 0
    v_lshrrev_b32 v1, 4, v255
    s_lshl_b32 s70, s28, 3
    v_add_u32 v4, s70, v1
    v_and_b32 v5, 15, v255
    v_add_u32 v6, 0, v4
    v_and_b32 v7, 15, v6
    v_xor_b32 v7, v7, v5
    v_lshlrev_b32 v7, 4, v7
    v_lshl_add_u32 v13, v4, 8, v7
    v_and_b32 v7, 7, v6
    v_lshlrev_b32 v7, 1, v7
    v_xor_b32 v7, v7, v5
    v_lshlrev_b32 v7, 4, v7
    v_lshl_add_u32 v15, v4, 8, v7
    v_add_u32 v6, 4, v4
    v_and_b32 v7, 15, v6
    v_xor_b32 v7, v7, v5
    v_lshlrev_b32 v7, 4, v7
    v_lshl_add_u32 v14, v4, 8, v7
    v_and_b32 v7, 7, v6
    v_lshlrev_b32 v7, 1, v7
    v_xor_b32 v7, v7, v5
    v_lshlrev_b32 v7, 4, v7
    v_lshl_add_u32 v16, v4, 8, v7
    s_waitcnt vmcnt(4)
    s_barrier
    s_add_u32 s62, s84, 32768
    s_and_b32 s62, s62, 0x1ffff
    s_add_u32 s62, s62, s60
    s_add_u32 m0, s66, 0
    s_nop 0
    buffer_load_dwordx4 v13, s[4:7], s62 offen nt lds
    buffer_load_dwordx4 v14, s[4:7], s62 offen offset:1024 nt lds
    s_add_u32 s62, s84, 24576
    s_and_b32 s62, s62, 0x1ffff
    s_add_u32 s62, s62, s60
    s_add_u32 m0, s66, 57344
    s_nop 0
    buffer_load_dwordx4 v15, s[8:11], s62 offen nt lds
    buffer_load_dwordx4 v16, s[8:11], s62 offen offset:1024 nt lds
    s_waitcnt vmcnt(6)
    s_barrier
    s_add_u32 s62, s84, 40960
    s_and_b32 s62, s62, 0x1ffff
    s_add_u32 s62, s62, s60
    s_add_u32 m0, s66, 16384
    s_nop 0
    buffer_load_dwordx4 v13, s[4:7], s62 offen nt lds
    buffer_load_dwordx4 v14, s[4:7], s62 offen offset:1024 nt lds
    s_add_u32 s62, s84, 32768
    s_and_b32 s62, s62, 0x1ffff
    s_add_u32 s62, s62, s60
    s_add_u32 m0, s66, 8192
    s_nop 0
    buffer_load_dwordx4 v15, s[8:11], s62 offen nt lds
    buffer_load_dwordx4 v16, s[8:11], s62 offen offset:1024 nt lds
    s_cmp_lt_u32 s28, 2
    s_cbranch_scc1 m_p1_noq3
    ds_write_b64 v248, v[128:129] offset:0
    ds_write_b64 v248, v[132:133] offset:4096
    ds_write_b64 v248, v[136:137] offset:8192
    ds_write_b64 v248, v[140:141] offset:12288
    ds_write_b64 v248, v[144:145] offset:16384
    ds_write_b64 v248, v[148:149] offset:20480
    ds_write_b64 v248, v[152:153] offset:24576
    ds_write_b64 v248, v[156:157] offset:512
    ds_write_b64 v248, v[160:161] offset:4608
    ds_write_b64 v248, v[164:165] offset:8704
    ds_write_b64 v248, v[168:169] offset:12800
    ds_write_b64 v248, v[172:173] offset:16896
    ds_write_b64 v248, v[176:177] offset:20992
    ds_write_b64 v248, v[180:181] offset:25088
    ds_write_b64 v248, v[184:185] offset:1024
    s_waitcnt lgkmcnt(14)
    ds_write_b64 v248, v[188:189] offset:5120
    s_waitcnt lgkmcnt(14)
    ds_write_b64 v248, v[192:193] offset:9216
    s_waitcnt lgkmcnt(14)
    ds_write_b64 v248, v[196:197] offset:13312
    s_waitcnt lgkmcnt(14)
    ds_write_b64 v248, v[200:201] offset:17408
    s_waitcnt lgkmcnt(14)
    ds_write_b64 v248, v[204:205] offset:21504
    s_waitcnt lgkmcnt(14)
    ds_write_b64 v248, v[208:209] offset:25600
    s_waitcnt lgkmcnt(14)
    ds_write_b64 v248, v[212:213] offset:1536
    s_waitcnt lgkmcnt(14)
    ds_write_b64 v248, v[216:217] offset:5632
    s_waitcnt lgkmcnt(14)
    ds_write_b64 v248, v[220:221] offset:9728
    s_waitcnt lgkmcnt(14)
    ds_write_b64 v248, v[224:225] offset:13824
    s_waitcnt lgkmcnt(14)
    ds_write_b64 v248, v[228:229] offset:17920
    s_waitcnt lgkmcnt(14)
    ds_write_b64 v248, v[232:233] offset:22016
    s_waitcnt lgkmcnt(14)
    ds_write_b64 v248, v[236:237] offset:26112
    s_waitcnt lgkmcnt(0)
m_p1_noq3:
    s_waitcnt vmcnt(8)
    s_barrier
    s_add_u32 s62, s84, 49152
    s_and_b32 s62, s62, 0x1ffff
    s_add_u32 s62, s62, s60
    s_add_u32 m0, s66, 32768
    s_nop 0
    buffer_load_dwordx4 v13, s[4:7], s62 offen nt lds
    buffer_load_dwordx4 v14, s[4:7], s62 offen offset:1024 nt lds
    s_add_u32 s62, s84, 40960
    s_and_b32 s62, s62, 0x1ffff
    s_add_u32 s62, s62, s60
    s_add_u32 m0, s66, 24576
    s_nop 0
    buffer_load_dwordx4 v15, s[8:11], s62 offen nt lds
    buffer_load_dwordx4 v16, s[8:11], s62 offen offset:1024 nt lds
    s_waitcnt vmcnt(8)
    s_barrier
    s_add_u32 s62, s84, 57344
    s_and_b32 s62, s62, 0x1ffff
    s_add_u32 s62, s62, s60
    s_add_u32 m0, s66, 49152
    s_nop 0
    buffer_load_dwordx4 v13, s[4:7], s62 offen nt lds
    buffer_load_dwordx4 v14, s[4:7], s62 offen offset:1024 nt lds
    s_add_u32 s62, s84, 49152
    s_and_b32 s62, s62, 0x1ffff
    s_add_u32 s62, s62, s60
    s_add_u32 m0, s66, 40960
    s_nop 0
    buffer_load_dwordx4 v15, s[8:11], s62 offen nt lds
    buffer_load_dwordx4 v16, s[8:11], s62 offen offset:1024 nt lds
    s_waitcnt vmcnt(8)
    s_barrier
    s_add_u32 s62, s84, 65536
    s_and_b32 s62, s62, 0x1ffff
    s_add_u32 s62, s62, s60
    s_add_u32 m0, s66, 0
    s_nop 0
    buffer_load_dwordx4 v13, s[4:7], s62 offen nt lds
    buffer_load_dwordx4 v14, s[4:7], s62 offen offset:1024 nt lds
    s_add_u32 s62, s84, 57344
    s_and_b32 s62, s62, 0x1ffff
    s_add_u32 s62, s62, s60
    s_add_u32 m0, s66, 57344
    s_nop 0
    buffer_load_dwordx4 v15, s[8:11], s62 offen nt lds
    buffer_load_dwordx4 v16, s[8:11], s62 offen offset:1024 nt lds
    s_waitcnt vmcnt(8)
    s_barrier
    s_add_u32 s62, s84, 73728
    s_and_b32 s62, s62, 0x1ffff
    s_add_u32 s62, s62, s60
    s_add_u32 m0, s66, 16384
    s_nop 0
    buffer_load_dwordx4 v13, s[4:7], s62 offen nt lds
    buffer_load_dwordx4 v14, s[4:7], s62 offen offset:1024 nt lds
    s_add_u32 s62, s84, 65536
    s_and_b32 s62, s62, 0x1ffff
    s_add_u32 s62, s62, s60
    s_add_u32 m0, s66, 8192
    s_nop 0
    buffer_load_dwordx4 v15, s[8:11], s62 offen nt lds
    buffer_load_dwordx4 v16, s[8:11], s62 offen offset:1024 nt lds
    s_waitcnt vmcnt(8)
    s_barrier
    s_add_u32 s62, s84, 81920
    s_and_b32 s62, s62, 0x1ffff
    s_add_u32 s62, s62, s60
    s_add_u32 m0, s66, 32768
    s_nop 0
    buffer_load_dwordx4 v13, s[4:7], s62 offen nt lds
    buffer_load_dwordx4 v14, s[4:7], s62 offen offset:1024 nt lds
    s_add_u32 s62, s84, 73728
    s_and_b32 s62, s62, 0x1ffff
    s_add_u32 s62, s62, s60
    s_add_u32 m0, s66, 24576
    s_nop 0
    buffer_load_dwordx4 v15, s[8:11], s62 offen nt lds
    buffer_load_dwordx4 v16, s[8:11], s62 offen offset:1024 nt lds
    s_waitcnt vmcnt(8)
    s_barrier
    s_add_u32 s62, s84, 90112
    s_and_b32 s62, s62, 0x1ffff
    s_add_u32 s62, s62, s60
    s_add_u32 m0, s66, 49152
    s_nop 0
    buffer_load_dwordx4 v13, s[4:7], s62 offen nt lds
    buffer_load_dwordx4 v14, s[4:7], s62 offen offset:1024 nt lds
    s_add_u32 s62, s84, 81920
    s_and_b32 s62, s62, 0x1ffff
    s_add_u32 s62, s62, s60
    s_add_u32 m0, s66, 40960
    s_nop 0
    buffer_load_dwordx4 v15, s[8:11], s62 offen nt lds
    buffer_load_dwordx4 v16, s[8:11], s62 offen offset:1024 nt lds
    s_waitcnt vmcnt(8)
    s_barrier
    s_add_u32 s62, s84, 98304
    s_and_b32 s62, s62, 0x1ffff
    s_add_u32 s62, s62, s60
    s_add_u32 m0, s66, 0
    s_nop 0
    buffer_load_dwordx4 v13, s[4:7], s62 offen nt lds
    buffer_load_dwordx4 v14, s[4:7], s62 offen offset:1024 nt lds
    s_add_u32 s62, s84, 90112
    s_and_b32 s62, s62, 0x1ffff
    s_add_u32 s62, s62, s60
    s_add_u32 m0, s66, 57344
    s_nop 0
    buffer_load_dwordx4 v15, s[8:11], s62 offen nt lds
    buffer_load_dwordx4 v16, s[8:11], s62 offen offset:1024 nt lds
    s_waitcnt vmcnt(8)
    s_barrier
    s_add_u32 s62, s84, 106496
    s_and_b32 s62, s62, 0x1ffff
    s_add_u32 s62, s62, s60
    s_add_u32 m0, s66, 16384
    s_nop 0
    buffer_load_dwordx4 v13, s[4:7], s62 offen nt lds
    buffer_load_dwordx4 v14, s[4:7], s62 offen offset:1024 nt lds
    s_add_u32 s62, s84, 98304
    s_and_b32 s62, s62, 0x1ffff
    s_add_u32 s62, s62, s60
    s_add_u32 m0, s66, 8192
    s_nop 0
    buffer_load_dwordx4 v15, s[8:11], s62 offen nt lds
    buffer_load_dwordx4 v16, s[8:11], s62 offen offset:1024 nt lds
    s_waitcnt vmcnt(8)
    s_barrier
    s_add_u32 s62, s84, 114688
    s_and_b32 s62, s62, 0x1ffff
    s_add_u32 s62, s62, s60
    s_add_u32 m0, s66, 32768
    s_nop 0
    buffer_load_dwordx4 v13, s[4:7], s62 offen nt lds
    buffer_load_dwordx4 v14, s[4:7], s62 offen offset:1024 nt lds
    s_add_u32 s62, s84, 106496
    s_and_b32 s62, s62, 0x1ffff
    s_add_u32 s62, s62, s60
    s_add_u32 m0, s66, 24576
    s_nop 0
    buffer_load_dwordx4 v15, s[8:11], s62 offen nt lds
    buffer_load_dwordx4 v16, s[8:11], s62 offen offset:1024 nt lds
    s_waitcnt vmcnt(8)
    s_barrier
    s_add_u32 s62, s84, 122880
    s_and_b32 s62, s62, 0x1ffff
    s_add_u32 s62, s62, s60
    s_add_u32 m0, s66, 49152
    s_nop 0
    buffer_load_dwordx4 v13, s[4:7], s62 offen nt lds
    buffer_load_dwordx4 v14, s[4:7], s62 offen offset:1024 nt lds
    s_add_u32 s62, s84, 114688
    s_and_b32 s62, s62, 0x1ffff
    s_add_u32 s62, s62, s60
    s_add_u32 m0, s66, 40960
    s_nop 0
    buffer_load_dwordx4 v15, s[8:11], s62 offen nt lds
    buffer_load_dwordx4 v16, s[8:11], s62 offen offset:1024 nt lds
    s_waitcnt vmcnt(8)
    s_barrier
    s_add_u32 s62, s84, 0
    s_and_b32 s62, s62, 0x1ffff
    s_add_u32 s62, s62, s60
    s_add_u32 s62, s62, 131072
    s_add_u32 m0, s66, 0
    s_nop 0
    buffer_load_dwordx4 v13, s[4:7], s62 offen nt lds
    buffer_load_dwordx4 v14, s[4:7], s62 offen offset:1024 nt lds
    s_add_u32 s62, s84, 122880
    s_and_b32 s62, s62, 0x1ffff
    s_add_u32 s62, s62, s60
    s_add_u32 m0, s66, 57344
    s_nop 0
    buffer_load_dwordx4 v15, s[8:11], s62 offen nt lds
    buffer_load_dwordx4 v16, s[8:11], s62 offen offset:1024 nt lds
    s_waitcnt vmcnt(8)
    s_barrier
    s_add_u32 s62, s84, 8192
    s_and_b32 s62, s62, 0x1ffff
    s_add_u32 s62, s62, s60
    s_add_u32 s62, s62, 131072
    s_add_u32 m0, s66, 16384
    s_nop 0
    buffer_load_dwordx4 v13, s[4:7], s62 offen nt lds
    buffer_load_dwordx4 v14, s[4:7], s62 offen offset:1024 nt lds
    s_add_u32 s62, s84, 0
    s_and_b32 s62, s62, 0x1ffff
    s_add_u32 s62, s62, s60
    s_add_u32 s62, s62, 131072
    s_add_u32 m0, s66, 8192
    s_nop 0
    buffer_load_dwordx4 v15, s[8:11], s62 offen nt lds
    buffer_load_dwordx4 v16, s[8:11], s62 offen offset:1024 nt lds
    s_waitcnt vmcnt(8)
    s_barrier
    s_add_u32 s62, s84, 16384
    s_and_b32 s62, s62, 0x1ffff
    s_add_u32 s62, s62, s60
    s_add_u32 s62, s62, 131072
    s_add_u32 m0, s66, 32768
    s_nop 0
    buffer_load_dwordx4 v13, s[4:7], s62 offen nt lds
    buffer_load_dwordx4 v14, s[4:7], s62 offen offset:1024 nt lds
    s_add_u32 s62, s84, 8192
    s_and_b32 s62, s62, 0x1ffff
    s_add_u32 s62, s62, s60
    s_add_u32 s62, s62, 131072
    s_add_u32 m0, s66, 24576
    s_nop 0
    buffer_load_dwordx4 v15, s[8:11], s62 offen nt lds
    buffer_load_dwordx4 v16, s[8:11], s62 offen offset:1024 nt lds
    s_waitcnt vmcnt(8)
    s_barrier
    s_add_u32 s62, s84, 24576
    s_and_b32 s62, s62, 0x1ffff
    s_add_u32 s62, s62, s60
    s_add_u32 s62, s62, 131072
    s_add_u32 m0, s66, 49152
    s_nop 0
    buffer_load_dwordx4 v13, s[4:7], s62 offen nt lds
    buffer_load_dwordx4 v14, s[4:7], s62 offen offset:1024 nt lds
    s_add_u32 s62, s84, 16384
    s_and_b32 s62, s62, 0x1ffff
    s_add_u32 s62, s62, s60
    s_add_u32 s62, s62, 131072
    s_add_u32 m0, s66, 40960
    s_nop 0
    buffer_load_dwordx4 v15, s[8:11], s62 offen nt lds
    buffer_load_dwordx4 v16, s[8:11], s62 offen offset:1024 nt lds
    s_waitcnt vmcnt(8)
    s_barrier
    s_add_u32 s60, s60, 131072
    s_add_u32 s62, s84, 32768
    s_and_b32 s62, s62, 0x1ffff
    s_add_u32 s62, s62, s60
    s_add_u32 m0, s66, 0
    s_nop 0
    buffer_load_dwordx4 v13, s[4:7], s62 offen nt lds
    buffer_load_dwordx4 v14, s[4:7], s62 offen offset:1024 nt lds
    s_add_u32 s62, s84, 24576
    s_and_b32 s62, s62, 0x1ffff
    s_add_u32 s62, s62, s60
    s_add_u32 m0, s66, 57344
    s_nop 0
    buffer_load_dwordx4 v15, s[8:11], s62 offen nt lds
    buffer_load_dwordx4 v16, s[8:11], s62 offen offset:1024 nt lds
    s_waitcnt vmcnt(8)
    s_barrier
    s_add_u32 s62, s84, 40960
    s_and_b32 s62, s62, 0x1ffff
    s_add_u32 s62, s62, s60
    s_add_u32 m0, s66, 16384
    s_nop 0
    buffer_load_dwordx4 v13, s[4:7], s62 offen nt lds
    buffer_load_dwordx4 v14, s[4:7], s62 offen offset:1024 nt lds
    s_add_u32 s62, s84, 32768
    s_and_b32 s62, s62, 0x1ffff
    s_add_u32 s62, s62, s60
    s_add_u32 m0, s66, 8192
    s_nop 0
    buffer_load_dwordx4 v15, s[8:11], s62 offen nt lds
    buffer_load_dwordx4 v16, s[8:11], s62 offen offset:1024 nt lds
    s_waitcnt vmcnt(8)
    s_barrier
    s_add_u32 s62, s84, 49152
    s_and_b32 s62, s62, 0x1ffff
    s_add_u32 s62, s62, s60
    s_add_u32 m0, s66, 32768
    s_nop 0
    buffer_load_dwordx4 v13, s[4:7], s62 offen nt lds
    buffer_load_dwordx4 v14, s[4:7], s62 offen offset:1024 nt lds
    s_add_u32 s62, s84, 40960
    s_and_b32 s62, s62, 0x1ffff
    s_add_u32 s62, s62, s60
    s_add_u32 m0, s66, 24576
    s_nop 0
    buffer_load_dwordx4 v15, s[8:11], s62 offen nt lds
    buffer_load_dwordx4 v16, s[8:11], s62 offen offset:1024 nt lds
    v_mbcnt_lo_u32_b32 v18, -1, 0
    v_mbcnt_hi_u32_b32 v18, -1, v18
    v_lshlrev_b32 v18, 4, v18
    s_lshl_b32 s70, s28, 13
    s_add_u32 s70, s70, 106496
    v_add_u32 v18, s70, v18
    ds_read_b128 v[160:163], v18 offset:28672
    ds_read_b128 v[164:167], v18 offset:29696
    ds_read_b128 v[168:171], v18 offset:30720
    ds_read_b128 v[172:175], v18 offset:31744
    s_waitcnt lgkmcnt(0)
    s_waitcnt vmcnt(8)
    s_barrier
    s_add_u32 s62, s84, 57344
    s_and_b32 s62, s62, 0x1ffff
    s_add_u32 s62, s62, s60
    s_add_u32 m0, s66, 49152
    s_nop 0
    buffer_load_dwordx4 v13, s[4:7], s62 offen nt lds
    buffer_load_dwordx4 v14, s[4:7], s62 offen offset:1024 nt lds
    s_add_u32 s62, s84, 49152
    s_and_b32 s62, s62, 0x1ffff
    s_add_u32 s62, s62, s60
    s_add_u32 m0, s66, 40960
    s_nop 0
    buffer_load_dwordx4 v15, s[8:11], s62 offen nt lds
    buffer_load_dwordx4 v16, s[8:11], s62 offen offset:1024 nt lds
    s_waitcnt vmcnt(8)
    s_barrier
    s_add_u32 s62, s84, 65536
    s_and_b32 s62, s62, 0x1ffff
    s_add_u32 s62, s62, s60
    s_add_u32 m0, s66, 0
    s_nop 0
    buffer_load_dwordx4 v13, s[4:7], s62 offen nt lds
    buffer_load_dwordx4 v14, s[4:7], s62 offen offset:1024 nt lds
    s_add_u32 s62, s84, 57344
    s_and_b32 s62, s62, 0x1ffff
    s_add_u32 s62, s62, s60
    s_add_u32 m0, s66, 57344
    s_nop 0
    buffer_load_dwordx4 v15, s[8:11], s62 offen nt lds
    buffer_load_dwordx4 v16, s[8:11], s62 offen offset:1024 nt lds
    s_waitcnt vmcnt(8)
    s_barrier
    s_add_u32 s62, s84, 73728
    s_and_b32 s62, s62, 0x1ffff
    s_add_u32 s62, s62, s60
    s_add_u32 m0, s66, 16384
    s_nop 0
    buffer_load_dwordx4 v13, s[4:7], s62 offen nt lds
    buffer_load_dwordx4 v14, s[4:7], s62 offen offset:1024 nt lds
    s_add_u32 s62, s84, 65536
    s_and_b32 s62, s62, 0x1ffff
    s_add_u32 s62, s62, s60
    s_add_u32 m0, s66, 8192
    s_nop 0
    buffer_load_dwordx4 v15, s[8:11], s62 offen nt lds
    buffer_load_dwordx4 v16, s[8:11], s62 offen offset:1024 nt lds
    s_waitcnt vmcnt(8)
    s_barrier
    s_add_u32 s62, s84, 81920
    s_and_b32 s62, s62, 0x1ffff
    s_add_u32 s62, s62, s60
    s_add_u32 m0, s66, 32768
    s_nop 0
    buffer_load_dwordx4 v13, s[4:7], s62 offen nt lds
    buffer_load_dwordx4 v14, s[4:7], s62 offen offset:1024 nt lds
    s_add_u32 s62, s84, 73728
    s_and_b32 s62, s62, 0x1ffff
    s_add_u32 s62, s62, s60
    s_add_u32 m0, s66, 24576
    s_nop 0
    buffer_load_dwordx4 v15, s[8:11], s62 offen nt lds
    buffer_load_dwordx4 v16, s[8:11], s62 offen offset:1024 nt lds
    s_waitcnt vmcnt(8)
    s_barrier
    s_add_u32 s62, s84, 90112
    s_and_b32 s62, s62, 0x1ffff
    s_add_u32 s62, s62, s60
    s_add_u32 m0, s66, 49152
    s_nop 0
    buffer_load_dwordx4 v13, s[4:7], s62 offen nt lds
    buffer_load_dwordx4 v14, s[4:7], s62 offen offset:1024 nt lds
    s_add_u32 s62, s84, 81920
    s_and_b32 s62, s62, 0x1ffff
    s_add_u32 s62, s62, s60
    s_add_u32 m0, s66, 40960
    s_nop 0
    buffer_load_dwordx4 v15, s[8:11], s62 offen nt lds
    buffer_load_dwordx4 v16, s[8:11], s62 offen offset:1024 nt lds
    s_waitcnt vmcnt(8)
    s_barrier
    s_add_u32 s62, s84, 98304
    s_and_b32 s62, s62, 0x1ffff
    s_add_u32 s62, s62, s60
    s_add_u32 m0, s66, 0
    s_nop 0
    buffer_load_dwordx4 v13, s[4:7], s62 offen nt lds
    buffer_load_dwordx4 v14, s[4:7], s62 offen offset:1024 nt lds
    s_add_u32 s62, s84, 90112
    s_and_b32 s62, s62, 0x1ffff
    s_add_u32 s62, s62, s60
    s_add_u32 m0, s66, 57344
    s_nop 0
    buffer_load_dwordx4 v15, s[8:11], s62 offen nt lds
    buffer_load_dwordx4 v16, s[8:11], s62 offen offset:1024 nt lds
    s_waitcnt vmcnt(8)
    s_barrier
    s_add_u32 s62, s84, 106496
    s_and_b32 s62, s62, 0x1ffff
    s_add_u32 s62, s62, s60
    s_add_u32 m0, s66, 16384
    s_nop 0
    buffer_load_dwordx4 v13, s[4:7], s62 offen nt lds
    buffer_load_dwordx4 v14, s[4:7], s62 offen offset:1024 nt lds
    s_add_u32 s62, s84, 98304
    s_and_b32 s62, s62, 0x1ffff
    s_add_u32 s62, s62, s60
    s_add_u32 m0, s66, 8192
    s_nop 0
    buffer_load_dwordx4 v15, s[8:11], s62 offen nt lds
    buffer_load_dwordx4 v16, s[8:11], s62 offen offset:1024 nt lds
    s_waitcnt vmcnt(8)
    s_barrier
    s_add_u32 s62, s84, 114688
    s_and_b32 s62, s62, 0x1ffff
    s_add_u32 s62, s62, s60
    s_add_u32 m0, s66, 32768
    s_nop 0
    buffer_load_dwordx4 v13, s[4:7], s62 offen nt lds
    buffer_load_dwordx4 v14, s[4:7], s62 offen offset:1024 nt lds
    s_add_u32 s62, s84, 106496
    s_and_b32 s62, s62, 0x1ffff
    s_add_u32 s62, s62, s60
    s_add_u32 m0, s66, 24576
    s_nop 0
    buffer_load_dwordx4 v15, s[8:11], s62 offen nt lds
    buffer_load_dwordx4 v16, s[8:11], s62 offen offset:1024 nt lds
    s_waitcnt vmcnt(8)
    s_barrier
    s_add_u32 s62, s84, 122880
    s_and_b32 s62, s62, 0x1ffff
    s_add_u32 s62, s62, s60
    s_add_u32 m0, s66, 49152
    s_nop 0
    buffer_load_dwordx4 v13, s[4:7], s62 offen nt lds
    buffer_load_dwordx4 v14, s[4:7], s62 offen offset:1024 nt lds
    s_add_u32 s62, s84, 114688
    s_and_b32 s62, s62, 0x1ffff
    s_add_u32 s62, s62, s60
    s_add_u32 m0, s66, 40960
    s_nop 0
    buffer_load_dwordx4 v15, s[8:11], s62 offen nt lds
    buffer_load_dwordx4 v16, s[8:11], s62 offen offset:1024 nt lds
    s_waitcnt vmcnt(8)
    s_barrier
    s_add_u32 s62, s84, 0
    s_and_b32 s62, s62, 0x1ffff
    s_add_u32 s62, s62, s60
    s_add_u32 s62, s62, 131072
    s_add_u32 m0, s66, 0
    s_nop 0
    buffer_load_dwordx4 v13, s[4:7], s62 offen nt lds
    buffer_load_dwordx4 v14, s[4:7], s62 offen offset:1024 nt lds
    s_add_u32 s62, s84, 122880
    s_and_b32 s62, s62, 0x1ffff
    s_add_u32 s62, s62, s60
    s_add_u32 m0, s66, 57344
    s_nop 0
    buffer_load_dwordx4 v15, s[8:11], s62 offen nt lds
    buffer_load_dwordx4 v16, s[8:11], s62 offen offset:1024 nt lds
    s_waitcnt vmcnt(8)
    s_barrier
    s_add_u32 s62, s84, 8192
    s_and_b32 s62, s62, 0x1ffff
    s_add_u32 s62, s62, s60
    s_add_u32 s62, s62, 131072
    s_add_u32 m0, s66, 16384
    s_nop 0
    buffer_load_dwordx4 v13, s[4:7], s62 offen nt lds
    buffer_load_dwordx4 v14, s[4:7], s62 offen offset:1024 nt lds
    s_add_u32 s62, s84, 0
    s_and_b32 s62, s62, 0x1ffff
    s_add_u32 s62, s62, s60
    s_add_u32 s62, s62, 131072
    s_add_u32 m0, s66, 8192
    s_nop 0
    buffer_load_dwordx4 v15, s[8:11], s62 offen nt lds
    buffer_load_dwordx4 v16, s[8:11], s62 offen offset:1024 nt lds
    s_waitcnt vmcnt(8)
    s_barrier
    s_add_u32 s62, s84, 16384
    s_and_b32 s62, s62, 0x1ffff
    s_add_u32 s62, s62, s60
    s_add_u32 s62, s62, 131072
    s_add_u32 m0, s66, 32768
    s_nop 0
    buffer_load_dwordx4 v13, s[4:7], s62 offen nt lds
    buffer_load_dwordx4 v14, s[4:7], s62 offen offset:1024 nt lds
    s_add_u32 s62, s84, 8192
    s_and_b32 s62, s62, 0x1ffff
    s_add_u32 s62, s62, s60
    s_add_u32 s62, s62, 131072
    s_add_u32 m0, s66, 24576
    s_nop 0
    buffer_load_dwordx4 v15, s[8:11], s62 offen nt lds
    buffer_load_dwordx4 v16, s[8:11], s62 offen offset:1024 nt lds
    s_waitcnt vmcnt(8)
    s_barrier
    s_add_u32 s62, s84, 24576
    s_and_b32 s62, s62, 0x1ffff
    s_add_u32 s62, s62, s60
    s_add_u32 s62, s62, 131072
    s_add_u32 m0, s66, 49152
    s_nop 0
    buffer_load_dwordx4 v13, s[4:7], s62 offen nt lds
    buffer_load_dwordx4 v14, s[4:7], s62 offen offset:1024 nt lds
    s_add_u32 s62, s84, 16384
    s_and_b32 s62, s62, 0x1ffff
    s_add_u32 s62, s62, s60
    s_add_u32 s62, s62, 131072
    s_add_u32 m0, s66, 40960
    s_nop 0
    buffer_load_dwordx4 v15, s[8:11], s62 offen nt lds
    buffer_load_dwordx4 v16, s[8:11], s62 offen offset:1024 nt lds
    s_waitcnt vmcnt(8)
    s_barrier
    s_add_u32 s60, s60, 131072
    s_add_u32 s62, s84, 32768
    s_and_b32 s62, s62, 0x1ffff
    s_add_u32 s62, s62, s60
    s_add_u32 m0, s66, 0
    s_nop 0
    buffer_load_dwordx4 v13, s[4:7], s62 offen nt lds
    buffer_load_dwordx4 v14, s[4:7], s62 offen offset:1024 nt lds
    s_add_u32 s62, s84, 24576
    s_and_b32 s62, s62, 0x1ffff
    s_add_u32 s62, s62, s60
    s_add_u32 m0, s66, 57344
    s_nop 0
    buffer_load_dwordx4 v15, s[8:11], s62 offen nt lds
    buffer_load_dwordx4 v16, s[8:11], s62 offen offset:1024 nt lds
    s_waitcnt vmcnt(8)
    s_barrier
    s_add_u32 s62, s84, 40960
    s_and_b32 s62, s62, 0x1ffff
    s_add_u32 s62, s62, s60
    s_add_u32 m0, s66, 16384
    s_nop 0
    buffer_load_dwordx4 v13, s[4:7], s62 offen nt lds
    buffer_load_dwordx4 v14, s[4:7], s62 offen offset:1024 nt lds
    s_add_u32 s62, s84, 32768
    s_and_b32 s62, s62, 0x1ffff
    s_add_u32 s62, s62, s60
    s_add_u32 m0, s66, 8192
    s_nop 0
    buffer_load_dwordx4 v15, s[8:11], s62 offen nt lds
    buffer_load_dwordx4 v16, s[8:11], s62 offen offset:1024 nt lds
    s_waitcnt vmcnt(8)
    s_barrier
    s_add_u32 s62, s84, 49152
    s_and_b32 s62, s62, 0x1ffff
    s_add_u32 s62, s62, s60
    s_add_u32 m0, s66, 32768
    s_nop 0
    buffer_load_dwordx4 v13, s[4:7], s62 offen nt lds
    buffer_load_dwordx4 v14, s[4:7], s62 offen offset:1024 nt lds
    s_add_u32 s62, s84, 40960
    s_and_b32 s62, s62, 0x1ffff
    s_add_u32 s62, s62, s60
    s_add_u32 m0, s66, 24576
    s_nop 0
    buffer_load_dwordx4 v15, s[8:11], s62 offen nt lds
    buffer_load_dwordx4 v16, s[8:11], s62 offen offset:1024 nt lds
    v_subrev_u32 v19, 40960, v18
    ds_read_b128 v[224:227], v19 offset:0
    ds_read_b128 v[228:231], v19 offset:1024
    ds_read_b128 v[232:235], v19 offset:2048
    ds_read_b128 v[236:239], v19 offset:3072
    s_waitcnt lgkmcnt(0)
    s_waitcnt vmcnt(8)
    s_barrier
    s_add_u32 s62, s84, 57344
    s_and_b32 s62, s62, 0x1ffff
    s_add_u32 s62, s62, s60
    s_add_u32 m0, s66, 49152
    s_nop 0
    buffer_load_dwordx4 v13, s[4:7], s62 offen nt lds
    buffer_load_dwordx4 v14, s[4:7], s62 offen offset:1024 nt lds
    s_add_u32 s62, s84, 49152
    s_and_b32 s62, s62, 0x1ffff
    s_add_u32 s62, s62, s60
    s_add_u32 m0, s66, 40960
    s_nop 0
    buffer_load_dwordx4 v15, s[8:11], s62 offen nt lds
    buffer_load_dwordx4 v16, s[8:11], s62 offen offset:1024 nt lds
    s_waitcnt vmcnt(8)
    s_barrier
    s_add_u32 s62, s84, 65536
    s_and_b32 s62, s62, 0x1ffff
    s_add_u32 s62, s62, s60
    s_add_u32 m0, s66, 0
    s_nop 0
    buffer_load_dwordx4 v13, s[4:7], s62 offen nt lds
    buffer_load_dwordx4 v14, s[4:7], s62 offen offset:1024 nt lds
    s_add_u32 s62, s84, 57344
    s_and_b32 s62, s62, 0x1ffff
    s_add_u32 s62, s62, s60
    s_add_u32 m0, s66, 57344
    s_nop 0
    buffer_load_dwordx4 v15, s[8:11], s62 offen nt lds
    buffer_load_dwordx4 v16, s[8:11], s62 offen offset:1024 nt lds
    s_waitcnt vmcnt(8)
    s_barrier
    s_add_u32 s62, s84, 73728
    s_and_b32 s62, s62, 0x1ffff
    s_add_u32 s62, s62, s60
    s_add_u32 m0, s66, 16384
    s_nop 0
    buffer_load_dwordx4 v13, s[4:7], s62 offen nt lds
    buffer_load_dwordx4 v14, s[4:7], s62 offen offset:1024 nt lds
    s_add_u32 s62, s84, 65536
    s_and_b32 s62, s62, 0x1ffff
    s_add_u32 s62, s62, s60
    s_add_u32 m0, s66, 8192
    s_nop 0
    buffer_load_dwordx4 v15, s[8:11], s62 offen nt lds
    buffer_load_dwordx4 v16, s[8:11], s62 offen offset:1024 nt lds
    s_waitcnt vmcnt(8)
    s_barrier
    s_add_u32 s62, s84, 81920
    s_and_b32 s62, s62, 0x1ffff
    s_add_u32 s62, s62, s60
    s_add_u32 m0, s66, 32768
    s_nop 0
    buffer_load_dwordx4 v13, s[4:7], s62 offen nt lds
    buffer_load_dwordx4 v14, s[4:7], s62 offen offset:1024 nt lds
    s_add_u32 s62, s84, 73728
    s_and_b32 s62, s62, 0x1ffff
    s_add_u32 s62, s62, s60
    s_add_u32 m0, s66, 24576
    s_nop 0
    buffer_load_dwordx4 v15, s[8:11], s62 offen nt lds
    buffer_load_dwordx4 v16, s[8:11], s62 offen offset:1024 nt lds
    s_waitcnt vmcnt(8)
    s_barrier
    s_add_u32 s62, s84, 90112
    s_and_b32 s62, s62, 0x1ffff
    s_add_u32 s62, s62, s60
    s_add_u32 m0, s66, 49152
    s_nop 0
    buffer_load_dwordx4 v13, s[4:7], s62 offen nt lds
    buffer_load_dwordx4 v14, s[4:7], s62 offen offset:1024 nt lds
    s_add_u32 s62, s84, 81920
    s_and_b32 s62, s62, 0x1ffff
    s_add_u32 s62, s62, s60
    s_add_u32 m0, s66, 40960
    s_nop 0
    buffer_load_dwordx4 v15, s[8:11], s62 offen nt lds
    buffer_load_dwordx4 v16, s[8:11], s62 offen offset:1024 nt lds
    s_waitcnt vmcnt(8)
    s_barrier
    s_add_u32 s62, s84, 98304
    s_and_b32 s62, s62, 0x1ffff
    s_add_u32 s62, s62, s60
    s_add_u32 m0, s66, 0
    s_nop 0
    buffer_load_dwordx4 v13, s[4:7], s62 offen nt lds
    buffer_load_dwordx4 v14, s[4:7], s62 offen offset:1024 nt lds
    s_add_u32 s62, s84, 90112
    s_and_b32 s62, s62, 0x1ffff
    s_add_u32 s62, s62, s60
    s_add_u32 m0, s66, 57344
    s_nop 0
    buffer_load_dwordx4 v15, s[8:11], s62 offen nt lds
    buffer_load_dwordx4 v16, s[8:11], s62 offen offset:1024 nt lds
    s_waitcnt vmcnt(8)
    s_barrier
    s_add_u32 s62, s84, 106496
    s_and_b32 s62, s62, 0x1ffff
    s_add_u32 s62, s62, s60
    s_add_u32 m0, s66, 16384
    s_nop 0
    buffer_load_dwordx4 v13, s[4:7], s62 offen nt lds
    buffer_load_dwordx4 v14, s[4:7], s62 offen offset:1024 nt lds
    s_add_u32 s62, s84, 98304
    s_and_b32 s62, s62, 0x1ffff
    s_add_u32 s62, s62, s60
    s_add_u32 m0, s66, 8192
    s_nop 0
    buffer_load_dwordx4 v15, s[8:11], s62 offen nt lds
    buffer_load_dwordx4 v16, s[8:11], s62 offen offset:1024 nt lds
    s_waitcnt vmcnt(8)
    s_barrier
    s_add_u32 s62, s84, 114688
    s_and_b32 s62, s62, 0x1ffff
    s_add_u32 s62, s62, s60
    s_add_u32 m0, s66, 32768
    s_nop 0
    buffer_load_dwordx4 v13, s[4:7], s62 offen nt lds
    buffer_load_dwordx4 v14, s[4:7], s62 offen offset:1024 nt lds
    s_add_u32 s62, s84, 106496
    s_and_b32 s62, s62, 0x1ffff
    s_add_u32 s62, s62, s60
    s_add_u32 m0, s66, 24576
    s_nop 0
    buffer_load_dwordx4 v15, s[8:11], s62 offen nt lds
    buffer_load_dwordx4 v16, s[8:11], s62 offen offset:1024 nt lds
    s_waitcnt vmcnt(8)
    s_barrier
    s_add_u32 s62, s84, 122880
    s_and_b32 s62, s62, 0x1ffff
    s_add_u32 s62, s62, s60
    s_add_u32 m0, s66, 49152
    s_nop 0
    buffer_load_dwordx4 v13, s[4:7], s62 offen nt lds
    buffer_load_dwordx4 v14, s[4:7], s62 offen offset:1024 nt lds
    s_add_u32 s62, s84, 114688
    s_and_b32 s62, s62, 0x1ffff
    s_add_u32 s62, s62, s60
    s_add_u32 m0, s66, 40960
    s_nop 0
    buffer_load_dwordx4 v15, s[8:11], s62 offen nt lds
    buffer_load_dwordx4 v16, s[8:11], s62 offen offset:1024 nt lds
    s_waitcnt vmcnt(8)
    s_barrier
    s_add_u32 s62, s84, 0
    s_and_b32 s62, s62, 0x1ffff
    s_add_u32 s62, s62, s60
    s_add_u32 s62, s62, 131072
    s_add_u32 m0, s66, 0
    s_nop 0
    buffer_load_dwordx4 v13, s[4:7], s62 offen nt lds
    buffer_load_dwordx4 v14, s[4:7], s62 offen offset:1024 nt lds
    s_add_u32 s62, s84, 122880
    s_and_b32 s62, s62, 0x1ffff
    s_add_u32 s62, s62, s60
    s_add_u32 m0, s66, 57344
    s_nop 0
    buffer_load_dwordx4 v15, s[8:11], s62 offen nt lds
    buffer_load_dwordx4 v16, s[8:11], s62 offen offset:1024 nt lds
    s_waitcnt vmcnt(8)
    s_barrier
    s_add_u32 s62, s84, 8192
    s_and_b32 s62, s62, 0x1ffff
    s_add_u32 s62, s62, s60
    s_add_u32 s62, s62, 131072
    s_add_u32 m0, s66, 16384
    s_nop 0
    buffer_load_dwordx4 v13, s[4:7], s62 offen nt lds
    buffer_load_dwordx4 v14, s[4:7], s62 offen offset:1024 nt lds
    s_add_u32 s62, s84, 0
    s_and_b32 s62, s62, 0x1ffff
    s_add_u32 s62, s62, s60
    s_add_u32 s62, s62, 131072
    s_add_u32 m0, s66, 8192
    s_nop 0
    buffer_load_dwordx4 v15, s[8:11], s62 offen nt lds
    buffer_load_dwordx4 v16, s[8:11], s62 offen offset:1024 nt lds
    s_waitcnt vmcnt(8)
    s_barrier
    s_add_u32 s62, s84, 16384
    s_and_b32 s62, s62, 0x1ffff
    s_add_u32 s62, s62, s60
    s_add_u32 s62, s62, 131072
    s_add_u32 m0, s66, 32768
    s_nop 0
    buffer_load_dwordx4 v13, s[4:7], s62 offen nt lds
    buffer_load_dwordx4 v14, s[4:7], s62 offen offset:1024 nt lds
    s_add_u32 s62, s84, 8192
    s_and_b32 s62, s62, 0x1ffff
    s_add_u32 s62, s62, s60
    s_add_u32 s62, s62, 131072
    s_add_u32 m0, s66, 24576
    s_nop 0
    buffer_load_dwordx4 v15, s[8:11], s62 offen nt lds
    buffer_load_dwordx4 v16, s[8:11], s62 offen offset:1024 nt lds
    s_waitcnt vmcnt(8)
    s_barrier
    s_add_u32 s62, s84, 24576
    s_and_b32 s62, s62, 0x1ffff
    s_add_u32 s62, s62, s60
    s_add_u32 s62, s62, 131072
    s_add_u32 m0, s66, 49152
    s_nop 0
    buffer_load_dwordx4 v13, s[4:7], s62 offen nt lds
    buffer_load_dwordx4 v14, s[4:7], s62 offen offset:1024 nt lds
    s_add_u32 s62, s84, 16384
    s_and_b32 s62, s62, 0x1ffff
    s_add_u32 s62, s62, s60
    s_add_u32 s62, s62, 131072
    s_add_u32 m0, s66, 40960
    s_nop 0
    buffer_load_dwordx4 v15, s[8:11], s62 offen nt lds
    buffer_load_dwordx4 v16, s[8:11], s62 offen offset:1024 nt lds
    s_waitcnt vmcnt(8)
    s_barrier
    s_add_u32 s60, s60, 131072
    s_add_u32 s62, s84, 32768
    s_and_b32 s62, s62, 0x1ffff
    s_add_u32 s62, s62, s60
    s_add_u32 m0, s66, 0
    s_nop 0
    buffer_load_dwordx4 v13, s[4:7], s62 offen nt lds
    buffer_load_dwordx4 v14, s[4:7], s62 offen offset:1024 nt lds
    s_add_u32 s62, s84, 24576
    s_and_b32 s62, s62, 0x1ffff
    s_add_u32 s62, s62, s60
    s_add_u32 m0, s66, 57344
    s_nop 0
    buffer_load_dwordx4 v15, s[8:11], s62 offen nt lds
    buffer_load_dwordx4 v16, s[8:11], s62 offen offset:1024 nt lds
    s_waitcnt vmcnt(8)
    s_barrier
    s_add_u32 s62, s84, 40960
    s_and_b32 s62, s62, 0x1ffff
    s_add_u32 s62, s62, s60
    s_add_u32 m0, s66, 16384
    s_nop 0
    buffer_load_dwordx4 v13, s[4:7], s62 offen nt lds
    buffer_load_dwordx4 v14, s[4:7], s62 offen offset:1024 nt lds
    s_add_u32 s62, s84, 32768
    s_and_b32 s62, s62, 0x1ffff
    s_add_u32 s62, s62, s60
    s_add_u32 m0, s66, 8192
    s_nop 0
    buffer_load_dwordx4 v15, s[8:11], s62 offen nt lds
    buffer_load_dwordx4 v16, s[8:11], s62 offen offset:1024 nt lds
    s_waitcnt vmcnt(8)
    s_barrier
    s_add_u32 s62, s84, 49152
    s_and_b32 s62, s62, 0x1ffff
    s_add_u32 s62, s62, s60
    s_add_u32 m0, s66, 32768
    s_nop 0
    buffer_load_dwordx4 v13, s[4:7], s62 offen nt lds
    buffer_load_dwordx4 v14, s[4:7], s62 offen offset:1024 nt lds
    s_add_u32 s62, s84, 40960
    s_and_b32 s62, s62, 0x1ffff
    s_add_u32 s62, s62, s60
    s_add_u32 m0, s66, 24576
    s_nop 0
    buffer_load_dwordx4 v15, s[8:11], s62 offen nt lds
    buffer_load_dwordx4 v16, s[8:11], s62 offen offset:1024 nt lds
    ds_read_b128 v[192:195], v18 offset:0
    ds_read_b128 v[196:199], v18 offset:1024
    ds_read_b128 v[200:203], v18 offset:2048
    ds_read_b128 v[204:207], v18 offset:3072
    s_waitcnt lgkmcnt(0)
    s_waitcnt vmcnt(8)
    s_barrier
    s_add_u32 s62, s84, 57344
    s_and_b32 s62, s62, 0x1ffff
    s_add_u32 s62, s62, s60
    s_add_u32 m0, s66, 49152
    s_nop 0
    buffer_load_dwordx4 v13, s[4:7], s62 offen nt lds
    buffer_load_dwordx4 v14, s[4:7], s62 offen offset:1024 nt lds
    s_add_u32 s62, s84, 49152
    s_and_b32 s62, s62, 0x1ffff
    s_add_u32 s62, s62, s60
    s_add_u32 m0, s66, 40960
    s_nop 0
    buffer_load_dwordx4 v15, s[8:11], s62 offen nt lds
    buffer_load_dwordx4 v16, s[8:11], s62 offen offset:1024 nt lds
    s_waitcnt vmcnt(8)
    s_barrier
    s_add_u32 s62, s84, 65536
    s_and_b32 s62, s62, 0x1ffff
    s_add_u32 s62, s62, s60
    s_add_u32 m0, s66, 0
    s_nop 0
    buffer_load_dwordx4 v13, s[4:7], s62 offen nt lds
    buffer_load_dwordx4 v14, s[4:7], s62 offen offset:1024 nt lds
    s_add_u32 s62, s84, 57344
    s_and_b32 s62, s62, 0x1ffff
    s_add_u32 s62, s62, s60
    s_add_u32 m0, s66, 57344
    s_nop 0
    buffer_load_dwordx4 v15, s[8:11], s62 offen nt lds
    buffer_load_dwordx4 v16, s[8:11], s62 offen offset:1024 nt lds
    s_waitcnt vmcnt(8)
    s_barrier
    s_add_u32 s62, s84, 73728
    s_and_b32 s62, s62, 0x1ffff
    s_add_u32 s62, s62, s60
    s_add_u32 m0, s66, 16384
    s_nop 0
    buffer_load_dwordx4 v13, s[4:7], s62 offen nt lds
    buffer_load_dwordx4 v14, s[4:7], s62 offen offset:1024 nt lds
    s_add_u32 s62, s84, 65536
    s_and_b32 s62, s62, 0x1ffff
    s_add_u32 s62, s62, s60
    s_add_u32 m0, s66, 8192
    s_nop 0
    buffer_load_dwordx4 v15, s[8:11], s62 offen nt lds
    buffer_load_dwordx4 v16, s[8:11], s62 offen offset:1024 nt lds
    s_waitcnt vmcnt(8)
    s_barrier
    s_add_u32 s62, s84, 81920
    s_and_b32 s62, s62, 0x1ffff
    s_add_u32 s62, s62, s60
    s_add_u32 m0, s66, 32768
    s_nop 0
    buffer_load_dwordx4 v13, s[4:7], s62 offen nt lds
    buffer_load_dwordx4 v14, s[4:7], s62 offen offset:1024 nt lds
    s_add_u32 s62, s84, 73728
    s_and_b32 s62, s62, 0x1ffff
    s_add_u32 s62, s62, s60
    s_add_u32 m0, s66, 24576
    s_nop 0
    buffer_load_dwordx4 v15, s[8:11], s62 offen nt lds
    buffer_load_dwordx4 v16, s[8:11], s62 offen offset:1024 nt lds
    s_waitcnt vmcnt(8)
    s_barrier
    s_add_u32 s62, s84, 90112
    s_and_b32 s62, s62, 0x1ffff
    s_add_u32 s62, s62, s60
    s_add_u32 m0, s66, 49152
    s_nop 0
    buffer_load_dwordx4 v13, s[4:7], s62 offen nt lds
    buffer_load_dwordx4 v14, s[4:7], s62 offen offset:1024 nt lds
    s_add_u32 s62, s84, 81920
    s_and_b32 s62, s62, 0x1ffff
    s_add_u32 s62, s62, s60
    s_add_u32 m0, s66, 40960
    s_nop 0
    buffer_load_dwordx4 v15, s[8:11], s62 offen nt lds
    buffer_load_dwordx4 v16, s[8:11], s62 offen offset:1024 nt lds
    s_waitcnt vmcnt(8)
    s_barrier
    s_add_u32 s62, s84, 98304
    s_and_b32 s62, s62, 0x1ffff
    s_add_u32 s62, s62, s60
    s_add_u32 m0, s66, 0
    s_nop 0
    buffer_load_dwordx4 v13, s[4:7], s62 offen nt lds
    buffer_load_dwordx4 v14, s[4:7], s62 offen offset:1024 nt lds
    s_add_u32 s62, s84, 90112
    s_and_b32 s62, s62, 0x1ffff
    s_add_u32 s62, s62, s60
    s_add_u32 m0, s66, 57344
    s_nop 0
    buffer_load_dwordx4 v15, s[8:11], s62 offen nt lds
    buffer_load_dwordx4 v16, s[8:11], s62 offen offset:1024 nt lds
    s_waitcnt vmcnt(8)
    s_barrier
    s_add_u32 s62, s84, 106496
    s_and_b32 s62, s62, 0x1ffff
    s_add_u32 s62, s62, s60
    s_add_u32 m0, s66, 16384
    s_nop 0
    buffer_load_dwordx4 v13, s[4:7], s62 offen nt lds
    buffer_load_dwordx4 v14, s[4:7], s62 offen offset:1024 nt lds
    s_add_u32 s62, s84, 98304
    s_and_b32 s62, s62, 0x1ffff
    s_add_u32 s62, s62, s60
    s_add_u32 m0, s66, 8192
    s_nop 0
    buffer_load_dwordx4 v15, s[8:11], s62 offen nt lds
    buffer_load_dwordx4 v16, s[8:11], s62 offen offset:1024 nt lds
    s_waitcnt vmcnt(8)
    s_barrier
    s_add_u32 s62, s84, 114688
    s_and_b32 s62, s62, 0x1ffff
    s_add_u32 s62, s62, s60
    s_add_u32 m0, s66, 32768
    s_nop 0
    buffer_load_dwordx4 v13, s[4:7], s62 offen nt lds
    buffer_load_dwordx4 v14, s[4:7], s62 offen offset:1024 nt lds
    s_add_u32 s62, s84, 106496
    s_and_b32 s62, s62, 0x1ffff
    s_add_u32 s62, s62, s60
    s_add_u32 m0, s66, 24576
    s_nop 0
    buffer_load_dwordx4 v15, s[8:11], s62 offen nt lds
    buffer_load_dwordx4 v16, s[8:11], s62 offen offset:1024 nt lds
    s_waitcnt vmcnt(8)
    s_barrier
    s_add_u32 s62, s84, 122880
    s_and_b32 s62, s62, 0x1ffff
    s_add_u32 s62, s62, s60
    s_add_u32 m0, s66, 49152
    s_nop 0
    buffer_load_dwordx4 v13, s[4:7], s62 offen nt lds
    buffer_load_dwordx4 v14, s[4:7], s62 offen offset:1024 nt lds
    s_add_u32 s62, s84, 114688
    s_and_b32 s62, s62, 0x1ffff
    s_add_u32 s62, s62, s60
    s_add_u32 m0, s66, 40960
    s_nop 0
    buffer_load_dwordx4 v15, s[8:11], s62 offen nt lds
    buffer_load_dwordx4 v16, s[8:11], s62 offen offset:1024 nt lds
    s_waitcnt vmcnt(8)
    s_barrier
    s_add_u32 s62, s84, 122880
    s_and_b32 s62, s62, 0x1ffff
    s_add_u32 s62, s62, s60
    s_add_u32 m0, s66, 57344
    s_nop 0
    buffer_load_dwordx4 v15, s[8:11], s62 offen nt lds
    buffer_load_dwordx4 v16, s[8:11], s62 offen offset:1024 nt lds
    s_waitcnt vmcnt(6)
    s_barrier
    s_mov_b32 s12, s58
    s_and_b32 s13, s59, 0xffff
    s_mov_b32 s14, 5242880
    s_mov_b32 s15, 0x00020000
    s_lshl_b32 s70, s25, 4
    s_add_u32 s70, s70, s26
    s_lshl_b32 s70, s70, 3
    s_add_u32 s70, s70, s27
    s_mul_i32 s70, s70, 163840
    s_add_u32 s4, s56, s70
    s_addc_u32 s5, s57, 0
    s_and_b32 s5, s5, 0xffff
    s_mov_b32 s6, 163840
    s_mov_b32 s7, 0x00020000
    s_mul_i32 s70, s28, 5120
    s_add_u32 s72, s70, 122880
    s_add_u32 s73, s70, 20480
    s_add_u32 s74, s70, 143360
    s_add_u32 s97, s70, 81920
    s_mul_i32 s75, s27, 655360
    s_add_u32 s75, s75, 640
    s_mov_b32 s76, 81920
    v_mbcnt_lo_u32_b32 v0, -1, 0
    v_mbcnt_hi_u32_b32 v0, -1, v0
    s_lshl_b32 s71, s28, 5
    s_mov_b32 s77, 6554
    v_add_u32 v56, 0, v0
    v_mul_lo_u32 v57, v56, s77
    v_lshrrev_b32 v57, 16, v57
    v_mul_u32_u24 v58, 10, v57
    v_sub_u32 v58, v56, v58
    v_add_u32 v57, s71, v57
    v_mul_u32_u24 v57, 1280, v57
    v_lshl_add_u32 v4, v58, 4, v57
    v_add_u32 v56, 64, v0
    v_mul_lo_u32 v57, v56, s77
    v_lshrrev_b32 v57, 16, v57
    v_mul_u32_u24 v58, 10, v57
    v_sub_u32 v58, v56, v58
    v_add_u32 v57, s71, v57
    v_mul_u32_u24 v57, 1280, v57
    v_lshl_add_u32 v5, v58, 4, v57
    v_add_u32 v56, 128, v0
    v_mul_lo_u32 v57, v56, s77
    v_lshrrev_b32 v57, 16, v57
    v_mul_u32_u24 v58, 10, v57
    v_sub_u32 v58, v56, v58
    v_add_u32 v57, s71, v57
    v_mul_u32_u24 v57, 1280, v57
    v_lshl_add_u32 v6, v58, 4, v57
    v_add_u32 v56, 192, v0
    v_mul_lo_u32 v57, v56, s77
    v_lshrrev_b32 v57, 16, v57
    v_mul_u32_u24 v58, 10, v57
    v_sub_u32 v58, v56, v58
    v_add_u32 v57, s71, v57
    v_mul_u32_u24 v57, 1280, v57
    v_lshl_add_u32 v7, v58, 4, v57
    v_add_u32 v56, 256, v0
    v_mul_lo_u32 v57, v56, s77
    v_lshrrev_b32 v57, 16, v57
    v_mul_u32_u24 v58, 10, v57
    v_sub_u32 v58, v56, v58
    v_add_u32 v57, s71, v57
    v_mul_u32_u24 v57, 1280, v57
    v_lshl_add_u32 v8, v58, 4, v57
    v_lshrrev_b32 v56, 4, v0
    v_bfe_u32 v57, v0, 2, 2
    v_lshl_add_u32 v57, v56, 2, v57
    v_mul_u32_u24 v57, 160, v57
    v_and_b32 v58, 3, v0
    v_lshl_add_u32 v57, v58, 3, v57
    v_add_u32 v9, 122880, v57
    v_add_u32 v10, 20480, v57
    v_add_u32 v11, 143360, v57
    v_add_u32 v63, 81920, v57
    v_add_u32 v61, 86016, v57
    v_lshlrev_b32 v57, 4, v0
    v_add_u32 v59, s70, v57
    s_lshl_b32 s71, s28, 13
    v_add_u32 v1, s71, v57
    s_lshl_b32 s70, s25, 4
    s_add_u32 s70, s70, s26
    s_lshl_b32 s71, s70, 10
    s_add_u32 s71, s71, 46137344
    s_add_u32 s88, s56, s71
    s_addc_u32 s89, s57, 0
    s_and_b32 s89, s89, 0xffff
    s_mov_b32 s90, 1024
    s_mov_b32 s91, 0x00020000
    s_mov_b32 s92, s86
    s_and_b32 s93, s87, 0xffff
    s_mov_b32 s94, 256
    s_mov_b32 s95, 0x00020000
    s_lshl_b32 s96, s70, 2
    s_add_u32 s96, s96, 128
    s_waitcnt vmcnt(2)
    s_barrier
    s_waitcnt vmcnt(0)
    s_barrier
    s_mul_i32 s70, s28, 5120
    s_add_u32 s78, s70, 65536
    s_mul_i32 s79, s27, 655360
    s_add_u32 s62, s79, 0
    s_add_u32 m0, s78, 0
    s_nop 0
    buffer_load_dwordx4 v4, s[12:15], s62 offen lds
    s_add_u32 m0, s78, 1024
    s_nop 0
    buffer_load_dwordx4 v5, s[12:15], s62 offen lds
    s_add_u32 m0, s78, 2048
    s_nop 0
    buffer_load_dwordx4 v6, s[12:15], s62 offen lds
    s_add_u32 m0, s78, 3072
    s_nop 0
    buffer_load_dwordx4 v7, s[12:15], s62 offen lds
    s_add_u32 m0, s78, 4096
    s_nop 0
    buffer_load_dwordx4 v8, s[12:15], s62 offen lds
    s_mul_i32 s70, s28, 5120
    s_add_u32 s78, s70, 86016
    s_mul_i32 s79, s27, 655360
    s_add_u32 s79, s79, 640
    s_add_u32 s62, s79, 0
    s_add_u32 m0, s78, 0
    s_nop 0
    buffer_load_dwordx4 v4, s[12:15], s62 offen lds
    s_add_u32 m0, s78, 1024
    s_nop 0
    buffer_load_dwordx4 v5, s[12:15], s62 offen lds
    s_add_u32 m0, s78, 2048
    s_nop 0
    buffer_load_dwordx4 v6, s[12:15], s62 offen lds
    s_add_u32 m0, s78, 3072
    s_nop 0
    buffer_load_dwordx4 v7, s[12:15], s62 offen lds
    s_add_u32 m0, s78, 4096
    s_nop 0
    buffer_load_dwordx4 v8, s[12:15], s62 offen lds
    s_mov_b32 s80, s58
    s_and_b32 s81, s59, 0xffff
    s_mov_b32 s82, 5242880
    s_mov_b32 s83, 0x00020000
    s_lshr_b32 s70, s2, 3
    s_mul_i32 s70, s70, 40960
    s_lshr_b32 s71, s27, 1
    s_mul_i32 s71, s71, 1310720
    s_add_u32 s70, s70, s71
    s_mul_i32 s71, s28, 10240
    s_add_u32 s70, s70, s71
    v_mbcnt_lo_u32_b32 v19, -1, 0
    v_mbcnt_hi_u32_b32 v19, -1, v19
    v_lshlrev_b32 v19, 6, v19
    s_add_u32 s71, s70, 0
    buffer_load_dword v20, v19, s[80:83], s71 offen
    s_add_u32 s71, s70, 4096
    buffer_load_dword v21, v19, s[80:83], s71 offen
    s_add_u32 s71, s70, 6144
    buffer_load_dword v22, v19, s[80:83], s71 offen
    s_waitcnt vmcnt(3)
    s_barrier
    ds_read_b128 v[128:131], v18 offset:0
    ds_read_b128 v[132:135], v18 offset:1024
    ds_read_b128 v[136:139], v18 offset:2048
    ds_read_b128 v[140:143], v18 offset:3072
    s_add_u32 s62, s75, 163840
    s_add_u32 m0, s73, 0
    s_nop 0
    buffer_load_dwordx4 v4, s[12:15], s62 offen lds
    s_add_u32 m0, s73, 1024
    s_nop 0
    buffer_load_dwordx4 v5, s[12:15], s62 offen lds
    s_add_u32 m0, s73, 2048
    s_nop 0
    buffer_load_dwordx4 v6, s[12:15], s62 offen lds
    s_add_u32 m0, s73, 3072
    s_nop 0
    buffer_load_dwordx4 v7, s[12:15], s62 offen lds
    s_add_u32 m0, s73, 4096
    s_nop 0
    buffer_load_dwordx4 v8, s[12:15], s62 offen lds
    s_waitcnt lgkmcnt(0)
    s_branch m_tail1
m_tail1:
    s_barrier
    ds_read_b64_tr_b16 v[104:105], v61 offset:0
    ds_read_b64_tr_b16 v[106:107], v61 offset:2560
    ds_read_b64_tr_b16 v[108:109], v61 offset:32
    ds_read_b64_tr_b16 v[110:111], v61 offset:2592
    ds_read_b64_tr_b16 v[112:113], v61 offset:64
    ds_read_b64_tr_b16 v[114:115], v61 offset:2624
    ds_read_b64_tr_b16 v[116:117], v61 offset:96
    ds_read_b64_tr_b16 v[118:119], v61 offset:2656
    ds_read_b64_tr_b16 v[120:121], v61 offset:128
    ds_read_b64_tr_b16 v[122:123], v61 offset:2688
    s_waitcnt lgkmcnt(8)
    ds_read_b64_tr_b16 v[32:33], v61 offset:5120
    ds_read_b64_tr_b16 v[34:35], v61 offset:7680
    v_mfma_f32_16x16x32_bf16 v[64:67], v[104:107], v[160:163], 0
    s_add_u32 s62, s75, 327680
    s_add_u32 m0, s74, 0
    s_nop 0
    buffer_load_dwordx4 v4, s[12:15], s62 offen lds
    s_waitcnt lgkmcnt(8)
    ds_read_b64_tr_b16 v[36:37], v61 offset:5152
    ds_read_b64_tr_b16 v[38:39], v61 offset:7712
    v_mfma_f32_16x16x32_bf16 v[72:75], v[108:111], v[160:163], 0
    s_waitcnt lgkmcnt(8)
    ds_read_b64_tr_b16 v[40:41], v61 offset:5184
    ds_read_b64_tr_b16 v[42:43], v61 offset:7744
    v_mfma_f32_16x16x32_bf16 v[80:83], v[112:115], v[160:163], 0
    s_add_u32 m0, s74, 1024
    s_nop 0
    buffer_load_dwordx4 v5, s[12:15], s62 offen lds
    s_waitcnt lgkmcnt(8)
    ds_read_b64_tr_b16 v[44:45], v61 offset:5216
    ds_read_b64_tr_b16 v[46:47], v61 offset:7776
    v_mfma_f32_16x16x32_bf16 v[88:91], v[116:119], v[160:163], 0
    s_waitcnt lgkmcnt(8)
    ds_read_b64_tr_b16 v[48:49], v61 offset:5248
    ds_read_b64_tr_b16 v[50:51], v61 offset:7808
    v_mfma_f32_16x16x32_bf16 v[96:99], v[120:123], v[160:163], 0
    s_add_u32 m0, s74, 2048
    s_nop 0
    buffer_load_dwordx4 v6, s[12:15], s62 offen lds
    s_waitcnt lgkmcnt(8)
    ds_read_b64_tr_b16 v[104:105], v61 offset:10240
    ds_read_b64_tr_b16 v[106:107], v61 offset:12800
    v_mfma_f32_16x16x32_bf16 v[64:67], v[32:35], v[164:167], v[64:67]
    s_add_u32 m0, s74, 3072
    s_nop 0
    buffer_load_dwordx4 v7, s[12:15], s62 offen lds
    s_waitcnt lgkmcnt(8)
    ds_read_b64_tr_b16 v[108:109], v61 offset:10272
    ds_read_b64_tr_b16 v[110:111], v61 offset:12832
    v_mfma_f32_16x16x32_bf16 v[72:75], v[36:39], v[164:167], v[72:75]
    s_waitcnt lgkmcnt(8)
    ds_read_b64_tr_b16 v[112:113], v61 offset:10304
    ds_read_b64_tr_b16 v[114:115], v61 offset:12864
    v_mfma_f32_16x16x32_bf16 v[80:83], v[40:43], v[164:167], v[80:83]
    s_add_u32 m0, s74, 4096
    s_nop 0
    buffer_load_dwordx4 v8, s[12:15], s62 offen lds
    s_waitcnt lgkmcnt(8)
    ds_read_b64_tr_b16 v[116:117], v61 offset:10336
    ds_read_b64_tr_b16 v[118:119], v61 offset:12896
    v_mfma_f32_16x16x32_bf16 v[88:91], v[44:47], v[164:167], v[88:91]
    s_waitcnt lgkmcnt(8)
    ds_read_b64_tr_b16 v[120:121], v61 offset:10368
    ds_read_b64_tr_b16 v[122:123], v61 offset:12928
    v_mfma_f32_16x16x32_bf16 v[96:99], v[48:51], v[164:167], v[96:99]
    s_waitcnt lgkmcnt(8)
    ds_read_b64_tr_b16 v[32:33], v61 offset:15360
    ds_read_b64_tr_b16 v[34:35], v61 offset:17920
    v_mfma_f32_16x16x32_bf16 v[64:67], v[104:107], v[168:171], v[64:67]
    s_waitcnt lgkmcnt(8)
    ds_read_b64_tr_b16 v[36:37], v61 offset:15392
    ds_read_b64_tr_b16 v[38:39], v61 offset:17952
    v_mfma_f32_16x16x32_bf16 v[72:75], v[108:111], v[168:171], v[72:75]
    s_waitcnt lgkmcnt(8)
    ds_read_b64_tr_b16 v[40:41], v61 offset:15424
    ds_read_b64_tr_b16 v[42:43], v61 offset:17984
    v_mfma_f32_16x16x32_bf16 v[80:83], v[112:115], v[168:171], v[80:83]
    s_waitcnt lgkmcnt(8)
    ds_read_b64_tr_b16 v[44:45], v61 offset:15456
    ds_read_b64_tr_b16 v[46:47], v61 offset:18016
    v_mfma_f32_16x16x32_bf16 v[88:91], v[116:119], v[168:171], v[88:91]
    s_waitcnt lgkmcnt(8)
    ds_read_b64_tr_b16 v[48:49], v61 offset:15488
    ds_read_b64_tr_b16 v[50:51], v61 offset:18048
    v_mfma_f32_16x16x32_bf16 v[96:99], v[120:123], v[168:171], v[96:99]
    s_waitcnt lgkmcnt(8)
    v_mfma_f32_16x16x32_bf16 v[64:67], v[32:35], v[172:175], v[64:67]
    s_waitcnt lgkmcnt(6)
    v_mfma_f32_16x16x32_bf16 v[72:75], v[36:39], v[172:175], v[72:75]
    s_waitcnt lgkmcnt(4)
    v_mfma_f32_16x16x32_bf16 v[80:83], v[40:43], v[172:175], v[80:83]
    s_waitcnt lgkmcnt(2)
    v_mfma_f32_16x16x32_bf16 v[88:91], v[44:47], v[172:175], v[88:91]
    s_waitcnt lgkmcnt(0)
    v_mfma_f32_16x16x32_bf16 v[96:99], v[48:51], v[172:175], v[96:99]
    s_waitcnt vmcnt(0)
    s_barrier
    ds_read_b64_tr_b16 v[104:105], v10 offset:0
    ds_read_b64_tr_b16 v[106:107], v10 offset:2560
    ds_read_b64_tr_b16 v[108:109], v10 offset:32
    ds_read_b64_tr_b16 v[110:111], v10 offset:2592
    ds_read_b64_tr_b16 v[112:113], v10 offset:64
    ds_read_b64_tr_b16 v[114:115], v10 offset:2624
    ds_read_b64_tr_b16 v[116:117], v10 offset:96
    ds_read_b64_tr_b16 v[118:119], v10 offset:2656
    ds_read_b64_tr_b16 v[120:121], v10 offset:128
    ds_read_b64_tr_b16 v[122:123], v10 offset:2688
    s_waitcnt lgkmcnt(8)
    ds_read_b64_tr_b16 v[32:33], v10 offset:5120
    ds_read_b64_tr_b16 v[34:35], v10 offset:7680
    v_mfma_f32_16x16x32_bf16 v[64:67], v[104:107], v[224:227], v[64:67]
    s_add_u32 s62, s75, 491520
    s_add_u32 m0, s97, 0
    s_nop 0
    buffer_load_dwordx4 v4, s[12:15], s62 offen lds
    s_waitcnt lgkmcnt(8)
    ds_read_b64_tr_b16 v[36:37], v10 offset:5152
    ds_read_b64_tr_b16 v[38:39], v10 offset:7712
    v_mfma_f32_16x16x32_bf16 v[72:75], v[108:111], v[224:227], v[72:75]
    s_waitcnt lgkmcnt(8)
    ds_read_b64_tr_b16 v[40:41], v10 offset:5184
    ds_read_b64_tr_b16 v[42:43], v10 offset:7744
    v_mfma_f32_16x16x32_bf16 v[80:83], v[112:115], v[224:227], v[80:83]
    s_add_u32 m0, s97, 1024
    s_nop 0
    buffer_load_dwordx4 v5, s[12:15], s62 offen lds
    s_waitcnt lgkmcnt(8)
    ds_read_b64_tr_b16 v[44:45], v10 offset:5216
    ds_read_b64_tr_b16 v[46:47], v10 offset:7776
    v_mfma_f32_16x16x32_bf16 v[88:91], v[116:119], v[224:227], v[88:91]
    s_waitcnt lgkmcnt(8)
    ds_read_b64_tr_b16 v[48:49], v10 offset:5248
    ds_read_b64_tr_b16 v[50:51], v10 offset:7808
    v_mfma_f32_16x16x32_bf16 v[96:99], v[120:123], v[224:227], v[96:99]
    s_add_u32 m0, s97, 2048
    s_nop 0
    buffer_load_dwordx4 v6, s[12:15], s62 offen lds
    s_waitcnt lgkmcnt(8)
    ds_read_b64_tr_b16 v[104:105], v10 offset:10240
    ds_read_b64_tr_b16 v[106:107], v10 offset:12800
    v_mfma_f32_16x16x32_bf16 v[64:67], v[32:35], v[228:231], v[64:67]
    s_add_u32 m0, s97, 3072
    s_nop 0
    buffer_load_dwordx4 v7, s[12:15], s62 offen lds
    s_waitcnt lgkmcnt(8)
    ds_read_b64_tr_b16 v[108:109], v10 offset:10272
    ds_read_b64_tr_b16 v[110:111], v10 offset:12832
    v_mfma_f32_16x16x32_bf16 v[72:75], v[36:39], v[228:231], v[72:75]
    s_waitcnt lgkmcnt(8)
    ds_read_b64_tr_b16 v[112:113], v10 offset:10304
    ds_read_b64_tr_b16 v[114:115], v10 offset:12864
    v_mfma_f32_16x16x32_bf16 v[80:83], v[40:43], v[228:231], v[80:83]
    s_add_u32 m0, s97, 4096
    s_nop 0
    buffer_load_dwordx4 v8, s[12:15], s62 offen lds
    s_waitcnt lgkmcnt(8)
    ds_read_b64_tr_b16 v[116:117], v10 offset:10336
    ds_read_b64_tr_b16 v[118:119], v10 offset:12896
    v_mfma_f32_16x16x32_bf16 v[88:91], v[44:47], v[228:231], v[88:91]
    s_waitcnt lgkmcnt(8)
    ds_read_b64_tr_b16 v[120:121], v10 offset:10368
    ds_read_b64_tr_b16 v[122:123], v10 offset:12928
    v_mfma_f32_16x16x32_bf16 v[96:99], v[48:51], v[228:231], v[96:99]
    s_add_u32 s62, s75, 160
    s_add_u32 m0, s72, 0
    s_nop 0
    buffer_load_dwordx4 v4, s[12:15], s62 offen lds
    s_waitcnt lgkmcnt(8)
    ds_read_b64_tr_b16 v[32:33], v10 offset:15360
    ds_read_b64_tr_b16 v[34:35], v10 offset:17920
    v_mfma_f32_16x16x32_bf16 v[64:67], v[104:107], v[232:235], v[64:67]
    s_add_u32 m0, s72, 1024
    s_nop 0
    buffer_load_dwordx4 v5, s[12:15], s62 offen lds
    s_waitcnt lgkmcnt(8)
    ds_read_b64_tr_b16 v[36:37], v10 offset:15392
    ds_read_b64_tr_b16 v[38:39], v10 offset:17952
    v_mfma_f32_16x16x32_bf16 v[72:75], v[108:111], v[232:235], v[72:75]
    s_waitcnt lgkmcnt(8)
    ds_read_b64_tr_b16 v[40:41], v10 offset:15424
    ds_read_b64_tr_b16 v[42:43], v10 offset:17984
    v_mfma_f32_16x16x32_bf16 v[80:83], v[112:115], v[232:235], v[80:83]
    s_add_u32 m0, s72, 2048
    s_nop 0
    buffer_load_dwordx4 v6, s[12:15], s62 offen lds
    s_waitcnt lgkmcnt(8)
    ds_read_b64_tr_b16 v[44:45], v10 offset:15456
    ds_read_b64_tr_b16 v[46:47], v10 offset:18016
    v_mfma_f32_16x16x32_bf16 v[88:91], v[116:119], v[232:235], v[88:91]
    s_waitcnt lgkmcnt(8)
    ds_read_b64_tr_b16 v[48:49], v10 offset:15488
    ds_read_b64_tr_b16 v[50:51], v10 offset:18048
    v_mfma_f32_16x16x32_bf16 v[96:99], v[120:123], v[232:235], v[96:99]
    s_add_u32 m0, s72, 3072
    s_nop 0
    buffer_load_dwordx4 v7, s[12:15], s62 offen lds
    s_waitcnt lgkmcnt(8)
    ds_read_b64_tr_b16 v[104:105], v11 offset:0
    ds_read_b64_tr_b16 v[106:107], v11 offset:2560
    v_mfma_f32_16x16x32_bf16 v[64:67], v[32:35], v[236:239], v[64:67]
    s_add_u32 m0, s72, 4096
    s_nop 0
    buffer_load_dwordx4 v8, s[12:15], s62 offen lds
    s_waitcnt lgkmcnt(8)
    ds_read_b64_tr_b16 v[108:109], v11 offset:32
    ds_read_b64_tr_b16 v[110:111], v11 offset:2592
    v_mfma_f32_16x16x32_bf16 v[72:75], v[36:39], v[236:239], v[72:75]
    s_waitcnt lgkmcnt(8)
    ds_read_b64_tr_b16 v[112:113], v11 offset:64
    ds_read_b64_tr_b16 v[114:115], v11 offset:2624
    v_mfma_f32_16x16x32_bf16 v[80:83], v[40:43], v[236:239], v[80:83]
    s_waitcnt lgkmcnt(8)
    ds_read_b64_tr_b16 v[116:117], v11 offset:96
    ds_read_b64_tr_b16 v[118:119], v11 offset:2656
    v_mfma_f32_16x16x32_bf16 v[88:91], v[44:47], v[236:239], v[88:91]
    s_waitcnt lgkmcnt(8)
    ds_read_b64_tr_b16 v[120:121], v11 offset:128
    ds_read_b64_tr_b16 v[122:123], v11 offset:2688
    v_mfma_f32_16x16x32_bf16 v[96:99], v[48:51], v[236:239], v[96:99]
    s_waitcnt vmcnt(5)
    s_barrier
    s_waitcnt lgkmcnt(8)
    ds_read_b64_tr_b16 v[32:33], v11 offset:5120
    ds_read_b64_tr_b16 v[34:35], v11 offset:7680
    v_mfma_f32_16x16x32_bf16 v[64:67], v[104:107], v[192:195], v[64:67]
    s_add_u32 s62, s75, 164000
    s_add_u32 m0, s73, 0
    s_nop 0
    buffer_load_dwordx4 v4, s[12:15], s62 offen lds
    s_waitcnt lgkmcnt(8)
    ds_read_b64_tr_b16 v[36:37], v11 offset:5152
    ds_read_b64_tr_b16 v[38:39], v11 offset:7712
    v_mfma_f32_16x16x32_bf16 v[72:75], v[108:111], v[192:195], v[72:75]
    s_waitcnt lgkmcnt(8)
    ds_read_b64_tr_b16 v[40:41], v11 offset:5184
    ds_read_b64_tr_b16 v[42:43], v11 offset:7744
    v_mfma_f32_16x16x32_bf16 v[80:83], v[112:115], v[192:195], v[80:83]
    s_add_u32 m0, s73, 1024
    s_nop 0
    buffer_load_dwordx4 v5, s[12:15], s62 offen lds
    s_waitcnt lgkmcnt(8)
    ds_read_b64_tr_b16 v[44:45], v11 offset:5216
    ds_read_b64_tr_b16 v[46:47], v11 offset:7776
    v_mfma_f32_16x16x32_bf16 v[88:91], v[116:119], v[192:195], v[88:91]
    s_waitcnt lgkmcnt(8)
    ds_read_b64_tr_b16 v[48:49], v11 offset:5248
    ds_read_b64_tr_b16 v[50:51], v11 offset:7808
    v_mfma_f32_16x16x32_bf16 v[96:99], v[120:123], v[192:195], v[96:99]
    s_add_u32 m0, s73, 2048
    s_nop 0
    buffer_load_dwordx4 v6, s[12:15], s62 offen lds
    s_waitcnt lgkmcnt(8)
    ds_read_b64_tr_b16 v[104:105], v11 offset:10240
    ds_read_b64_tr_b16 v[106:107], v11 offset:12800
    v_mfma_f32_16x16x32_bf16 v[64:67], v[32:35], v[196:199], v[64:67]
    s_add_u32 m0, s73, 3072
    s_nop 0
    buffer_load_dwordx4 v7, s[12:15], s62 offen lds
    s_waitcnt lgkmcnt(8)
    ds_read_b64_tr_b16 v[108:109], v11 offset:10272
    ds_read_b64_tr_b16 v[110:111], v11 offset:12832
    v_mfma_f32_16x16x32_bf16 v[72:75], v[36:39], v[196:199], v[72:75]
    s_waitcnt lgkmcnt(8)
    ds_read_b64_tr_b16 v[112:113], v11 offset:10304
    ds_read_b64_tr_b16 v[114:115], v11 offset:12864
    v_mfma_f32_16x16x32_bf16 v[80:83], v[40:43], v[196:199], v[80:83]
    s_add_u32 m0, s73, 4096
    s_nop 0
    buffer_load_dwordx4 v8, s[12:15], s62 offen lds
    s_waitcnt lgkmcnt(8)
    ds_read_b64_tr_b16 v[116:117], v11 offset:10336
    ds_read_b64_tr_b16 v[118:119], v11 offset:12896
    v_mfma_f32_16x16x32_bf16 v[88:91], v[44:47], v[196:199], v[88:91]
    s_waitcnt lgkmcnt(8)
    ds_read_b64_tr_b16 v[120:121], v11 offset:10368
    ds_read_b64_tr_b16 v[122:123], v11 offset:12928
    v_mfma_f32_16x16x32_bf16 v[96:99], v[48:51], v[196:199], v[96:99]
    s_waitcnt lgkmcnt(8)
    ds_read_b64_tr_b16 v[32:33], v11 offset:15360
    ds_read_b64_tr_b16 v[34:35], v11 offset:17920
    v_mfma_f32_16x16x32_bf16 v[64:67], v[104:107], v[200:203], v[64:67]
    s_waitcnt lgkmcnt(8)
    ds_read_b64_tr_b16 v[36:37], v11 offset:15392
    ds_read_b64_tr_b16 v[38:39], v11 offset:17952
    v_mfma_f32_16x16x32_bf16 v[72:75], v[108:111], v[200:203], v[72:75]
    s_waitcnt lgkmcnt(8)
    ds_read_b64_tr_b16 v[40:41], v11 offset:15424
    ds_read_b64_tr_b16 v[42:43], v11 offset:17984
    v_mfma_f32_16x16x32_bf16 v[80:83], v[112:115], v[200:203], v[80:83]
    s_waitcnt lgkmcnt(8)
    ds_read_b64_tr_b16 v[44:45], v11 offset:15456
    ds_read_b64_tr_b16 v[46:47], v11 offset:18016
    v_mfma_f32_16x16x32_bf16 v[88:91], v[116:119], v[200:203], v[88:91]
    s_waitcnt lgkmcnt(8)
    ds_read_b64_tr_b16 v[48:49], v11 offset:15488
    ds_read_b64_tr_b16 v[50:51], v11 offset:18048
    v_mfma_f32_16x16x32_bf16 v[96:99], v[120:123], v[200:203], v[96:99]
    s_waitcnt lgkmcnt(8)
    ds_read_b64_tr_b16 v[104:105], v63 offset:0
    ds_read_b64_tr_b16 v[106:107], v63 offset:2560
    v_mfma_f32_16x16x32_bf16 v[64:67], v[32:35], v[204:207], v[64:67]
    s_waitcnt lgkmcnt(8)
    ds_read_b64_tr_b16 v[108:109], v63 offset:32
    ds_read_b64_tr_b16 v[110:111], v63 offset:2592
    v_mfma_f32_16x16x32_bf16 v[72:75], v[36:39], v[204:207], v[72:75]
    s_waitcnt lgkmcnt(8)
    ds_read_b64_tr_b16 v[112:113], v63 offset:64
    ds_read_b64_tr_b16 v[114:115], v63 offset:2624
    v_mfma_f32_16x16x32_bf16 v[80:83], v[40:43], v[204:207], v[80:83]
    s_waitcnt lgkmcnt(8)
    ds_read_b64_tr_b16 v[116:117], v63 offset:96
    ds_read_b64_tr_b16 v[118:119], v63 offset:2656
    v_mfma_f32_16x16x32_bf16 v[88:91], v[44:47], v[204:207], v[88:91]
    s_waitcnt lgkmcnt(8)
    ds_read_b64_tr_b16 v[120:121], v63 offset:128
    ds_read_b64_tr_b16 v[122:123], v63 offset:2688
    v_mfma_f32_16x16x32_bf16 v[96:99], v[48:51], v[204:207], v[96:99]
    s_waitcnt vmcnt(5)
    s_barrier
    s_waitcnt lgkmcnt(8)
    ds_read_b64_tr_b16 v[32:33], v63 offset:5120
    ds_read_b64_tr_b16 v[34:35], v63 offset:7680
    v_mfma_f32_16x16x32_bf16 v[64:67], v[104:107], v[128:131], v[64:67]
    s_add_u32 s62, s75, 327840
    s_add_u32 m0, s74, 0
    s_nop 0
    buffer_load_dwordx4 v4, s[12:15], s62 offen lds
    s_waitcnt lgkmcnt(8)
    ds_read_b64_tr_b16 v[36:37], v63 offset:5152
    ds_read_b64_tr_b16 v[38:39], v63 offset:7712
    v_mfma_f32_16x16x32_bf16 v[72:75], v[108:111], v[128:131], v[72:75]
    s_waitcnt lgkmcnt(8)
    ds_read_b64_tr_b16 v[40:41], v63 offset:5184
    ds_read_b64_tr_b16 v[42:43], v63 offset:7744
    v_mfma_f32_16x16x32_bf16 v[80:83], v[112:115], v[128:131], v[80:83]
    s_add_u32 m0, s74, 1024
    s_nop 0
    buffer_load_dwordx4 v5, s[12:15], s62 offen lds
    s_waitcnt lgkmcnt(8)
    ds_read_b64_tr_b16 v[44:45], v63 offset:5216
    ds_read_b64_tr_b16 v[46:47], v63 offset:7776
    v_mfma_f32_16x16x32_bf16 v[88:91], v[116:119], v[128:131], v[88:91]
    s_waitcnt lgkmcnt(8)
    ds_read_b64_tr_b16 v[48:49], v63 offset:5248
    ds_read_b64_tr_b16 v[50:51], v63 offset:7808
    v_mfma_f32_16x16x32_bf16 v[96:99], v[120:123], v[128:131], v[96:99]
    s_add_u32 m0, s74, 2048
    s_nop 0
    buffer_load_dwordx4 v6, s[12:15], s62 offen lds
    s_waitcnt lgkmcnt(8)
    ds_read_b64_tr_b16 v[104:105], v63 offset:10240
    ds_read_b64_tr_b16 v[106:107], v63 offset:12800
    v_mfma_f32_16x16x32_bf16 v[64:67], v[32:35], v[132:135], v[64:67]
    s_add_u32 m0, s74, 3072
    s_nop 0
    buffer_load_dwordx4 v7, s[12:15], s62 offen lds
    s_waitcnt lgkmcnt(8)
    ds_read_b64_tr_b16 v[108:109], v63 offset:10272
    ds_read_b64_tr_b16 v[110:111], v63 offset:12832
    v_mfma_f32_16x16x32_bf16 v[72:75], v[36:39], v[132:135], v[72:75]
    s_waitcnt lgkmcnt(8)
    ds_read_b64_tr_b16 v[112:113], v63 offset:10304
    ds_read_b64_tr_b16 v[114:115], v63 offset:12864
    v_mfma_f32_16x16x32_bf16 v[80:83], v[40:43], v[132:135], v[80:83]
    s_add_u32 m0, s74, 4096
    s_nop 0
    buffer_load_dwordx4 v8, s[12:15], s62 offen lds
    s_waitcnt lgkmcnt(8)
    ds_read_b64_tr_b16 v[116:117], v63 offset:10336
    ds_read_b64_tr_b16 v[118:119], v63 offset:12896
    v_mfma_f32_16x16x32_bf16 v[88:91], v[44:47], v[132:135], v[88:91]
    s_waitcnt lgkmcnt(8)
    ds_read_b64_tr_b16 v[120:121], v63 offset:10368
    ds_read_b64_tr_b16 v[122:123], v63 offset:12928
    v_mfma_f32_16x16x32_bf16 v[96:99], v[48:51], v[132:135], v[96:99]
    s_waitcnt lgkmcnt(8)
    ds_read_b64_tr_b16 v[32:33], v63 offset:15360
    ds_read_b64_tr_b16 v[34:35], v63 offset:17920
    v_mfma_f32_16x16x32_bf16 v[64:67], v[104:107], v[136:139], v[64:67]
    s_waitcnt lgkmcnt(8)
    ds_read_b64_tr_b16 v[36:37], v63 offset:15392
    ds_read_b64_tr_b16 v[38:39], v63 offset:17952
    v_mfma_f32_16x16x32_bf16 v[72:75], v[108:111], v[136:139], v[72:75]
    s_waitcnt lgkmcnt(8)
    ds_read_b64_tr_b16 v[40:41], v63 offset:15424
    ds_read_b64_tr_b16 v[42:43], v63 offset:17984
    v_mfma_f32_16x16x32_bf16 v[80:83], v[112:115], v[136:139], v[80:83]
    s_waitcnt lgkmcnt(8)
    ds_read_b64_tr_b16 v[44:45], v63 offset:15456
    ds_read_b64_tr_b16 v[46:47], v63 offset:18016
    v_mfma_f32_16x16x32_bf16 v[88:91], v[116:119], v[136:139], v[88:91]
    s_waitcnt lgkmcnt(8)
    ds_read_b64_tr_b16 v[48:49], v63 offset:15488
    ds_read_b64_tr_b16 v[50:51], v63 offset:18048
    v_mfma_f32_16x16x32_bf16 v[96:99], v[120:123], v[136:139], v[96:99]
    s_waitcnt lgkmcnt(8)
    ds_read_b64_tr_b16 v[104:105], v9 offset:0
    ds_read_b64_tr_b16 v[106:107], v9 offset:2560
    v_mfma_f32_16x16x32_bf16 v[64:67], v[32:35], v[140:143], v[64:67]
    s_waitcnt lgkmcnt(8)
    ds_read_b64_tr_b16 v[108:109], v9 offset:32
    ds_read_b64_tr_b16 v[110:111], v9 offset:2592
    v_mfma_f32_16x16x32_bf16 v[72:75], v[36:39], v[140:143], v[72:75]
    s_waitcnt lgkmcnt(8)
    ds_read_b64_tr_b16 v[112:113], v9 offset:64
    ds_read_b64_tr_b16 v[114:115], v9 offset:2624
    v_mfma_f32_16x16x32_bf16 v[80:83], v[40:43], v[140:143], v[80:83]
    s_waitcnt lgkmcnt(8)
    ds_read_b64_tr_b16 v[116:117], v9 offset:96
    ds_read_b64_tr_b16 v[118:119], v9 offset:2656
    v_mfma_f32_16x16x32_bf16 v[88:91], v[44:47], v[140:143], v[88:91]
    s_waitcnt lgkmcnt(8)
    ds_read_b64_tr_b16 v[120:121], v9 offset:128
    ds_read_b64_tr_b16 v[122:123], v9 offset:2688
    v_mfma_f32_16x16x32_bf16 v[96:99], v[48:51], v[140:143], v[96:99]
    v_cvt_pk_bf16_f32 v16, v64, v65
    v_cvt_pk_bf16_f32 v17, v66, v67
    v_cvt_pk_bf16_f32 v20, v72, v73
    v_cvt_pk_bf16_f32 v21, v74, v75
    v_cvt_pk_bf16_f32 v24, v80, v81
    v_cvt_pk_bf16_f32 v25, v82, v83
    v_cvt_pk_bf16_f32 v28, v88, v89
    v_cvt_pk_bf16_f32 v29, v90, v91
    v_cvt_pk_bf16_f32 v52, v96, v97
    v_cvt_pk_bf16_f32 v53, v98, v99
    s_add_u32 s69, s76, 0
    buffer_store_dwordx2 v[16:17], v59, s[4:7], s69 offen offset:0 sc1
    s_add_u32 s69, s76, 0
    buffer_store_dwordx2 v[20:21], v59, s[4:7], s69 offen offset:1024 sc1
    s_add_u32 s69, s76, 0
    buffer_store_dwordx2 v[24:25], v59, s[4:7], s69 offen offset:2048 sc1
    s_add_u32 s69, s76, 0
    buffer_store_dwordx2 v[28:29], v59, s[4:7], s69 offen offset:3072 sc1
    s_add_u32 s69, s76, 4096
    buffer_store_dwordx2 v[52:53], v59, s[4:7], s69 offen offset:0 sc1
    s_waitcnt vmcnt(10)
    s_barrier
    s_waitcnt lgkmcnt(8)
    ds_read_b64_tr_b16 v[32:33], v9 offset:5120
    ds_read_b64_tr_b16 v[34:35], v9 offset:7680
    v_mfma_f32_16x16x32_bf16 v[64:67], v[104:107], v[160:163], 0
    s_add_u32 s62, s75, 491680
    s_add_u32 m0, s97, 0
    s_nop 0
    buffer_load_dwordx4 v4, s[12:15], s62 offen lds
    s_waitcnt lgkmcnt(8)
    ds_read_b64_tr_b16 v[36:37], v9 offset:5152
    ds_read_b64_tr_b16 v[38:39], v9 offset:7712
    v_mfma_f32_16x16x32_bf16 v[72:75], v[108:111], v[160:163], 0
    s_waitcnt lgkmcnt(8)
    ds_read_b64_tr_b16 v[40:41], v9 offset:5184
    ds_read_b64_tr_b16 v[42:43], v9 offset:7744
    v_mfma_f32_16x16x32_bf16 v[80:83], v[112:115], v[160:163], 0
    s_add_u32 m0, s97, 1024
    s_nop 0
    buffer_load_dwordx4 v5, s[12:15], s62 offen lds
    s_waitcnt lgkmcnt(8)
    ds_read_b64_tr_b16 v[44:45], v9 offset:5216
    ds_read_b64_tr_b16 v[46:47], v9 offset:7776
    v_mfma_f32_16x16x32_bf16 v[88:91], v[116:119], v[160:163], 0
    s_waitcnt lgkmcnt(8)
    ds_read_b64_tr_b16 v[48:49], v9 offset:5248
    ds_read_b64_tr_b16 v[50:51], v9 offset:7808
    v_mfma_f32_16x16x32_bf16 v[96:99], v[120:123], v[160:163], 0
    s_add_u32 m0, s97, 2048
    s_nop 0
    buffer_load_dwordx4 v6, s[12:15], s62 offen lds
    s_waitcnt lgkmcnt(8)
    ds_read_b64_tr_b16 v[104:105], v9 offset:10240
    ds_read_b64_tr_b16 v[106:107], v9 offset:12800
    v_mfma_f32_16x16x32_bf16 v[64:67], v[32:35], v[164:167], v[64:67]
    s_add_u32 m0, s97, 3072
    s_nop 0
    buffer_load_dwordx4 v7, s[12:15], s62 offen lds
    s_waitcnt lgkmcnt(8)
    ds_read_b64_tr_b16 v[108:109], v9 offset:10272
    ds_read_b64_tr_b16 v[110:111], v9 offset:12832
    v_mfma_f32_16x16x32_bf16 v[72:75], v[36:39], v[164:167], v[72:75]
    s_waitcnt lgkmcnt(8)
    ds_read_b64_tr_b16 v[112:113], v9 offset:10304
    ds_read_b64_tr_b16 v[114:115], v9 offset:12864
    v_mfma_f32_16x16x32_bf16 v[80:83], v[40:43], v[164:167], v[80:83]
    s_add_u32 m0, s97, 4096
    s_nop 0
    buffer_load_dwordx4 v8, s[12:15], s62 offen lds
    s_waitcnt lgkmcnt(8)
    ds_read_b64_tr_b16 v[116:117], v9 offset:10336
    ds_read_b64_tr_b16 v[118:119], v9 offset:12896
    v_mfma_f32_16x16x32_bf16 v[88:91], v[44:47], v[164:167], v[88:91]
    s_waitcnt lgkmcnt(8)
    ds_read_b64_tr_b16 v[120:121], v9 offset:10368
    ds_read_b64_tr_b16 v[122:123], v9 offset:12928
    v_mfma_f32_16x16x32_bf16 v[96:99], v[48:51], v[164:167], v[96:99]
    s_waitcnt lgkmcnt(8)
    ds_read_b64_tr_b16 v[32:33], v9 offset:15360
    ds_read_b64_tr_b16 v[34:35], v9 offset:17920
    v_mfma_f32_16x16x32_bf16 v[64:67], v[104:107], v[168:171], v[64:67]
    s_waitcnt lgkmcnt(8)
    ds_read_b64_tr_b16 v[36:37], v9 offset:15392
    ds_read_b64_tr_b16 v[38:39], v9 offset:17952
    v_mfma_f32_16x16x32_bf16 v[72:75], v[108:111], v[168:171], v[72:75]
    s_waitcnt lgkmcnt(8)
    ds_read_b64_tr_b16 v[40:41], v9 offset:15424
    ds_read_b64_tr_b16 v[42:43], v9 offset:17984
    v_mfma_f32_16x16x32_bf16 v[80:83], v[112:115], v[168:171], v[80:83]
    s_waitcnt lgkmcnt(8)
    ds_read_b64_tr_b16 v[44:45], v9 offset:15456
    ds_read_b64_tr_b16 v[46:47], v9 offset:18016
    v_mfma_f32_16x16x32_bf16 v[88:91], v[116:119], v[168:171], v[88:91]
    s_waitcnt lgkmcnt(8)
    ds_read_b64_tr_b16 v[48:49], v9 offset:15488
    ds_read_b64_tr_b16 v[50:51], v9 offset:18048
    v_mfma_f32_16x16x32_bf16 v[96:99], v[120:123], v[168:171], v[96:99]
    s_waitcnt lgkmcnt(8)
    ds_read_b64_tr_b16 v[104:105], v10 offset:0
    ds_read_b64_tr_b16 v[106:107], v10 offset:2560
    v_mfma_f32_16x16x32_bf16 v[64:67], v[32:35], v[172:175], v[64:67]
    s_waitcnt lgkmcnt(8)
    ds_read_b64_tr_b16 v[108:109], v10 offset:32
    ds_read_b64_tr_b16 v[110:111], v10 offset:2592
    v_mfma_f32_16x16x32_bf16 v[72:75], v[36:39], v[172:175], v[72:75]
    s_waitcnt lgkmcnt(8)
    ds_read_b64_tr_b16 v[112:113], v10 offset:64
    ds_read_b64_tr_b16 v[114:115], v10 offset:2624
    v_mfma_f32_16x16x32_bf16 v[80:83], v[40:43], v[172:175], v[80:83]
    s_waitcnt lgkmcnt(8)
    ds_read_b64_tr_b16 v[116:117], v10 offset:96
    ds_read_b64_tr_b16 v[118:119], v10 offset:2656
    v_mfma_f32_16x16x32_bf16 v[88:91], v[44:47], v[172:175], v[88:91]
    s_waitcnt lgkmcnt(8)
    ds_read_b64_tr_b16 v[120:121], v10 offset:128
    ds_read_b64_tr_b16 v[122:123], v10 offset:2688
    v_mfma_f32_16x16x32_bf16 v[96:99], v[48:51], v[172:175], v[96:99]
    s_waitcnt vmcnt(10)
    s_barrier
    s_cmp_lg_u32 s24, 7
    s_cbranch_scc1 m_epc1
    v_mov_b32 v57, s96
    buffer_load_dword v56, v57, s[92:95], 0 offen sc1
m_epc1:
    s_waitcnt lgkmcnt(8)
    ds_read_b64_tr_b16 v[32:33], v10 offset:5120
    ds_read_b64_tr_b16 v[34:35], v10 offset:7680
    v_mfma_f32_16x16x32_bf16 v[64:67], v[104:107], v[224:227], v[64:67]
    s_add_u32 s62, s75, 320
    s_add_u32 m0, s72, 0
    s_nop 0
    buffer_load_dwordx4 v4, s[12:15], s62 offen lds
    s_waitcnt lgkmcnt(8)
    ds_read_b64_tr_b16 v[36:37], v10 offset:5152
    ds_read_b64_tr_b16 v[38:39], v10 offset:7712
    v_mfma_f32_16x16x32_bf16 v[72:75], v[108:111], v[224:227], v[72:75]
    s_waitcnt lgkmcnt(8)
    ds_read_b64_tr_b16 v[40:41], v10 offset:5184
    ds_read_b64_tr_b16 v[42:43], v10 offset:7744
    v_mfma_f32_16x16x32_bf16 v[80:83], v[112:115], v[224:227], v[80:83]
    s_add_u32 m0, s72, 1024
    s_nop 0
    buffer_load_dwordx4 v5, s[12:15], s62 offen lds
    s_waitcnt lgkmcnt(8)
    ds_read_b64_tr_b16 v[44:45], v10 offset:5216
    ds_read_b64_tr_b16 v[46:47], v10 offset:7776
    v_mfma_f32_16x16x32_bf16 v[88:91], v[116:119], v[224:227], v[88:91]
    s_waitcnt lgkmcnt(8)
    ds_read_b64_tr_b16 v[48:49], v10 offset:5248
    ds_read_b64_tr_b16 v[50:51], v10 offset:7808
    v_mfma_f32_16x16x32_bf16 v[96:99], v[120:123], v[224:227], v[96:99]
    s_add_u32 m0, s72, 2048
    s_nop 0
    buffer_load_dwordx4 v6, s[12:15], s62 offen lds
    s_waitcnt lgkmcnt(8)
    ds_read_b64_tr_b16 v[104:105], v10 offset:10240
    ds_read_b64_tr_b16 v[106:107], v10 offset:12800
    v_mfma_f32_16x16x32_bf16 v[64:67], v[32:35], v[228:231], v[64:67]
    s_add_u32 m0, s72, 3072
    s_nop 0
    buffer_load_dwordx4 v7, s[12:15], s62 offen lds
    s_waitcnt lgkmcnt(8)
    ds_read_b64_tr_b16 v[108:109], v10 offset:10272
    ds_read_b64_tr_b16 v[110:111], v10 offset:12832
    v_mfma_f32_16x16x32_bf16 v[72:75], v[36:39], v[228:231], v[72:75]
    s_waitcnt lgkmcnt(8)
    ds_read_b64_tr_b16 v[112:113], v10 offset:10304
    ds_read_b64_tr_b16 v[114:115], v10 offset:12864
    v_mfma_f32_16x16x32_bf16 v[80:83], v[40:43], v[228:231], v[80:83]
    s_add_u32 m0, s72, 4096
    s_nop 0
    buffer_load_dwordx4 v8, s[12:15], s62 offen lds
    s_waitcnt lgkmcnt(8)
    ds_read_b64_tr_b16 v[116:117], v10 offset:10336
    ds_read_b64_tr_b16 v[118:119], v10 offset:12896
    v_mfma_f32_16x16x32_bf16 v[88:91], v[44:47], v[228:231], v[88:91]
    s_waitcnt lgkmcnt(8)
    ds_read_b64_tr_b16 v[120:121], v10 offset:10368
    ds_read_b64_tr_b16 v[122:123], v10 offset:12928
    v_mfma_f32_16x16x32_bf16 v[96:99], v[48:51], v[228:231], v[96:99]
    s_waitcnt lgkmcnt(8)
    ds_read_b64_tr_b16 v[32:33], v10 offset:15360
    ds_read_b64_tr_b16 v[34:35], v10 offset:17920
    v_mfma_f32_16x16x32_bf16 v[64:67], v[104:107], v[232:235], v[64:67]
    s_waitcnt lgkmcnt(8)
    ds_read_b64_tr_b16 v[36:37], v10 offset:15392
    ds_read_b64_tr_b16 v[38:39], v10 offset:17952
    v_mfma_f32_16x16x32_bf16 v[72:75], v[108:111], v[232:235], v[72:75]
    s_waitcnt lgkmcnt(8)
    ds_read_b64_tr_b16 v[40:41], v10 offset:15424
    ds_read_b64_tr_b16 v[42:43], v10 offset:17984
    v_mfma_f32_16x16x32_bf16 v[80:83], v[112:115], v[232:235], v[80:83]
    s_waitcnt lgkmcnt(8)
    ds_read_b64_tr_b16 v[44:45], v10 offset:15456
    ds_read_b64_tr_b16 v[46:47], v10 offset:18016
    v_mfma_f32_16x16x32_bf16 v[88:91], v[116:119], v[232:235], v[88:91]
    s_waitcnt lgkmcnt(8)
    ds_read_b64_tr_b16 v[48:49], v10 offset:15488
    ds_read_b64_tr_b16 v[50:51], v10 offset:18048
    v_mfma_f32_16x16x32_bf16 v[96:99], v[120:123], v[232:235], v[96:99]
    s_waitcnt lgkmcnt(8)
    ds_read_b64_tr_b16 v[104:105], v11 offset:0
    ds_read_b64_tr_b16 v[106:107], v11 offset:2560
    v_mfma_f32_16x16x32_bf16 v[64:67], v[32:35], v[236:239], v[64:67]
    s_waitcnt lgkmcnt(8)
    ds_read_b64_tr_b16 v[108:109], v11 offset:32
    ds_read_b64_tr_b16 v[110:111], v11 offset:2592
    v_mfma_f32_16x16x32_bf16 v[72:75], v[36:39], v[236:239], v[72:75]
    s_waitcnt lgkmcnt(8)
    ds_read_b64_tr_b16 v[112:113], v11 offset:64
    ds_read_b64_tr_b16 v[114:115], v11 offset:2624
    v_mfma_f32_16x16x32_bf16 v[80:83], v[40:43], v[236:239], v[80:83]
    s_waitcnt lgkmcnt(8)
    ds_read_b64_tr_b16 v[116:117], v11 offset:96
    ds_read_b64_tr_b16 v[118:119], v11 offset:2656
    v_mfma_f32_16x16x32_bf16 v[88:91], v[44:47], v[236:239], v[88:91]
    s_waitcnt lgkmcnt(8)
    ds_read_b64_tr_b16 v[120:121], v11 offset:128
    ds_read_b64_tr_b16 v[122:123], v11 offset:2688
    v_mfma_f32_16x16x32_bf16 v[96:99], v[48:51], v[236:239], v[96:99]
    s_waitcnt vmcnt(5)
    s_barrier
    s_waitcnt lgkmcnt(8)
    ds_read_b64_tr_b16 v[32:33], v11 offset:5120
    ds_read_b64_tr_b16 v[34:35], v11 offset:7680
    v_mfma_f32_16x16x32_bf16 v[64:67], v[104:107], v[192:195], v[64:67]
    s_add_u32 s62, s75, 164160
    s_add_u32 m0, s73, 0
    s_nop 0
    buffer_load_dwordx4 v4, s[12:15], s62 offen lds
    s_waitcnt lgkmcnt(8)
    ds_read_b64_tr_b16 v[36:37], v11 offset:5152
    ds_read_b64_tr_b16 v[38:39], v11 offset:7712
    v_mfma_f32_16x16x32_bf16 v[72:75], v[108:111], v[192:195], v[72:75]
    s_waitcnt lgkmcnt(8)
    ds_read_b64_tr_b16 v[40:41], v11 offset:5184
    ds_read_b64_tr_b16 v[42:43], v11 offset:7744
    v_mfma_f32_16x16x32_bf16 v[80:83], v[112:115], v[192:195], v[80:83]
    s_add_u32 m0, s73, 1024
    s_nop 0
    buffer_load_dwordx4 v5, s[12:15], s62 offen lds
    s_waitcnt lgkmcnt(8)
    ds_read_b64_tr_b16 v[44:45], v11 offset:5216
    ds_read_b64_tr_b16 v[46:47], v11 offset:7776
    v_mfma_f32_16x16x32_bf16 v[88:91], v[116:119], v[192:195], v[88:91]
    s_waitcnt lgkmcnt(8)
    ds_read_b64_tr_b16 v[48:49], v11 offset:5248
    ds_read_b64_tr_b16 v[50:51], v11 offset:7808
    v_mfma_f32_16x16x32_bf16 v[96:99], v[120:123], v[192:195], v[96:99]
    s_add_u32 m0, s73, 2048
    s_nop 0
    buffer_load_dwordx4 v6, s[12:15], s62 offen lds
    s_waitcnt lgkmcnt(8)
    ds_read_b64_tr_b16 v[104:105], v11 offset:10240
    ds_read_b64_tr_b16 v[106:107], v11 offset:12800
    v_mfma_f32_16x16x32_bf16 v[64:67], v[32:35], v[196:199], v[64:67]
    s_add_u32 m0, s73, 3072
    s_nop 0
    buffer_load_dwordx4 v7, s[12:15], s62 offen lds
    s_waitcnt lgkmcnt(8)
    ds_read_b64_tr_b16 v[108:109], v11 offset:10272
    ds_read_b64_tr_b16 v[110:111], v11 offset:12832
    v_mfma_f32_16x16x32_bf16 v[72:75], v[36:39], v[196:199], v[72:75]
    s_waitcnt lgkmcnt(8)
    ds_read_b64_tr_b16 v[112:113], v11 offset:10304
    ds_read_b64_tr_b16 v[114:115], v11 offset:12864
    v_mfma_f32_16x16x32_bf16 v[80:83], v[40:43], v[196:199], v[80:83]
    s_add_u32 m0, s73, 4096
    s_nop 0
    buffer_load_dwordx4 v8, s[12:15], s62 offen lds
    s_waitcnt lgkmcnt(8)
    ds_read_b64_tr_b16 v[116:117], v11 offset:10336
    ds_read_b64_tr_b16 v[118:119], v11 offset:12896
    v_mfma_f32_16x16x32_bf16 v[88:91], v[44:47], v[196:199], v[88:91]
    s_waitcnt lgkmcnt(8)
    ds_read_b64_tr_b16 v[120:121], v11 offset:10368
    ds_read_b64_tr_b16 v[122:123], v11 offset:12928
    v_mfma_f32_16x16x32_bf16 v[96:99], v[48:51], v[196:199], v[96:99]
    s_waitcnt lgkmcnt(8)
    ds_read_b64_tr_b16 v[32:33], v11 offset:15360
    ds_read_b64_tr_b16 v[34:35], v11 offset:17920
    v_mfma_f32_16x16x32_bf16 v[64:67], v[104:107], v[200:203], v[64:67]
    s_waitcnt lgkmcnt(8)
    ds_read_b64_tr_b16 v[36:37], v11 offset:15392
    ds_read_b64_tr_b16 v[38:39], v11 offset:17952
    v_mfma_f32_16x16x32_bf16 v[72:75], v[108:111], v[200:203], v[72:75]
    s_waitcnt lgkmcnt(8)
    ds_read_b64_tr_b16 v[40:41], v11 offset:15424
    ds_read_b64_tr_b16 v[42:43], v11 offset:17984
    v_mfma_f32_16x16x32_bf16 v[80:83], v[112:115], v[200:203], v[80:83]
    s_waitcnt lgkmcnt(8)
    ds_read_b64_tr_b16 v[44:45], v11 offset:15456
    ds_read_b64_tr_b16 v[46:47], v11 offset:18016
    v_mfma_f32_16x16x32_bf16 v[88:91], v[116:119], v[200:203], v[88:91]
    s_waitcnt lgkmcnt(8)
    ds_read_b64_tr_b16 v[48:49], v11 offset:15488
    ds_read_b64_tr_b16 v[50:51], v11 offset:18048
    v_mfma_f32_16x16x32_bf16 v[96:99], v[120:123], v[200:203], v[96:99]
    s_waitcnt lgkmcnt(8)
    ds_read_b64_tr_b16 v[104:105], v63 offset:0
    ds_read_b64_tr_b16 v[106:107], v63 offset:2560
    v_mfma_f32_16x16x32_bf16 v[64:67], v[32:35], v[204:207], v[64:67]
    s_waitcnt lgkmcnt(8)
    ds_read_b64_tr_b16 v[108:109], v63 offset:32
    ds_read_b64_tr_b16 v[110:111], v63 offset:2592
    v_mfma_f32_16x16x32_bf16 v[72:75], v[36:39], v[204:207], v[72:75]
    s_waitcnt lgkmcnt(8)
    ds_read_b64_tr_b16 v[112:113], v63 offset:64
    ds_read_b64_tr_b16 v[114:115], v63 offset:2624
    v_mfma_f32_16x16x32_bf16 v[80:83], v[40:43], v[204:207], v[80:83]
    s_waitcnt lgkmcnt(8)
    ds_read_b64_tr_b16 v[116:117], v63 offset:96
    ds_read_b64_tr_b16 v[118:119], v63 offset:2656
    v_mfma_f32_16x16x32_bf16 v[88:91], v[44:47], v[204:207], v[88:91]
    s_waitcnt lgkmcnt(8)
    ds_read_b64_tr_b16 v[120:121], v63 offset:128
    ds_read_b64_tr_b16 v[122:123], v63 offset:2688
    v_mfma_f32_16x16x32_bf16 v[96:99], v[48:51], v[204:207], v[96:99]
    s_waitcnt vmcnt(5)
    s_barrier
    s_waitcnt lgkmcnt(8)
    ds_read_b64_tr_b16 v[32:33], v63 offset:5120
    ds_read_b64_tr_b16 v[34:35], v63 offset:7680
    v_mfma_f32_16x16x32_bf16 v[64:67], v[104:107], v[128:131], v[64:67]
    s_add_u32 s62, s75, 328000
    s_add_u32 m0, s74, 0
    s_nop 0
    buffer_load_dwordx4 v4, s[12:15], s62 offen lds
    s_waitcnt lgkmcnt(8)
    ds_read_b64_tr_b16 v[36:37], v63 offset:5152
    ds_read_b64_tr_b16 v[38:39], v63 offset:7712
    v_mfma_f32_16x16x32_bf16 v[72:75], v[108:111], v[128:131], v[72:75]
    s_waitcnt lgkmcnt(8)
    ds_read_b64_tr_b16 v[40:41], v63 offset:5184
    ds_read_b64_tr_b16 v[42:43], v63 offset:7744
    v_mfma_f32_16x16x32_bf16 v[80:83], v[112:115], v[128:131], v[80:83]
    s_add_u32 m0, s74, 1024
    s_nop 0
    buffer_load_dwordx4 v5, s[12:15], s62 offen lds
    s_waitcnt lgkmcnt(8)
    ds_read_b64_tr_b16 v[44:45], v63 offset:5216
    ds_read_b64_tr_b16 v[46:47], v63 offset:7776
    v_mfma_f32_16x16x32_bf16 v[88:91], v[116:119], v[128:131], v[88:91]
    s_waitcnt lgkmcnt(8)
    ds_read_b64_tr_b16 v[48:49], v63 offset:5248
    ds_read_b64_tr_b16 v[50:51], v63 offset:7808
    v_mfma_f32_16x16x32_bf16 v[96:99], v[120:123], v[128:131], v[96:99]
    s_add_u32 m0, s74, 2048
    s_nop 0
    buffer_load_dwordx4 v6, s[12:15], s62 offen lds
    s_waitcnt lgkmcnt(8)
    ds_read_b64_tr_b16 v[104:105], v63 offset:10240
    ds_read_b64_tr_b16 v[106:107], v63 offset:12800
    v_mfma_f32_16x16x32_bf16 v[64:67], v[32:35], v[132:135], v[64:67]
    s_add_u32 m0, s74, 3072
    s_nop 0
    buffer_load_dwordx4 v7, s[12:15], s62 offen lds
    s_waitcnt lgkmcnt(8)
    ds_read_b64_tr_b16 v[108:109], v63 offset:10272
    ds_read_b64_tr_b16 v[110:111], v63 offset:12832
    v_mfma_f32_16x16x32_bf16 v[72:75], v[36:39], v[132:135], v[72:75]
    s_waitcnt lgkmcnt(8)
    ds_read_b64_tr_b16 v[112:113], v63 offset:10304
    ds_read_b64_tr_b16 v[114:115], v63 offset:12864
    v_mfma_f32_16x16x32_bf16 v[80:83], v[40:43], v[132:135], v[80:83]
    s_add_u32 m0, s74, 4096
    s_nop 0
    buffer_load_dwordx4 v8, s[12:15], s62 offen lds
    s_waitcnt lgkmcnt(8)
    ds_read_b64_tr_b16 v[116:117], v63 offset:10336
    ds_read_b64_tr_b16 v[118:119], v63 offset:12896
    v_mfma_f32_16x16x32_bf16 v[88:91], v[44:47], v[132:135], v[88:91]
    s_waitcnt lgkmcnt(8)
    ds_read_b64_tr_b16 v[120:121], v63 offset:10368
    ds_read_b64_tr_b16 v[122:123], v63 offset:12928
    v_mfma_f32_16x16x32_bf16 v[96:99], v[48:51], v[132:135], v[96:99]
    s_waitcnt lgkmcnt(8)
    ds_read_b64_tr_b16 v[32:33], v63 offset:15360
    ds_read_b64_tr_b16 v[34:35], v63 offset:17920
    v_mfma_f32_16x16x32_bf16 v[64:67], v[104:107], v[136:139], v[64:67]
    s_waitcnt lgkmcnt(8)
    ds_read_b64_tr_b16 v[36:37], v63 offset:15392
    ds_read_b64_tr_b16 v[38:39], v63 offset:17952
    v_mfma_f32_16x16x32_bf16 v[72:75], v[108:111], v[136:139], v[72:75]
    s_waitcnt lgkmcnt(8)
    ds_read_b64_tr_b16 v[40:41], v63 offset:15424
    ds_read_b64_tr_b16 v[42:43], v63 offset:17984
    v_mfma_f32_16x16x32_bf16 v[80:83], v[112:115], v[136:139], v[80:83]
    s_waitcnt lgkmcnt(8)
    ds_read_b64_tr_b16 v[44:45], v63 offset:15456
    ds_read_b64_tr_b16 v[46:47], v63 offset:18016
    v_mfma_f32_16x16x32_bf16 v[88:91], v[116:119], v[136:139], v[88:91]
    s_waitcnt lgkmcnt(8)
    ds_read_b64_tr_b16 v[48:49], v63 offset:15488
    ds_read_b64_tr_b16 v[50:51], v63 offset:18048
    v_mfma_f32_16x16x32_bf16 v[96:99], v[120:123], v[136:139], v[96:99]
    s_waitcnt lgkmcnt(8)
    ds_read_b64_tr_b16 v[104:105], v9 offset:0
    ds_read_b64_tr_b16 v[106:107], v9 offset:2560
    v_mfma_f32_16x16x32_bf16 v[64:67], v[32:35], v[140:143], v[64:67]
    s_waitcnt lgkmcnt(8)
    ds_read_b64_tr_b16 v[108:109], v9 offset:32
    ds_read_b64_tr_b16 v[110:111], v9 offset:2592
    v_mfma_f32_16x16x32_bf16 v[72:75], v[36:39], v[140:143], v[72:75]
    s_waitcnt lgkmcnt(8)
    ds_read_b64_tr_b16 v[112:113], v9 offset:64
    ds_read_b64_tr_b16 v[114:115], v9 offset:2624
    v_mfma_f32_16x16x32_bf16 v[80:83], v[40:43], v[140:143], v[80:83]
    s_waitcnt lgkmcnt(8)
    ds_read_b64_tr_b16 v[116:117], v9 offset:96
    ds_read_b64_tr_b16 v[118:119], v9 offset:2656
    v_mfma_f32_16x16x32_bf16 v[88:91], v[44:47], v[140:143], v[88:91]
    s_waitcnt lgkmcnt(8)
    ds_read_b64_tr_b16 v[120:121], v9 offset:128
    ds_read_b64_tr_b16 v[122:123], v9 offset:2688
    v_mfma_f32_16x16x32_bf16 v[96:99], v[48:51], v[140:143], v[96:99]
    v_cvt_pk_bf16_f32 v16, v64, v65
    v_cvt_pk_bf16_f32 v17, v66, v67
    v_cvt_pk_bf16_f32 v20, v72, v73
    v_cvt_pk_bf16_f32 v21, v74, v75
    v_cvt_pk_bf16_f32 v24, v80, v81
    v_cvt_pk_bf16_f32 v25, v82, v83
    v_cvt_pk_bf16_f32 v28, v88, v89
    v_cvt_pk_bf16_f32 v29, v90, v91
    v_cvt_pk_bf16_f32 v52, v96, v97
    v_cvt_pk_bf16_f32 v53, v98, v99
    s_add_u32 s69, s76, 20480
    buffer_store_dwordx2 v[16:17], v59, s[4:7], s69 offen offset:0 sc1
    s_add_u32 s69, s76, 20480
    buffer_store_dwordx2 v[20:21], v59, s[4:7], s69 offen offset:1024 sc1
    s_add_u32 s69, s76, 20480
    buffer_store_dwordx2 v[24:25], v59, s[4:7], s69 offen offset:2048 sc1
    s_add_u32 s69, s76, 20480
    buffer_store_dwordx2 v[28:29], v59, s[4:7], s69 offen offset:3072 sc1
    s_add_u32 s69, s76, 24576
    buffer_store_dwordx2 v[52:53], v59, s[4:7], s69 offen offset:0 sc1
    s_waitcnt vmcnt(10)
    s_barrier
    s_waitcnt lgkmcnt(8)
    ds_read_b64_tr_b16 v[32:33], v9 offset:5120
    ds_read_b64_tr_b16 v[34:35], v9 offset:7680
    v_mfma_f32_16x16x32_bf16 v[64:67], v[104:107], v[160:163], 0
    s_add_u32 s62, s75, 491840
    s_add_u32 m0, s97, 0
    s_nop 0
    buffer_load_dwordx4 v4, s[12:15], s62 offen lds
    s_waitcnt lgkmcnt(8)
    ds_read_b64_tr_b16 v[36:37], v9 offset:5152
    ds_read_b64_tr_b16 v[38:39], v9 offset:7712
    v_mfma_f32_16x16x32_bf16 v[72:75], v[108:111], v[160:163], 0
    s_waitcnt lgkmcnt(8)
    ds_read_b64_tr_b16 v[40:41], v9 offset:5184
    ds_read_b64_tr_b16 v[42:43], v9 offset:7744
    v_mfma_f32_16x16x32_bf16 v[80:83], v[112:115], v[160:163], 0
    s_add_u32 m0, s97, 1024
    s_nop 0
    buffer_load_dwordx4 v5, s[12:15], s62 offen lds
    s_waitcnt lgkmcnt(8)
    ds_read_b64_tr_b16 v[44:45], v9 offset:5216
    ds_read_b64_tr_b16 v[46:47], v9 offset:7776
    v_mfma_f32_16x16x32_bf16 v[88:91], v[116:119], v[160:163], 0
    s_waitcnt lgkmcnt(8)
    ds_read_b64_tr_b16 v[48:49], v9 offset:5248
    ds_read_b64_tr_b16 v[50:51], v9 offset:7808
    v_mfma_f32_16x16x32_bf16 v[96:99], v[120:123], v[160:163], 0
    s_add_u32 m0, s97, 2048
    s_nop 0
    buffer_load_dwordx4 v6, s[12:15], s62 offen lds
    s_waitcnt lgkmcnt(8)
    ds_read_b64_tr_b16 v[104:105], v9 offset:10240
    ds_read_b64_tr_b16 v[106:107], v9 offset:12800
    v_mfma_f32_16x16x32_bf16 v[64:67], v[32:35], v[164:167], v[64:67]
    s_add_u32 m0, s97, 3072
    s_nop 0
    buffer_load_dwordx4 v7, s[12:15], s62 offen lds
    s_waitcnt lgkmcnt(8)
    ds_read_b64_tr_b16 v[108:109], v9 offset:10272
    ds_read_b64_tr_b16 v[110:111], v9 offset:12832
    v_mfma_f32_16x16x32_bf16 v[72:75], v[36:39], v[164:167], v[72:75]
    s_waitcnt lgkmcnt(8)
    ds_read_b64_tr_b16 v[112:113], v9 offset:10304
    ds_read_b64_tr_b16 v[114:115], v9 offset:12864
    v_mfma_f32_16x16x32_bf16 v[80:83], v[40:43], v[164:167], v[80:83]
    s_add_u32 m0, s97, 4096
    s_nop 0
    buffer_load_dwordx4 v8, s[12:15], s62 offen lds
    s_waitcnt lgkmcnt(8)
    ds_read_b64_tr_b16 v[116:117], v9 offset:10336
    ds_read_b64_tr_b16 v[118:119], v9 offset:12896
    v_mfma_f32_16x16x32_bf16 v[88:91], v[44:47], v[164:167], v[88:91]
    s_waitcnt lgkmcnt(8)
    ds_read_b64_tr_b16 v[120:121], v9 offset:10368
    ds_read_b64_tr_b16 v[122:123], v9 offset:12928
    v_mfma_f32_16x16x32_bf16 v[96:99], v[48:51], v[164:167], v[96:99]
    s_waitcnt lgkmcnt(8)
    ds_read_b64_tr_b16 v[32:33], v9 offset:15360
    ds_read_b64_tr_b16 v[34:35], v9 offset:17920
    v_mfma_f32_16x16x32_bf16 v[64:67], v[104:107], v[168:171], v[64:67]
    s_waitcnt lgkmcnt(8)
    ds_read_b64_tr_b16 v[36:37], v9 offset:15392
    ds_read_b64_tr_b16 v[38:39], v9 offset:17952
    v_mfma_f32_16x16x32_bf16 v[72:75], v[108:111], v[168:171], v[72:75]
    s_waitcnt lgkmcnt(8)
    ds_read_b64_tr_b16 v[40:41], v9 offset:15424
    ds_read_b64_tr_b16 v[42:43], v9 offset:17984
    v_mfma_f32_16x16x32_bf16 v[80:83], v[112:115], v[168:171], v[80:83]
    s_waitcnt lgkmcnt(8)
    ds_read_b64_tr_b16 v[44:45], v9 offset:15456
    ds_read_b64_tr_b16 v[46:47], v9 offset:18016
    v_mfma_f32_16x16x32_bf16 v[88:91], v[116:119], v[168:171], v[88:91]
    s_waitcnt lgkmcnt(8)
    ds_read_b64_tr_b16 v[48:49], v9 offset:15488
    ds_read_b64_tr_b16 v[50:51], v9 offset:18048
    v_mfma_f32_16x16x32_bf16 v[96:99], v[120:123], v[168:171], v[96:99]
    s_waitcnt lgkmcnt(8)
    ds_read_b64_tr_b16 v[104:105], v10 offset:0
    ds_read_b64_tr_b16 v[106:107], v10 offset:2560
    v_mfma_f32_16x16x32_bf16 v[64:67], v[32:35], v[172:175], v[64:67]
    s_waitcnt lgkmcnt(8)
    ds_read_b64_tr_b16 v[108:109], v10 offset:32
    ds_read_b64_tr_b16 v[110:111], v10 offset:2592
    v_mfma_f32_16x16x32_bf16 v[72:75], v[36:39], v[172:175], v[72:75]
    s_waitcnt lgkmcnt(8)
    ds_read_b64_tr_b16 v[112:113], v10 offset:64
    ds_read_b64_tr_b16 v[114:115], v10 offset:2624
    v_mfma_f32_16x16x32_bf16 v[80:83], v[40:43], v[172:175], v[80:83]
    s_waitcnt lgkmcnt(8)
    ds_read_b64_tr_b16 v[116:117], v10 offset:96
    ds_read_b64_tr_b16 v[118:119], v10 offset:2656
    v_mfma_f32_16x16x32_bf16 v[88:91], v[44:47], v[172:175], v[88:91]
    s_waitcnt lgkmcnt(8)
    ds_read_b64_tr_b16 v[120:121], v10 offset:128
    ds_read_b64_tr_b16 v[122:123], v10 offset:2688
    v_mfma_f32_16x16x32_bf16 v[96:99], v[48:51], v[172:175], v[96:99]
    s_waitcnt vmcnt(10)
    s_barrier
    s_waitcnt lgkmcnt(8)
    ds_read_b64_tr_b16 v[32:33], v10 offset:5120
    ds_read_b64_tr_b16 v[34:35], v10 offset:7680
    v_mfma_f32_16x16x32_bf16 v[64:67], v[104:107], v[224:227], v[64:67]
    s_add_u32 s62, s75, 480
    s_add_u32 m0, s72, 0
    s_nop 0
    buffer_load_dwordx4 v4, s[12:15], s62 offen lds
    s_waitcnt lgkmcnt(8)
    ds_read_b64_tr_b16 v[36:37], v10 offset:5152
    ds_read_b64_tr_b16 v[38:39], v10 offset:7712
    v_mfma_f32_16x16x32_bf16 v[72:75], v[108:111], v[224:227], v[72:75]
    s_waitcnt lgkmcnt(8)
    ds_read_b64_tr_b16 v[40:41], v10 offset:5184
    ds_read_b64_tr_b16 v[42:43], v10 offset:7744
    v_mfma_f32_16x16x32_bf16 v[80:83], v[112:115], v[224:227], v[80:83]
    s_add_u32 m0, s72, 1024
    s_nop 0
    buffer_load_dwordx4 v5, s[12:15], s62 offen lds
    s_waitcnt lgkmcnt(8)
    ds_read_b64_tr_b16 v[44:45], v10 offset:5216
    ds_read_b64_tr_b16 v[46:47], v10 offset:7776
    v_mfma_f32_16x16x32_bf16 v[88:91], v[116:119], v[224:227], v[88:91]
    s_waitcnt lgkmcnt(8)
    ds_read_b64_tr_b16 v[48:49], v10 offset:5248
    ds_read_b64_tr_b16 v[50:51], v10 offset:7808
    v_mfma_f32_16x16x32_bf16 v[96:99], v[120:123], v[224:227], v[96:99]
    s_add_u32 m0, s72, 2048
    s_nop 0
    buffer_load_dwordx4 v6, s[12:15], s62 offen lds
    s_waitcnt lgkmcnt(8)
    ds_read_b64_tr_b16 v[104:105], v10 offset:10240
    ds_read_b64_tr_b16 v[106:107], v10 offset:12800
    v_mfma_f32_16x16x32_bf16 v[64:67], v[32:35], v[228:231], v[64:67]
    s_add_u32 m0, s72, 3072
    s_nop 0
    buffer_load_dwordx4 v7, s[12:15], s62 offen lds
    s_waitcnt lgkmcnt(8)
    ds_read_b64_tr_b16 v[108:109], v10 offset:10272
    ds_read_b64_tr_b16 v[110:111], v10 offset:12832
    v_mfma_f32_16x16x32_bf16 v[72:75], v[36:39], v[228:231], v[72:75]
    s_waitcnt lgkmcnt(8)
    ds_read_b64_tr_b16 v[112:113], v10 offset:10304
    ds_read_b64_tr_b16 v[114:115], v10 offset:12864
    v_mfma_f32_16x16x32_bf16 v[80:83], v[40:43], v[228:231], v[80:83]
    s_add_u32 m0, s72, 4096
    s_nop 0
    buffer_load_dwordx4 v8, s[12:15], s62 offen lds
    s_waitcnt lgkmcnt(8)
    ds_read_b64_tr_b16 v[116:117], v10 offset:10336
    ds_read_b64_tr_b16 v[118:119], v10 offset:12896
    v_mfma_f32_16x16x32_bf16 v[88:91], v[44:47], v[228:231], v[88:91]
    s_waitcnt lgkmcnt(8)
    ds_read_b64_tr_b16 v[120:121], v10 offset:10368
    ds_read_b64_tr_b16 v[122:123], v10 offset:12928
    v_mfma_f32_16x16x32_bf16 v[96:99], v[48:51], v[228:231], v[96:99]
    s_waitcnt lgkmcnt(8)
    ds_read_b64_tr_b16 v[32:33], v10 offset:15360
    ds_read_b64_tr_b16 v[34:35], v10 offset:17920
    v_mfma_f32_16x16x32_bf16 v[64:67], v[104:107], v[232:235], v[64:67]
    s_waitcnt lgkmcnt(8)
    ds_read_b64_tr_b16 v[36:37], v10 offset:15392
    ds_read_b64_tr_b16 v[38:39], v10 offset:17952
    v_mfma_f32_16x16x32_bf16 v[72:75], v[108:111], v[232:235], v[72:75]
    s_waitcnt lgkmcnt(8)
    ds_read_b64_tr_b16 v[40:41], v10 offset:15424
    ds_read_b64_tr_b16 v[42:43], v10 offset:17984
    v_mfma_f32_16x16x32_bf16 v[80:83], v[112:115], v[232:235], v[80:83]
    s_waitcnt lgkmcnt(8)
    ds_read_b64_tr_b16 v[44:45], v10 offset:15456
    ds_read_b64_tr_b16 v[46:47], v10 offset:18016
    v_mfma_f32_16x16x32_bf16 v[88:91], v[116:119], v[232:235], v[88:91]
    s_waitcnt lgkmcnt(8)
    ds_read_b64_tr_b16 v[48:49], v10 offset:15488
    ds_read_b64_tr_b16 v[50:51], v10 offset:18048
    v_mfma_f32_16x16x32_bf16 v[96:99], v[120:123], v[232:235], v[96:99]
    s_waitcnt lgkmcnt(8)
    ds_read_b64_tr_b16 v[104:105], v11 offset:0
    ds_read_b64_tr_b16 v[106:107], v11 offset:2560
    v_mfma_f32_16x16x32_bf16 v[64:67], v[32:35], v[236:239], v[64:67]
    s_waitcnt lgkmcnt(8)
    ds_read_b64_tr_b16 v[108:109], v11 offset:32
    ds_read_b64_tr_b16 v[110:111], v11 offset:2592
    v_mfma_f32_16x16x32_bf16 v[72:75], v[36:39], v[236:239], v[72:75]
    s_waitcnt lgkmcnt(8)
    ds_read_b64_tr_b16 v[112:113], v11 offset:64
    ds_read_b64_tr_b16 v[114:115], v11 offset:2624
    v_mfma_f32_16x16x32_bf16 v[80:83], v[40:43], v[236:239], v[80:83]
    s_waitcnt lgkmcnt(8)
    ds_read_b64_tr_b16 v[116:117], v11 offset:96
    ds_read_b64_tr_b16 v[118:119], v11 offset:2656
    v_mfma_f32_16x16x32_bf16 v[88:91], v[44:47], v[236:239], v[88:91]
    s_waitcnt lgkmcnt(8)
    ds_read_b64_tr_b16 v[120:121], v11 offset:128
    ds_read_b64_tr_b16 v[122:123], v11 offset:2688
    v_mfma_f32_16x16x32_bf16 v[96:99], v[48:51], v[236:239], v[96:99]
    s_waitcnt vmcnt(5)
    s_barrier
    s_waitcnt lgkmcnt(8)
    ds_read_b64_tr_b16 v[32:33], v11 offset:5120
    ds_read_b64_tr_b16 v[34:35], v11 offset:7680
    v_mfma_f32_16x16x32_bf16 v[64:67], v[104:107], v[192:195], v[64:67]
    s_add_u32 s62, s75, 164320
    s_add_u32 m0, s73, 0
    s_nop 0
    buffer_load_dwordx4 v4, s[12:15], s62 offen lds
    s_waitcnt lgkmcnt(8)
    ds_read_b64_tr_b16 v[36:37], v11 offset:5152
    ds_read_b64_tr_b16 v[38:39], v11 offset:7712
    v_mfma_f32_16x16x32_bf16 v[72:75], v[108:111], v[192:195], v[72:75]
    s_waitcnt lgkmcnt(8)
    ds_read_b64_tr_b16 v[40:41], v11 offset:5184
    ds_read_b64_tr_b16 v[42:43], v11 offset:7744
    v_mfma_f32_16x16x32_bf16 v[80:83], v[112:115], v[192:195], v[80:83]
    s_add_u32 m0, s73, 1024
    s_nop 0
    buffer_load_dwordx4 v5, s[12:15], s62 offen lds
    s_waitcnt lgkmcnt(8)
    ds_read_b64_tr_b16 v[44:45], v11 offset:5216
    ds_read_b64_tr_b16 v[46:47], v11 offset:7776
    v_mfma_f32_16x16x32_bf16 v[88:91], v[116:119], v[192:195], v[88:91]
    s_waitcnt lgkmcnt(8)
    ds_read_b64_tr_b16 v[48:49], v11 offset:5248
    ds_read_b64_tr_b16 v[50:51], v11 offset:7808
    v_mfma_f32_16x16x32_bf16 v[96:99], v[120:123], v[192:195], v[96:99]
    s_add_u32 m0, s73, 2048
    s_nop 0
    buffer_load_dwordx4 v6, s[12:15], s62 offen lds
    s_waitcnt lgkmcnt(8)
    ds_read_b64_tr_b16 v[104:105], v11 offset:10240
    ds_read_b64_tr_b16 v[106:107], v11 offset:12800
    v_mfma_f32_16x16x32_bf16 v[64:67], v[32:35], v[196:199], v[64:67]
    s_add_u32 m0, s73, 3072
    s_nop 0
    buffer_load_dwordx4 v7, s[12:15], s62 offen lds
    s_waitcnt lgkmcnt(8)
    ds_read_b64_tr_b16 v[108:109], v11 offset:10272
    ds_read_b64_tr_b16 v[110:111], v11 offset:12832
    v_mfma_f32_16x16x32_bf16 v[72:75], v[36:39], v[196:199], v[72:75]
    s_waitcnt lgkmcnt(8)
    ds_read_b64_tr_b16 v[112:113], v11 offset:10304
    ds_read_b64_tr_b16 v[114:115], v11 offset:12864
    v_mfma_f32_16x16x32_bf16 v[80:83], v[40:43], v[196:199], v[80:83]
    s_add_u32 m0, s73, 4096
    s_nop 0
    buffer_load_dwordx4 v8, s[12:15], s62 offen lds
    s_waitcnt lgkmcnt(8)
    ds_read_b64_tr_b16 v[116:117], v11 offset:10336
    ds_read_b64_tr_b16 v[118:119], v11 offset:12896
    v_mfma_f32_16x16x32_bf16 v[88:91], v[44:47], v[196:199], v[88:91]
    s_waitcnt lgkmcnt(8)
    ds_read_b64_tr_b16 v[120:121], v11 offset:10368
    ds_read_b64_tr_b16 v[122:123], v11 offset:12928
    v_mfma_f32_16x16x32_bf16 v[96:99], v[48:51], v[196:199], v[96:99]
    s_waitcnt lgkmcnt(8)
    ds_read_b64_tr_b16 v[32:33], v11 offset:15360
    ds_read_b64_tr_b16 v[34:35], v11 offset:17920
    v_mfma_f32_16x16x32_bf16 v[64:67], v[104:107], v[200:203], v[64:67]
    s_waitcnt lgkmcnt(8)
    ds_read_b64_tr_b16 v[36:37], v11 offset:15392
    ds_read_b64_tr_b16 v[38:39], v11 offset:17952
    v_mfma_f32_16x16x32_bf16 v[72:75], v[108:111], v[200:203], v[72:75]
    s_waitcnt lgkmcnt(8)
    ds_read_b64_tr_b16 v[40:41], v11 offset:15424
    ds_read_b64_tr_b16 v[42:43], v11 offset:17984
    v_mfma_f32_16x16x32_bf16 v[80:83], v[112:115], v[200:203], v[80:83]
    s_waitcnt lgkmcnt(8)
    ds_read_b64_tr_b16 v[44:45], v11 offset:15456
    ds_read_b64_tr_b16 v[46:47], v11 offset:18016
    v_mfma_f32_16x16x32_bf16 v[88:91], v[116:119], v[200:203], v[88:91]
    s_waitcnt lgkmcnt(8)
    ds_read_b64_tr_b16 v[48:49], v11 offset:15488
    ds_read_b64_tr_b16 v[50:51], v11 offset:18048
    v_mfma_f32_16x16x32_bf16 v[96:99], v[120:123], v[200:203], v[96:99]
    s_waitcnt lgkmcnt(8)
    ds_read_b64_tr_b16 v[104:105], v63 offset:0
    ds_read_b64_tr_b16 v[106:107], v63 offset:2560
    v_mfma_f32_16x16x32_bf16 v[64:67], v[32:35], v[204:207], v[64:67]
    s_waitcnt lgkmcnt(8)
    ds_read_b64_tr_b16 v[108:109], v63 offset:32
    ds_read_b64_tr_b16 v[110:111], v63 offset:2592
    v_mfma_f32_16x16x32_bf16 v[72:75], v[36:39], v[204:207], v[72:75]
    s_waitcnt lgkmcnt(8)
    ds_read_b64_tr_b16 v[112:113], v63 offset:64
    ds_read_b64_tr_b16 v[114:115], v63 offset:2624
    v_mfma_f32_16x16x32_bf16 v[80:83], v[40:43], v[204:207], v[80:83]
    s_waitcnt lgkmcnt(8)
    ds_read_b64_tr_b16 v[116:117], v63 offset:96
    ds_read_b64_tr_b16 v[118:119], v63 offset:2656
    v_mfma_f32_16x16x32_bf16 v[88:91], v[44:47], v[204:207], v[88:91]
    s_waitcnt lgkmcnt(8)
    ds_read_b64_tr_b16 v[120:121], v63 offset:128
    ds_read_b64_tr_b16 v[122:123], v63 offset:2688
    v_mfma_f32_16x16x32_bf16 v[96:99], v[48:51], v[204:207], v[96:99]
    s_cmp_lg_u32 s24, 3
    s_cbranch_scc1 m_nf10_1
    s_lshl_b32 s70, s27, 7
    v_mov_b32 v56, 1
    v_mov_b32 v57, s70
    buffer_store_dword v56, v57, s[88:91], 0 offen sc1
m_nf10_1:
    s_waitcnt vmcnt(5)
    s_barrier
    s_waitcnt lgkmcnt(8)
    ds_read_b64_tr_b16 v[32:33], v63 offset:5120
    ds_read_b64_tr_b16 v[34:35], v63 offset:7680
    v_mfma_f32_16x16x32_bf16 v[64:67], v[104:107], v[128:131], v[64:67]
    s_add_u32 s62, s75, 328160
    s_add_u32 m0, s74, 0
    s_nop 0
    buffer_load_dwordx4 v4, s[12:15], s62 offen lds
    s_waitcnt lgkmcnt(8)
    ds_read_b64_tr_b16 v[36:37], v63 offset:5152
    ds_read_b64_tr_b16 v[38:39], v63 offset:7712
    v_mfma_f32_16x16x32_bf16 v[72:75], v[108:111], v[128:131], v[72:75]
    s_waitcnt lgkmcnt(8)
    ds_read_b64_tr_b16 v[40:41], v63 offset:5184
    ds_read_b64_tr_b16 v[42:43], v63 offset:7744
    v_mfma_f32_16x16x32_bf16 v[80:83], v[112:115], v[128:131], v[80:83]
    s_add_u32 m0, s74, 1024
    s_nop 0
    buffer_load_dwordx4 v5, s[12:15], s62 offen lds
    s_waitcnt lgkmcnt(8)
    ds_read_b64_tr_b16 v[44:45], v63 offset:5216
    ds_read_b64_tr_b16 v[46:47], v63 offset:7776
    v_mfma_f32_16x16x32_bf16 v[88:91], v[116:119], v[128:131], v[88:91]
    s_waitcnt lgkmcnt(8)
    ds_read_b64_tr_b16 v[48:49], v63 offset:5248
    ds_read_b64_tr_b16 v[50:51], v63 offset:7808
    v_mfma_f32_16x16x32_bf16 v[96:99], v[120:123], v[128:131], v[96:99]
    s_add_u32 m0, s74, 2048
    s_nop 0
    buffer_load_dwordx4 v6, s[12:15], s62 offen lds
    s_waitcnt lgkmcnt(8)
    ds_read_b64_tr_b16 v[104:105], v63 offset:10240
    ds_read_b64_tr_b16 v[106:107], v63 offset:12800
    v_mfma_f32_16x16x32_bf16 v[64:67], v[32:35], v[132:135], v[64:67]
    s_add_u32 m0, s74, 3072
    s_nop 0
    buffer_load_dwordx4 v7, s[12:15], s62 offen lds
    s_waitcnt lgkmcnt(8)
    ds_read_b64_tr_b16 v[108:109], v63 offset:10272
    ds_read_b64_tr_b16 v[110:111], v63 offset:12832
    v_mfma_f32_16x16x32_bf16 v[72:75], v[36:39], v[132:135], v[72:75]
    s_waitcnt lgkmcnt(8)
    ds_read_b64_tr_b16 v[112:113], v63 offset:10304
    ds_read_b64_tr_b16 v[114:115], v63 offset:12864
    v_mfma_f32_16x16x32_bf16 v[80:83], v[40:43], v[132:135], v[80:83]
    s_add_u32 m0, s74, 4096
    s_nop 0
    buffer_load_dwordx4 v8, s[12:15], s62 offen lds
    s_waitcnt lgkmcnt(8)
    ds_read_b64_tr_b16 v[116:117], v63 offset:10336
    ds_read_b64_tr_b16 v[118:119], v63 offset:12896
    v_mfma_f32_16x16x32_bf16 v[88:91], v[44:47], v[132:135], v[88:91]
    s_waitcnt lgkmcnt(8)
    ds_read_b64_tr_b16 v[120:121], v63 offset:10368
    ds_read_b64_tr_b16 v[122:123], v63 offset:12928
    v_mfma_f32_16x16x32_bf16 v[96:99], v[48:51], v[132:135], v[96:99]
    s_waitcnt lgkmcnt(8)
    ds_read_b64_tr_b16 v[32:33], v63 offset:15360
    ds_read_b64_tr_b16 v[34:35], v63 offset:17920
    v_mfma_f32_16x16x32_bf16 v[64:67], v[104:107], v[136:139], v[64:67]
    s_waitcnt lgkmcnt(8)
    ds_read_b64_tr_b16 v[36:37], v63 offset:15392
    ds_read_b64_tr_b16 v[38:39], v63 offset:17952
    v_mfma_f32_16x16x32_bf16 v[72:75], v[108:111], v[136:139], v[72:75]
    s_waitcnt lgkmcnt(8)
    ds_read_b64_tr_b16 v[40:41], v63 offset:15424
    ds_read_b64_tr_b16 v[42:43], v63 offset:17984
    v_mfma_f32_16x16x32_bf16 v[80:83], v[112:115], v[136:139], v[80:83]
    s_waitcnt lgkmcnt(8)
    ds_read_b64_tr_b16 v[44:45], v63 offset:15456
    ds_read_b64_tr_b16 v[46:47], v63 offset:18016
    v_mfma_f32_16x16x32_bf16 v[88:91], v[116:119], v[136:139], v[88:91]
    s_waitcnt lgkmcnt(8)
    ds_read_b64_tr_b16 v[48:49], v63 offset:15488
    ds_read_b64_tr_b16 v[50:51], v63 offset:18048
    v_mfma_f32_16x16x32_bf16 v[96:99], v[120:123], v[136:139], v[96:99]
    s_waitcnt lgkmcnt(8)
    ds_read_b64_tr_b16 v[104:105], v9 offset:0
    ds_read_b64_tr_b16 v[106:107], v9 offset:2560
    v_mfma_f32_16x16x32_bf16 v[64:67], v[32:35], v[140:143], v[64:67]
    s_waitcnt lgkmcnt(8)
    ds_read_b64_tr_b16 v[108:109], v9 offset:32
    ds_read_b64_tr_b16 v[110:111], v9 offset:2592
    v_mfma_f32_16x16x32_bf16 v[72:75], v[36:39], v[140:143], v[72:75]
    s_waitcnt lgkmcnt(8)
    ds_read_b64_tr_b16 v[112:113], v9 offset:64
    ds_read_b64_tr_b16 v[114:115], v9 offset:2624
    v_mfma_f32_16x16x32_bf16 v[80:83], v[40:43], v[140:143], v[80:83]
    s_waitcnt lgkmcnt(8)
    ds_read_b64_tr_b16 v[116:117], v9 offset:96
    ds_read_b64_tr_b16 v[118:119], v9 offset:2656
    v_mfma_f32_16x16x32_bf16 v[88:91], v[44:47], v[140:143], v[88:91]
    s_waitcnt lgkmcnt(8)
    ds_read_b64_tr_b16 v[120:121], v9 offset:128
    ds_read_b64_tr_b16 v[122:123], v9 offset:2688
    v_mfma_f32_16x16x32_bf16 v[96:99], v[48:51], v[140:143], v[96:99]
    v_cvt_pk_bf16_f32 v16, v64, v65
    v_cvt_pk_bf16_f32 v17, v66, v67
    v_cvt_pk_bf16_f32 v20, v72, v73
    v_cvt_pk_bf16_f32 v21, v74, v75
    v_cvt_pk_bf16_f32 v24, v80, v81
    v_cvt_pk_bf16_f32 v25, v82, v83
    v_cvt_pk_bf16_f32 v28, v88, v89
    v_cvt_pk_bf16_f32 v29, v90, v91
    v_cvt_pk_bf16_f32 v52, v96, v97
    v_cvt_pk_bf16_f32 v53, v98, v99
    s_add_u32 s69, s76, 40960
    buffer_store_dwordx2 v[16:17], v59, s[4:7], s69 offen offset:0 sc1
    s_add_u32 s69, s76, 40960
    buffer_store_dwordx2 v[20:21], v59, s[4:7], s69 offen offset:1024 sc1
    s_add_u32 s69, s76, 40960
    buffer_store_dwordx2 v[24:25], v59, s[4:7], s69 offen offset:2048 sc1
    s_add_u32 s69, s76, 40960
    buffer_store_dwordx2 v[28:29], v59, s[4:7], s69 offen offset:3072 sc1
    s_add_u32 s69, s76, 45056
    buffer_store_dwordx2 v[52:53], v59, s[4:7], s69 offen offset:0 sc1
    s_waitcnt vmcnt(10)
    s_barrier
    s_waitcnt lgkmcnt(8)
    ds_read_b64_tr_b16 v[32:33], v9 offset:5120
    ds_read_b64_tr_b16 v[34:35], v9 offset:7680
    v_mfma_f32_16x16x32_bf16 v[64:67], v[104:107], v[160:163], 0
    s_add_u32 s62, s75, 492000
    s_add_u32 m0, s97, 0
    s_nop 0
    buffer_load_dwordx4 v4, s[12:15], s62 offen lds
    s_waitcnt lgkmcnt(8)
    ds_read_b64_tr_b16 v[36:37], v9 offset:5152
    ds_read_b64_tr_b16 v[38:39], v9 offset:7712
    v_mfma_f32_16x16x32_bf16 v[72:75], v[108:111], v[160:163], 0
    s_waitcnt lgkmcnt(8)
    ds_read_b64_tr_b16 v[40:41], v9 offset:5184
    ds_read_b64_tr_b16 v[42:43], v9 offset:7744
    v_mfma_f32_16x16x32_bf16 v[80:83], v[112:115], v[160:163], 0
    s_add_u32 m0, s97, 1024
    s_nop 0
    buffer_load_dwordx4 v5, s[12:15], s62 offen lds
    s_waitcnt lgkmcnt(8)
    ds_read_b64_tr_b16 v[44:45], v9 offset:5216
    ds_read_b64_tr_b16 v[46:47], v9 offset:7776
    v_mfma_f32_16x16x32_bf16 v[88:91], v[116:119], v[160:163], 0
    s_waitcnt lgkmcnt(8)
    ds_read_b64_tr_b16 v[48:49], v9 offset:5248
    ds_read_b64_tr_b16 v[50:51], v9 offset:7808
    v_mfma_f32_16x16x32_bf16 v[96:99], v[120:123], v[160:163], 0
    s_add_u32 m0, s97, 2048
    s_nop 0
    buffer_load_dwordx4 v6, s[12:15], s62 offen lds
    s_waitcnt lgkmcnt(8)
    ds_read_b64_tr_b16 v[104:105], v9 offset:10240
    ds_read_b64_tr_b16 v[106:107], v9 offset:12800
    v_mfma_f32_16x16x32_bf16 v[64:67], v[32:35], v[164:167], v[64:67]
    s_add_u32 m0, s97, 3072
    s_nop 0
    buffer_load_dwordx4 v7, s[12:15], s62 offen lds
    s_waitcnt lgkmcnt(8)
    ds_read_b64_tr_b16 v[108:109], v9 offset:10272
    ds_read_b64_tr_b16 v[110:111], v9 offset:12832
    v_mfma_f32_16x16x32_bf16 v[72:75], v[36:39], v[164:167], v[72:75]
    s_waitcnt lgkmcnt(8)
    ds_read_b64_tr_b16 v[112:113], v9 offset:10304
    ds_read_b64_tr_b16 v[114:115], v9 offset:12864
    v_mfma_f32_16x16x32_bf16 v[80:83], v[40:43], v[164:167], v[80:83]
    s_add_u32 m0, s97, 4096
    s_nop 0
    buffer_load_dwordx4 v8, s[12:15], s62 offen lds
    s_waitcnt lgkmcnt(8)
    ds_read_b64_tr_b16 v[116:117], v9 offset:10336
    ds_read_b64_tr_b16 v[118:119], v9 offset:12896
    v_mfma_f32_16x16x32_bf16 v[88:91], v[44:47], v[164:167], v[88:91]
    s_waitcnt lgkmcnt(8)
    ds_read_b64_tr_b16 v[120:121], v9 offset:10368
    ds_read_b64_tr_b16 v[122:123], v9 offset:12928
    v_mfma_f32_16x16x32_bf16 v[96:99], v[48:51], v[164:167], v[96:99]
    s_waitcnt lgkmcnt(8)
    ds_read_b64_tr_b16 v[32:33], v9 offset:15360
    ds_read_b64_tr_b16 v[34:35], v9 offset:17920
    v_mfma_f32_16x16x32_bf16 v[64:67], v[104:107], v[168:171], v[64:67]
    s_waitcnt lgkmcnt(8)
    ds_read_b64_tr_b16 v[36:37], v9 offset:15392
    ds_read_b64_tr_b16 v[38:39], v9 offset:17952
    v_mfma_f32_16x16x32_bf16 v[72:75], v[108:111], v[168:171], v[72:75]
    s_waitcnt lgkmcnt(8)
    ds_read_b64_tr_b16 v[40:41], v9 offset:15424
    ds_read_b64_tr_b16 v[42:43], v9 offset:17984
    v_mfma_f32_16x16x32_bf16 v[80:83], v[112:115], v[168:171], v[80:83]
    s_waitcnt lgkmcnt(8)
    ds_read_b64_tr_b16 v[44:45], v9 offset:15456
    ds_read_b64_tr_b16 v[46:47], v9 offset:18016
    v_mfma_f32_16x16x32_bf16 v[88:91], v[116:119], v[168:171], v[88:91]
    s_waitcnt lgkmcnt(8)
    ds_read_b64_tr_b16 v[48:49], v9 offset:15488
    ds_read_b64_tr_b16 v[50:51], v9 offset:18048
    v_mfma_f32_16x16x32_bf16 v[96:99], v[120:123], v[168:171], v[96:99]
    s_waitcnt lgkmcnt(8)
    ds_read_b64_tr_b16 v[104:105], v10 offset:0
    ds_read_b64_tr_b16 v[106:107], v10 offset:2560
    v_mfma_f32_16x16x32_bf16 v[64:67], v[32:35], v[172:175], v[64:67]
    s_waitcnt lgkmcnt(8)
    ds_read_b64_tr_b16 v[108:109], v10 offset:32
    ds_read_b64_tr_b16 v[110:111], v10 offset:2592
    v_mfma_f32_16x16x32_bf16 v[72:75], v[36:39], v[172:175], v[72:75]
    s_waitcnt lgkmcnt(8)
    ds_read_b64_tr_b16 v[112:113], v10 offset:64
    ds_read_b64_tr_b16 v[114:115], v10 offset:2624
    v_mfma_f32_16x16x32_bf16 v[80:83], v[40:43], v[172:175], v[80:83]
    s_waitcnt lgkmcnt(8)
    ds_read_b64_tr_b16 v[116:117], v10 offset:96
    ds_read_b64_tr_b16 v[118:119], v10 offset:2656
    v_mfma_f32_16x16x32_bf16 v[88:91], v[44:47], v[172:175], v[88:91]
    s_waitcnt lgkmcnt(8)
    ds_read_b64_tr_b16 v[120:121], v10 offset:128
    ds_read_b64_tr_b16 v[122:123], v10 offset:2688
    v_mfma_f32_16x16x32_bf16 v[96:99], v[48:51], v[172:175], v[96:99]
    s_waitcnt vmcnt(10)
    s_barrier
    s_cmp_lg_u32 s24, 7
    s_cbranch_scc1 m_ep1
    v_mbcnt_lo_u32_b32 v57, -1, 0
    v_mbcnt_hi_u32_b32 v57, -1, v57
    v_and_b32 v57, 7, v57
    v_lshlrev_b32 v57, 7, v57
    buffer_load_dword v58, v57, s[88:91], 0 offen sc1
m_ep1:
    s_waitcnt lgkmcnt(8)
    ds_read_b64_tr_b16 v[32:33], v10 offset:5120
    ds_read_b64_tr_b16 v[34:35], v10 offset:7680
    v_mfma_f32_16x16x32_bf16 v[64:67], v[104:107], v[224:227], v[64:67]
    s_waitcnt lgkmcnt(8)
    ds_read_b64_tr_b16 v[36:37], v10 offset:5152
    ds_read_b64_tr_b16 v[38:39], v10 offset:7712
    v_mfma_f32_16x16x32_bf16 v[72:75], v[108:111], v[224:227], v[72:75]
    s_waitcnt lgkmcnt(8)
    ds_read_b64_tr_b16 v[40:41], v10 offset:5184
    ds_read_b64_tr_b16 v[42:43], v10 offset:7744
    v_mfma_f32_16x16x32_bf16 v[80:83], v[112:115], v[224:227], v[80:83]
    s_waitcnt lgkmcnt(8)
    ds_read_b64_tr_b16 v[44:45], v10 offset:5216
    ds_read_b64_tr_b16 v[46:47], v10 offset:7776
    v_mfma_f32_16x16x32_bf16 v[88:91], v[116:119], v[224:227], v[88:91]
    s_waitcnt lgkmcnt(8)
    ds_read_b64_tr_b16 v[48:49], v10 offset:5248
    ds_read_b64_tr_b16 v[50:51], v10 offset:7808
    v_mfma_f32_16x16x32_bf16 v[96:99], v[120:123], v[224:227], v[96:99]
    s_waitcnt lgkmcnt(8)
    ds_read_b64_tr_b16 v[104:105], v10 offset:10240
    ds_read_b64_tr_b16 v[106:107], v10 offset:12800
    v_mfma_f32_16x16x32_bf16 v[64:67], v[32:35], v[228:231], v[64:67]
    s_waitcnt lgkmcnt(8)
    ds_read_b64_tr_b16 v[108:109], v10 offset:10272
    ds_read_b64_tr_b16 v[110:111], v10 offset:12832
    v_mfma_f32_16x16x32_bf16 v[72:75], v[36:39], v[228:231], v[72:75]
    s_waitcnt lgkmcnt(8)
    ds_read_b64_tr_b16 v[112:113], v10 offset:10304
    ds_read_b64_tr_b16 v[114:115], v10 offset:12864
    v_mfma_f32_16x16x32_bf16 v[80:83], v[40:43], v[228:231], v[80:83]
    s_waitcnt lgkmcnt(8)
    ds_read_b64_tr_b16 v[116:117], v10 offset:10336
    ds_read_b64_tr_b16 v[118:119], v10 offset:12896
    v_mfma_f32_16x16x32_bf16 v[88:91], v[44:47], v[228:231], v[88:91]
    s_waitcnt lgkmcnt(8)
    ds_read_b64_tr_b16 v[120:121], v10 offset:10368
    ds_read_b64_tr_b16 v[122:123], v10 offset:12928
    v_mfma_f32_16x16x32_bf16 v[96:99], v[48:51], v[228:231], v[96:99]
    s_waitcnt lgkmcnt(8)
    ds_read_b64_tr_b16 v[32:33], v10 offset:15360
    ds_read_b64_tr_b16 v[34:35], v10 offset:17920
    v_mfma_f32_16x16x32_bf16 v[64:67], v[104:107], v[232:235], v[64:67]
    s_waitcnt lgkmcnt(8)
    ds_read_b64_tr_b16 v[36:37], v10 offset:15392
    ds_read_b64_tr_b16 v[38:39], v10 offset:17952
    v_mfma_f32_16x16x32_bf16 v[72:75], v[108:111], v[232:235], v[72:75]
    s_waitcnt lgkmcnt(8)
    ds_read_b64_tr_b16 v[40:41], v10 offset:15424
    ds_read_b64_tr_b16 v[42:43], v10 offset:17984
    v_mfma_f32_16x16x32_bf16 v[80:83], v[112:115], v[232:235], v[80:83]
    s_waitcnt lgkmcnt(8)
    ds_read_b64_tr_b16 v[44:45], v10 offset:15456
    ds_read_b64_tr_b16 v[46:47], v10 offset:18016
    v_mfma_f32_16x16x32_bf16 v[88:91], v[116:119], v[232:235], v[88:91]
    s_waitcnt lgkmcnt(8)
    ds_read_b64_tr_b16 v[48:49], v10 offset:15488
    ds_read_b64_tr_b16 v[50:51], v10 offset:18048
    v_mfma_f32_16x16x32_bf16 v[96:99], v[120:123], v[232:235], v[96:99]
    s_waitcnt lgkmcnt(8)
    ds_read_b64_tr_b16 v[104:105], v11 offset:0
    ds_read_b64_tr_b16 v[106:107], v11 offset:2560
    v_mfma_f32_16x16x32_bf16 v[64:67], v[32:35], v[236:239], v[64:67]
    s_waitcnt lgkmcnt(8)
    ds_read_b64_tr_b16 v[108:109], v11 offset:32
    ds_read_b64_tr_b16 v[110:111], v11 offset:2592
    v_mfma_f32_16x16x32_bf16 v[72:75], v[36:39], v[236:239], v[72:75]
    s_waitcnt lgkmcnt(8)
    ds_read_b64_tr_b16 v[112:113], v11 offset:64
    ds_read_b64_tr_b16 v[114:115], v11 offset:2624
    v_mfma_f32_16x16x32_bf16 v[80:83], v[40:43], v[236:239], v[80:83]
    s_waitcnt lgkmcnt(8)
    ds_read_b64_tr_b16 v[116:117], v11 offset:96
    ds_read_b64_tr_b16 v[118:119], v11 offset:2656
    v_mfma_f32_16x16x32_bf16 v[88:91], v[44:47], v[236:239], v[88:91]
    s_waitcnt lgkmcnt(8)
    ds_read_b64_tr_b16 v[120:121], v11 offset:128
    ds_read_b64_tr_b16 v[122:123], v11 offset:2688
    v_mfma_f32_16x16x32_bf16 v[96:99], v[48:51], v[236:239], v[96:99]
    s_waitcnt vmcnt(0)
    s_waitcnt vmcnt(0)
    s_cmp_lg_u32 s24, 7
    s_cbranch_scc1 m_ec1_x
    v_cmp_gt_u32 vcc, 8, v56
    s_cbranch_vccnz m_ec1_slow
    v_cmp_gt_u32 vcc, 1, v58
    s_cbranch_vccz m_ec1_x
m_ec1_slow:
    s_mov_b32 s72, 0
    v_mov_b32 v57, s96
m_ec1_c:
    buffer_load_dword v56, v57, s[92:95], 0 offen sc1
    s_waitcnt vmcnt(0)
    v_cmp_gt_u32 vcc, 8, v56
    s_add_u32 s72, s72, 1
    s_cmp_ge_u32 s72, 0x40000
    s_cbranch_scc1 m_ec1_cx
    s_cbranch_vccz m_ec1_cx
    s_sleep 1
    s_branch m_ec1_c
m_ec1_cx:
    s_mov_b32 s72, 0
    v_mbcnt_lo_u32_b32 v57, -1, 0
    v_mbcnt_hi_u32_b32 v57, -1, v57
    v_and_b32 v57, 7, v57
    v_lshlrev_b32 v57, 7, v57
m_ec1_f:
    buffer_load_dword v56, v57, s[88:91], 0 offen sc1
    s_waitcnt vmcnt(0)
    v_cmp_gt_u32 vcc, 1, v56
    s_add_u32 s72, s72, 1
    s_cmp_ge_u32 s72, 0x40000
    s_cbranch_scc1 m_ec1_fx
    s_cbranch_vccz m_ec1_fx
    s_sleep 1
    s_branch m_ec1_f
m_ec1_fx:
m_ec1_x:
    s_barrier
    s_cmp_lg_u32 s24, 0
    s_cbranch_scc1 m_nf14_1
    s_lshl_b32 s70, s27, 7
    v_mov_b32 v56, 2
    v_mov_b32 v57, s70
    buffer_store_dword v56, v57, s[88:91], 0 offen sc1
m_nf14_1:
    s_mov_b32 s8, s98
    s_and_b32 s9, s99, 0xffff
    s_mov_b32 s10, 4587520
    s_mov_b32 s11, 0x00020000
    s_lshl_b32 s70, s25, 4
    s_add_u32 s70, s70, s26
    s_mul_i32 s70, s70, 1310720
    s_add_u32 s16, s56, s70
    s_addc_u32 s17, s57, 0
    s_and_b32 s17, s17, 0xffff
    s_mov_b32 s18, 1310720
    s_mov_b32 s19, 0x00020000
    s_lshr_b32 s72, s27, 2
    s_and_b32 s73, s27, 3
    s_mul_i32 s77, s72, 81920
    s_mul_i32 s74, s73, 5120
    s_add_u32 s77, s77, s74
    s_mul_i32 s75, s26, 286720
    s_mul_i32 s74, s25, 1280
    s_add_u32 s75, s75, s74
    s_mul_i32 s74, s72, 640
    s_add_u32 s75, s75, s74
    v_mbcnt_lo_u32_b32 v0, -1, 0
    v_mbcnt_hi_u32_b32 v0, -1, v0
    v_lshlrev_b32 v1, 4, v0
    s_mov_b32 s70, s24
    s_mul_i32 s71, s70, 52
    s_lshr_b32 s71, s71, 8
    s_mul_i32 s74, s71, 5
    s_sub_u32 s74, s70, s74
    s_mul_i32 s78, s71, 20480
    s_lshl_b32 s79, s74, 10
    s_add_u32 s78, s78, s79
    s_add_u32 s64, s78, s77
    s_mul_i32 s78, s71, 160
    s_lshl_b32 s79, s74, 5
    s_add_u32 s78, s78, s79
    s_add_u32 s65, s78, s75
    s_add_u32 s62, s64, 0
    buffer_load_dwordx4 v[160:163], v1, s[16:19], s62 offen sc1
    s_add_u32 s62, s64, 163840
    buffer_load_dwordx4 v[164:167], v1, s[16:19], s62 offen sc1
    s_add_u32 s62, s64, 327680
    buffer_load_dwordx4 v[168:171], v1, s[16:19], s62 offen sc1
    s_add_u32 s62, s64, 491520
    buffer_load_dwordx4 v[172:175], v1, s[16:19], s62 offen sc1
    s_add_u32 s62, s64, 655360
    buffer_load_dwordx4 v[176:179], v1, s[16:19], s62 offen sc1
    s_add_u32 s62, s64, 819200
    buffer_load_dwordx4 v[180:183], v1, s[16:19], s62 offen sc1
    s_add_u32 s62, s64, 983040
    buffer_load_dwordx4 v[184:187], v1, s[16:19], s62 offen sc1
    s_add_u32 s62, s64, 1146880
    buffer_load_dwordx4 v[188:191], v1, s[16:19], s62 offen sc1
    s_cmp_ge_u32 s24, 2
    s_cbranch_scc1 m_pl1
    s_add_u32 s70, s24, 8
    s_mul_i32 s71, s70, 52
    s_lshr_b32 s71, s71, 8
    s_mul_i32 s74, s71, 5
    s_sub_u32 s74, s70, s74
    s_mul_i32 s78, s71, 20480
    s_lshl_b32 s79, s74, 10
    s_add_u32 s78, s78, s79
    s_add_u32 s64, s78, s77
    s_mul_i32 s78, s71, 160
    s_lshl_b32 s79, s74, 5
    s_add_u32 s78, s78, s79
    s_add_u32 s66, s78, s75
    s_add_u32 s62, s64, 0
    buffer_load_dwordx4 v[224:227], v1, s[16:19], s62 offen sc1
    s_add_u32 s62, s64, 163840
    buffer_load_dwordx4 v[228:231], v1, s[16:19], s62 offen sc1
    s_add_u32 s62, s64, 327680
    buffer_load_dwordx4 v[232:235], v1, s[16:19], s62 offen sc1
    s_add_u32 s62, s64, 491520
    buffer_load_dwordx4 v[236:239], v1, s[16:19], s62 offen sc1
    s_add_u32 s62, s64, 655360
    buffer_load_dwordx4 v[240:243], v1, s[16:19], s62 offen sc1
    s_add_u32 s62, s64, 819200
    buffer_load_dwordx4 v[244:247], v1, s[16:19], s62 offen sc1
    s_add_u32 s62, s64, 983040
    buffer_load_dwordx4 v[248:251], v1, s[16:19], s62 offen sc1
    s_add_u32 s62, s64, 1146880
    buffer_load_dwordx4 v[252:255], v1, s[16:19], s62 offen sc1
m_pl1:
    s_waitcnt lgkmcnt(8)
    ds_read_b64_tr_b16 v[32:33], v11 offset:5120
    ds_read_b64_tr_b16 v[34:35], v11 offset:7680
    v_mfma_f32_16x16x32_bf16 v[64:67], v[104:107], v[192:195], v[64:67]
    s_waitcnt lgkmcnt(8)
    ds_read_b64_tr_b16 v[36:37], v11 offset:5152
    ds_read_b64_tr_b16 v[38:39], v11 offset:7712
    v_mfma_f32_16x16x32_bf16 v[72:75], v[108:111], v[192:195], v[72:75]
    s_waitcnt lgkmcnt(8)
    ds_read_b64_tr_b16 v[40:41], v11 offset:5184
    ds_read_b64_tr_b16 v[42:43], v11 offset:7744
    v_mfma_f32_16x16x32_bf16 v[80:83], v[112:115], v[192:195], v[80:83]
    s_waitcnt lgkmcnt(8)
    ds_read_b64_tr_b16 v[44:45], v11 offset:5216
    ds_read_b64_tr_b16 v[46:47], v11 offset:7776
    v_mfma_f32_16x16x32_bf16 v[88:91], v[116:119], v[192:195], v[88:91]
    s_waitcnt lgkmcnt(8)
    ds_read_b64_tr_b16 v[48:49], v11 offset:5248
    ds_read_b64_tr_b16 v[50:51], v11 offset:7808
    v_mfma_f32_16x16x32_bf16 v[96:99], v[120:123], v[192:195], v[96:99]
    s_waitcnt lgkmcnt(8)
    ds_read_b64_tr_b16 v[104:105], v11 offset:10240
    ds_read_b64_tr_b16 v[106:107], v11 offset:12800
    v_mfma_f32_16x16x32_bf16 v[64:67], v[32:35], v[196:199], v[64:67]
    s_waitcnt lgkmcnt(8)
    ds_read_b64_tr_b16 v[108:109], v11 offset:10272
    ds_read_b64_tr_b16 v[110:111], v11 offset:12832
    v_mfma_f32_16x16x32_bf16 v[72:75], v[36:39], v[196:199], v[72:75]
    s_waitcnt lgkmcnt(8)
    ds_read_b64_tr_b16 v[112:113], v11 offset:10304
    ds_read_b64_tr_b16 v[114:115], v11 offset:12864
    v_mfma_f32_16x16x32_bf16 v[80:83], v[40:43], v[196:199], v[80:83]
    s_waitcnt lgkmcnt(8)
    ds_read_b64_tr_b16 v[116:117], v11 offset:10336
    ds_read_b64_tr_b16 v[118:119], v11 offset:12896
    v_mfma_f32_16x16x32_bf16 v[88:91], v[44:47], v[196:199], v[88:91]
    s_waitcnt lgkmcnt(8)
    ds_read_b64_tr_b16 v[120:121], v11 offset:10368
    ds_read_b64_tr_b16 v[122:123], v11 offset:12928
    v_mfma_f32_16x16x32_bf16 v[96:99], v[48:51], v[196:199], v[96:99]
    s_waitcnt lgkmcnt(8)
    ds_read_b64_tr_b16 v[32:33], v11 offset:15360
    ds_read_b64_tr_b16 v[34:35], v11 offset:17920
    v_mfma_f32_16x16x32_bf16 v[64:67], v[104:107], v[200:203], v[64:67]
    s_waitcnt lgkmcnt(8)
    ds_read_b64_tr_b16 v[36:37], v11 offset:15392
    ds_read_b64_tr_b16 v[38:39], v11 offset:17952
    v_mfma_f32_16x16x32_bf16 v[72:75], v[108:111], v[200:203], v[72:75]
    s_waitcnt lgkmcnt(8)
    ds_read_b64_tr_b16 v[40:41], v11 offset:15424
    ds_read_b64_tr_b16 v[42:43], v11 offset:17984
    v_mfma_f32_16x16x32_bf16 v[80:83], v[112:115], v[200:203], v[80:83]
    s_waitcnt lgkmcnt(8)
    ds_read_b64_tr_b16 v[44:45], v11 offset:15456
    ds_read_b64_tr_b16 v[46:47], v11 offset:18016
    v_mfma_f32_16x16x32_bf16 v[88:91], v[116:119], v[200:203], v[88:91]
    s_waitcnt lgkmcnt(8)
    ds_read_b64_tr_b16 v[48:49], v11 offset:15488
    ds_read_b64_tr_b16 v[50:51], v11 offset:18048
    v_mfma_f32_16x16x32_bf16 v[96:99], v[120:123], v[200:203], v[96:99]
    s_waitcnt lgkmcnt(8)
    ds_read_b64_tr_b16 v[104:105], v63 offset:0
    ds_read_b64_tr_b16 v[106:107], v63 offset:2560
    v_mfma_f32_16x16x32_bf16 v[64:67], v[32:35], v[204:207], v[64:67]
    s_waitcnt lgkmcnt(8)
    ds_read_b64_tr_b16 v[108:109], v63 offset:32
    ds_read_b64_tr_b16 v[110:111], v63 offset:2592
    v_mfma_f32_16x16x32_bf16 v[72:75], v[36:39], v[204:207], v[72:75]
    s_waitcnt lgkmcnt(8)
    ds_read_b64_tr_b16 v[112:113], v63 offset:64
    ds_read_b64_tr_b16 v[114:115], v63 offset:2624
    v_mfma_f32_16x16x32_bf16 v[80:83], v[40:43], v[204:207], v[80:83]
    s_waitcnt lgkmcnt(8)
    ds_read_b64_tr_b16 v[116:117], v63 offset:96
    ds_read_b64_tr_b16 v[118:119], v63 offset:2656
    v_mfma_f32_16x16x32_bf16 v[88:91], v[44:47], v[204:207], v[88:91]
    s_waitcnt lgkmcnt(8)
    ds_read_b64_tr_b16 v[120:121], v63 offset:128
    ds_read_b64_tr_b16 v[122:123], v63 offset:2688
    v_mfma_f32_16x16x32_bf16 v[96:99], v[48:51], v[204:207], v[96:99]
    s_barrier
    s_waitcnt lgkmcnt(8)
    ds_read_b64_tr_b16 v[32:33], v63 offset:5120
    ds_read_b64_tr_b16 v[34:35], v63 offset:7680
    v_mfma_f32_16x16x32_bf16 v[64:67], v[104:107], v[128:131], v[64:67]
    s_waitcnt lgkmcnt(8)
    ds_read_b64_tr_b16 v[36:37], v63 offset:5152
    ds_read_b64_tr_b16 v[38:39], v63 offset:7712
    v_mfma_f32_16x16x32_bf16 v[72:75], v[108:111], v[128:131], v[72:75]
    s_waitcnt lgkmcnt(8)
    ds_read_b64_tr_b16 v[40:41], v63 offset:5184
    ds_read_b64_tr_b16 v[42:43], v63 offset:7744
    v_mfma_f32_16x16x32_bf16 v[80:83], v[112:115], v[128:131], v[80:83]
    s_waitcnt lgkmcnt(8)
    ds_read_b64_tr_b16 v[44:45], v63 offset:5216
    ds_read_b64_tr_b16 v[46:47], v63 offset:7776
    v_mfma_f32_16x16x32_bf16 v[88:91], v[116:119], v[128:131], v[88:91]
    s_waitcnt lgkmcnt(8)
    ds_read_b64_tr_b16 v[48:49], v63 offset:5248
    ds_read_b64_tr_b16 v[50:51], v63 offset:7808
    v_mfma_f32_16x16x32_bf16 v[96:99], v[120:123], v[128:131], v[96:99]
    s_waitcnt lgkmcnt(8)
    ds_read_b64_tr_b16 v[104:105], v63 offset:10240
    ds_read_b64_tr_b16 v[106:107], v63 offset:12800
    v_mfma_f32_16x16x32_bf16 v[64:67], v[32:35], v[132:135], v[64:67]
    s_waitcnt lgkmcnt(8)
    ds_read_b64_tr_b16 v[108:109], v63 offset:10272
    ds_read_b64_tr_b16 v[110:111], v63 offset:12832
    v_mfma_f32_16x16x32_bf16 v[72:75], v[36:39], v[132:135], v[72:75]
    s_waitcnt lgkmcnt(8)
    ds_read_b64_tr_b16 v[112:113], v63 offset:10304
    ds_read_b64_tr_b16 v[114:115], v63 offset:12864
    v_mfma_f32_16x16x32_bf16 v[80:83], v[40:43], v[132:135], v[80:83]
    s_waitcnt lgkmcnt(8)
    ds_read_b64_tr_b16 v[116:117], v63 offset:10336
    ds_read_b64_tr_b16 v[118:119], v63 offset:12896
    v_mfma_f32_16x16x32_bf16 v[88:91], v[44:47], v[132:135], v[88:91]
    s_waitcnt lgkmcnt(8)
    ds_read_b64_tr_b16 v[120:121], v63 offset:10368
    ds_read_b64_tr_b16 v[122:123], v63 offset:12928
    v_mfma_f32_16x16x32_bf16 v[96:99], v[48:51], v[132:135], v[96:99]
    s_waitcnt lgkmcnt(8)
    ds_read_b64_tr_b16 v[32:33], v63 offset:15360
    ds_read_b64_tr_b16 v[34:35], v63 offset:17920
    v_mfma_f32_16x16x32_bf16 v[64:67], v[104:107], v[136:139], v[64:67]
    s_waitcnt lgkmcnt(8)
    ds_read_b64_tr_b16 v[36:37], v63 offset:15392
    ds_read_b64_tr_b16 v[38:39], v63 offset:17952
    v_mfma_f32_16x16x32_bf16 v[72:75], v[108:111], v[136:139], v[72:75]
    s_waitcnt lgkmcnt(8)
    ds_read_b64_tr_b16 v[40:41], v63 offset:15424
    ds_read_b64_tr_b16 v[42:43], v63 offset:17984
    v_mfma_f32_16x16x32_bf16 v[80:83], v[112:115], v[136:139], v[80:83]
    s_waitcnt lgkmcnt(8)
    ds_read_b64_tr_b16 v[44:45], v63 offset:15456
    ds_read_b64_tr_b16 v[46:47], v63 offset:18016
    v_mfma_f32_16x16x32_bf16 v[88:91], v[116:119], v[136:139], v[88:91]
    s_waitcnt lgkmcnt(8)
    ds_read_b64_tr_b16 v[48:49], v63 offset:15488
    ds_read_b64_tr_b16 v[50:51], v63 offset:18048
    v_mfma_f32_16x16x32_bf16 v[96:99], v[120:123], v[136:139], v[96:99]
    s_waitcnt lgkmcnt(8)
    v_mfma_f32_16x16x32_bf16 v[64:67], v[32:35], v[140:143], v[64:67]
    s_waitcnt lgkmcnt(6)
    v_mfma_f32_16x16x32_bf16 v[72:75], v[36:39], v[140:143], v[72:75]
    s_waitcnt lgkmcnt(4)
    v_mfma_f32_16x16x32_bf16 v[80:83], v[40:43], v[140:143], v[80:83]
    s_waitcnt lgkmcnt(2)
    v_mfma_f32_16x16x32_bf16 v[88:91], v[44:47], v[140:143], v[88:91]
    s_waitcnt lgkmcnt(0)
    v_mfma_f32_16x16x32_bf16 v[96:99], v[48:51], v[140:143], v[96:99]
    v_cvt_pk_bf16_f32 v16, v64, v65
    v_cvt_pk_bf16_f32 v17, v66, v67
    v_cvt_pk_bf16_f32 v20, v72, v73
    v_cvt_pk_bf16_f32 v21, v74, v75
    v_cvt_pk_bf16_f32 v24, v80, v81
    v_cvt_pk_bf16_f32 v25, v82, v83
    v_cvt_pk_bf16_f32 v28, v88, v89
    v_cvt_pk_bf16_f32 v29, v90, v91
    v_cvt_pk_bf16_f32 v52, v96, v97
    v_cvt_pk_bf16_f32 v53, v98, v99
    s_add_u32 s69, s76, 61440
    buffer_store_dwordx2 v[16:17], v59, s[4:7], s69 offen offset:0 sc1
    s_add_u32 s69, s76, 61440
    buffer_store_dwordx2 v[20:21], v59, s[4:7], s69 offen offset:1024 sc1
    s_add_u32 s69, s76, 61440
    buffer_store_dwordx2 v[24:25], v59, s[4:7], s69 offen offset:2048 sc1
    s_add_u32 s69, s76, 61440
    buffer_store_dwordx2 v[28:29], v59, s[4:7], s69 offen offset:3072 sc1
    s_add_u32 s69, s76, 65536
    buffer_store_dwordx2 v[52:53], v59, s[4:7], s69 offen offset:0 sc1
    v_and_b32 v4, 15, v0
    s_lshl_b32 s74, s73, 5
    v_add_u32 v4, s74, v4
    v_mul_u32_u24 v4, 2560, v4
    v_lshrrev_b32 v5, 4, v0
    v_lshl_add_u32 v4, v5, 3, v4
    v_add_u32 v5, 40960, v4
    s_waitcnt vmcnt(5)
    s_mov_b32 s78, 0x00003f80
    s_mov_b32 s79, 0x3f800000
    v_dot2_f32_bf16 v64, v160, s78, 0
    v_dot2_f32_bf16 v65, v160, s79, 0
    v_dot2_f32_bf16 v66, v161, s78, 0
    v_dot2_f32_bf16 v67, v161, s79, 0
    v_dot2_f32_bf16 v68, v162, s78, 0
    v_dot2_f32_bf16 v69, v162, s79, 0
    v_dot2_f32_bf16 v70, v163, s78, 0
    v_dot2_f32_bf16 v71, v163, s79, 0
    v_dot2_f32_bf16 v64, v164, s78, v64
    v_dot2_f32_bf16 v65, v164, s79, v65
    v_dot2_f32_bf16 v66, v165, s78, v66
    v_dot2_f32_bf16 v67, v165, s79, v67
    v_dot2_f32_bf16 v68, v166, s78, v68
    v_dot2_f32_bf16 v69, v166, s79, v69
    v_dot2_f32_bf16 v70, v167, s78, v70
    v_dot2_f32_bf16 v71, v167, s79, v71
    v_dot2_f32_bf16 v64, v168, s78, v64
    v_dot2_f32_bf16 v65, v168, s79, v65
    v_dot2_f32_bf16 v66, v169, s78, v66
    v_dot2_f32_bf16 v67, v169, s79, v67
    v_dot2_f32_bf16 v68, v170, s78, v68
    v_dot2_f32_bf16 v69, v170, s79, v69
    v_dot2_f32_bf16 v70, v171, s78, v70
    v_dot2_f32_bf16 v71, v171, s79, v71
    v_dot2_f32_bf16 v64, v172, s78, v64
    v_dot2_f32_bf16 v65, v172, s79, v65
    v_dot2_f32_bf16 v66, v173, s78, v66
    v_dot2_f32_bf16 v67, v173, s79, v67
    v_dot2_f32_bf16 v68, v174, s78, v68
    v_dot2_f32_bf16 v69, v174, s79, v69
    v_dot2_f32_bf16 v70, v175, s78, v70
    v_dot2_f32_bf16 v71, v175, s79, v71
    v_dot2_f32_bf16 v64, v176, s78, v64
    v_dot2_f32_bf16 v65, v176, s79, v65
    v_dot2_f32_bf16 v66, v177, s78, v66
    v_dot2_f32_bf16 v67, v177, s79, v67
    v_dot2_f32_bf16 v68, v178, s78, v68
    v_dot2_f32_bf16 v69, v178, s79, v69
    v_dot2_f32_bf16 v70, v179, s78, v70
    v_dot2_f32_bf16 v71, v179, s79, v71
    v_dot2_f32_bf16 v64, v180, s78, v64
    v_dot2_f32_bf16 v65, v180, s79, v65
    v_dot2_f32_bf16 v66, v181, s78, v66
    v_dot2_f32_bf16 v67, v181, s79, v67
    v_dot2_f32_bf16 v68, v182, s78, v68
    v_dot2_f32_bf16 v69, v182, s79, v69
    v_dot2_f32_bf16 v70, v183, s78, v70
    v_dot2_f32_bf16 v71, v183, s79, v71
    v_dot2_f32_bf16 v64, v184, s78, v64
    v_dot2_f32_bf16 v65, v184, s79, v65
    v_dot2_f32_bf16 v66, v185, s78, v66
    v_dot2_f32_bf16 v67, v185, s79, v67
    v_dot2_f32_bf16 v68, v186, s78, v68
    v_dot2_f32_bf16 v69, v186, s79, v69
    v_dot2_f32_bf16 v70, v187, s78, v70
    v_dot2_f32_bf16 v71, v187, s79, v71
    v_dot2_f32_bf16 v64, v188, s78, v64
    v_dot2_f32_bf16 v65, v188, s79, v65
    v_dot2_f32_bf16 v66, v189, s78, v66
    v_dot2_f32_bf16 v67, v189, s79, v67
    v_dot2_f32_bf16 v68, v190, s78, v68
    v_dot2_f32_bf16 v69, v190, s79, v69
    v_dot2_f32_bf16 v70, v191, s78, v70
    v_dot2_f32_bf16 v71, v191, s79, v71
    v_cvt_pk_bf16_f32 v80, v64, v65
    v_cvt_pk_bf16_f32 v81, v66, v67
    v_cvt_pk_bf16_f32 v82, v68, v69
    v_cvt_pk_bf16_f32 v83, v70, v71
    s_cmp_ge_u32 s24, 2
    s_cbranch_scc1 m_fin1_k1
    s_mov_b32 s78, 0x00003f80
    s_mov_b32 s79, 0x3f800000
    v_dot2_f32_bf16 v64, v224, s78, 0
    v_dot2_f32_bf16 v65, v224, s79, 0
    v_dot2_f32_bf16 v66, v225, s78, 0
    v_dot2_f32_bf16 v67, v225, s79, 0
    v_dot2_f32_bf16 v68, v226, s78, 0
    v_dot2_f32_bf16 v69, v226, s79, 0
    v_dot2_f32_bf16 v70, v227, s78, 0
    v_dot2_f32_bf16 v71, v227, s79, 0
    v_dot2_f32_bf16 v64, v228, s78, v64
    v_dot2_f32_bf16 v65, v228, s79, v65
    v_dot2_f32_bf16 v66, v229, s78, v66
    v_dot2_f32_bf16 v67, v229, s79, v67
    v_dot2_f32_bf16 v68, v230, s78, v68
    v_dot2_f32_bf16 v69, v230, s79, v69
    v_dot2_f32_bf16 v70, v231, s78, v70
    v_dot2_f32_bf16 v71, v231, s79, v71
    v_dot2_f32_bf16 v64, v232, s78, v64
    v_dot2_f32_bf16 v65, v232, s79, v65
    v_dot2_f32_bf16 v66, v233, s78, v66
    v_dot2_f32_bf16 v67, v233, s79, v67
    v_dot2_f32_bf16 v68, v234, s78, v68
    v_dot2_f32_bf16 v69, v234, s79, v69
    v_dot2_f32_bf16 v70, v235, s78, v70
    v_dot2_f32_bf16 v71, v235, s79, v71
    v_dot2_f32_bf16 v64, v236, s78, v64
    v_dot2_f32_bf16 v65, v236, s79, v65
    v_dot2_f32_bf16 v66, v237, s78, v66
    v_dot2_f32_bf16 v67, v237, s79, v67
    v_dot2_f32_bf16 v68, v238, s78, v68
    v_dot2_f32_bf16 v69, v238, s79, v69
    v_dot2_f32_bf16 v70, v239, s78, v70
    v_dot2_f32_bf16 v71, v239, s79, v71
    v_dot2_f32_bf16 v64, v240, s78, v64
    v_dot2_f32_bf16 v65, v240, s79, v65
    v_dot2_f32_bf16 v66, v241, s78, v66
    v_dot2_f32_bf16 v67, v241, s79, v67
    v_dot2_f32_bf16 v68, v242, s78, v68
    v_dot2_f32_bf16 v69, v242, s79, v69
    v_dot2_f32_bf16 v70, v243, s78, v70
    v_dot2_f32_bf16 v71, v243, s79, v71
    v_dot2_f32_bf16 v64, v244, s78, v64
    v_dot2_f32_bf16 v65, v244, s79, v65
    v_dot2_f32_bf16 v66, v245, s78, v66
    v_dot2_f32_bf16 v67, v245, s79, v67
    v_dot2_f32_bf16 v68, v246, s78, v68
    v_dot2_f32_bf16 v69, v246, s79, v69
    v_dot2_f32_bf16 v70, v247, s78, v70
    v_dot2_f32_bf16 v71, v247, s79, v71
    v_dot2_f32_bf16 v64, v248, s78, v64
    v_dot2_f32_bf16 v65, v248, s79, v65
    v_dot2_f32_bf16 v66, v249, s78, v66
    v_dot2_f32_bf16 v67, v249, s79, v67
    v_dot2_f32_bf16 v68, v250, s78, v68
    v_dot2_f32_bf16 v69, v250, s79, v69
    v_dot2_f32_bf16 v70, v251, s78, v70
    v_dot2_f32_bf16 v71, v251, s79, v71
    v_dot2_f32_bf16 v64, v252, s78, v64
    v_dot2_f32_bf16 v65, v252, s79, v65
    v_dot2_f32_bf16 v66, v253, s78, v66
    v_dot2_f32_bf16 v67, v253, s79, v67
    v_dot2_f32_bf16 v68, v254, s78, v68
    v_dot2_f32_bf16 v69, v254, s79, v69
    v_dot2_f32_bf16 v70, v255, s78, v70
    v_dot2_f32_bf16 v71, v255, s79, v71
    v_cvt_pk_bf16_f32 v84, v64, v65
    v_cvt_pk_bf16_f32 v85, v66, v67
    v_cvt_pk_bf16_f32 v86, v68, v69
    v_cvt_pk_bf16_f32 v87, v70, v71
m_fin1_k1:
    s_cmp_lg_u32 s24, 7
    s_cbranch_scc1 m_fin1_np1
    s_mov_b32 s72, 0
    v_mbcnt_lo_u32_b32 v57, -1, 0
    v_mbcnt_hi_u32_b32 v57, -1, v57
    v_and_b32 v57, 7, v57
    v_lshlrev_b32 v57, 7, v57
m_fin1_f2:
    buffer_load_dword v56, v57, s[88:91], 0 offen sc1
    s_waitcnt vmcnt(0)
    v_cmp_gt_u32 vcc, 2, v56
    s_add_u32 s72, s72, 1
    s_cmp_ge_u32 s72, 0x40000
    s_cbranch_scc1 m_fin1_f2x
    s_cbranch_vccz m_fin1_f2x
    s_sleep 1
    s_branch m_fin1_f2
m_fin1_f2x:
m_fin1_np1:
    s_waitcnt vmcnt(0)
    s_barrier
    s_cmp_lg_u32 s24, 0
    s_cbranch_scc1 m_fin1_nf3
    s_lshl_b32 s70, s27, 7
    v_mov_b32 v56, 3
    v_mov_b32 v57, s70
    buffer_store_dword v56, v57, s[88:91], 0 offen sc1
m_fin1_nf3:
    s_cmp_eq_u32 s24, 7
    s_cbranch_scc1 m_fin1_a2
    s_cmp_lt_u32 s24, 2
    s_cbranch_scc1 m_fin1_a3
    s_add_u32 s70, s24, 8
    s_mul_i32 s71, s70, 52
    s_lshr_b32 s71, s71, 8
    s_mul_i32 s74, s71, 5
    s_sub_u32 s74, s70, s74
    s_mul_i32 s78, s71, 20480
    s_lshl_b32 s79, s74, 10
    s_add_u32 s78, s78, s79
    s_add_u32 s64, s78, s77
    s_mul_i32 s78, s71, 160
    s_lshl_b32 s79, s74, 5
    s_add_u32 s78, s78, s79
    s_add_u32 s66, s78, s75
    s_add_u32 s62, s64, 0
    buffer_load_dwordx4 v[224:227], v1, s[16:19], s62 offen sc1
    s_add_u32 s62, s64, 163840
    buffer_load_dwordx4 v[228:231], v1, s[16:19], s62 offen sc1
    s_add_u32 s62, s64, 327680
    buffer_load_dwordx4 v[232:235], v1, s[16:19], s62 offen sc1
    s_add_u32 s62, s64, 491520
    buffer_load_dwordx4 v[236:239], v1, s[16:19], s62 offen sc1
    s_add_u32 s62, s64, 655360
    buffer_load_dwordx4 v[240:243], v1, s[16:19], s62 offen sc1
    s_add_u32 s62, s64, 819200
    buffer_load_dwordx4 v[244:247], v1, s[16:19], s62 offen sc1
    s_add_u32 s62, s64, 983040
    buffer_load_dwordx4 v[248:251], v1, s[16:19], s62 offen sc1
    s_add_u32 s62, s64, 1146880
    buffer_load_dwordx4 v[252:255], v1, s[16:19], s62 offen sc1
    s_waitcnt vmcnt(0)
    s_mov_b32 s78, 0x00003f80
    s_mov_b32 s79, 0x3f800000
    v_dot2_f32_bf16 v64, v224, s78, 0
    v_dot2_f32_bf16 v65, v224, s79, 0
    v_dot2_f32_bf16 v66, v225, s78, 0
    v_dot2_f32_bf16 v67, v225, s79, 0
    v_dot2_f32_bf16 v68, v226, s78, 0
    v_dot2_f32_bf16 v69, v226, s79, 0
    v_dot2_f32_bf16 v70, v227, s78, 0
    v_dot2_f32_bf16 v71, v227, s79, 0
    v_dot2_f32_bf16 v64, v228, s78, v64
    v_dot2_f32_bf16 v65, v228, s79, v65
    v_dot2_f32_bf16 v66, v229, s78, v66
    v_dot2_f32_bf16 v67, v229, s79, v67
    v_dot2_f32_bf16 v68, v230, s78, v68
    v_dot2_f32_bf16 v69, v230, s79, v69
    v_dot2_f32_bf16 v70, v231, s78, v70
    v_dot2_f32_bf16 v71, v231, s79, v71
    v_dot2_f32_bf16 v64, v232, s78, v64
    v_dot2_f32_bf16 v65, v232, s79, v65
    v_dot2_f32_bf16 v66, v233, s78, v66
    v_dot2_f32_bf16 v67, v233, s79, v67
    v_dot2_f32_bf16 v68, v234, s78, v68
    v_dot2_f32_bf16 v69, v234, s79, v69
    v_dot2_f32_bf16 v70, v235, s78, v70
    v_dot2_f32_bf16 v71, v235, s79, v71
    v_dot2_f32_bf16 v64, v236, s78, v64
    v_dot2_f32_bf16 v65, v236, s79, v65
    v_dot2_f32_bf16 v66, v237, s78, v66
    v_dot2_f32_bf16 v67, v237, s79, v67
    v_dot2_f32_bf16 v68, v238, s78, v68
    v_dot2_f32_bf16 v69, v238, s79, v69
    v_dot2_f32_bf16 v70, v239, s78, v70
    v_dot2_f32_bf16 v71, v239, s79, v71
    v_dot2_f32_bf16 v64, v240, s78, v64
    v_dot2_f32_bf16 v65, v240, s79, v65
    v_dot2_f32_bf16 v66, v241, s78, v66
    v_dot2_f32_bf16 v67, v241, s79, v67
    v_dot2_f32_bf16 v68, v242, s78, v68
    v_dot2_f32_bf16 v69, v242, s79, v69
    v_dot2_f32_bf16 v70, v243, s78, v70
    v_dot2_f32_bf16 v71, v243, s79, v71
    v_dot2_f32_bf16 v64, v244, s78, v64
    v_dot2_f32_bf16 v65, v244, s79, v65
    v_dot2_f32_bf16 v66, v245, s78, v66
    v_dot2_f32_bf16 v67, v245, s79, v67
    v_dot2_f32_bf16 v68, v246, s78, v68
    v_dot2_f32_bf16 v69, v246, s79, v69
    v_dot2_f32_bf16 v70, v247, s78, v70
    v_dot2_f32_bf16 v71, v247, s79, v71
    v_dot2_f32_bf16 v64, v248, s78, v64
    v_dot2_f32_bf16 v65, v248, s79, v65
    v_dot2_f32_bf16 v66, v249, s78, v66
    v_dot2_f32_bf16 v67, v249, s79, v67
    v_dot2_f32_bf16 v68, v250, s78, v68
    v_dot2_f32_bf16 v69, v250, s79, v69
    v_dot2_f32_bf16 v70, v251, s78, v70
    v_dot2_f32_bf16 v71, v251, s79, v71
    v_dot2_f32_bf16 v64, v252, s78, v64
    v_dot2_f32_bf16 v65, v252, s79, v65
    v_dot2_f32_bf16 v66, v253, s78, v66
    v_dot2_f32_bf16 v67, v253, s79, v67
    v_dot2_f32_bf16 v68, v254, s78, v68
    v_dot2_f32_bf16 v69, v254, s79, v69
    v_dot2_f32_bf16 v70, v255, s78, v70
    v_dot2_f32_bf16 v71, v255, s79, v71
    v_cvt_pk_bf16_f32 v84, v64, v65
    v_cvt_pk_bf16_f32 v85, v66, v67
    v_cvt_pk_bf16_f32 v86, v68, v69
    v_cvt_pk_bf16_f32 v87, v70, v71
    s_branch m_fin1_a3
m_fin1_a2:
    s_mov_b32 s72, 0
    v_mbcnt_lo_u32_b32 v57, -1, 0
    v_mbcnt_hi_u32_b32 v57, -1, v57
    v_and_b32 v57, 7, v57
    v_lshlrev_b32 v57, 7, v57
m_fin1_f3:
    buffer_load_dword v56, v57, s[88:91], 0 offen sc1
    s_waitcnt vmcnt(0)
    v_cmp_gt_u32 vcc, 3, v56
    s_add_u32 s72, s72, 1
    s_cmp_ge_u32 s72, 0x40000
    s_cbranch_scc1 m_fin1_f3x
    s_cbranch_vccz m_fin1_f3x
    s_sleep 1
    s_branch m_fin1_f3
m_fin1_f3x:
m_fin1_a3:
    s_barrier
    s_cmp_lt_u32 s24, 3
    s_cbranch_scc1 m_fin1_b0
    s_sub_u32 s70, 22, s24
    s_mul_i32 s71, s70, 52
    s_lshr_b32 s71, s71, 8
    s_mul_i32 s74, s71, 5
    s_sub_u32 s74, s70, s74
    s_mul_i32 s78, s71, 20480
    s_lshl_b32 s79, s74, 10
    s_add_u32 s78, s78, s79
    s_add_u32 s64, s78, s77
    s_mul_i32 s78, s71, 160
    s_lshl_b32 s79, s74, 5
    s_add_u32 s78, s78, s79
    s_add_u32 s67, s78, s75
    s_add_u32 s62, s64, 0
    buffer_load_dwordx4 v[128:131], v1, s[16:19], s62 offen sc1
    s_add_u32 s62, s64, 163840
    buffer_load_dwordx4 v[132:135], v1, s[16:19], s62 offen sc1
    s_add_u32 s62, s64, 327680
    buffer_load_dwordx4 v[136:139], v1, s[16:19], s62 offen sc1
    s_add_u32 s62, s64, 491520
    buffer_load_dwordx4 v[140:143], v1, s[16:19], s62 offen sc1
    s_add_u32 s62, s64, 655360
    buffer_load_dwordx4 v[144:147], v1, s[16:19], s62 offen sc1
    s_add_u32 s62, s64, 819200
    buffer_load_dwordx4 v[148:151], v1, s[16:19], s62 offen sc1
    s_add_u32 s62, s64, 983040
    buffer_load_dwordx4 v[152:155], v1, s[16:19], s62 offen sc1
    s_add_u32 s62, s64, 1146880
    buffer_load_dwordx4 v[156:159], v1, s[16:19], s62 offen sc1
    s_waitcnt vmcnt(0)
    s_mov_b32 s78, 0x00003f80
    s_mov_b32 s79, 0x3f800000
    v_dot2_f32_bf16 v64, v128, s78, 0
    v_dot2_f32_bf16 v65, v128, s79, 0
    v_dot2_f32_bf16 v66, v129, s78, 0
    v_dot2_f32_bf16 v67, v129, s79, 0
    v_dot2_f32_bf16 v68, v130, s78, 0
    v_dot2_f32_bf16 v69, v130, s79, 0
    v_dot2_f32_bf16 v70, v131, s78, 0
    v_dot2_f32_bf16 v71, v131, s79, 0
    v_dot2_f32_bf16 v64, v132, s78, v64
    v_dot2_f32_bf16 v65, v132, s79, v65
    v_dot2_f32_bf16 v66, v133, s78, v66
    v_dot2_f32_bf16 v67, v133, s79, v67
    v_dot2_f32_bf16 v68, v134, s78, v68
    v_dot2_f32_bf16 v69, v134, s79, v69
    v_dot2_f32_bf16 v70, v135, s78, v70
    v_dot2_f32_bf16 v71, v135, s79, v71
    v_dot2_f32_bf16 v64, v136, s78, v64
    v_dot2_f32_bf16 v65, v136, s79, v65
    v_dot2_f32_bf16 v66, v137, s78, v66
    v_dot2_f32_bf16 v67, v137, s79, v67
    v_dot2_f32_bf16 v68, v138, s78, v68
    v_dot2_f32_bf16 v69, v138, s79, v69
    v_dot2_f32_bf16 v70, v139, s78, v70
    v_dot2_f32_bf16 v71, v139, s79, v71
    v_dot2_f32_bf16 v64, v140, s78, v64
    v_dot2_f32_bf16 v65, v140, s79, v65
    v_dot2_f32_bf16 v66, v141, s78, v66
    v_dot2_f32_bf16 v67, v141, s79, v67
    v_dot2_f32_bf16 v68, v142, s78, v68
    v_dot2_f32_bf16 v69, v142, s79, v69
    v_dot2_f32_bf16 v70, v143, s78, v70
    v_dot2_f32_bf16 v71, v143, s79, v71
    v_dot2_f32_bf16 v64, v144, s78, v64
    v_dot2_f32_bf16 v65, v144, s79, v65
    v_dot2_f32_bf16 v66, v145, s78, v66
    v_dot2_f32_bf16 v67, v145, s79, v67
    v_dot2_f32_bf16 v68, v146, s78, v68
    v_dot2_f32_bf16 v69, v146, s79, v69
    v_dot2_f32_bf16 v70, v147, s78, v70
    v_dot2_f32_bf16 v71, v147, s79, v71
    v_dot2_f32_bf16 v64, v148, s78, v64
    v_dot2_f32_bf16 v65, v148, s79, v65
    v_dot2_f32_bf16 v66, v149, s78, v66
    v_dot2_f32_bf16 v67, v149, s79, v67
    v_dot2_f32_bf16 v68, v150, s78, v68
    v_dot2_f32_bf16 v69, v150, s79, v69
    v_dot2_f32_bf16 v70, v151, s78, v70
    v_dot2_f32_bf16 v71, v151, s79, v71
    v_dot2_f32_bf16 v64, v152, s78, v64
    v_dot2_f32_bf16 v65, v152, s79, v65
    v_dot2_f32_bf16 v66, v153, s78, v66
    v_dot2_f32_bf16 v67, v153, s79, v67
    v_dot2_f32_bf16 v68, v154, s78, v68
    v_dot2_f32_bf16 v69, v154, s79, v69
    v_dot2_f32_bf16 v70, v155, s78, v70
    v_dot2_f32_bf16 v71, v155, s79, v71
    v_dot2_f32_bf16 v64, v156, s78, v64
    v_dot2_f32_bf16 v65, v156, s79, v65
    v_dot2_f32_bf16 v66, v157, s78, v66
    v_dot2_f32_bf16 v67, v157, s79, v67
    v_dot2_f32_bf16 v68, v158, s78, v68
    v_dot2_f32_bf16 v69, v158, s79, v69
    v_dot2_f32_bf16 v70, v159, s78, v70
    v_dot2_f32_bf16 v71, v159, s79, v71
    v_cvt_pk_bf16_f32 v88, v64, v65
    v_cvt_pk_bf16_f32 v89, v66, v67
    v_cvt_pk_bf16_f32 v90, v68, v69
    v_cvt_pk_bf16_f32 v91, v70, v71
m_fin1_b0:
    buffer_store_dwordx2 v[80:81], v4, s[8:11], s65 offen
    s_cmp_eq_u32 s73, 3
    s_cbranch_scc1 m_fin1_s0
    buffer_store_dwordx2 v[82:83], v5, s[8:11], s65 offen
m_fin1_s0:
    s_cmp_eq_u32 s24, 7
    s_cbranch_scc1 m_fin1_s1
    buffer_store_dwordx2 v[84:85], v4, s[8:11], s66 offen
    s_cmp_eq_u32 s73, 3
    s_cbranch_scc1 m_fin1_s1
    buffer_store_dwordx2 v[86:87], v5, s[8:11], s66 offen
m_fin1_s1:
    s_cmp_lt_u32 s24, 3
    s_cbranch_scc1 m_fin1_end
    buffer_store_dwordx2 v[88:89], v4, s[8:11], s67 offen
    s_cmp_eq_u32 s73, 3
    s_cbranch_scc1 m_fin1_s2
    buffer_store_dwordx2 v[90:91], v5, s[8:11], s67 offen
m_fin1_s2:
m_fin1_end:
    s_endpgm
m_code_end:
    s_endpgm

.section .rodata,"a"
.p2align 6
.amdhsa_kernel concat_heads__gqa_block_cached__mha_block_cached__near_ridge_kernel
  .amdhsa_next_free_vgpr 256
  .amdhsa_next_free_sgpr 102
  .amdhsa_accum_offset 256
  .amdhsa_group_segment_fixed_size 0
  .amdhsa_kernarg_size 104
  .amdhsa_user_sgpr_count 2
  .amdhsa_user_sgpr_kernarg_segment_ptr 1
  .amdhsa_system_sgpr_workgroup_id_x 1
  .amdhsa_float_denorm_mode_32 3
.end_amdhsa_kernel
```
